```python
import torch

def _softmax(x, axis=-1):
    return torch.softmax(x, dim=axis)

def _gelu(x):
    return torch.nn.functional.gelu(x, approximate='tanh')

def _silu(x):
    return torch.nn.functional.silu(x)

def _sigmoid(x):
    return torch.sigmoid(x)

def _layernorm(x, axis=-1, eps=1e-05):
    m = x.mean(dim=axis, keepdim=True)
    v = x.var(dim=axis, keepdim=True, unbiased=False)
    return (x - m) / torch.sqrt(v + eps)

def _scatter_add(tgt, idx, src, axis=0):
    return tgt.clone().index_add_(axis, idx, src)

def _segment_sum(src, seg, n):
    out = torch.zeros((n,) + src.shape[1:], dtype=src.dtype)
    return out.index_add_(0, seg, src)

def _pad(x, pw):
    flat = tuple((v for pair in reversed(pw) for v in pair))
    return torch.nn.functional.pad(x, flat)
kernel_name = 'gated_mix__memory_aug_recurrent_mem_tr__mha_block__prompt'

def setup_inputs():

    _w = lambda a: (lambda t: t.to(torch.bfloat16) if t.is_floating_point() else t)(torch.as_tensor(a))

    def _A_setup():
        B, S, Dm = (1, 2048, 640)
        H, Dh = (32, 192)
        M, seg = (8, 32)
        seg = min(seg, S)
        S = S // seg * seg
        return {'x': _w((lambda *s: torch.randn(*s, dtype=torch.bfloat16) * 0.05)(B, S, Dm)), 'mem0': _w((lambda *s: torch.randn(*s, dtype=torch.bfloat16) * 0.8)(B, M, Dm)), 'Wq': _w((lambda *s: torch.randn(*s, dtype=torch.bfloat16) * 1.6)(Dm, H, Dh) * Dm ** (-0.5)), 'Wk': _w((lambda *s: torch.randn(*s, dtype=torch.bfloat16) * 1.6)(Dm, H, Dh) * Dm ** (-0.5)), 'Wv': _w((lambda *s: torch.randn(*s, dtype=torch.bfloat16) * 0.8)(Dm, H, Dh) * Dm ** (-0.5)), 'Wo': _w((lambda *s: torch.randn(*s, dtype=torch.bfloat16) * 0.8)(H, Dh, Dm) * (H * Dh) ** (-0.5)), 'seg_len': seg}
    _A_in = _A_setup()

    def _B_setup():
        B, S, D, H = (1, 2048, 640, 32)
        return {'x': _w((lambda *s: torch.randn(*s, dtype=torch.bfloat16) * 0.05)(B, S, D)), 'wqkv': _w((lambda *s: torch.randn(*s, dtype=torch.bfloat16) * 0.8)(D, 3 * D)), 'wo': _w((lambda *s: torch.randn(*s, dtype=torch.bfloat16) * 0.05)(D, D))}
    _B_in = _B_setup()
    return {'A_x': _A_in['x'], 'A_mem0': _A_in['mem0'], 'A_Wq': _A_in['Wq'], 'A_Wk': _A_in['Wk'], 'A_Wv': _A_in['Wv'], 'A_Wo': _A_in['Wo'], 'A_seg_len': _A_in['seg_len'], 'B_x': _B_in['x'], 'B_wqkv': _B_in['wqkv'], 'B_wo': _B_in['wo'], 'gate_w': _w((lambda *s: torch.randn(*s, dtype=torch.bfloat16) * 0.05)(640) * 16.0)}

def reference(A_x, A_mem0, A_Wq, A_Wk, A_Wv, A_Wo, A_seg_len, B_x, B_wqkv, B_wo, gate_w):

    def _A_ref(x, mem0, Wq, Wk, Wv, Wo, seg_len):
        B, S, Dm = x.shape
        H, Dh = (Wq.shape[1], Wq.shape[2])
        M = mem0.shape[1]
        scale = Dh ** (-0.5)
        n_seg = S // seg_len
        L = M + seg_len
        idx = torch.arange(L)
        mask = (idx[:, None] < M) | (idx[:, None] >= idx[None, :])
        mem = mem0
        outs = []
        for s in range(n_seg):
            xs = x[:, s * seg_len:(s + 1) * seg_len, :].clone()
            h = torch.concatenate([mem, xs], axis=1)
            q = torch.einsum('btd,dhe->bhte', h, Wq)
            k = torch.einsum('btd,dhe->bhte', h, Wk)
            v = torch.einsum('btd,dhe->bhte', h, Wv)
            scores = torch.einsum('bhqe,bhke->bhqk', q, k) * scale
            scores = torch.where(mask[None, None], scores, -1000000000.0)
            p = _softmax(scores, axis=-1)
            o = torch.einsum('bhqk,bhke->bhqe', p, v)
            o = torch.einsum('bhte,hed->btd', o, Wo)
            mem = o[:, :M, :].clone()
            outs.append(o[:, M:, :])
        return torch.concatenate(outs, axis=1)

    def _B_ref(x, wqkv, wo):
        B, S, D = x.shape
        H = 32
        Dh = D // H
        qkv = (lambda x, *d: x.permute(*d))((x @ wqkv).reshape(B, S, 3, H, Dh), 2, 0, 3, 1, 4)
        q, k, v = (qkv[0], qkv[1], qkv[2])
        scores = torch.einsum('bhqd,bhkd->bhqk', q, k) * Dh ** (-0.5)
        p = _softmax(scores, axis=-1)
        o = torch.einsum('bhqk,bhkd->bhqd', p, v)
        return (lambda x, *d: x.permute(*d))(o, 0, 2, 1, 3).reshape(B, S, D) @ wo
    x = A_x
    g = _sigmoid((x * gate_w).sum(-1, keepdims=True))
    a = _A_ref(x, A_mem0, A_Wq, A_Wk, A_Wv, A_Wo, A_seg_len)
    b = _B_ref(x, B_wqkv, B_wo)
    return g * a + (1 - g) * b
```

```asm
; @launch grid=(256,1,1) block=(256,1,1) lds=163840
.amdgcn_target "amdgcn-amd-amdhsa--gfx950"
.text
.globl gated_mix__memory_aug_recurrent_mem_tr__mha_block__prompt_kernel
.p2align 8
.type gated_mix__memory_aug_recurrent_mem_tr__mha_block__prompt_kernel,@function
gated_mix__memory_aug_recurrent_mem_tr__mha_block__prompt_kernel:
s_cmp_ge_u32 s2, 256
s_cbranch_scc1 L_exit
s_load_dwordx16 s[16:31], s[0:1], 0
s_load_dwordx8 s[32:39], s[0:1], 64
s_load_dwordx4 s[40:43], s[0:1], 96
s_getreg_b32 s46, hwreg(HW_REG_XCC_ID, 0, 4)
s_and_b32 s46, s46, 7
v_and_b32 v1, 63, v0
v_lshrrev_b32 v2, 6, v0
s_nop 0
v_readfirstlane_b32 s44, v2
s_waitcnt lgkmcnt(0)
s_mov_b32 s4, s42
s_mov_b32 s5, s43
s_mov_b32 s6, 268435456
s_mov_b32 s7, 0x20000
s_cmp_lg_u32 s44, 0
s_cbranch_scc1 L_rank_w
s_and_b32 s48, s46, 1
s_lshl_b32 s48, s48, 7
s_lshr_b32 s49, s46, 1
s_lshl_b32 s49, s49, 2
s_add_u32 s48, s48, s49
v_mov_b32 v2, s48
v_mov_b32 v3, 1
v_mov_b32 v5, 0
s_mov_b64 exec, 1
global_atomic_add v4, v2, v3, s[40:41] sc0 sc1
s_waitcnt vmcnt(0)
ds_write_b32 v5, v4
s_mov_b64 exec, -1
s_waitcnt lgkmcnt(0)
L_rank_w:
s_barrier
v_mov_b32 v5, 0
ds_read_b32 v4, v5
s_waitcnt lgkmcnt(0)
v_readfirstlane_b32 s47, v4
s_barrier
s_cmp_lt_u32 s47, 32
s_cbranch_scc1 L_slot_ok
s_mov_b32 s53, 0
v_and_b32 v2, 1, v1
v_lshlrev_b32 v2, 7, v2
v_lshrrev_b32 v3, 1, v1
v_and_b32 v3, 3, v3
v_lshl_add_u32 v2, v3, 2, v2
L_ovf:
global_load_dword v3, v2, s[40:41] sc1
s_waitcnt vmcnt(0)
s_mov_b32 s48, 0
v_readlane_b32 s60, v3, 0
s_add_u32 s48, s48, s60
v_readlane_b32 s61, v3, 1
s_add_u32 s48, s48, s61
v_readlane_b32 s62, v3, 2
s_add_u32 s48, s48, s62
v_readlane_b32 s63, v3, 3
s_add_u32 s48, s48, s63
v_readlane_b32 s64, v3, 4
s_add_u32 s48, s48, s64
v_readlane_b32 s65, v3, 5
s_add_u32 s48, s48, s65
v_readlane_b32 s66, v3, 6
s_add_u32 s48, s48, s66
v_readlane_b32 s67, v3, 7
s_add_u32 s48, s48, s67
s_add_u32 s53, s53, 1
s_cmp_gt_u32 s53, 100000
s_cbranch_scc1 L_exit
s_cmp_lt_u32 s48, 256
s_cbranch_scc1 L_ovf
s_sub_u32 s48, s47, 32
s_max_u32 s49, s60, 32
s_sub_u32 s49, s49, 32
s_cmp_gt_u32 s46, 0
s_cselect_b32 s49, s49, 0
s_add_u32 s48, s48, s49
s_max_u32 s49, s61, 32
s_sub_u32 s49, s49, 32
s_cmp_gt_u32 s46, 1
s_cselect_b32 s49, s49, 0
s_add_u32 s48, s48, s49
s_max_u32 s49, s62, 32
s_sub_u32 s49, s49, 32
s_cmp_gt_u32 s46, 2
s_cselect_b32 s49, s49, 0
s_add_u32 s48, s48, s49
s_max_u32 s49, s63, 32
s_sub_u32 s49, s49, 32
s_cmp_gt_u32 s46, 3
s_cselect_b32 s49, s49, 0
s_add_u32 s48, s48, s49
s_max_u32 s49, s64, 32
s_sub_u32 s49, s49, 32
s_cmp_gt_u32 s46, 4
s_cselect_b32 s49, s49, 0
s_add_u32 s48, s48, s49
s_max_u32 s49, s65, 32
s_sub_u32 s49, s49, 32
s_cmp_gt_u32 s46, 5
s_cselect_b32 s49, s49, 0
s_add_u32 s48, s48, s49
s_max_u32 s49, s66, 32
s_sub_u32 s49, s49, 32
s_cmp_gt_u32 s46, 6
s_cselect_b32 s49, s49, 0
s_add_u32 s48, s48, s49
s_min_u32 s49, s60, 32
s_sub_u32 s50, 32, s49
s_cmp_ge_u32 s48, s50
s_cbranch_scc1 L_ov_1
s_mov_b32 s46, 0
s_add_u32 s47, s49, s48
s_branch L_slot_ok
L_ov_1:
s_sub_u32 s48, s48, s50
s_min_u32 s49, s61, 32
s_sub_u32 s50, 32, s49
s_cmp_ge_u32 s48, s50
s_cbranch_scc1 L_ov_2
s_mov_b32 s46, 1
s_add_u32 s47, s49, s48
s_branch L_slot_ok
L_ov_2:
s_sub_u32 s48, s48, s50
s_min_u32 s49, s62, 32
s_sub_u32 s50, 32, s49
s_cmp_ge_u32 s48, s50
s_cbranch_scc1 L_ov_3
s_mov_b32 s46, 2
s_add_u32 s47, s49, s48
s_branch L_slot_ok
L_ov_3:
s_sub_u32 s48, s48, s50
s_min_u32 s49, s63, 32
s_sub_u32 s50, 32, s49
s_cmp_ge_u32 s48, s50
s_cbranch_scc1 L_ov_4
s_mov_b32 s46, 3
s_add_u32 s47, s49, s48
s_branch L_slot_ok
L_ov_4:
s_sub_u32 s48, s48, s50
s_min_u32 s49, s64, 32
s_sub_u32 s50, 32, s49
s_cmp_ge_u32 s48, s50
s_cbranch_scc1 L_ov_5
s_mov_b32 s46, 4
s_add_u32 s47, s49, s48
s_branch L_slot_ok
L_ov_5:
s_sub_u32 s48, s48, s50
s_min_u32 s49, s65, 32
s_sub_u32 s50, 32, s49
s_cmp_ge_u32 s48, s50
s_cbranch_scc1 L_ov_6
s_mov_b32 s46, 5
s_add_u32 s47, s49, s48
s_branch L_slot_ok
L_ov_6:
s_sub_u32 s48, s48, s50
s_min_u32 s49, s66, 32
s_sub_u32 s50, 32, s49
s_cmp_ge_u32 s48, s50
s_cbranch_scc1 L_ov_7
s_mov_b32 s46, 6
s_add_u32 s47, s49, s48
s_branch L_slot_ok
L_ov_7:
s_sub_u32 s48, s48, s50
s_min_u32 s49, s67, 32
s_sub_u32 s50, 32, s49
s_cmp_ge_u32 s48, s50
s_cbranch_scc1 L_ov_8
s_mov_b32 s46, 7
s_add_u32 s47, s49, s48
s_branch L_slot_ok
L_ov_8:
s_sub_u32 s48, s48, s50
s_branch L_exit
L_slot_ok:
s_cmp_ge_u32 s46, 4
s_cbranch_scc1 L_hi
s_cmp_ge_u32 s47, 24
s_cbranch_scc1 L_lo_bulk
s_mul_i32 s45, s46, 24
s_add_u32 s45, s45, s47
s_branch L_chain
L_lo_bulk:
s_lshl_b32 s45, s46, 3
s_add_u32 s45, s45, s47
s_add_u32 s45, s45, 72
s_branch L_bulk
L_hi:
s_sub_u32 s49, s46, 4
s_lshl_b32 s48, s47, 2
s_add_u32 s45, s49, s48
s_cmp_lt_u32 s47, 24
s_cbranch_scc1 L_bulk
s_lshl_b32 s45, s49, 3
s_add_u32 s45, s45, s47
s_add_u32 s45, s45, 104
L_bulk:
s_cmp_lt_u32 s45, 96
s_cbranch_scc1 L_g1
s_sub_u32 s54, s45, 96
s_cmp_lg_u32 s46, 3
s_cbranch_scc1 L_npb_9
s_sub_u32 s48, s47, 30
s_cmp_ge_u32 s48, 2
s_cbranch_scc1 L_npb_9
s_lshl_b32 s51, s48, 21
s_add_u32 s51, s51, 2097152
s_lshl_b32 s52, s48, 2
s_add_u32 s52, s52, 48
s_cmp_lg_u32 s44, 0
s_cbranch_scc1 L_prb_10
s_waitcnt vmcnt(0)
s_mov_b64 exec, 1
v_mov_b32 v8, 0
s_mov_b32 s70, -1
s_mov_b32 s71, -1
s_add_u32 s49, s51, 2080768
s_memtime s[72:73]
s_waitcnt lgkmcnt(0)
buffer_store_dword v8, v8, s[4:7], s49 offen sc1
s_waitcnt vmcnt(0)
buffer_load_dword v9, v8, s[4:7], s49 offen sc1
s_waitcnt vmcnt(0)
s_memtime s[74:75]
s_waitcnt lgkmcnt(0)
s_sub_u32 s74, s74, s72
s_min_u32 s70, s70, s74
s_add_u32 s49, s51, 2088960
s_memtime s[72:73]
s_waitcnt lgkmcnt(0)
buffer_store_dword v8, v8, s[4:7], s49 offen sc1
s_waitcnt vmcnt(0)
buffer_load_dword v9, v8, s[4:7], s49 offen sc1
s_waitcnt vmcnt(0)
s_memtime s[74:75]
s_waitcnt lgkmcnt(0)
s_sub_u32 s74, s74, s72
s_min_u32 s71, s71, s74
s_add_u32 s49, s51, 2080768
s_memtime s[72:73]
s_waitcnt lgkmcnt(0)
buffer_store_dword v8, v8, s[4:7], s49 offen sc1
s_waitcnt vmcnt(0)
buffer_load_dword v9, v8, s[4:7], s49 offen sc1
s_waitcnt vmcnt(0)
s_memtime s[74:75]
s_waitcnt lgkmcnt(0)
s_sub_u32 s74, s74, s72
s_min_u32 s70, s70, s74
s_add_u32 s49, s51, 2088960
s_memtime s[72:73]
s_waitcnt lgkmcnt(0)
buffer_store_dword v8, v8, s[4:7], s49 offen sc1
s_waitcnt vmcnt(0)
buffer_load_dword v9, v8, s[4:7], s49 offen sc1
s_waitcnt vmcnt(0)
s_memtime s[74:75]
s_waitcnt lgkmcnt(0)
s_sub_u32 s74, s74, s72
s_min_u32 s71, s71, s74
s_add_u32 s49, s51, 2080768
s_memtime s[72:73]
s_waitcnt lgkmcnt(0)
buffer_store_dword v8, v8, s[4:7], s49 offen sc1
s_waitcnt vmcnt(0)
buffer_load_dword v9, v8, s[4:7], s49 offen sc1
s_waitcnt vmcnt(0)
s_memtime s[74:75]
s_waitcnt lgkmcnt(0)
s_sub_u32 s74, s74, s72
s_min_u32 s70, s70, s74
s_add_u32 s49, s51, 2088960
s_memtime s[72:73]
s_waitcnt lgkmcnt(0)
buffer_store_dword v8, v8, s[4:7], s49 offen sc1
s_waitcnt vmcnt(0)
buffer_load_dword v9, v8, s[4:7], s49 offen sc1
s_waitcnt vmcnt(0)
s_memtime s[74:75]
s_waitcnt lgkmcnt(0)
s_sub_u32 s74, s74, s72
s_min_u32 s71, s71, s74
s_cmp_lt_u32 s71, s70
s_cselect_b32 s49, 2, 1
v_mov_b32 v9, s49
v_mov_b32 v10, s52
global_atomic_add v10, v9, s[40:41] sc1
s_mov_b64 exec, -1
L_prb_10:
L_npb_9:
s_mul_i32 s48, s54, 20480
s_add_u32 s48, s48, 2097152
v_lshlrev_b32 v2, 4, v0
v_mov_b32 v4, -1
v_mov_b32 v5, -1
v_mov_b32 v6, -1
v_mov_b32 v7, -1
s_mov_b32 s49, s48
buffer_store_dwordx4 v[4:7], v2, s[4:7], s49 offen sc1
s_add_u32 s49, s49, 4096
buffer_store_dwordx4 v[4:7], v2, s[4:7], s49 offen sc1
s_add_u32 s49, s49, 4096
buffer_store_dwordx4 v[4:7], v2, s[4:7], s49 offen sc1
s_add_u32 s49, s49, 4096
buffer_store_dwordx4 v[4:7], v2, s[4:7], s49 offen sc1
s_add_u32 s49, s49, 4096
buffer_store_dwordx4 v[4:7], v2, s[4:7], s49 offen sc1
s_cmp_ge_u32 s54, 40
s_cbranch_scc1 L_fb_11
s_lshl_b32 s48, s54, 14
s_add_u32 s48, s48, 4194304
v_lshlrev_b32 v2, 4, v0
v_mov_b32 v4, -1
v_mov_b32 v5, -1
v_mov_b32 v6, -1
v_mov_b32 v7, -1
s_mov_b32 s49, s48
buffer_store_dwordx4 v[4:7], v2, s[4:7], s49 offen sc1
s_add_u32 s49, s49, 4096
buffer_store_dwordx4 v[4:7], v2, s[4:7], s49 offen sc1
s_add_u32 s49, s49, 4096
buffer_store_dwordx4 v[4:7], v2, s[4:7], s49 offen sc1
s_add_u32 s49, s49, 4096
buffer_store_dwordx4 v[4:7], v2, s[4:7], s49 offen sc1
L_fb_11:
s_and_b32 s48, s54, 31
s_mul_i32 s48, s48, 12288
s_lshr_b32 s50, s54, 5
s_mul_i32 s50, s50, 8388608
s_add_u32 s48, s48, s50
s_add_u32 s48, s48, 156893184
v_lshlrev_b32 v2, 4, v0
v_mov_b32 v4, -1
v_mov_b32 v5, -1
v_mov_b32 v6, -1
v_mov_b32 v7, -1
s_mov_b32 s49, s48
buffer_store_dwordx4 v[4:7], v2, s[4:7], s49 offen sc1
s_add_u32 s49, s49, 4096
buffer_store_dwordx4 v[4:7], v2, s[4:7], s49 offen sc1
s_add_u32 s49, s49, 4096
buffer_store_dwordx4 v[4:7], v2, s[4:7], s49 offen sc1
s_lshl_b32 s48, s54, 13
s_cmp_lt_u32 s54, 16
s_cbranch_scc1 L_z2_13
s_add_u32 s48, s48, 917504
L_z2_13:
v_lshlrev_b32 v2, 4, v0
v_mov_b32 v4, 0
v_mov_b32 v5, 0
v_mov_b32 v6, 0
v_mov_b32 v7, 0
s_mov_b32 s49, s48
buffer_store_dwordx4 v[4:7], v2, s[4:7], s49 offen sc1
s_add_u32 s49, s49, 4096
buffer_store_dwordx4 v[4:7], v2, s[4:7], s49 offen sc1
L_z_12:
s_cmp_eq_u32 s54, 0
s_cselect_b32 s50, 0, 2
s_cmp_eq_u32 s54, 51
s_cselect_b32 s50, 1, s50
s_cmp_eq_u32 s50, 2
s_cbranch_scc1 L_m0_14
s_waitcnt vmcnt(0)
s_barrier
s_mov_b32 s8, s18
s_mov_b32 s9, s19
s_mov_b32 s10, 10240
s_mov_b32 s11, 0x20000
s_lshl_b32 s51, s50, 20
s_add_u32 s51, s51, 2097152
v_and_b32 v2, 3, v0
v_lshrrev_b32 v3, 2, v0
v_lshrrev_b32 v4, 4, v3
v_lshl_add_u32 v2, v4, 2, v2
v_bfe_u32 v4, v3, 1, 1
v_lshl_add_u32 v2, v4, 5, v2
v_bfe_u32 v4, v3, 2, 2
v_and_b32 v5, 1, v3
v_lshl_add_u32 v4, v4, 1, v5
v_mul_u32_u24 v4, 640, v4
v_add_u32 v2, v2, v4
v_lshlrev_b32 v2, 1, v2
v_lshlrev_b32 v3, 2, v0
s_lshl_b32 s48, s50, 10
buffer_load_ushort v8, v2, s[8:11], s48 offen offset:0
buffer_load_ushort v9, v2, s[8:11], s48 offen offset:32
buffer_load_ushort v10, v2, s[8:11], s48 offen offset:128
buffer_load_ushort v11, v2, s[8:11], s48 offen offset:160
buffer_load_ushort v12, v2, s[8:11], s48 offen offset:256
buffer_load_ushort v13, v2, s[8:11], s48 offen offset:288
buffer_load_ushort v14, v2, s[8:11], s48 offen offset:384
buffer_load_ushort v15, v2, s[8:11], s48 offen offset:416
buffer_load_ushort v16, v2, s[8:11], s48 offen offset:512
buffer_load_ushort v17, v2, s[8:11], s48 offen offset:544
buffer_load_ushort v18, v2, s[8:11], s48 offen offset:640
buffer_load_ushort v19, v2, s[8:11], s48 offen offset:672
buffer_load_ushort v20, v2, s[8:11], s48 offen offset:768
buffer_load_ushort v21, v2, s[8:11], s48 offen offset:800
buffer_load_ushort v22, v2, s[8:11], s48 offen offset:896
buffer_load_ushort v23, v2, s[8:11], s48 offen offset:928
s_waitcnt vmcnt(0)
v_lshl_or_b32 v8, v9, 16, v8
s_add_u32 s49, s51, 0
buffer_store_dword v8, v3, s[4:7], s49 offen sc1
s_add_u32 s49, s49, 8192
buffer_store_dword v8, v3, s[4:7], s49 offen sc1
v_lshl_or_b32 v10, v11, 16, v10
s_add_u32 s49, s51, 1024
buffer_store_dword v10, v3, s[4:7], s49 offen sc1
s_add_u32 s49, s49, 8192
buffer_store_dword v10, v3, s[4:7], s49 offen sc1
s_cmp_eq_u32 s50, 1
s_cbranch_scc1 L_m0_14
v_lshl_or_b32 v12, v13, 16, v12
s_add_u32 s49, s51, 2048
buffer_store_dword v12, v3, s[4:7], s49 offen sc1
s_add_u32 s49, s49, 8192
buffer_store_dword v12, v3, s[4:7], s49 offen sc1
v_lshl_or_b32 v14, v15, 16, v14
s_add_u32 s49, s51, 3072
buffer_store_dword v14, v3, s[4:7], s49 offen sc1
s_add_u32 s49, s49, 8192
buffer_store_dword v14, v3, s[4:7], s49 offen sc1
v_lshl_or_b32 v16, v17, 16, v16
s_add_u32 s49, s51, 4096
buffer_store_dword v16, v3, s[4:7], s49 offen sc1
s_add_u32 s49, s49, 8192
buffer_store_dword v16, v3, s[4:7], s49 offen sc1
v_lshl_or_b32 v18, v19, 16, v18
s_add_u32 s49, s51, 5120
buffer_store_dword v18, v3, s[4:7], s49 offen sc1
s_add_u32 s49, s49, 8192
buffer_store_dword v18, v3, s[4:7], s49 offen sc1
v_lshl_or_b32 v20, v21, 16, v20
s_add_u32 s49, s51, 6144
buffer_store_dword v20, v3, s[4:7], s49 offen sc1
s_add_u32 s49, s49, 8192
buffer_store_dword v20, v3, s[4:7], s49 offen sc1
v_lshl_or_b32 v22, v23, 16, v22
s_add_u32 s49, s51, 7168
buffer_store_dword v22, v3, s[4:7], s49 offen sc1
s_add_u32 s49, s49, 8192
buffer_store_dword v22, v3, s[4:7], s49 offen sc1
L_m0_14:
s_cmp_ge_u32 s45, 128
s_cbranch_scc1 L_gc
s_branch L_gb
L_g1:
s_cmp_lt_u32 s44, 2
s_mov_b32 s48, 1037384597
s_cselect_b32 s66, 1.0, s48
s_mov_b32 s67, s66
s_mov_b32 s48, 83886080
s_cselect_b32 s51, 16777216, s48
s_mov_b32 s8, s22
s_mov_b32 s9, s23
s_mov_b32 s10, 7864320
s_mov_b32 s11, 0x20000
s_mov_b32 s12, s20
s_mov_b32 s13, s21
s_mov_b32 s14, 7864320
s_mov_b32 s15, 0x20000
s_mov_b32 s68, s24
s_mov_b32 s69, s25
s_mov_b32 s70, 7864320
s_mov_b32 s71, 0x20000
s_mov_b32 s72, s16
s_mov_b32 s73, s17
s_mov_b32 s74, 2621440
s_mov_b32 s75, 0x20000
s_mul_i32 s48, s44, 98304
s_lshl_b32 s62, s45, 7
s_add_u32 s62, s62, s48
v_lshrrev_b32 v122, 3, v1
v_mul_u32_u24 v122, 12288, v122
v_and_b32 v128, 7, v1
v_lshl_add_u32 v128, v128, 4, v122
s_lshr_b32 s48, s44, 1
s_lshl_b32 s48, s48, 12
s_and_b32 s49, s44, 1
s_lshl_b32 s49, s49, 6
s_add_u32 s48, s48, s49
s_add_u32 s48, s48, 81920
v_lshrrev_b32 v122, 4, v1
v_lshlrev_b32 v122, 3, v122
v_bfe_u32 v123, v1, 2, 2
v_add_u32 v122, v122, v123
v_and_b32 v123, 3, v1
v_lshlrev_b32 v122, 7, v122
v_lshl_add_u32 v122, v123, 4, v122
v_add_u32 v129, s48, v122
s_lshl_b32 s48, s44, 5
s_add_u32 s48, s48, 90112
v_lshrrev_b32 v122, 4, v1
v_lshlrev_b32 v122, 3, v122
v_bfe_u32 v123, v1, 2, 2
v_add_u32 v122, v122, v123
v_and_b32 v123, 3, v1
v_lshlrev_b32 v122, 7, v122
v_lshl_add_u32 v122, v123, 3, v122
v_add_u32 v130, s48, v122
s_lshl_b32 s59, s45, 12
s_mov_b32 s60, 393216
s_mov_b32 s55, 0
s_mov_b32 s61, 64
s_and_b32 s48, s44, 1
s_lshl_b32 s48, s48, 11
s_add_u32 s51, s51, s48
v_lshrrev_b32 v122, 4, v1
v_and_b32 v123, 15, v1
v_lshlrev_b32 v122, 9, v122
v_lshl_add_u32 v122, v123, 4, v122
v_add_u32 v112, s51, v122
s_lshl_b32 s48, s44, 10
s_add_u32 s48, s48, 50331648
v_lshlrev_b32 v122, 4, v1
v_add_u32 v113, s48, v122
s_lshl_b32 s48, s45, 7
s_add_u32 s48, s48, 0
v_mov_b32 v120, s48
v_mov_b32 v122, 1879048192
v_cmp_eq_u32 vcc, 0, v0
s_nop 1
v_cndmask_b32 v120, v122, v120, vcc
s_mul_i32 s48, s44, 640
s_add_u32 s48, s48, 0
v_add_u32 v122, s48, v1
v_mul_u32_u24 v123, 52429, v122
v_lshrrev_b32 v123, 22, v123
v_mul_u32_u24 v124, 80, v123
v_sub_u32 v124, v122, v124
v_and_b32 v125, 15, v123
v_xor_b32 v124, v124, v125
v_mul_u32_u24 v123, 1280, v123
v_lshl_add_u32 v100, v124, 4, v123
s_mul_i32 s48, s44, 640
s_add_u32 s48, s48, 64
v_add_u32 v122, s48, v1
v_mul_u32_u24 v123, 52429, v122
v_lshrrev_b32 v123, 22, v123
v_mul_u32_u24 v124, 80, v123
v_sub_u32 v124, v122, v124
v_and_b32 v125, 15, v123
v_xor_b32 v124, v124, v125
v_mul_u32_u24 v123, 1280, v123
v_lshl_add_u32 v101, v124, 4, v123
s_mul_i32 s48, s44, 640
s_add_u32 s48, s48, 128
v_add_u32 v122, s48, v1
v_mul_u32_u24 v123, 52429, v122
v_lshrrev_b32 v123, 22, v123
v_mul_u32_u24 v124, 80, v123
v_sub_u32 v124, v122, v124
v_and_b32 v125, 15, v123
v_xor_b32 v124, v124, v125
v_mul_u32_u24 v123, 1280, v123
v_lshl_add_u32 v102, v124, 4, v123
s_mul_i32 s48, s44, 640
s_add_u32 s48, s48, 192
v_add_u32 v122, s48, v1
v_mul_u32_u24 v123, 52429, v122
v_lshrrev_b32 v123, 22, v123
v_mul_u32_u24 v124, 80, v123
v_sub_u32 v124, v122, v124
v_and_b32 v125, 15, v123
v_xor_b32 v124, v124, v125
v_mul_u32_u24 v123, 1280, v123
v_lshl_add_u32 v103, v124, 4, v123
s_mul_i32 s48, s44, 640
s_add_u32 s48, s48, 256
v_add_u32 v122, s48, v1
v_mul_u32_u24 v123, 52429, v122
v_lshrrev_b32 v123, 22, v123
v_mul_u32_u24 v124, 80, v123
v_sub_u32 v124, v122, v124
v_and_b32 v125, 15, v123
v_xor_b32 v124, v124, v125
v_mul_u32_u24 v123, 1280, v123
v_lshl_add_u32 v104, v124, 4, v123
s_mul_i32 s48, s44, 640
s_add_u32 s48, s48, 320
v_add_u32 v122, s48, v1
v_mul_u32_u24 v123, 52429, v122
v_lshrrev_b32 v123, 22, v123
v_mul_u32_u24 v124, 80, v123
v_sub_u32 v124, v122, v124
v_and_b32 v125, 15, v123
v_xor_b32 v124, v124, v125
v_mul_u32_u24 v123, 1280, v123
v_lshl_add_u32 v105, v124, 4, v123
s_mul_i32 s48, s44, 640
s_add_u32 s48, s48, 384
v_add_u32 v122, s48, v1
v_mul_u32_u24 v123, 52429, v122
v_lshrrev_b32 v123, 22, v123
v_mul_u32_u24 v124, 80, v123
v_sub_u32 v124, v122, v124
v_and_b32 v125, 15, v123
v_xor_b32 v124, v124, v125
v_mul_u32_u24 v123, 1280, v123
v_lshl_add_u32 v106, v124, 4, v123
s_mul_i32 s48, s44, 640
s_add_u32 s48, s48, 448
v_add_u32 v122, s48, v1
v_mul_u32_u24 v123, 52429, v122
v_lshrrev_b32 v123, 22, v123
v_mul_u32_u24 v124, 80, v123
v_sub_u32 v124, v122, v124
v_and_b32 v125, 15, v123
v_xor_b32 v124, v124, v125
v_mul_u32_u24 v123, 1280, v123
v_lshl_add_u32 v107, v124, 4, v123
s_mul_i32 s48, s44, 640
s_add_u32 s48, s48, 512
v_add_u32 v122, s48, v1
v_mul_u32_u24 v123, 52429, v122
v_lshrrev_b32 v123, 22, v123
v_mul_u32_u24 v124, 80, v123
v_sub_u32 v124, v122, v124
v_and_b32 v125, 15, v123
v_xor_b32 v124, v124, v125
v_mul_u32_u24 v123, 1280, v123
v_lshl_add_u32 v108, v124, 4, v123
s_mul_i32 s48, s44, 640
s_add_u32 s48, s48, 576
v_add_u32 v122, s48, v1
v_mul_u32_u24 v123, 52429, v122
v_lshrrev_b32 v123, 22, v123
v_mul_u32_u24 v124, 80, v123
v_sub_u32 v124, v122, v124
v_and_b32 v125, 15, v123
v_xor_b32 v124, v124, v125
v_mul_u32_u24 v123, 1280, v123
v_lshl_add_u32 v109, v124, 4, v123
v_and_b32 v122, 15, v1
v_lshrrev_b32 v123, 4, v1
v_xor_b32 v123, v123, v122
v_mul_u32_u24 v122, 1280, v122
v_xor_b32 v124, 0, v123
v_lshl_add_u32 v96, v124, 4, v122
v_xor_b32 v124, 4, v123
v_lshl_add_u32 v97, v124, 4, v122
v_xor_b32 v124, 8, v123
v_lshl_add_u32 v98, v124, 4, v122
v_xor_b32 v124, 12, v123
v_lshl_add_u32 v99, v124, 4, v122
s_mul_i32 s50, s44, 10240
s_add_u32 m0, s50, 0
s_mov_b32 s49, 0
buffer_load_dwordx4 v100, s[72:75], s49 offen lds
s_mul_i32 s50, s44, 10240
s_add_u32 m0, s50, 1024
s_mov_b32 s49, 0
buffer_load_dwordx4 v101, s[72:75], s49 offen lds
s_mul_i32 s50, s44, 10240
s_add_u32 m0, s50, 2048
s_mov_b32 s49, 0
buffer_load_dwordx4 v102, s[72:75], s49 offen lds
s_mul_i32 s50, s44, 10240
s_add_u32 m0, s50, 3072
s_mov_b32 s49, 0
buffer_load_dwordx4 v103, s[72:75], s49 offen lds
s_mul_i32 s50, s44, 10240
s_add_u32 m0, s50, 4096
s_mov_b32 s49, 0
buffer_load_dwordx4 v104, s[72:75], s49 offen lds
s_mul_i32 s50, s44, 10240
s_add_u32 m0, s50, 5120
s_mov_b32 s49, 0
buffer_load_dwordx4 v105, s[72:75], s49 offen lds
s_mul_i32 s50, s44, 10240
s_add_u32 m0, s50, 6144
s_mov_b32 s49, 0
buffer_load_dwordx4 v106, s[72:75], s49 offen lds
s_mul_i32 s50, s44, 10240
s_add_u32 m0, s50, 7168
s_mov_b32 s49, 0
buffer_load_dwordx4 v107, s[72:75], s49 offen lds
s_mul_i32 s50, s44, 10240
s_add_u32 m0, s50, 8192
s_mov_b32 s49, 0
buffer_load_dwordx4 v108, s[72:75], s49 offen lds
s_mul_i32 s50, s44, 10240
s_add_u32 m0, s50, 9216
s_mov_b32 s49, 0
buffer_load_dwordx4 v109, s[72:75], s49 offen lds
s_mul_i32 s50, s44, 10240
s_add_u32 m0, s50, 40960
s_mov_b32 s49, 40960
buffer_load_dwordx4 v100, s[72:75], s49 offen lds
s_mul_i32 s50, s44, 10240
s_add_u32 m0, s50, 41984
s_mov_b32 s49, 40960
buffer_load_dwordx4 v101, s[72:75], s49 offen lds
s_mul_i32 s50, s44, 10240
s_add_u32 m0, s50, 43008
s_mov_b32 s49, 40960
buffer_load_dwordx4 v102, s[72:75], s49 offen lds
s_mul_i32 s50, s44, 10240
s_add_u32 m0, s50, 44032
s_mov_b32 s49, 40960
buffer_load_dwordx4 v103, s[72:75], s49 offen lds
s_mul_i32 s50, s44, 10240
s_add_u32 m0, s50, 45056
s_mov_b32 s49, 40960
buffer_load_dwordx4 v104, s[72:75], s49 offen lds
s_mul_i32 s50, s44, 10240
s_add_u32 m0, s50, 46080
s_mov_b32 s49, 40960
buffer_load_dwordx4 v105, s[72:75], s49 offen lds
s_mul_i32 s50, s44, 10240
s_add_u32 m0, s50, 47104
s_mov_b32 s49, 40960
buffer_load_dwordx4 v106, s[72:75], s49 offen lds
s_mul_i32 s50, s44, 10240
s_add_u32 m0, s50, 48128
s_mov_b32 s49, 40960
buffer_load_dwordx4 v107, s[72:75], s49 offen lds
s_mul_i32 s50, s44, 10240
s_add_u32 m0, s50, 49152
s_mov_b32 s49, 40960
buffer_load_dwordx4 v108, s[72:75], s49 offen lds
s_mul_i32 s50, s44, 10240
s_add_u32 m0, s50, 50176
s_mov_b32 s49, 40960
buffer_load_dwordx4 v109, s[72:75], s49 offen lds
s_mul_i32 s50, s44, 1024
s_add_u32 m0, s50, 81920
s_add_u32 s49, s62, 0
buffer_load_dwordx4 v128, s[8:11], s49 offen nt lds
s_mul_i32 s50, s44, 1024
s_add_u32 m0, s50, 86016
s_add_u32 s49, s62, 0
buffer_load_dwordx4 v128, s[12:15], s49 offen nt lds
s_mul_i32 s50, s44, 1024
s_add_u32 m0, s50, 90112
s_add_u32 s49, s62, 0
buffer_load_dwordx4 v128, s[68:71], s49 offen nt lds
s_mul_i32 s50, s44, 1024
s_add_u32 m0, s50, 94208
s_add_u32 s49, s62, 393216
buffer_load_dwordx4 v128, s[8:11], s49 offen nt lds
s_mul_i32 s50, s44, 1024
s_add_u32 m0, s50, 98304
s_add_u32 s49, s62, 393216
buffer_load_dwordx4 v128, s[12:15], s49 offen nt lds
s_mul_i32 s50, s44, 1024
s_add_u32 m0, s50, 102400
s_add_u32 s49, s62, 393216
buffer_load_dwordx4 v128, s[68:71], s49 offen nt lds
s_mul_i32 s50, s44, 1024
s_add_u32 m0, s50, 106496
s_add_u32 s49, s62, 786432
buffer_load_dwordx4 v128, s[8:11], s49 offen nt lds
s_mul_i32 s50, s44, 1024
s_add_u32 m0, s50, 110592
s_add_u32 s49, s62, 786432
buffer_load_dwordx4 v128, s[12:15], s49 offen nt lds
s_mul_i32 s50, s44, 1024
s_add_u32 m0, s50, 114688
s_add_u32 s49, s62, 786432
buffer_load_dwordx4 v128, s[68:71], s49 offen nt lds
s_mul_i32 s50, s44, 1024
s_add_u32 m0, s50, 118784
s_add_u32 s49, s62, 1179648
buffer_load_dwordx4 v128, s[8:11], s49 offen nt lds
s_mul_i32 s50, s44, 1024
s_add_u32 m0, s50, 122880
s_add_u32 s49, s62, 1179648
buffer_load_dwordx4 v128, s[12:15], s49 offen nt lds
s_mul_i32 s50, s44, 1024
s_add_u32 m0, s50, 126976
s_add_u32 s49, s62, 1179648
buffer_load_dwordx4 v128, s[68:71], s49 offen nt lds
s_waitcnt vmcnt(9) lgkmcnt(0)
s_barrier
s_mul_i32 s50, s44, 1024
s_add_u32 m0, s50, 131072
s_add_u32 s49, s62, 1572864
buffer_load_dwordx4 v128, s[8:11], s49 offen nt lds
s_mul_i32 s50, s44, 1024
s_add_u32 m0, s50, 135168
s_add_u32 s49, s62, 1572864
buffer_load_dwordx4 v128, s[12:15], s49 offen nt lds
s_mul_i32 s50, s44, 1024
s_add_u32 m0, s50, 139264
s_add_u32 s49, s62, 1572864
buffer_load_dwordx4 v128, s[68:71], s49 offen nt lds
ds_read_b64_tr_b16 a[0:1], v129 offset:0
ds_read_b64_tr_b16 a[2:3], v129 offset:512
ds_read_b64_tr_b16 a[4:5], v129 offset:8
ds_read_b64_tr_b16 a[6:7], v129 offset:520
ds_read_b64_tr_b16 a[8:9], v130 offset:0
ds_read_b64_tr_b16 a[10:11], v130 offset:512
ds_read_b128 v[64:67], v96 offset:0
ds_read_b128 v[68:71], v96 offset:20480
ds_read_b128 v[72:75], v96 offset:40960
ds_read_b128 v[76:79], v96 offset:61440
s_waitcnt lgkmcnt(0)
v_mfma_f32_16x16x32_bf16 v[16:19], a[0:3], v[64:67], 0
v_mfma_f32_16x16x32_bf16 v[24:27], a[4:7], v[64:67], 0
v_mfma_f32_16x16x32_bf16 v[32:35], v[64:67], a[8:11], 0
v_mfma_f32_16x16x32_bf16 v[20:23], a[0:3], v[68:71], 0
v_mfma_f32_16x16x32_bf16 v[28:31], a[4:7], v[68:71], 0
v_mfma_f32_16x16x32_bf16 v[36:39], v[68:71], a[8:11], 0
v_mfma_f32_16x16x32_bf16 v[40:43], a[0:3], v[72:75], 0
v_mfma_f32_16x16x32_bf16 v[48:51], a[4:7], v[72:75], 0
v_mfma_f32_16x16x32_bf16 v[56:59], v[72:75], a[8:11], 0
v_mfma_f32_16x16x32_bf16 v[44:47], a[0:3], v[76:79], 0
v_mfma_f32_16x16x32_bf16 v[52:55], a[4:7], v[76:79], 0
v_mfma_f32_16x16x32_bf16 v[60:63], v[76:79], a[8:11], 0
s_waitcnt vmcnt(9) lgkmcnt(0)
s_barrier
s_mul_i32 s50, s44, 1024
s_add_u32 m0, s50, 81920
s_add_u32 s49, s62, 1966080
buffer_load_dwordx4 v128, s[8:11], s49 offen nt lds
s_mul_i32 s50, s44, 1024
s_add_u32 m0, s50, 86016
s_add_u32 s49, s62, 1966080
buffer_load_dwordx4 v128, s[12:15], s49 offen nt lds
s_mul_i32 s50, s44, 1024
s_add_u32 m0, s50, 90112
s_add_u32 s49, s62, 1966080
buffer_load_dwordx4 v128, s[68:71], s49 offen nt lds
ds_read_b64_tr_b16 a[12:13], v129 offset:12288
ds_read_b64_tr_b16 a[14:15], v129 offset:12800
ds_read_b64_tr_b16 a[16:17], v129 offset:12296
ds_read_b64_tr_b16 a[18:19], v129 offset:12808
ds_read_b64_tr_b16 a[20:21], v130 offset:12288
ds_read_b64_tr_b16 a[22:23], v130 offset:12800
ds_read_b128 v[64:67], v97 offset:0
ds_read_b128 v[68:71], v97 offset:20480
ds_read_b128 v[72:75], v97 offset:40960
ds_read_b128 v[76:79], v97 offset:61440
s_waitcnt lgkmcnt(0)
v_mfma_f32_16x16x32_bf16 v[16:19], a[12:15], v[64:67], v[16:19]
v_mfma_f32_16x16x32_bf16 v[24:27], a[16:19], v[64:67], v[24:27]
v_mfma_f32_16x16x32_bf16 v[32:35], v[64:67], a[20:23], v[32:35]
v_mfma_f32_16x16x32_bf16 v[20:23], a[12:15], v[68:71], v[20:23]
v_mfma_f32_16x16x32_bf16 v[28:31], a[16:19], v[68:71], v[28:31]
v_mfma_f32_16x16x32_bf16 v[36:39], v[68:71], a[20:23], v[36:39]
v_mfma_f32_16x16x32_bf16 v[40:43], a[12:15], v[72:75], v[40:43]
v_mfma_f32_16x16x32_bf16 v[48:51], a[16:19], v[72:75], v[48:51]
v_mfma_f32_16x16x32_bf16 v[56:59], v[72:75], a[20:23], v[56:59]
v_mfma_f32_16x16x32_bf16 v[44:47], a[12:15], v[76:79], v[44:47]
v_mfma_f32_16x16x32_bf16 v[52:55], a[16:19], v[76:79], v[52:55]
v_mfma_f32_16x16x32_bf16 v[60:63], v[76:79], a[20:23], v[60:63]
s_waitcnt vmcnt(9) lgkmcnt(0)
s_barrier
s_mul_i32 s50, s44, 1024
s_add_u32 m0, s50, 94208
s_add_u32 s49, s62, 2359296
buffer_load_dwordx4 v128, s[8:11], s49 offen nt lds
s_mul_i32 s50, s44, 1024
s_add_u32 m0, s50, 98304
s_add_u32 s49, s62, 2359296
buffer_load_dwordx4 v128, s[12:15], s49 offen nt lds
s_mul_i32 s50, s44, 1024
s_add_u32 m0, s50, 102400
s_add_u32 s49, s62, 2359296
buffer_load_dwordx4 v128, s[68:71], s49 offen nt lds
ds_read_b64_tr_b16 a[24:25], v129 offset:24576
ds_read_b64_tr_b16 a[26:27], v129 offset:25088
ds_read_b64_tr_b16 a[28:29], v129 offset:24584
ds_read_b64_tr_b16 a[30:31], v129 offset:25096
ds_read_b64_tr_b16 a[32:33], v130 offset:24576
ds_read_b64_tr_b16 a[34:35], v130 offset:25088
ds_read_b128 v[64:67], v98 offset:0
ds_read_b128 v[68:71], v98 offset:20480
ds_read_b128 v[72:75], v98 offset:40960
ds_read_b128 v[76:79], v98 offset:61440
s_waitcnt lgkmcnt(0)
v_mfma_f32_16x16x32_bf16 v[16:19], a[24:27], v[64:67], v[16:19]
v_mfma_f32_16x16x32_bf16 v[24:27], a[28:31], v[64:67], v[24:27]
v_mfma_f32_16x16x32_bf16 v[32:35], v[64:67], a[32:35], v[32:35]
v_mfma_f32_16x16x32_bf16 v[20:23], a[24:27], v[68:71], v[20:23]
v_mfma_f32_16x16x32_bf16 v[28:31], a[28:31], v[68:71], v[28:31]
v_mfma_f32_16x16x32_bf16 v[36:39], v[68:71], a[32:35], v[36:39]
v_mfma_f32_16x16x32_bf16 v[40:43], a[24:27], v[72:75], v[40:43]
v_mfma_f32_16x16x32_bf16 v[48:51], a[28:31], v[72:75], v[48:51]
v_mfma_f32_16x16x32_bf16 v[56:59], v[72:75], a[32:35], v[56:59]
v_mfma_f32_16x16x32_bf16 v[44:47], a[24:27], v[76:79], v[44:47]
v_mfma_f32_16x16x32_bf16 v[52:55], a[28:31], v[76:79], v[52:55]
v_mfma_f32_16x16x32_bf16 v[60:63], v[76:79], a[32:35], v[60:63]
s_waitcnt vmcnt(9) lgkmcnt(0)
s_barrier
s_mul_i32 s50, s44, 1024
s_add_u32 m0, s50, 106496
s_add_u32 s49, s62, 2752512
buffer_load_dwordx4 v128, s[8:11], s49 offen nt lds
s_mul_i32 s50, s44, 1024
s_add_u32 m0, s50, 110592
s_add_u32 s49, s62, 2752512
buffer_load_dwordx4 v128, s[12:15], s49 offen nt lds
s_mul_i32 s50, s44, 1024
s_add_u32 m0, s50, 114688
s_add_u32 s49, s62, 2752512
buffer_load_dwordx4 v128, s[68:71], s49 offen nt lds
ds_read_b64_tr_b16 a[36:37], v129 offset:36864
ds_read_b64_tr_b16 a[38:39], v129 offset:37376
ds_read_b64_tr_b16 a[40:41], v129 offset:36872
ds_read_b64_tr_b16 a[42:43], v129 offset:37384
ds_read_b64_tr_b16 a[44:45], v130 offset:36864
ds_read_b64_tr_b16 a[46:47], v130 offset:37376
ds_read_b128 v[64:67], v99 offset:0
ds_read_b128 v[68:71], v99 offset:20480
ds_read_b128 v[72:75], v99 offset:40960
ds_read_b128 v[76:79], v99 offset:61440
s_waitcnt lgkmcnt(0)
v_mfma_f32_16x16x32_bf16 v[16:19], a[36:39], v[64:67], v[16:19]
v_mfma_f32_16x16x32_bf16 v[24:27], a[40:43], v[64:67], v[24:27]
v_mfma_f32_16x16x32_bf16 v[32:35], v[64:67], a[44:47], v[32:35]
v_mfma_f32_16x16x32_bf16 v[20:23], a[36:39], v[68:71], v[20:23]
v_mfma_f32_16x16x32_bf16 v[28:31], a[40:43], v[68:71], v[28:31]
v_mfma_f32_16x16x32_bf16 v[36:39], v[68:71], a[44:47], v[36:39]
v_mfma_f32_16x16x32_bf16 v[40:43], a[36:39], v[72:75], v[40:43]
v_mfma_f32_16x16x32_bf16 v[48:51], a[40:43], v[72:75], v[48:51]
v_mfma_f32_16x16x32_bf16 v[56:59], v[72:75], a[44:47], v[56:59]
v_mfma_f32_16x16x32_bf16 v[44:47], a[36:39], v[76:79], v[44:47]
v_mfma_f32_16x16x32_bf16 v[52:55], a[40:43], v[76:79], v[52:55]
v_mfma_f32_16x16x32_bf16 v[60:63], v[76:79], a[44:47], v[60:63]
s_waitcnt vmcnt(9) lgkmcnt(0)
s_barrier
s_mul_i32 s50, s44, 1024
s_add_u32 m0, s50, 118784
s_add_u32 s49, s62, 3145728
buffer_load_dwordx4 v128, s[8:11], s49 offen nt lds
s_mul_i32 s50, s44, 1024
s_add_u32 m0, s50, 122880
s_add_u32 s49, s62, 3145728
buffer_load_dwordx4 v128, s[12:15], s49 offen nt lds
s_mul_i32 s50, s44, 1024
s_add_u32 m0, s50, 126976
s_add_u32 s49, s62, 3145728
buffer_load_dwordx4 v128, s[68:71], s49 offen nt lds
ds_read_b64_tr_b16 a[48:49], v129 offset:49152
ds_read_b64_tr_b16 a[50:51], v129 offset:49664
ds_read_b64_tr_b16 a[52:53], v129 offset:49160
ds_read_b64_tr_b16 a[54:55], v129 offset:49672
ds_read_b64_tr_b16 a[56:57], v130 offset:49152
ds_read_b64_tr_b16 a[58:59], v130 offset:49664
ds_read_b128 v[64:67], v96 offset:256
ds_read_b128 v[68:71], v96 offset:20736
ds_read_b128 v[72:75], v96 offset:41216
ds_read_b128 v[76:79], v96 offset:61696
s_waitcnt lgkmcnt(0)
v_mfma_f32_16x16x32_bf16 v[16:19], a[48:51], v[64:67], v[16:19]
v_mfma_f32_16x16x32_bf16 v[24:27], a[52:55], v[64:67], v[24:27]
v_mfma_f32_16x16x32_bf16 v[32:35], v[64:67], a[56:59], v[32:35]
v_mfma_f32_16x16x32_bf16 v[20:23], a[48:51], v[68:71], v[20:23]
v_mfma_f32_16x16x32_bf16 v[28:31], a[52:55], v[68:71], v[28:31]
v_mfma_f32_16x16x32_bf16 v[36:39], v[68:71], a[56:59], v[36:39]
v_mfma_f32_16x16x32_bf16 v[40:43], a[48:51], v[72:75], v[40:43]
v_mfma_f32_16x16x32_bf16 v[48:51], a[52:55], v[72:75], v[48:51]
v_mfma_f32_16x16x32_bf16 v[56:59], v[72:75], a[56:59], v[56:59]
v_mfma_f32_16x16x32_bf16 v[44:47], a[48:51], v[76:79], v[44:47]
v_mfma_f32_16x16x32_bf16 v[52:55], a[52:55], v[76:79], v[52:55]
v_mfma_f32_16x16x32_bf16 v[60:63], v[76:79], a[56:59], v[60:63]
s_waitcnt vmcnt(9) lgkmcnt(0)
s_barrier
s_mul_i32 s50, s44, 1024
s_add_u32 m0, s50, 131072
s_add_u32 s49, s62, 3538944
buffer_load_dwordx4 v128, s[8:11], s49 offen nt lds
s_mul_i32 s50, s44, 1024
s_add_u32 m0, s50, 135168
s_add_u32 s49, s62, 3538944
buffer_load_dwordx4 v128, s[12:15], s49 offen nt lds
s_mul_i32 s50, s44, 1024
s_add_u32 m0, s50, 139264
s_add_u32 s49, s62, 3538944
buffer_load_dwordx4 v128, s[68:71], s49 offen nt lds
ds_read_b64_tr_b16 a[60:61], v129 offset:0
ds_read_b64_tr_b16 a[62:63], v129 offset:512
ds_read_b64_tr_b16 a[64:65], v129 offset:8
ds_read_b64_tr_b16 a[66:67], v129 offset:520
ds_read_b64_tr_b16 a[68:69], v130 offset:0
ds_read_b64_tr_b16 a[70:71], v130 offset:512
ds_read_b128 v[64:67], v97 offset:256
ds_read_b128 v[68:71], v97 offset:20736
ds_read_b128 v[72:75], v97 offset:41216
ds_read_b128 v[76:79], v97 offset:61696
s_waitcnt lgkmcnt(0)
v_mfma_f32_16x16x32_bf16 v[16:19], a[60:63], v[64:67], v[16:19]
v_mfma_f32_16x16x32_bf16 v[24:27], a[64:67], v[64:67], v[24:27]
v_mfma_f32_16x16x32_bf16 v[32:35], v[64:67], a[68:71], v[32:35]
v_mfma_f32_16x16x32_bf16 v[20:23], a[60:63], v[68:71], v[20:23]
v_mfma_f32_16x16x32_bf16 v[28:31], a[64:67], v[68:71], v[28:31]
v_mfma_f32_16x16x32_bf16 v[36:39], v[68:71], a[68:71], v[36:39]
v_mfma_f32_16x16x32_bf16 v[40:43], a[60:63], v[72:75], v[40:43]
v_mfma_f32_16x16x32_bf16 v[48:51], a[64:67], v[72:75], v[48:51]
v_mfma_f32_16x16x32_bf16 v[56:59], v[72:75], a[68:71], v[56:59]
v_mfma_f32_16x16x32_bf16 v[44:47], a[60:63], v[76:79], v[44:47]
v_mfma_f32_16x16x32_bf16 v[52:55], a[64:67], v[76:79], v[52:55]
v_mfma_f32_16x16x32_bf16 v[60:63], v[76:79], a[68:71], v[60:63]
s_waitcnt vmcnt(9) lgkmcnt(0)
s_barrier
s_mul_i32 s50, s44, 1024
s_add_u32 m0, s50, 81920
s_add_u32 s49, s62, 3932160
buffer_load_dwordx4 v128, s[8:11], s49 offen nt lds
s_mul_i32 s50, s44, 1024
s_add_u32 m0, s50, 86016
s_add_u32 s49, s62, 3932160
buffer_load_dwordx4 v128, s[12:15], s49 offen nt lds
s_mul_i32 s50, s44, 1024
s_add_u32 m0, s50, 90112
s_add_u32 s49, s62, 3932160
buffer_load_dwordx4 v128, s[68:71], s49 offen nt lds
ds_read_b64_tr_b16 a[72:73], v129 offset:12288
ds_read_b64_tr_b16 a[74:75], v129 offset:12800
ds_read_b64_tr_b16 a[76:77], v129 offset:12296
ds_read_b64_tr_b16 a[78:79], v129 offset:12808
ds_read_b64_tr_b16 a[80:81], v130 offset:12288
ds_read_b64_tr_b16 a[82:83], v130 offset:12800
ds_read_b128 v[64:67], v98 offset:256
ds_read_b128 v[68:71], v98 offset:20736
ds_read_b128 v[72:75], v98 offset:41216
ds_read_b128 v[76:79], v98 offset:61696
s_waitcnt lgkmcnt(0)
v_mfma_f32_16x16x32_bf16 v[16:19], a[72:75], v[64:67], v[16:19]
v_mfma_f32_16x16x32_bf16 v[24:27], a[76:79], v[64:67], v[24:27]
v_mfma_f32_16x16x32_bf16 v[32:35], v[64:67], a[80:83], v[32:35]
v_mfma_f32_16x16x32_bf16 v[20:23], a[72:75], v[68:71], v[20:23]
v_mfma_f32_16x16x32_bf16 v[28:31], a[76:79], v[68:71], v[28:31]
v_mfma_f32_16x16x32_bf16 v[36:39], v[68:71], a[80:83], v[36:39]
v_mfma_f32_16x16x32_bf16 v[40:43], a[72:75], v[72:75], v[40:43]
v_mfma_f32_16x16x32_bf16 v[48:51], a[76:79], v[72:75], v[48:51]
v_mfma_f32_16x16x32_bf16 v[56:59], v[72:75], a[80:83], v[56:59]
v_mfma_f32_16x16x32_bf16 v[44:47], a[72:75], v[76:79], v[44:47]
v_mfma_f32_16x16x32_bf16 v[52:55], a[76:79], v[76:79], v[52:55]
v_mfma_f32_16x16x32_bf16 v[60:63], v[76:79], a[80:83], v[60:63]
s_waitcnt vmcnt(9) lgkmcnt(0)
s_barrier
s_mul_i32 s50, s44, 1024
s_add_u32 m0, s50, 94208
s_add_u32 s49, s62, 4325376
buffer_load_dwordx4 v128, s[8:11], s49 offen nt lds
s_mul_i32 s50, s44, 1024
s_add_u32 m0, s50, 98304
s_add_u32 s49, s62, 4325376
buffer_load_dwordx4 v128, s[12:15], s49 offen nt lds
s_mul_i32 s50, s44, 1024
s_add_u32 m0, s50, 102400
s_add_u32 s49, s62, 4325376
buffer_load_dwordx4 v128, s[68:71], s49 offen nt lds
ds_read_b64_tr_b16 a[84:85], v129 offset:24576
ds_read_b64_tr_b16 a[86:87], v129 offset:25088
ds_read_b64_tr_b16 a[88:89], v129 offset:24584
ds_read_b64_tr_b16 a[90:91], v129 offset:25096
ds_read_b64_tr_b16 a[92:93], v130 offset:24576
ds_read_b64_tr_b16 a[94:95], v130 offset:25088
ds_read_b128 v[64:67], v99 offset:256
ds_read_b128 v[68:71], v99 offset:20736
ds_read_b128 v[72:75], v99 offset:41216
ds_read_b128 v[76:79], v99 offset:61696
s_waitcnt lgkmcnt(0)
v_mfma_f32_16x16x32_bf16 v[16:19], a[84:87], v[64:67], v[16:19]
v_mfma_f32_16x16x32_bf16 v[24:27], a[88:91], v[64:67], v[24:27]
v_mfma_f32_16x16x32_bf16 v[32:35], v[64:67], a[92:95], v[32:35]
v_mfma_f32_16x16x32_bf16 v[20:23], a[84:87], v[68:71], v[20:23]
v_mfma_f32_16x16x32_bf16 v[28:31], a[88:91], v[68:71], v[28:31]
v_mfma_f32_16x16x32_bf16 v[36:39], v[68:71], a[92:95], v[36:39]
v_mfma_f32_16x16x32_bf16 v[40:43], a[84:87], v[72:75], v[40:43]
v_mfma_f32_16x16x32_bf16 v[48:51], a[88:91], v[72:75], v[48:51]
v_mfma_f32_16x16x32_bf16 v[56:59], v[72:75], a[92:95], v[56:59]
v_mfma_f32_16x16x32_bf16 v[44:47], a[84:87], v[76:79], v[44:47]
v_mfma_f32_16x16x32_bf16 v[52:55], a[88:91], v[76:79], v[52:55]
v_mfma_f32_16x16x32_bf16 v[60:63], v[76:79], a[92:95], v[60:63]
s_waitcnt vmcnt(9) lgkmcnt(0)
s_barrier
s_mul_i32 s50, s44, 1024
s_add_u32 m0, s50, 106496
s_add_u32 s49, s62, 4718592
buffer_load_dwordx4 v128, s[8:11], s49 offen nt lds
s_mul_i32 s50, s44, 1024
s_add_u32 m0, s50, 110592
s_add_u32 s49, s62, 4718592
buffer_load_dwordx4 v128, s[12:15], s49 offen nt lds
s_mul_i32 s50, s44, 1024
s_add_u32 m0, s50, 114688
s_add_u32 s49, s62, 4718592
buffer_load_dwordx4 v128, s[68:71], s49 offen nt lds
ds_read_b64_tr_b16 a[96:97], v129 offset:36864
ds_read_b64_tr_b16 a[98:99], v129 offset:37376
ds_read_b64_tr_b16 a[100:101], v129 offset:36872
ds_read_b64_tr_b16 a[102:103], v129 offset:37384
ds_read_b64_tr_b16 a[104:105], v130 offset:36864
ds_read_b64_tr_b16 a[106:107], v130 offset:37376
ds_read_b128 v[64:67], v96 offset:512
ds_read_b128 v[68:71], v96 offset:20992
ds_read_b128 v[72:75], v96 offset:41472
ds_read_b128 v[76:79], v96 offset:61952
s_waitcnt lgkmcnt(0)
v_mfma_f32_16x16x32_bf16 v[16:19], a[96:99], v[64:67], v[16:19]
v_mfma_f32_16x16x32_bf16 v[24:27], a[100:103], v[64:67], v[24:27]
v_mfma_f32_16x16x32_bf16 v[32:35], v[64:67], a[104:107], v[32:35]
v_mfma_f32_16x16x32_bf16 v[20:23], a[96:99], v[68:71], v[20:23]
v_mfma_f32_16x16x32_bf16 v[28:31], a[100:103], v[68:71], v[28:31]
v_mfma_f32_16x16x32_bf16 v[36:39], v[68:71], a[104:107], v[36:39]
v_mfma_f32_16x16x32_bf16 v[40:43], a[96:99], v[72:75], v[40:43]
v_mfma_f32_16x16x32_bf16 v[48:51], a[100:103], v[72:75], v[48:51]
v_mfma_f32_16x16x32_bf16 v[56:59], v[72:75], a[104:107], v[56:59]
v_mfma_f32_16x16x32_bf16 v[44:47], a[96:99], v[76:79], v[44:47]
v_mfma_f32_16x16x32_bf16 v[52:55], a[100:103], v[76:79], v[52:55]
v_mfma_f32_16x16x32_bf16 v[60:63], v[76:79], a[104:107], v[60:63]
s_waitcnt vmcnt(9) lgkmcnt(0)
s_barrier
s_mul_i32 s50, s44, 1024
s_add_u32 m0, s50, 118784
s_add_u32 s49, s62, 5111808
buffer_load_dwordx4 v128, s[8:11], s49 offen nt lds
s_mul_i32 s50, s44, 1024
s_add_u32 m0, s50, 122880
s_add_u32 s49, s62, 5111808
buffer_load_dwordx4 v128, s[12:15], s49 offen nt lds
s_mul_i32 s50, s44, 1024
s_add_u32 m0, s50, 126976
s_add_u32 s49, s62, 5111808
buffer_load_dwordx4 v128, s[68:71], s49 offen nt lds
ds_read_b64_tr_b16 a[108:109], v129 offset:49152
ds_read_b64_tr_b16 a[110:111], v129 offset:49664
ds_read_b64_tr_b16 a[112:113], v129 offset:49160
ds_read_b64_tr_b16 a[114:115], v129 offset:49672
ds_read_b64_tr_b16 a[116:117], v130 offset:49152
ds_read_b64_tr_b16 a[118:119], v130 offset:49664
ds_read_b128 v[64:67], v97 offset:512
ds_read_b128 v[68:71], v97 offset:20992
ds_read_b128 v[72:75], v97 offset:41472
ds_read_b128 v[76:79], v97 offset:61952
s_waitcnt lgkmcnt(0)
v_mfma_f32_16x16x32_bf16 v[16:19], a[108:111], v[64:67], v[16:19]
v_mfma_f32_16x16x32_bf16 v[24:27], a[112:115], v[64:67], v[24:27]
v_mfma_f32_16x16x32_bf16 v[32:35], v[64:67], a[116:119], v[32:35]
v_mfma_f32_16x16x32_bf16 v[20:23], a[108:111], v[68:71], v[20:23]
v_mfma_f32_16x16x32_bf16 v[28:31], a[112:115], v[68:71], v[28:31]
v_mfma_f32_16x16x32_bf16 v[36:39], v[68:71], a[116:119], v[36:39]
v_mfma_f32_16x16x32_bf16 v[40:43], a[108:111], v[72:75], v[40:43]
v_mfma_f32_16x16x32_bf16 v[48:51], a[112:115], v[72:75], v[48:51]
v_mfma_f32_16x16x32_bf16 v[56:59], v[72:75], a[116:119], v[56:59]
v_mfma_f32_16x16x32_bf16 v[44:47], a[108:111], v[76:79], v[44:47]
v_mfma_f32_16x16x32_bf16 v[52:55], a[112:115], v[76:79], v[52:55]
v_mfma_f32_16x16x32_bf16 v[60:63], v[76:79], a[116:119], v[60:63]
s_waitcnt vmcnt(9) lgkmcnt(0)
s_barrier
s_mul_i32 s50, s44, 1024
s_add_u32 m0, s50, 131072
s_add_u32 s49, s62, 5505024
buffer_load_dwordx4 v128, s[8:11], s49 offen nt lds
s_mul_i32 s50, s44, 1024
s_add_u32 m0, s50, 135168
s_add_u32 s49, s62, 5505024
buffer_load_dwordx4 v128, s[12:15], s49 offen nt lds
s_mul_i32 s50, s44, 1024
s_add_u32 m0, s50, 139264
s_add_u32 s49, s62, 5505024
buffer_load_dwordx4 v128, s[68:71], s49 offen nt lds
ds_read_b64_tr_b16 a[120:121], v129 offset:0
ds_read_b64_tr_b16 a[122:123], v129 offset:512
ds_read_b64_tr_b16 a[124:125], v129 offset:8
ds_read_b64_tr_b16 a[126:127], v129 offset:520
ds_read_b64_tr_b16 a[128:129], v130 offset:0
ds_read_b64_tr_b16 a[130:131], v130 offset:512
ds_read_b128 v[64:67], v98 offset:512
ds_read_b128 v[68:71], v98 offset:20992
ds_read_b128 v[72:75], v98 offset:41472
ds_read_b128 v[76:79], v98 offset:61952
s_waitcnt lgkmcnt(0)
v_mfma_f32_16x16x32_bf16 v[16:19], a[120:123], v[64:67], v[16:19]
v_mfma_f32_16x16x32_bf16 v[24:27], a[124:127], v[64:67], v[24:27]
v_mfma_f32_16x16x32_bf16 v[32:35], v[64:67], a[128:131], v[32:35]
v_mfma_f32_16x16x32_bf16 v[20:23], a[120:123], v[68:71], v[20:23]
v_mfma_f32_16x16x32_bf16 v[28:31], a[124:127], v[68:71], v[28:31]
v_mfma_f32_16x16x32_bf16 v[36:39], v[68:71], a[128:131], v[36:39]
v_mfma_f32_16x16x32_bf16 v[40:43], a[120:123], v[72:75], v[40:43]
v_mfma_f32_16x16x32_bf16 v[48:51], a[124:127], v[72:75], v[48:51]
v_mfma_f32_16x16x32_bf16 v[56:59], v[72:75], a[128:131], v[56:59]
v_mfma_f32_16x16x32_bf16 v[44:47], a[120:123], v[76:79], v[44:47]
v_mfma_f32_16x16x32_bf16 v[52:55], a[124:127], v[76:79], v[52:55]
v_mfma_f32_16x16x32_bf16 v[60:63], v[76:79], a[128:131], v[60:63]
s_waitcnt vmcnt(9) lgkmcnt(0)
s_barrier
s_mul_i32 s50, s44, 1024
s_add_u32 m0, s50, 81920
s_add_u32 s49, s62, 5898240
buffer_load_dwordx4 v128, s[8:11], s49 offen nt lds
s_mul_i32 s50, s44, 1024
s_add_u32 m0, s50, 86016
s_add_u32 s49, s62, 5898240
buffer_load_dwordx4 v128, s[12:15], s49 offen nt lds
s_mul_i32 s50, s44, 1024
s_add_u32 m0, s50, 90112
s_add_u32 s49, s62, 5898240
buffer_load_dwordx4 v128, s[68:71], s49 offen nt lds
ds_read_b64_tr_b16 a[132:133], v129 offset:12288
ds_read_b64_tr_b16 a[134:135], v129 offset:12800
ds_read_b64_tr_b16 a[136:137], v129 offset:12296
ds_read_b64_tr_b16 a[138:139], v129 offset:12808
ds_read_b64_tr_b16 a[140:141], v130 offset:12288
ds_read_b64_tr_b16 a[142:143], v130 offset:12800
ds_read_b128 v[64:67], v99 offset:512
ds_read_b128 v[68:71], v99 offset:20992
ds_read_b128 v[72:75], v99 offset:41472
ds_read_b128 v[76:79], v99 offset:61952
s_waitcnt lgkmcnt(0)
v_mfma_f32_16x16x32_bf16 v[16:19], a[132:135], v[64:67], v[16:19]
v_mfma_f32_16x16x32_bf16 v[24:27], a[136:139], v[64:67], v[24:27]
v_mfma_f32_16x16x32_bf16 v[32:35], v[64:67], a[140:143], v[32:35]
v_mfma_f32_16x16x32_bf16 v[20:23], a[132:135], v[68:71], v[20:23]
v_mfma_f32_16x16x32_bf16 v[28:31], a[136:139], v[68:71], v[28:31]
v_mfma_f32_16x16x32_bf16 v[36:39], v[68:71], a[140:143], v[36:39]
v_mfma_f32_16x16x32_bf16 v[40:43], a[132:135], v[72:75], v[40:43]
v_mfma_f32_16x16x32_bf16 v[48:51], a[136:139], v[72:75], v[48:51]
v_mfma_f32_16x16x32_bf16 v[56:59], v[72:75], a[140:143], v[56:59]
v_mfma_f32_16x16x32_bf16 v[44:47], a[132:135], v[76:79], v[44:47]
v_mfma_f32_16x16x32_bf16 v[52:55], a[136:139], v[76:79], v[52:55]
v_mfma_f32_16x16x32_bf16 v[60:63], v[76:79], a[140:143], v[60:63]
s_waitcnt vmcnt(9) lgkmcnt(0)
s_barrier
s_mul_i32 s50, s44, 1024
s_add_u32 m0, s50, 94208
s_add_u32 s49, s62, 6291456
buffer_load_dwordx4 v128, s[8:11], s49 offen nt lds
s_mul_i32 s50, s44, 1024
s_add_u32 m0, s50, 98304
s_add_u32 s49, s62, 6291456
buffer_load_dwordx4 v128, s[12:15], s49 offen nt lds
s_mul_i32 s50, s44, 1024
s_add_u32 m0, s50, 102400
s_add_u32 s49, s62, 6291456
buffer_load_dwordx4 v128, s[68:71], s49 offen nt lds
ds_read_b64_tr_b16 a[144:145], v129 offset:24576
ds_read_b64_tr_b16 a[146:147], v129 offset:25088
ds_read_b64_tr_b16 a[148:149], v129 offset:24584
ds_read_b64_tr_b16 a[150:151], v129 offset:25096
ds_read_b64_tr_b16 a[152:153], v130 offset:24576
ds_read_b64_tr_b16 a[154:155], v130 offset:25088
ds_read_b128 v[64:67], v96 offset:768
ds_read_b128 v[68:71], v96 offset:21248
ds_read_b128 v[72:75], v96 offset:41728
ds_read_b128 v[76:79], v96 offset:62208
s_waitcnt lgkmcnt(0)
v_mfma_f32_16x16x32_bf16 v[16:19], a[144:147], v[64:67], v[16:19]
v_mfma_f32_16x16x32_bf16 v[24:27], a[148:151], v[64:67], v[24:27]
v_mfma_f32_16x16x32_bf16 v[32:35], v[64:67], a[152:155], v[32:35]
v_mfma_f32_16x16x32_bf16 v[20:23], a[144:147], v[68:71], v[20:23]
v_mfma_f32_16x16x32_bf16 v[28:31], a[148:151], v[68:71], v[28:31]
v_mfma_f32_16x16x32_bf16 v[36:39], v[68:71], a[152:155], v[36:39]
v_mfma_f32_16x16x32_bf16 v[40:43], a[144:147], v[72:75], v[40:43]
v_mfma_f32_16x16x32_bf16 v[48:51], a[148:151], v[72:75], v[48:51]
v_mfma_f32_16x16x32_bf16 v[56:59], v[72:75], a[152:155], v[56:59]
v_mfma_f32_16x16x32_bf16 v[44:47], a[144:147], v[76:79], v[44:47]
v_mfma_f32_16x16x32_bf16 v[52:55], a[148:151], v[76:79], v[52:55]
v_mfma_f32_16x16x32_bf16 v[60:63], v[76:79], a[152:155], v[60:63]
s_waitcnt vmcnt(9) lgkmcnt(0)
s_barrier
s_mul_i32 s50, s44, 1024
s_add_u32 m0, s50, 106496
s_add_u32 s49, s62, 6684672
buffer_load_dwordx4 v128, s[8:11], s49 offen nt lds
s_mul_i32 s50, s44, 1024
s_add_u32 m0, s50, 110592
s_add_u32 s49, s62, 6684672
buffer_load_dwordx4 v128, s[12:15], s49 offen nt lds
s_mul_i32 s50, s44, 1024
s_add_u32 m0, s50, 114688
s_add_u32 s49, s62, 6684672
buffer_load_dwordx4 v128, s[68:71], s49 offen nt lds
ds_read_b64_tr_b16 a[156:157], v129 offset:36864
ds_read_b64_tr_b16 a[158:159], v129 offset:37376
ds_read_b64_tr_b16 a[160:161], v129 offset:36872
ds_read_b64_tr_b16 a[162:163], v129 offset:37384
ds_read_b64_tr_b16 a[164:165], v130 offset:36864
ds_read_b64_tr_b16 a[166:167], v130 offset:37376
ds_read_b128 v[64:67], v97 offset:768
ds_read_b128 v[68:71], v97 offset:21248
ds_read_b128 v[72:75], v97 offset:41728
ds_read_b128 v[76:79], v97 offset:62208
s_waitcnt lgkmcnt(0)
v_mfma_f32_16x16x32_bf16 v[16:19], a[156:159], v[64:67], v[16:19]
v_mfma_f32_16x16x32_bf16 v[24:27], a[160:163], v[64:67], v[24:27]
v_mfma_f32_16x16x32_bf16 v[32:35], v[64:67], a[164:167], v[32:35]
v_mfma_f32_16x16x32_bf16 v[20:23], a[156:159], v[68:71], v[20:23]
v_mfma_f32_16x16x32_bf16 v[28:31], a[160:163], v[68:71], v[28:31]
v_mfma_f32_16x16x32_bf16 v[36:39], v[68:71], a[164:167], v[36:39]
v_mfma_f32_16x16x32_bf16 v[40:43], a[156:159], v[72:75], v[40:43]
v_mfma_f32_16x16x32_bf16 v[48:51], a[160:163], v[72:75], v[48:51]
v_mfma_f32_16x16x32_bf16 v[56:59], v[72:75], a[164:167], v[56:59]
v_mfma_f32_16x16x32_bf16 v[44:47], a[156:159], v[76:79], v[44:47]
v_mfma_f32_16x16x32_bf16 v[52:55], a[160:163], v[76:79], v[52:55]
v_mfma_f32_16x16x32_bf16 v[60:63], v[76:79], a[164:167], v[60:63]
s_waitcnt vmcnt(9) lgkmcnt(0)
s_barrier
s_mul_i32 s50, s44, 1024
s_add_u32 m0, s50, 118784
s_add_u32 s49, s62, 7077888
buffer_load_dwordx4 v128, s[8:11], s49 offen nt lds
s_mul_i32 s50, s44, 1024
s_add_u32 m0, s50, 122880
s_add_u32 s49, s62, 7077888
buffer_load_dwordx4 v128, s[12:15], s49 offen nt lds
s_mul_i32 s50, s44, 1024
s_add_u32 m0, s50, 126976
s_add_u32 s49, s62, 7077888
buffer_load_dwordx4 v128, s[68:71], s49 offen nt lds
ds_read_b64_tr_b16 a[168:169], v129 offset:49152
ds_read_b64_tr_b16 a[170:171], v129 offset:49664
ds_read_b64_tr_b16 a[172:173], v129 offset:49160
ds_read_b64_tr_b16 a[174:175], v129 offset:49672
ds_read_b64_tr_b16 a[176:177], v130 offset:49152
ds_read_b64_tr_b16 a[178:179], v130 offset:49664
ds_read_b128 v[64:67], v98 offset:768
ds_read_b128 v[68:71], v98 offset:21248
ds_read_b128 v[72:75], v98 offset:41728
ds_read_b128 v[76:79], v98 offset:62208
s_waitcnt lgkmcnt(0)
v_mfma_f32_16x16x32_bf16 v[16:19], a[168:171], v[64:67], v[16:19]
v_mfma_f32_16x16x32_bf16 v[24:27], a[172:175], v[64:67], v[24:27]
v_mfma_f32_16x16x32_bf16 v[32:35], v[64:67], a[176:179], v[32:35]
v_mfma_f32_16x16x32_bf16 v[20:23], a[168:171], v[68:71], v[20:23]
v_mfma_f32_16x16x32_bf16 v[28:31], a[172:175], v[68:71], v[28:31]
v_mfma_f32_16x16x32_bf16 v[36:39], v[68:71], a[176:179], v[36:39]
v_mfma_f32_16x16x32_bf16 v[40:43], a[168:171], v[72:75], v[40:43]
v_mfma_f32_16x16x32_bf16 v[48:51], a[172:175], v[72:75], v[48:51]
v_mfma_f32_16x16x32_bf16 v[56:59], v[72:75], a[176:179], v[56:59]
v_mfma_f32_16x16x32_bf16 v[44:47], a[168:171], v[76:79], v[44:47]
v_mfma_f32_16x16x32_bf16 v[52:55], a[172:175], v[76:79], v[52:55]
v_mfma_f32_16x16x32_bf16 v[60:63], v[76:79], a[176:179], v[60:63]
s_waitcnt vmcnt(9) lgkmcnt(0)
s_barrier
s_mul_i32 s50, s44, 1024
s_add_u32 m0, s50, 131072
s_add_u32 s49, s62, 7471104
buffer_load_dwordx4 v128, s[8:11], s49 offen nt lds
s_mul_i32 s50, s44, 1024
s_add_u32 m0, s50, 135168
s_add_u32 s49, s62, 7471104
buffer_load_dwordx4 v128, s[12:15], s49 offen nt lds
s_mul_i32 s50, s44, 1024
s_add_u32 m0, s50, 139264
s_add_u32 s49, s62, 7471104
buffer_load_dwordx4 v128, s[68:71], s49 offen nt lds
ds_read_b64_tr_b16 a[180:181], v129 offset:0
ds_read_b64_tr_b16 a[182:183], v129 offset:512
ds_read_b64_tr_b16 a[184:185], v129 offset:8
ds_read_b64_tr_b16 a[186:187], v129 offset:520
ds_read_b64_tr_b16 a[188:189], v130 offset:0
ds_read_b64_tr_b16 a[190:191], v130 offset:512
ds_read_b128 v[64:67], v99 offset:768
ds_read_b128 v[68:71], v99 offset:21248
ds_read_b128 v[72:75], v99 offset:41728
ds_read_b128 v[76:79], v99 offset:62208
s_waitcnt lgkmcnt(0)
v_mfma_f32_16x16x32_bf16 v[16:19], a[180:183], v[64:67], v[16:19]
v_mfma_f32_16x16x32_bf16 v[24:27], a[184:187], v[64:67], v[24:27]
v_mfma_f32_16x16x32_bf16 v[32:35], v[64:67], a[188:191], v[32:35]
v_mfma_f32_16x16x32_bf16 v[20:23], a[180:183], v[68:71], v[20:23]
v_mfma_f32_16x16x32_bf16 v[28:31], a[184:187], v[68:71], v[28:31]
v_mfma_f32_16x16x32_bf16 v[36:39], v[68:71], a[188:191], v[36:39]
v_mfma_f32_16x16x32_bf16 v[40:43], a[180:183], v[72:75], v[40:43]
v_mfma_f32_16x16x32_bf16 v[48:51], a[184:187], v[72:75], v[48:51]
v_mfma_f32_16x16x32_bf16 v[56:59], v[72:75], a[188:191], v[56:59]
v_mfma_f32_16x16x32_bf16 v[44:47], a[180:183], v[76:79], v[44:47]
v_mfma_f32_16x16x32_bf16 v[52:55], a[184:187], v[76:79], v[52:55]
v_mfma_f32_16x16x32_bf16 v[60:63], v[76:79], a[188:191], v[60:63]
s_waitcnt vmcnt(9) lgkmcnt(0)
s_barrier
ds_read_b64_tr_b16 a[192:193], v129 offset:12288
ds_read_b64_tr_b16 a[194:195], v129 offset:12800
ds_read_b64_tr_b16 a[196:197], v129 offset:12296
ds_read_b64_tr_b16 a[198:199], v129 offset:12808
ds_read_b64_tr_b16 a[200:201], v130 offset:12288
ds_read_b64_tr_b16 a[202:203], v130 offset:12800
ds_read_b128 v[64:67], v96 offset:1024
ds_read_b128 v[68:71], v96 offset:21504
ds_read_b128 v[72:75], v96 offset:41984
ds_read_b128 v[76:79], v96 offset:62464
s_waitcnt lgkmcnt(0)
v_mfma_f32_16x16x32_bf16 v[16:19], a[192:195], v[64:67], v[16:19]
v_mfma_f32_16x16x32_bf16 v[24:27], a[196:199], v[64:67], v[24:27]
v_mfma_f32_16x16x32_bf16 v[32:35], v[64:67], a[200:203], v[32:35]
v_mfma_f32_16x16x32_bf16 v[20:23], a[192:195], v[68:71], v[20:23]
v_mfma_f32_16x16x32_bf16 v[28:31], a[196:199], v[68:71], v[28:31]
v_mfma_f32_16x16x32_bf16 v[36:39], v[68:71], a[200:203], v[36:39]
v_mfma_f32_16x16x32_bf16 v[40:43], a[192:195], v[72:75], v[40:43]
v_mfma_f32_16x16x32_bf16 v[48:51], a[196:199], v[72:75], v[48:51]
v_mfma_f32_16x16x32_bf16 v[56:59], v[72:75], a[200:203], v[56:59]
v_mfma_f32_16x16x32_bf16 v[44:47], a[192:195], v[76:79], v[44:47]
v_mfma_f32_16x16x32_bf16 v[52:55], a[196:199], v[76:79], v[52:55]
v_mfma_f32_16x16x32_bf16 v[60:63], v[76:79], a[200:203], v[60:63]
s_waitcnt vmcnt(6) lgkmcnt(0)
s_barrier
ds_read_b64_tr_b16 a[204:205], v129 offset:24576
ds_read_b64_tr_b16 a[206:207], v129 offset:25088
ds_read_b64_tr_b16 a[208:209], v129 offset:24584
ds_read_b64_tr_b16 a[210:211], v129 offset:25096
ds_read_b64_tr_b16 a[212:213], v130 offset:24576
ds_read_b64_tr_b16 a[214:215], v130 offset:25088
ds_read_b128 v[64:67], v97 offset:1024
ds_read_b128 v[68:71], v97 offset:21504
ds_read_b128 v[72:75], v97 offset:41984
ds_read_b128 v[76:79], v97 offset:62464
s_waitcnt lgkmcnt(0)
v_mfma_f32_16x16x32_bf16 v[16:19], a[204:207], v[64:67], v[16:19]
v_mfma_f32_16x16x32_bf16 v[24:27], a[208:211], v[64:67], v[24:27]
v_mfma_f32_16x16x32_bf16 v[32:35], v[64:67], a[212:215], v[32:35]
v_mfma_f32_16x16x32_bf16 v[20:23], a[204:207], v[68:71], v[20:23]
v_mfma_f32_16x16x32_bf16 v[28:31], a[208:211], v[68:71], v[28:31]
v_mfma_f32_16x16x32_bf16 v[36:39], v[68:71], a[212:215], v[36:39]
v_mfma_f32_16x16x32_bf16 v[40:43], a[204:207], v[72:75], v[40:43]
v_mfma_f32_16x16x32_bf16 v[48:51], a[208:211], v[72:75], v[48:51]
v_mfma_f32_16x16x32_bf16 v[56:59], v[72:75], a[212:215], v[56:59]
v_mfma_f32_16x16x32_bf16 v[44:47], a[204:207], v[76:79], v[44:47]
v_mfma_f32_16x16x32_bf16 v[52:55], a[208:211], v[76:79], v[52:55]
v_mfma_f32_16x16x32_bf16 v[60:63], v[76:79], a[212:215], v[60:63]
s_waitcnt vmcnt(3) lgkmcnt(0)
s_barrier
ds_read_b64_tr_b16 a[216:217], v129 offset:36864
ds_read_b64_tr_b16 a[218:219], v129 offset:37376
ds_read_b64_tr_b16 a[220:221], v129 offset:36872
ds_read_b64_tr_b16 a[222:223], v129 offset:37384
ds_read_b64_tr_b16 a[224:225], v130 offset:36864
ds_read_b64_tr_b16 a[226:227], v130 offset:37376
ds_read_b128 v[64:67], v98 offset:1024
ds_read_b128 v[68:71], v98 offset:21504
ds_read_b128 v[72:75], v98 offset:41984
ds_read_b128 v[76:79], v98 offset:62464
s_waitcnt lgkmcnt(0)
v_mfma_f32_16x16x32_bf16 v[16:19], a[216:219], v[64:67], v[16:19]
v_mfma_f32_16x16x32_bf16 v[24:27], a[220:223], v[64:67], v[24:27]
v_mfma_f32_16x16x32_bf16 v[32:35], v[64:67], a[224:227], v[32:35]
v_mfma_f32_16x16x32_bf16 v[20:23], a[216:219], v[68:71], v[20:23]
v_mfma_f32_16x16x32_bf16 v[28:31], a[220:223], v[68:71], v[28:31]
v_mfma_f32_16x16x32_bf16 v[36:39], v[68:71], a[224:227], v[36:39]
v_mfma_f32_16x16x32_bf16 v[40:43], a[216:219], v[72:75], v[40:43]
v_mfma_f32_16x16x32_bf16 v[48:51], a[220:223], v[72:75], v[48:51]
v_mfma_f32_16x16x32_bf16 v[56:59], v[72:75], a[224:227], v[56:59]
v_mfma_f32_16x16x32_bf16 v[44:47], a[216:219], v[76:79], v[44:47]
v_mfma_f32_16x16x32_bf16 v[52:55], a[220:223], v[76:79], v[52:55]
v_mfma_f32_16x16x32_bf16 v[60:63], v[76:79], a[224:227], v[60:63]
s_waitcnt vmcnt(0) lgkmcnt(0)
s_barrier
ds_read_b64_tr_b16 a[228:229], v129 offset:49152
ds_read_b64_tr_b16 a[230:231], v129 offset:49664
ds_read_b64_tr_b16 a[232:233], v129 offset:49160
ds_read_b64_tr_b16 a[234:235], v129 offset:49672
ds_read_b64_tr_b16 a[236:237], v130 offset:49152
ds_read_b64_tr_b16 a[238:239], v130 offset:49664
ds_read_b128 v[64:67], v99 offset:1024
ds_read_b128 v[68:71], v99 offset:21504
ds_read_b128 v[72:75], v99 offset:41984
ds_read_b128 v[76:79], v99 offset:62464
s_waitcnt lgkmcnt(0)
v_mfma_f32_16x16x32_bf16 v[16:19], a[228:231], v[64:67], v[16:19]
v_mfma_f32_16x16x32_bf16 v[24:27], a[232:235], v[64:67], v[24:27]
v_mfma_f32_16x16x32_bf16 v[32:35], v[64:67], a[236:239], v[32:35]
v_mfma_f32_16x16x32_bf16 v[20:23], a[228:231], v[68:71], v[20:23]
v_mfma_f32_16x16x32_bf16 v[28:31], a[232:235], v[68:71], v[28:31]
v_mfma_f32_16x16x32_bf16 v[36:39], v[68:71], a[236:239], v[36:39]
v_mfma_f32_16x16x32_bf16 v[40:43], a[228:231], v[72:75], v[40:43]
v_mfma_f32_16x16x32_bf16 v[48:51], a[232:235], v[72:75], v[48:51]
v_mfma_f32_16x16x32_bf16 v[56:59], v[72:75], a[236:239], v[56:59]
v_mfma_f32_16x16x32_bf16 v[44:47], a[228:231], v[76:79], v[44:47]
v_mfma_f32_16x16x32_bf16 v[52:55], a[232:235], v[76:79], v[52:55]
v_mfma_f32_16x16x32_bf16 v[60:63], v[76:79], a[236:239], v[60:63]
s_waitcnt lgkmcnt(0)
s_add_u32 s56, s59, 0
v_cvt_pk_bf16_f32 v128, v16, v17
v_cvt_pk_bf16_f32 v129, v18, v19
v_cvt_pk_bf16_f32 v130, v24, v25
v_cvt_pk_bf16_f32 v131, v26, v27
buffer_store_dwordx4 v[128:131], v112, s[4:7], s56 offen offset:0 sc1
v_cvt_pk_bf16_f32 v132, v20, v21
v_cvt_pk_bf16_f32 v133, v22, v23
v_cvt_pk_bf16_f32 v134, v28, v29
v_cvt_pk_bf16_f32 v135, v30, v31
buffer_store_dwordx4 v[132:135], v112, s[4:7], s56 offen offset:256 sc1
v_cvt_pk_bf16_f32 v136, v32, v33
v_cvt_pk_bf16_f32 v137, v34, v35
v_cvt_pk_bf16_f32 v138, v36, v37
v_cvt_pk_bf16_f32 v139, v38, v39
buffer_store_dwordx4 v[136:139], v113, s[4:7], s56 offen sc1
s_add_u32 s56, s59, 393216
v_cvt_pk_bf16_f32 v128, v40, v41
v_cvt_pk_bf16_f32 v129, v42, v43
v_cvt_pk_bf16_f32 v130, v48, v49
v_cvt_pk_bf16_f32 v131, v50, v51
buffer_store_dwordx4 v[128:131], v112, s[4:7], s56 offen offset:0 sc1
v_cvt_pk_bf16_f32 v132, v44, v45
v_cvt_pk_bf16_f32 v133, v46, v47
v_cvt_pk_bf16_f32 v134, v52, v53
v_cvt_pk_bf16_f32 v135, v54, v55
buffer_store_dwordx4 v[132:135], v112, s[4:7], s56 offen offset:256 sc1
v_cvt_pk_bf16_f32 v136, v56, v57
v_cvt_pk_bf16_f32 v137, v58, v59
v_cvt_pk_bf16_f32 v138, v60, v61
v_cvt_pk_bf16_f32 v139, v62, v63
buffer_store_dwordx4 v[136:139], v113, s[4:7], s56 offen sc1
s_add_u32 s59, s59, 786432
s_mov_b32 s55, 81920
s_mov_b32 s61, 62
v_mov_b32 v122, 32
s_cmp_lg_u32 s44, 0
s_cbranch_scc1 L_pdx_17
s_mov_b32 s53, 0
L_pd_16:
global_load_dword v123, v122, s[40:41] sc1
s_add_u32 s53, s53, 1
s_cmp_gt_u32 s53, 100000
s_cbranch_scc1 L_pdx_17
s_waitcnt vmcnt(0)
v_readfirstlane_b32 s48, v123
s_cmp_ge_u32 s48, 64
s_cbranch_scc1 L_pdx_17
s_sleep 16
s_branch L_pd_16
L_pdx_17:
s_waitcnt vmcnt(0)
s_barrier
v_mov_b32 v122, 2
buffer_store_dword v122, v120, s[4:7], 0 offen sc1
s_barrier
s_mul_i32 s57, s44, 10240
s_mov_b32 s58, 0
s_mov_b32 s56, 1879048192
s_mov_b32 s54, -2
s_mov_b32 s64, 40960
s_add_u32 m0, s57, 0
s_nop 0
buffer_load_dwordx4 v100, s[72:75], s55 offen  lds
s_add_u32 m0, s57, 1024
s_nop 0
buffer_load_dwordx4 v101, s[72:75], s55 offen  lds
s_add_u32 m0, s57, 2048
s_nop 0
buffer_load_dwordx4 v102, s[72:75], s55 offen  lds
s_add_u32 m0, s57, 3072
s_nop 0
buffer_load_dwordx4 v103, s[72:75], s55 offen  lds
s_add_u32 m0, s57, 4096
s_nop 0
buffer_load_dwordx4 v104, s[72:75], s55 offen  lds
s_add_u32 m0, s57, 5120
s_nop 0
buffer_load_dwordx4 v105, s[72:75], s55 offen  lds
s_add_u32 m0, s57, 6144
s_nop 0
buffer_load_dwordx4 v106, s[72:75], s55 offen  lds
s_add_u32 m0, s57, 7168
s_nop 0
buffer_load_dwordx4 v107, s[72:75], s55 offen  lds
s_add_u32 m0, s57, 8192
s_nop 0
buffer_load_dwordx4 v108, s[72:75], s55 offen  lds
s_add_u32 m0, s57, 9216
s_nop 0
buffer_load_dwordx4 v109, s[72:75], s55 offen  lds
s_add_u32 s55, s55, 40960
s_add_u32 s57, s57, 40960
s_cmp_ge_u32 s57, 122880
s_cselect_b32 s49, 122880, 0
s_sub_u32 s57, s57, s49
s_add_u32 s54, s54, 1
s_add_u32 m0, s57, 0
s_nop 0
buffer_load_dwordx4 v100, s[72:75], s55 offen  lds
s_add_u32 m0, s57, 1024
s_nop 0
buffer_load_dwordx4 v101, s[72:75], s55 offen  lds
s_add_u32 m0, s57, 2048
s_nop 0
buffer_load_dwordx4 v102, s[72:75], s55 offen  lds
s_add_u32 m0, s57, 3072
s_nop 0
buffer_load_dwordx4 v103, s[72:75], s55 offen  lds
s_add_u32 m0, s57, 4096
s_nop 0
buffer_load_dwordx4 v104, s[72:75], s55 offen  lds
s_add_u32 m0, s57, 5120
s_nop 0
buffer_load_dwordx4 v105, s[72:75], s55 offen  lds
s_add_u32 m0, s57, 6144
s_nop 0
buffer_load_dwordx4 v106, s[72:75], s55 offen  lds
s_add_u32 m0, s57, 7168
s_nop 0
buffer_load_dwordx4 v107, s[72:75], s55 offen  lds
s_add_u32 m0, s57, 8192
s_nop 0
buffer_load_dwordx4 v108, s[72:75], s55 offen  lds
s_add_u32 m0, s57, 9216
s_nop 0
buffer_load_dwordx4 v109, s[72:75], s55 offen  lds
s_add_u32 s55, s55, 40960
s_add_u32 s57, s57, 40960
s_cmp_ge_u32 s57, 122880
s_cselect_b32 s49, 122880, 0
s_sub_u32 s57, s57, s49
s_add_u32 s54, s54, 1
s_waitcnt vmcnt(10)
s_barrier
ds_read_b128 v[64:67], v96 offset:0
ds_read_b128 v[68:71], v96 offset:20480
ds_read_b128 v[72:75], v97 offset:0
ds_read_b128 v[76:79], v97 offset:20480
ds_read_b128 v[80:83], v98 offset:0
ds_read_b128 v[84:87], v98 offset:20480
ds_read_b128 v[88:91], v99 offset:0
ds_read_b128 v[92:95], v99 offset:20480
L_t1_loop_18:
s_sub_u32 s51, s54, 1
s_cmp_lt_u32 s51, 2
s_cbranch_scc1 L_f0_20
L_f0b_21:
s_waitcnt lgkmcnt(7)
v_mfma_f32_16x16x32_bf16 v[16:19], a[0:3], v[64:67], 0
s_add_u32 m0, s57, 0
s_sub_i32 s51, s54, 2
v_mfma_f32_16x16x32_bf16 v[24:27], a[4:7], v[64:67], 0
buffer_load_dwordx4 v100, s[72:75], s55 offen  lds
s_min_u32 s52, s54, 2
v_mfma_f32_16x16x32_bf16 v[32:35], v[64:67], a[8:11], 0
ds_read_b128 v[64:67], v96 offset:256
s_waitcnt lgkmcnt(7)
v_mfma_f32_16x16x32_bf16 v[20:23], a[0:3], v[68:71], 0
s_max_i32 s51, s51, s52
s_add_u32 s51, s51, 2
v_mfma_f32_16x16x32_bf16 v[28:31], a[4:7], v[68:71], 0
v_mov_b32 v122, s51
buffer_store_dword v122, v120, s[4:7], 0 offen sc1
v_mfma_f32_16x16x32_bf16 v[36:39], v[68:71], a[8:11], 0
ds_read_b128 v[68:71], v96 offset:20736
s_waitcnt lgkmcnt(7)
v_mfma_f32_16x16x32_bf16 v[16:19], a[12:15], v[72:75], v[16:19]
v_mfma_f32_16x16x32_bf16 v[24:27], a[16:19], v[72:75], v[24:27]
v_mfma_f32_16x16x32_bf16 v[32:35], v[72:75], a[20:23], v[32:35]
ds_read_b128 v[72:75], v97 offset:256
s_waitcnt lgkmcnt(7)
v_mfma_f32_16x16x32_bf16 v[20:23], a[12:15], v[76:79], v[20:23]
s_add_u32 m0, s57, 1024
v_mfma_f32_16x16x32_bf16 v[28:31], a[16:19], v[76:79], v[28:31]
buffer_load_dwordx4 v101, s[72:75], s55 offen  lds
v_mfma_f32_16x16x32_bf16 v[36:39], v[76:79], a[20:23], v[36:39]
ds_read_b128 v[76:79], v97 offset:20736
s_waitcnt lgkmcnt(7)
v_mfma_f32_16x16x32_bf16 v[16:19], a[24:27], v[80:83], v[16:19]
v_mfma_f32_16x16x32_bf16 v[24:27], a[28:31], v[80:83], v[24:27]
v_mfma_f32_16x16x32_bf16 v[32:35], v[80:83], a[32:35], v[32:35]
ds_read_b128 v[80:83], v98 offset:256
s_waitcnt lgkmcnt(7)
v_mfma_f32_16x16x32_bf16 v[20:23], a[24:27], v[84:87], v[20:23]
v_mfma_f32_16x16x32_bf16 v[28:31], a[28:31], v[84:87], v[28:31]
v_mfma_f32_16x16x32_bf16 v[36:39], v[84:87], a[32:35], v[36:39]
ds_read_b128 v[84:87], v98 offset:20736
s_waitcnt lgkmcnt(7)
v_mfma_f32_16x16x32_bf16 v[16:19], a[36:39], v[88:91], v[16:19]
s_add_u32 m0, s57, 2048
v_mfma_f32_16x16x32_bf16 v[24:27], a[40:43], v[88:91], v[24:27]
buffer_load_dwordx4 v102, s[72:75], s55 offen  lds
v_mfma_f32_16x16x32_bf16 v[32:35], v[88:91], a[44:47], v[32:35]
ds_read_b128 v[88:91], v99 offset:256
s_waitcnt lgkmcnt(7)
v_mfma_f32_16x16x32_bf16 v[20:23], a[36:39], v[92:95], v[20:23]
v_mfma_f32_16x16x32_bf16 v[28:31], a[40:43], v[92:95], v[28:31]
v_mfma_f32_16x16x32_bf16 v[36:39], v[92:95], a[44:47], v[36:39]
ds_read_b128 v[92:95], v99 offset:20736
s_waitcnt lgkmcnt(7)
v_mfma_f32_16x16x32_bf16 v[16:19], a[48:51], v[64:67], v[16:19]
v_mfma_f32_16x16x32_bf16 v[24:27], a[52:55], v[64:67], v[24:27]
v_mfma_f32_16x16x32_bf16 v[32:35], v[64:67], a[56:59], v[32:35]
ds_read_b128 v[64:67], v96 offset:512
s_waitcnt lgkmcnt(7)
v_mfma_f32_16x16x32_bf16 v[20:23], a[48:51], v[68:71], v[20:23]
s_add_u32 m0, s57, 3072
v_mfma_f32_16x16x32_bf16 v[28:31], a[52:55], v[68:71], v[28:31]
buffer_load_dwordx4 v103, s[72:75], s55 offen  lds
v_mfma_f32_16x16x32_bf16 v[36:39], v[68:71], a[56:59], v[36:39]
ds_read_b128 v[68:71], v96 offset:20992
s_waitcnt lgkmcnt(7)
v_mfma_f32_16x16x32_bf16 v[16:19], a[60:63], v[72:75], v[16:19]
v_cvt_pk_bf16_f32 v128, v40, v41
v_mfma_f32_16x16x32_bf16 v[24:27], a[64:67], v[72:75], v[24:27]
v_mfma_f32_16x16x32_bf16 v[32:35], v[72:75], a[68:71], v[32:35]
ds_read_b128 v[72:75], v97 offset:512
s_waitcnt lgkmcnt(7)
v_mfma_f32_16x16x32_bf16 v[20:23], a[60:63], v[76:79], v[20:23]
v_cvt_pk_bf16_f32 v129, v42, v43
v_mfma_f32_16x16x32_bf16 v[28:31], a[64:67], v[76:79], v[28:31]
v_mfma_f32_16x16x32_bf16 v[36:39], v[76:79], a[68:71], v[36:39]
ds_read_b128 v[76:79], v97 offset:20992
s_waitcnt lgkmcnt(7)
v_mfma_f32_16x16x32_bf16 v[16:19], a[72:75], v[80:83], v[16:19]
s_add_u32 m0, s57, 4096
v_cvt_pk_bf16_f32 v130, v48, v49
v_mfma_f32_16x16x32_bf16 v[24:27], a[76:79], v[80:83], v[24:27]
buffer_load_dwordx4 v104, s[72:75], s55 offen  lds
v_mfma_f32_16x16x32_bf16 v[32:35], v[80:83], a[80:83], v[32:35]
ds_read_b128 v[80:83], v98 offset:512
s_waitcnt lgkmcnt(7)
v_mfma_f32_16x16x32_bf16 v[20:23], a[72:75], v[84:87], v[20:23]
v_cvt_pk_bf16_f32 v131, v50, v51
v_mfma_f32_16x16x32_bf16 v[28:31], a[76:79], v[84:87], v[28:31]
v_mfma_f32_16x16x32_bf16 v[36:39], v[84:87], a[80:83], v[36:39]
ds_read_b128 v[84:87], v98 offset:20992
s_waitcnt lgkmcnt(7)
v_mfma_f32_16x16x32_bf16 v[16:19], a[84:87], v[88:91], v[16:19]
buffer_store_dwordx4 v[128:131], v112, s[4:7], s56 offen offset:0 sc1
v_mfma_f32_16x16x32_bf16 v[24:27], a[88:91], v[88:91], v[24:27]
v_mfma_f32_16x16x32_bf16 v[32:35], v[88:91], a[92:95], v[32:35]
ds_read_b128 v[88:91], v99 offset:512
s_waitcnt lgkmcnt(7)
v_mfma_f32_16x16x32_bf16 v[20:23], a[84:87], v[92:95], v[20:23]
s_add_u32 m0, s57, 5120
v_cvt_pk_bf16_f32 v132, v44, v45
v_mfma_f32_16x16x32_bf16 v[28:31], a[88:91], v[92:95], v[28:31]
buffer_load_dwordx4 v105, s[72:75], s55 offen  lds
v_mfma_f32_16x16x32_bf16 v[36:39], v[92:95], a[92:95], v[36:39]
ds_read_b128 v[92:95], v99 offset:20992
s_waitcnt lgkmcnt(7)
v_mfma_f32_16x16x32_bf16 v[16:19], a[96:99], v[64:67], v[16:19]
v_mfma_f32_16x16x32_bf16 v[24:27], a[100:103], v[64:67], v[24:27]
v_mfma_f32_16x16x32_bf16 v[32:35], v[64:67], a[104:107], v[32:35]
ds_read_b128 v[64:67], v96 offset:768
s_waitcnt lgkmcnt(7)
v_mfma_f32_16x16x32_bf16 v[20:23], a[96:99], v[68:71], v[20:23]
v_cvt_pk_bf16_f32 v133, v46, v47
v_mfma_f32_16x16x32_bf16 v[28:31], a[100:103], v[68:71], v[28:31]
v_mfma_f32_16x16x32_bf16 v[36:39], v[68:71], a[104:107], v[36:39]
ds_read_b128 v[68:71], v96 offset:21248
s_waitcnt lgkmcnt(7)
v_mfma_f32_16x16x32_bf16 v[16:19], a[108:111], v[72:75], v[16:19]
s_add_u32 m0, s57, 6144
v_cvt_pk_bf16_f32 v134, v52, v53
v_mfma_f32_16x16x32_bf16 v[24:27], a[112:115], v[72:75], v[24:27]
buffer_load_dwordx4 v106, s[72:75], s55 offen  lds
v_mfma_f32_16x16x32_bf16 v[32:35], v[72:75], a[116:119], v[32:35]
ds_read_b128 v[72:75], v97 offset:768
s_waitcnt lgkmcnt(7)
v_mfma_f32_16x16x32_bf16 v[20:23], a[108:111], v[76:79], v[20:23]
v_cvt_pk_bf16_f32 v135, v54, v55
v_mfma_f32_16x16x32_bf16 v[28:31], a[112:115], v[76:79], v[28:31]
v_mfma_f32_16x16x32_bf16 v[36:39], v[76:79], a[116:119], v[36:39]
ds_read_b128 v[76:79], v97 offset:21248
s_waitcnt lgkmcnt(7)
v_mfma_f32_16x16x32_bf16 v[16:19], a[120:123], v[80:83], v[16:19]
buffer_store_dwordx4 v[132:135], v112, s[4:7], s56 offen offset:256 sc1
v_mfma_f32_16x16x32_bf16 v[24:27], a[124:127], v[80:83], v[24:27]
v_mfma_f32_16x16x32_bf16 v[32:35], v[80:83], a[128:131], v[32:35]
ds_read_b128 v[80:83], v98 offset:768
s_waitcnt lgkmcnt(7)
v_mfma_f32_16x16x32_bf16 v[20:23], a[120:123], v[84:87], v[20:23]
s_add_u32 m0, s57, 7168
v_cvt_pk_bf16_f32 v136, v56, v57
v_mfma_f32_16x16x32_bf16 v[28:31], a[124:127], v[84:87], v[28:31]
buffer_load_dwordx4 v107, s[72:75], s55 offen  lds
v_mfma_f32_16x16x32_bf16 v[36:39], v[84:87], a[128:131], v[36:39]
ds_read_b128 v[84:87], v98 offset:21248
s_waitcnt lgkmcnt(7)
v_mfma_f32_16x16x32_bf16 v[16:19], a[132:135], v[88:91], v[16:19]
v_cvt_pk_bf16_f32 v137, v58, v59
v_mfma_f32_16x16x32_bf16 v[24:27], a[136:139], v[88:91], v[24:27]
v_mfma_f32_16x16x32_bf16 v[32:35], v[88:91], a[140:143], v[32:35]
ds_read_b128 v[88:91], v99 offset:768
s_waitcnt lgkmcnt(7)
v_mfma_f32_16x16x32_bf16 v[20:23], a[132:135], v[92:95], v[20:23]
v_mfma_f32_16x16x32_bf16 v[28:31], a[136:139], v[92:95], v[28:31]
v_mfma_f32_16x16x32_bf16 v[36:39], v[92:95], a[140:143], v[36:39]
ds_read_b128 v[92:95], v99 offset:21248
s_waitcnt lgkmcnt(7)
v_mfma_f32_16x16x32_bf16 v[16:19], a[144:147], v[64:67], v[16:19]
s_add_u32 m0, s57, 8192
v_cvt_pk_bf16_f32 v138, v60, v61
v_mfma_f32_16x16x32_bf16 v[24:27], a[148:151], v[64:67], v[24:27]
buffer_load_dwordx4 v108, s[72:75], s55 offen  lds
v_mfma_f32_16x16x32_bf16 v[32:35], v[64:67], a[152:155], v[32:35]
ds_read_b128 v[64:67], v96 offset:1024
s_waitcnt lgkmcnt(7)
v_mfma_f32_16x16x32_bf16 v[20:23], a[144:147], v[68:71], v[20:23]
v_cvt_pk_bf16_f32 v139, v62, v63
v_mfma_f32_16x16x32_bf16 v[28:31], a[148:151], v[68:71], v[28:31]
v_mfma_f32_16x16x32_bf16 v[36:39], v[68:71], a[152:155], v[36:39]
ds_read_b128 v[68:71], v96 offset:21504
s_waitcnt lgkmcnt(7)
v_mfma_f32_16x16x32_bf16 v[16:19], a[156:159], v[72:75], v[16:19]
buffer_store_dwordx4 v[136:139], v113, s[4:7], s56 offen sc1
v_mfma_f32_16x16x32_bf16 v[24:27], a[160:163], v[72:75], v[24:27]
v_mfma_f32_16x16x32_bf16 v[32:35], v[72:75], a[164:167], v[32:35]
ds_read_b128 v[72:75], v97 offset:1024
s_waitcnt lgkmcnt(7)
v_mfma_f32_16x16x32_bf16 v[20:23], a[156:159], v[76:79], v[20:23]
s_add_u32 m0, s57, 9216
s_mov_b32 s56, s59
v_mfma_f32_16x16x32_bf16 v[28:31], a[160:163], v[76:79], v[28:31]
buffer_load_dwordx4 v109, s[72:75], s55 offen  lds
v_mfma_f32_16x16x32_bf16 v[36:39], v[76:79], a[164:167], v[36:39]
ds_read_b128 v[76:79], v97 offset:21504
s_waitcnt lgkmcnt(7)
v_mfma_f32_16x16x32_bf16 v[16:19], a[168:171], v[80:83], v[16:19]
s_add_u32 s55, s55, 40960
s_add_u32 s57, s57, 40960
v_mfma_f32_16x16x32_bf16 v[24:27], a[172:175], v[80:83], v[24:27]
s_cmp_ge_u32 s57, 122880
s_cselect_b32 s49, 122880, 0
v_mfma_f32_16x16x32_bf16 v[32:35], v[80:83], a[176:179], v[32:35]
ds_read_b128 v[80:83], v98 offset:1024
s_waitcnt lgkmcnt(7)
v_mfma_f32_16x16x32_bf16 v[20:23], a[168:171], v[84:87], v[20:23]
s_sub_u32 s57, s57, s49
s_add_u32 s59, s59, s60
v_mfma_f32_16x16x32_bf16 v[28:31], a[172:175], v[84:87], v[28:31]
v_mfma_f32_16x16x32_bf16 v[36:39], v[84:87], a[176:179], v[36:39]
ds_read_b128 v[84:87], v98 offset:21504
s_waitcnt lgkmcnt(7)
v_mfma_f32_16x16x32_bf16 v[16:19], a[180:183], v[88:91], v[16:19]
s_add_u32 s54, s54, 1
s_add_u32 s58, s58, 40960
v_mfma_f32_16x16x32_bf16 v[24:27], a[184:187], v[88:91], v[24:27]
s_cmp_ge_u32 s58, 122880
s_cselect_b32 s50, -81920, s64
v_mfma_f32_16x16x32_bf16 v[32:35], v[88:91], a[188:191], v[32:35]
ds_read_b128 v[88:91], v99 offset:1024
s_waitcnt lgkmcnt(7)
v_mfma_f32_16x16x32_bf16 v[20:23], a[180:183], v[92:95], v[20:23]
s_cselect_b32 s58, 0, s58
v_mfma_f32_16x16x32_bf16 v[28:31], a[184:187], v[92:95], v[28:31]
v_mfma_f32_16x16x32_bf16 v[36:39], v[92:95], a[188:191], v[36:39]
ds_read_b128 v[92:95], v99 offset:21504
s_waitcnt lgkmcnt(7)
v_mfma_f32_16x16x32_bf16 v[16:19], a[192:195], v[64:67], v[16:19]
v_add_u32 v96, s50, v96
v_add_u32 v97, s50, v97
v_mfma_f32_16x16x32_bf16 v[24:27], a[196:199], v[64:67], v[24:27]
v_add_u32 v98, s50, v98
v_add_u32 v99, s50, v99
v_mfma_f32_16x16x32_bf16 v[32:35], v[64:67], a[200:203], v[32:35]
s_waitcnt lgkmcnt(6)
v_mfma_f32_16x16x32_bf16 v[20:23], a[192:195], v[68:71], v[20:23]
v_mfma_f32_16x16x32_bf16 v[28:31], a[196:199], v[68:71], v[28:31]
v_mfma_f32_16x16x32_bf16 v[36:39], v[68:71], a[200:203], v[36:39]
s_waitcnt vmcnt(14) lgkmcnt(0)
s_barrier
ds_read_b128 v[64:67], v96 offset:0
ds_read_b128 v[68:71], v96 offset:20480
v_mfma_f32_16x16x32_bf16 v[16:19], a[204:207], v[72:75], v[16:19]
v_mfma_f32_16x16x32_bf16 v[24:27], a[208:211], v[72:75], v[24:27]
v_mfma_f32_16x16x32_bf16 v[32:35], v[72:75], a[212:215], v[32:35]
ds_read_b128 v[72:75], v97 offset:0
v_mfma_f32_16x16x32_bf16 v[20:23], a[204:207], v[76:79], v[20:23]
v_mfma_f32_16x16x32_bf16 v[28:31], a[208:211], v[76:79], v[28:31]
v_mfma_f32_16x16x32_bf16 v[36:39], v[76:79], a[212:215], v[36:39]
ds_read_b128 v[76:79], v97 offset:20480
v_mfma_f32_16x16x32_bf16 v[16:19], a[216:219], v[80:83], v[16:19]
v_mfma_f32_16x16x32_bf16 v[24:27], a[220:223], v[80:83], v[24:27]
v_mfma_f32_16x16x32_bf16 v[32:35], v[80:83], a[224:227], v[32:35]
ds_read_b128 v[80:83], v98 offset:0
v_mfma_f32_16x16x32_bf16 v[20:23], a[216:219], v[84:87], v[20:23]
v_mfma_f32_16x16x32_bf16 v[28:31], a[220:223], v[84:87], v[28:31]
v_mfma_f32_16x16x32_bf16 v[36:39], v[84:87], a[224:227], v[36:39]
ds_read_b128 v[84:87], v98 offset:20480
v_mfma_f32_16x16x32_bf16 v[16:19], a[228:231], v[88:91], v[16:19]
v_mfma_f32_16x16x32_bf16 v[24:27], a[232:235], v[88:91], v[24:27]
v_mfma_f32_16x16x32_bf16 v[32:35], v[88:91], a[236:239], v[32:35]
ds_read_b128 v[88:91], v99 offset:0
v_mfma_f32_16x16x32_bf16 v[20:23], a[228:231], v[92:95], v[20:23]
v_mfma_f32_16x16x32_bf16 v[28:31], a[232:235], v[92:95], v[28:31]
v_mfma_f32_16x16x32_bf16 v[36:39], v[92:95], a[236:239], v[36:39]
ds_read_b128 v[92:95], v99 offset:20480
s_sub_u32 s51, s54, 1
s_cmp_lt_u32 s51, 2
s_cbranch_scc1 L_f0_22
L_f0b_23:
s_waitcnt lgkmcnt(7)
v_mfma_f32_16x16x32_bf16 v[40:43], a[0:3], v[64:67], 0
s_add_u32 m0, s57, 0
s_sub_i32 s51, s54, 2
v_mfma_f32_16x16x32_bf16 v[48:51], a[4:7], v[64:67], 0
buffer_load_dwordx4 v100, s[72:75], s55 offen  lds
s_min_u32 s52, s54, 2
v_mfma_f32_16x16x32_bf16 v[56:59], v[64:67], a[8:11], 0
ds_read_b128 v[64:67], v96 offset:256
s_waitcnt lgkmcnt(7)
v_mfma_f32_16x16x32_bf16 v[44:47], a[0:3], v[68:71], 0
s_max_i32 s51, s51, s52
s_add_u32 s51, s51, 2
v_mfma_f32_16x16x32_bf16 v[52:55], a[4:7], v[68:71], 0
v_mov_b32 v122, s51
buffer_store_dword v122, v120, s[4:7], 0 offen sc1
v_mfma_f32_16x16x32_bf16 v[60:63], v[68:71], a[8:11], 0
ds_read_b128 v[68:71], v96 offset:20736
s_waitcnt lgkmcnt(7)
v_mfma_f32_16x16x32_bf16 v[40:43], a[12:15], v[72:75], v[40:43]
v_mfma_f32_16x16x32_bf16 v[48:51], a[16:19], v[72:75], v[48:51]
v_mfma_f32_16x16x32_bf16 v[56:59], v[72:75], a[20:23], v[56:59]
ds_read_b128 v[72:75], v97 offset:256
s_waitcnt lgkmcnt(7)
v_mfma_f32_16x16x32_bf16 v[44:47], a[12:15], v[76:79], v[44:47]
s_add_u32 m0, s57, 1024
v_mfma_f32_16x16x32_bf16 v[52:55], a[16:19], v[76:79], v[52:55]
buffer_load_dwordx4 v101, s[72:75], s55 offen  lds
v_mfma_f32_16x16x32_bf16 v[60:63], v[76:79], a[20:23], v[60:63]
ds_read_b128 v[76:79], v97 offset:20736
s_waitcnt lgkmcnt(7)
v_mfma_f32_16x16x32_bf16 v[40:43], a[24:27], v[80:83], v[40:43]
v_mfma_f32_16x16x32_bf16 v[48:51], a[28:31], v[80:83], v[48:51]
v_mfma_f32_16x16x32_bf16 v[56:59], v[80:83], a[32:35], v[56:59]
ds_read_b128 v[80:83], v98 offset:256
s_waitcnt lgkmcnt(7)
v_mfma_f32_16x16x32_bf16 v[44:47], a[24:27], v[84:87], v[44:47]
v_mfma_f32_16x16x32_bf16 v[52:55], a[28:31], v[84:87], v[52:55]
v_mfma_f32_16x16x32_bf16 v[60:63], v[84:87], a[32:35], v[60:63]
ds_read_b128 v[84:87], v98 offset:20736
s_waitcnt lgkmcnt(7)
v_mfma_f32_16x16x32_bf16 v[40:43], a[36:39], v[88:91], v[40:43]
s_add_u32 m0, s57, 2048
v_mfma_f32_16x16x32_bf16 v[48:51], a[40:43], v[88:91], v[48:51]
buffer_load_dwordx4 v102, s[72:75], s55 offen  lds
v_mfma_f32_16x16x32_bf16 v[56:59], v[88:91], a[44:47], v[56:59]
ds_read_b128 v[88:91], v99 offset:256
s_waitcnt lgkmcnt(7)
v_mfma_f32_16x16x32_bf16 v[44:47], a[36:39], v[92:95], v[44:47]
v_mfma_f32_16x16x32_bf16 v[52:55], a[40:43], v[92:95], v[52:55]
v_mfma_f32_16x16x32_bf16 v[60:63], v[92:95], a[44:47], v[60:63]
ds_read_b128 v[92:95], v99 offset:20736
s_waitcnt lgkmcnt(7)
v_mfma_f32_16x16x32_bf16 v[40:43], a[48:51], v[64:67], v[40:43]
v_mfma_f32_16x16x32_bf16 v[48:51], a[52:55], v[64:67], v[48:51]
v_mfma_f32_16x16x32_bf16 v[56:59], v[64:67], a[56:59], v[56:59]
ds_read_b128 v[64:67], v96 offset:512
s_waitcnt lgkmcnt(7)
v_mfma_f32_16x16x32_bf16 v[44:47], a[48:51], v[68:71], v[44:47]
s_add_u32 m0, s57, 3072
v_mfma_f32_16x16x32_bf16 v[52:55], a[52:55], v[68:71], v[52:55]
buffer_load_dwordx4 v103, s[72:75], s55 offen  lds
v_mfma_f32_16x16x32_bf16 v[60:63], v[68:71], a[56:59], v[60:63]
ds_read_b128 v[68:71], v96 offset:20992
s_waitcnt lgkmcnt(7)
v_mfma_f32_16x16x32_bf16 v[40:43], a[60:63], v[72:75], v[40:43]
v_cvt_pk_bf16_f32 v128, v16, v17
v_mfma_f32_16x16x32_bf16 v[48:51], a[64:67], v[72:75], v[48:51]
v_mfma_f32_16x16x32_bf16 v[56:59], v[72:75], a[68:71], v[56:59]
ds_read_b128 v[72:75], v97 offset:512
s_waitcnt lgkmcnt(7)
v_mfma_f32_16x16x32_bf16 v[44:47], a[60:63], v[76:79], v[44:47]
v_cvt_pk_bf16_f32 v129, v18, v19
v_mfma_f32_16x16x32_bf16 v[52:55], a[64:67], v[76:79], v[52:55]
v_mfma_f32_16x16x32_bf16 v[60:63], v[76:79], a[68:71], v[60:63]
ds_read_b128 v[76:79], v97 offset:20992
s_waitcnt lgkmcnt(7)
v_mfma_f32_16x16x32_bf16 v[40:43], a[72:75], v[80:83], v[40:43]
s_add_u32 m0, s57, 4096
v_cvt_pk_bf16_f32 v130, v24, v25
v_mfma_f32_16x16x32_bf16 v[48:51], a[76:79], v[80:83], v[48:51]
buffer_load_dwordx4 v104, s[72:75], s55 offen  lds
v_mfma_f32_16x16x32_bf16 v[56:59], v[80:83], a[80:83], v[56:59]
ds_read_b128 v[80:83], v98 offset:512
s_waitcnt lgkmcnt(7)
v_mfma_f32_16x16x32_bf16 v[44:47], a[72:75], v[84:87], v[44:47]
v_cvt_pk_bf16_f32 v131, v26, v27
v_mfma_f32_16x16x32_bf16 v[52:55], a[76:79], v[84:87], v[52:55]
v_mfma_f32_16x16x32_bf16 v[60:63], v[84:87], a[80:83], v[60:63]
ds_read_b128 v[84:87], v98 offset:20992
s_waitcnt lgkmcnt(7)
v_mfma_f32_16x16x32_bf16 v[40:43], a[84:87], v[88:91], v[40:43]
buffer_store_dwordx4 v[128:131], v112, s[4:7], s56 offen offset:0 sc1
v_mfma_f32_16x16x32_bf16 v[48:51], a[88:91], v[88:91], v[48:51]
v_mfma_f32_16x16x32_bf16 v[56:59], v[88:91], a[92:95], v[56:59]
ds_read_b128 v[88:91], v99 offset:512
s_waitcnt lgkmcnt(7)
v_mfma_f32_16x16x32_bf16 v[44:47], a[84:87], v[92:95], v[44:47]
s_add_u32 m0, s57, 5120
v_cvt_pk_bf16_f32 v132, v20, v21
v_mfma_f32_16x16x32_bf16 v[52:55], a[88:91], v[92:95], v[52:55]
buffer_load_dwordx4 v105, s[72:75], s55 offen  lds
v_mfma_f32_16x16x32_bf16 v[60:63], v[92:95], a[92:95], v[60:63]
ds_read_b128 v[92:95], v99 offset:20992
s_waitcnt lgkmcnt(7)
v_mfma_f32_16x16x32_bf16 v[40:43], a[96:99], v[64:67], v[40:43]
v_mfma_f32_16x16x32_bf16 v[48:51], a[100:103], v[64:67], v[48:51]
v_mfma_f32_16x16x32_bf16 v[56:59], v[64:67], a[104:107], v[56:59]
ds_read_b128 v[64:67], v96 offset:768
s_waitcnt lgkmcnt(7)
v_mfma_f32_16x16x32_bf16 v[44:47], a[96:99], v[68:71], v[44:47]
v_cvt_pk_bf16_f32 v133, v22, v23
v_mfma_f32_16x16x32_bf16 v[52:55], a[100:103], v[68:71], v[52:55]
v_mfma_f32_16x16x32_bf16 v[60:63], v[68:71], a[104:107], v[60:63]
ds_read_b128 v[68:71], v96 offset:21248
s_waitcnt lgkmcnt(7)
v_mfma_f32_16x16x32_bf16 v[40:43], a[108:111], v[72:75], v[40:43]
s_add_u32 m0, s57, 6144
v_cvt_pk_bf16_f32 v134, v28, v29
v_mfma_f32_16x16x32_bf16 v[48:51], a[112:115], v[72:75], v[48:51]
buffer_load_dwordx4 v106, s[72:75], s55 offen  lds
v_mfma_f32_16x16x32_bf16 v[56:59], v[72:75], a[116:119], v[56:59]
ds_read_b128 v[72:75], v97 offset:768
s_waitcnt lgkmcnt(7)
v_mfma_f32_16x16x32_bf16 v[44:47], a[108:111], v[76:79], v[44:47]
v_cvt_pk_bf16_f32 v135, v30, v31
v_mfma_f32_16x16x32_bf16 v[52:55], a[112:115], v[76:79], v[52:55]
v_mfma_f32_16x16x32_bf16 v[60:63], v[76:79], a[116:119], v[60:63]
ds_read_b128 v[76:79], v97 offset:21248
s_waitcnt lgkmcnt(7)
v_mfma_f32_16x16x32_bf16 v[40:43], a[120:123], v[80:83], v[40:43]
buffer_store_dwordx4 v[132:135], v112, s[4:7], s56 offen offset:256 sc1
v_mfma_f32_16x16x32_bf16 v[48:51], a[124:127], v[80:83], v[48:51]
v_mfma_f32_16x16x32_bf16 v[56:59], v[80:83], a[128:131], v[56:59]
ds_read_b128 v[80:83], v98 offset:768
s_waitcnt lgkmcnt(7)
v_mfma_f32_16x16x32_bf16 v[44:47], a[120:123], v[84:87], v[44:47]
s_add_u32 m0, s57, 7168
v_cvt_pk_bf16_f32 v136, v32, v33
v_mfma_f32_16x16x32_bf16 v[52:55], a[124:127], v[84:87], v[52:55]
buffer_load_dwordx4 v107, s[72:75], s55 offen  lds
v_mfma_f32_16x16x32_bf16 v[60:63], v[84:87], a[128:131], v[60:63]
ds_read_b128 v[84:87], v98 offset:21248
s_waitcnt lgkmcnt(7)
v_mfma_f32_16x16x32_bf16 v[40:43], a[132:135], v[88:91], v[40:43]
v_cvt_pk_bf16_f32 v137, v34, v35
v_mfma_f32_16x16x32_bf16 v[48:51], a[136:139], v[88:91], v[48:51]
v_mfma_f32_16x16x32_bf16 v[56:59], v[88:91], a[140:143], v[56:59]
ds_read_b128 v[88:91], v99 offset:768
s_waitcnt lgkmcnt(7)
v_mfma_f32_16x16x32_bf16 v[44:47], a[132:135], v[92:95], v[44:47]
v_mfma_f32_16x16x32_bf16 v[52:55], a[136:139], v[92:95], v[52:55]
v_mfma_f32_16x16x32_bf16 v[60:63], v[92:95], a[140:143], v[60:63]
ds_read_b128 v[92:95], v99 offset:21248
s_waitcnt lgkmcnt(7)
v_mfma_f32_16x16x32_bf16 v[40:43], a[144:147], v[64:67], v[40:43]
s_add_u32 m0, s57, 8192
v_cvt_pk_bf16_f32 v138, v36, v37
v_mfma_f32_16x16x32_bf16 v[48:51], a[148:151], v[64:67], v[48:51]
buffer_load_dwordx4 v108, s[72:75], s55 offen  lds
v_mfma_f32_16x16x32_bf16 v[56:59], v[64:67], a[152:155], v[56:59]
ds_read_b128 v[64:67], v96 offset:1024
s_waitcnt lgkmcnt(7)
v_mfma_f32_16x16x32_bf16 v[44:47], a[144:147], v[68:71], v[44:47]
v_cvt_pk_bf16_f32 v139, v38, v39
v_mfma_f32_16x16x32_bf16 v[52:55], a[148:151], v[68:71], v[52:55]
v_mfma_f32_16x16x32_bf16 v[60:63], v[68:71], a[152:155], v[60:63]
ds_read_b128 v[68:71], v96 offset:21504
s_waitcnt lgkmcnt(7)
v_mfma_f32_16x16x32_bf16 v[40:43], a[156:159], v[72:75], v[40:43]
buffer_store_dwordx4 v[136:139], v113, s[4:7], s56 offen sc1
v_mfma_f32_16x16x32_bf16 v[48:51], a[160:163], v[72:75], v[48:51]
v_mfma_f32_16x16x32_bf16 v[56:59], v[72:75], a[164:167], v[56:59]
ds_read_b128 v[72:75], v97 offset:1024
s_waitcnt lgkmcnt(7)
v_mfma_f32_16x16x32_bf16 v[44:47], a[156:159], v[76:79], v[44:47]
s_add_u32 m0, s57, 9216
s_mov_b32 s56, s59
v_mfma_f32_16x16x32_bf16 v[52:55], a[160:163], v[76:79], v[52:55]
buffer_load_dwordx4 v109, s[72:75], s55 offen  lds
v_mfma_f32_16x16x32_bf16 v[60:63], v[76:79], a[164:167], v[60:63]
ds_read_b128 v[76:79], v97 offset:21504
s_waitcnt lgkmcnt(7)
v_mfma_f32_16x16x32_bf16 v[40:43], a[168:171], v[80:83], v[40:43]
s_add_u32 s55, s55, 40960
s_add_u32 s57, s57, 40960
v_mfma_f32_16x16x32_bf16 v[48:51], a[172:175], v[80:83], v[48:51]
s_cmp_ge_u32 s57, 122880
s_cselect_b32 s49, 122880, 0
v_mfma_f32_16x16x32_bf16 v[56:59], v[80:83], a[176:179], v[56:59]
ds_read_b128 v[80:83], v98 offset:1024
s_waitcnt lgkmcnt(7)
v_mfma_f32_16x16x32_bf16 v[44:47], a[168:171], v[84:87], v[44:47]
s_sub_u32 s57, s57, s49
s_add_u32 s59, s59, s60
v_mfma_f32_16x16x32_bf16 v[52:55], a[172:175], v[84:87], v[52:55]
v_mfma_f32_16x16x32_bf16 v[60:63], v[84:87], a[176:179], v[60:63]
ds_read_b128 v[84:87], v98 offset:21504
s_waitcnt lgkmcnt(7)
v_mfma_f32_16x16x32_bf16 v[40:43], a[180:183], v[88:91], v[40:43]
s_add_u32 s54, s54, 1
s_add_u32 s58, s58, 40960
v_mfma_f32_16x16x32_bf16 v[48:51], a[184:187], v[88:91], v[48:51]
s_cmp_ge_u32 s58, 122880
s_cselect_b32 s50, -81920, s64
v_mfma_f32_16x16x32_bf16 v[56:59], v[88:91], a[188:191], v[56:59]
ds_read_b128 v[88:91], v99 offset:1024
s_waitcnt lgkmcnt(7)
v_mfma_f32_16x16x32_bf16 v[44:47], a[180:183], v[92:95], v[44:47]
s_cselect_b32 s58, 0, s58
v_mfma_f32_16x16x32_bf16 v[52:55], a[184:187], v[92:95], v[52:55]
v_mfma_f32_16x16x32_bf16 v[60:63], v[92:95], a[188:191], v[60:63]
ds_read_b128 v[92:95], v99 offset:21504
s_waitcnt lgkmcnt(7)
v_mfma_f32_16x16x32_bf16 v[40:43], a[192:195], v[64:67], v[40:43]
v_add_u32 v96, s50, v96
v_add_u32 v97, s50, v97
v_mfma_f32_16x16x32_bf16 v[48:51], a[196:199], v[64:67], v[48:51]
v_add_u32 v98, s50, v98
v_add_u32 v99, s50, v99
v_mfma_f32_16x16x32_bf16 v[56:59], v[64:67], a[200:203], v[56:59]
s_waitcnt lgkmcnt(6)
v_mfma_f32_16x16x32_bf16 v[44:47], a[192:195], v[68:71], v[44:47]
v_mfma_f32_16x16x32_bf16 v[52:55], a[196:199], v[68:71], v[52:55]
v_mfma_f32_16x16x32_bf16 v[60:63], v[68:71], a[200:203], v[60:63]
s_cmp_ge_u32 s54, s61
s_cbranch_scc1 L_t1_end_19
s_waitcnt vmcnt(14) lgkmcnt(0)
s_barrier
ds_read_b128 v[64:67], v96 offset:0
ds_read_b128 v[68:71], v96 offset:20480
v_mfma_f32_16x16x32_bf16 v[40:43], a[204:207], v[72:75], v[40:43]
v_mfma_f32_16x16x32_bf16 v[48:51], a[208:211], v[72:75], v[48:51]
v_mfma_f32_16x16x32_bf16 v[56:59], v[72:75], a[212:215], v[56:59]
ds_read_b128 v[72:75], v97 offset:0
v_mfma_f32_16x16x32_bf16 v[44:47], a[204:207], v[76:79], v[44:47]
v_mfma_f32_16x16x32_bf16 v[52:55], a[208:211], v[76:79], v[52:55]
v_mfma_f32_16x16x32_bf16 v[60:63], v[76:79], a[212:215], v[60:63]
ds_read_b128 v[76:79], v97 offset:20480
v_mfma_f32_16x16x32_bf16 v[40:43], a[216:219], v[80:83], v[40:43]
v_mfma_f32_16x16x32_bf16 v[48:51], a[220:223], v[80:83], v[48:51]
v_mfma_f32_16x16x32_bf16 v[56:59], v[80:83], a[224:227], v[56:59]
ds_read_b128 v[80:83], v98 offset:0
v_mfma_f32_16x16x32_bf16 v[44:47], a[216:219], v[84:87], v[44:47]
v_mfma_f32_16x16x32_bf16 v[52:55], a[220:223], v[84:87], v[52:55]
v_mfma_f32_16x16x32_bf16 v[60:63], v[84:87], a[224:227], v[60:63]
ds_read_b128 v[84:87], v98 offset:20480
v_mfma_f32_16x16x32_bf16 v[40:43], a[228:231], v[88:91], v[40:43]
v_mfma_f32_16x16x32_bf16 v[48:51], a[232:235], v[88:91], v[48:51]
v_mfma_f32_16x16x32_bf16 v[56:59], v[88:91], a[236:239], v[56:59]
ds_read_b128 v[88:91], v99 offset:0
v_mfma_f32_16x16x32_bf16 v[44:47], a[228:231], v[92:95], v[44:47]
v_mfma_f32_16x16x32_bf16 v[52:55], a[232:235], v[92:95], v[52:55]
v_mfma_f32_16x16x32_bf16 v[60:63], v[92:95], a[236:239], v[60:63]
ds_read_b128 v[92:95], v99 offset:20480
s_branch L_t1_loop_18
L_f0_20:
v_cvt_pk_bf16_f32 v128, v40, v41
v_cvt_pk_bf16_f32 v129, v42, v43
v_cvt_pk_bf16_f32 v130, v48, v49
v_cvt_pk_bf16_f32 v131, v50, v51
buffer_store_dwordx4 v[128:131], v112, s[4:7], s56 offen offset:0 sc1
v_cvt_pk_bf16_f32 v132, v44, v45
v_cvt_pk_bf16_f32 v133, v46, v47
v_cvt_pk_bf16_f32 v134, v52, v53
v_cvt_pk_bf16_f32 v135, v54, v55
buffer_store_dwordx4 v[132:135], v112, s[4:7], s56 offen offset:256 sc1
v_cvt_pk_bf16_f32 v136, v56, v57
v_cvt_pk_bf16_f32 v137, v58, v59
v_cvt_pk_bf16_f32 v138, v60, v61
v_cvt_pk_bf16_f32 v139, v62, v63
buffer_store_dwordx4 v[136:139], v113, s[4:7], s56 offen sc1
s_waitcnt vmcnt(0)
s_barrier
s_branch L_f0b_21
L_f0_22:
v_cvt_pk_bf16_f32 v128, v16, v17
v_cvt_pk_bf16_f32 v129, v18, v19
v_cvt_pk_bf16_f32 v130, v24, v25
v_cvt_pk_bf16_f32 v131, v26, v27
buffer_store_dwordx4 v[128:131], v112, s[4:7], s56 offen offset:0 sc1
v_cvt_pk_bf16_f32 v132, v20, v21
v_cvt_pk_bf16_f32 v133, v22, v23
v_cvt_pk_bf16_f32 v134, v28, v29
v_cvt_pk_bf16_f32 v135, v30, v31
buffer_store_dwordx4 v[132:135], v112, s[4:7], s56 offen offset:256 sc1
v_cvt_pk_bf16_f32 v136, v32, v33
v_cvt_pk_bf16_f32 v137, v34, v35
v_cvt_pk_bf16_f32 v138, v36, v37
v_cvt_pk_bf16_f32 v139, v38, v39
buffer_store_dwordx4 v[136:139], v113, s[4:7], s56 offen sc1
s_waitcnt vmcnt(0)
s_barrier
s_branch L_f0b_23
L_t1_end_19:
s_waitcnt lgkmcnt(0)
v_mfma_f32_16x16x32_bf16 v[40:43], a[204:207], v[72:75], v[40:43]
v_mfma_f32_16x16x32_bf16 v[48:51], a[208:211], v[72:75], v[48:51]
v_mfma_f32_16x16x32_bf16 v[56:59], v[72:75], a[212:215], v[56:59]
v_mfma_f32_16x16x32_bf16 v[44:47], a[204:207], v[76:79], v[44:47]
v_mfma_f32_16x16x32_bf16 v[52:55], a[208:211], v[76:79], v[52:55]
v_mfma_f32_16x16x32_bf16 v[60:63], v[76:79], a[212:215], v[60:63]
v_mfma_f32_16x16x32_bf16 v[40:43], a[216:219], v[80:83], v[40:43]
v_mfma_f32_16x16x32_bf16 v[48:51], a[220:223], v[80:83], v[48:51]
v_mfma_f32_16x16x32_bf16 v[56:59], v[80:83], a[224:227], v[56:59]
v_mfma_f32_16x16x32_bf16 v[44:47], a[216:219], v[84:87], v[44:47]
v_mfma_f32_16x16x32_bf16 v[52:55], a[220:223], v[84:87], v[52:55]
v_mfma_f32_16x16x32_bf16 v[60:63], v[84:87], a[224:227], v[60:63]
v_mfma_f32_16x16x32_bf16 v[40:43], a[228:231], v[88:91], v[40:43]
v_mfma_f32_16x16x32_bf16 v[48:51], a[232:235], v[88:91], v[48:51]
v_mfma_f32_16x16x32_bf16 v[56:59], v[88:91], a[236:239], v[56:59]
v_mfma_f32_16x16x32_bf16 v[44:47], a[228:231], v[92:95], v[44:47]
v_mfma_f32_16x16x32_bf16 v[52:55], a[232:235], v[92:95], v[52:55]
v_mfma_f32_16x16x32_bf16 v[60:63], v[92:95], a[236:239], v[60:63]
s_nop 2
v_cvt_pk_bf16_f32 v128, v40, v41
v_cvt_pk_bf16_f32 v129, v42, v43
v_cvt_pk_bf16_f32 v130, v48, v49
v_cvt_pk_bf16_f32 v131, v50, v51
buffer_store_dwordx4 v[128:131], v112, s[4:7], s56 offen offset:0 sc1
v_cvt_pk_bf16_f32 v132, v44, v45
v_cvt_pk_bf16_f32 v133, v46, v47
v_cvt_pk_bf16_f32 v134, v52, v53
v_cvt_pk_bf16_f32 v135, v54, v55
buffer_store_dwordx4 v[132:135], v112, s[4:7], s56 offen offset:256 sc1
v_cvt_pk_bf16_f32 v136, v56, v57
v_cvt_pk_bf16_f32 v137, v58, v59
v_cvt_pk_bf16_f32 v138, v60, v61
v_cvt_pk_bf16_f32 v139, v62, v63
buffer_store_dwordx4 v[136:139], v113, s[4:7], s56 offen sc1
s_waitcnt vmcnt(0)
s_barrier
s_lshr_b32 s49, s61, 0
s_add_u32 s49, s49, 2
v_mov_b32 v122, s49
buffer_store_dword v122, v120, s[4:7], 0 offen sc1
s_branch L_t3
L_gb:
s_waitcnt vmcnt(0)
s_barrier
s_cmp_lg_u32 s44, 0
s_cbranch_scc1 L_da_25
v_mov_b32 v2, 32
v_mov_b32 v3, 1
s_mov_b64 exec, 1
global_atomic_add v2, v3, s[40:41] sc1
s_mov_b64 exec, -1
L_da_25:
v_mov_b32 v122, 32
s_cmp_lg_u32 s44, 0
s_cbranch_scc1 L_pdx_27
s_mov_b32 s53, 0
L_pd_26:
global_load_dword v123, v122, s[40:41] sc1
s_add_u32 s53, s53, 1
s_cmp_gt_u32 s53, 100000
s_cbranch_scc1 L_pdx_27
s_waitcnt vmcnt(0)
v_readfirstlane_b32 s48, v123
s_cmp_ge_u32 s48, 64
s_cbranch_scc1 L_pdx_27
s_sleep 16
s_branch L_pd_26
L_pdx_27:
s_waitcnt vmcnt(0)
s_barrier
s_and_b32 s48, s45, 63
s_lshl_b32 s48, s48, 7
s_add_u32 s48, s48, 0
v_mov_b32 v122, s48
s_cmp_lg_u32 s44, 0
s_cbranch_scc1 L_pdx_29
s_mov_b32 s53, 0
L_pd_28:
buffer_load_dword v123, v122, s[4:7], 0 offen sc1
s_add_u32 s53, s53, 1
s_cmp_gt_u32 s53, 100000
s_cbranch_scc1 L_pdx_29
s_waitcnt vmcnt(0)
v_readfirstlane_b32 s48, v123
s_cmp_ge_u32 s48, 6
s_cbranch_scc1 L_pdx_29
s_sleep 16
s_branch L_pd_28
L_pdx_29:
s_waitcnt vmcnt(0)
s_barrier
s_sub_u32 s54, s45, 96
s_lshr_b32 s51, s54, 3
s_and_b32 s52, s54, 7
s_cmp_lt_u32 s52, 5
s_cbranch_scc1 L_bt2_30
s_mul_i32 s51, s51, 3
s_add_u32 s51, s51, s52
s_sub_u32 s51, s51, 5
v_lshlrev_b32 v2, 4, v0
v_mov_b32 v4, -1
v_mov_b32 v5, -1
v_mov_b32 v6, -1
v_mov_b32 v7, -1
s_mov_b32 s48, s51
L_bf_31:
s_cmp_ge_u32 s48, 384
s_cbranch_scc1 L_bfx_32
s_lshl_b32 s49, s48, 12
s_add_u32 s49, s49, 141033472
buffer_store_dwordx4 v[4:7], v2, s[4:7], s49 offen sc1
s_add_u32 s48, s48, 12
s_sleep 6
s_branch L_bf_31
L_bfx_32:
s_mov_b32 s48, s51
L_bf_33:
s_cmp_ge_u32 s48, 720
s_cbranch_scc1 L_bfx_34
s_lshl_b32 s49, s48, 12
s_add_u32 s49, s49, 234881024
buffer_store_dwordx4 v[4:7], v2, s[4:7], s49 offen sc1
s_add_u32 s48, s48, 12
s_sleep 6
s_branch L_bf_33
L_bfx_34:
s_branch L_b2_24
L_bt2_30:
s_mul_i32 s51, s51, 5
s_add_u32 s51, s51, s52
s_mul_i32 s77, s51, 6554
s_lshr_b32 s77, s77, 16
s_mul_i32 s48, s77, 10
s_sub_u32 s76, s51, s48
s_mov_b32 s8, s32
s_mov_b32 s9, s33
s_mov_b32 s10, 2457600
s_mov_b32 s11, 0x20000
s_mov_b32 s72, s16
s_mov_b32 s73, s17
s_mov_b32 s74, 2621440
s_mov_b32 s75, 0x20000
s_cmp_lt_u32 s76, 5
s_mov_b32 s48, 1051011932
s_cselect_b32 s66, s48, 1.0
s_mov_b32 s67, s66
s_mov_b32 s48, 171966464
s_cselect_b32 s78, 167772160, s48
s_cselect_b32 s79, 0, 160
v_lshrrev_b32 v122, 4, v1
v_mul_u32_u24 v122, 3840, v122
v_and_b32 v128, 15, v1
v_lshl_add_u32 v128, v128, 4, v122
v_lshrrev_b32 v122, 3, v1
v_mul_u32_u24 v122, 3840, v122
v_and_b32 v131, 7, v1
v_lshl_add_u32 v131, v131, 4, v122
s_mul_i32 s48, s44, 30720
s_lshl_b32 s62, s76, 8
s_add_u32 s62, s62, s48
s_lshl_b32 s63, s76, 7
s_add_u32 s63, s63, s48
s_add_u32 s63, s63, 2560
s_lshl_b32 s48, s44, 6
s_add_u32 s48, s48, 81920
v_lshrrev_b32 v122, 4, v1
v_lshlrev_b32 v122, 3, v122
v_bfe_u32 v123, v1, 2, 2
v_add_u32 v122, v122, v123
v_and_b32 v123, 3, v1
v_lshlrev_b32 v122, 8, v122
v_lshl_add_u32 v122, v123, 3, v122
v_add_u32 v129, s48, v122
s_lshl_b32 s48, s44, 5
s_add_u32 s48, s48, 90112
v_lshrrev_b32 v122, 4, v1
v_lshlrev_b32 v122, 3, v122
v_bfe_u32 v123, v1, 2, 2
v_add_u32 v122, v122, v123
v_and_b32 v123, 3, v1
v_lshlrev_b32 v122, 7, v122
v_lshl_add_u32 v122, v123, 3, v122
v_add_u32 v130, s48, v122
v_and_b32 v126, 15, v1
v_lshrrev_b32 v127, 4, v1
s_lshl_b32 s48, s76, 5
s_lshl_b32 s49, s44, 3
s_add_u32 s48, s48, s49
s_add_u32 s48, s48, 0
s_sub_u32 s48, s48, s79
v_add_u32 v122, s48, v127
v_mul_u32_u24 v123, 13108, v122
v_lshrrev_b32 v123, 16, v123
v_mul_u32_u24 v124, 5, v123
v_sub_u32 v122, v122, v124
v_mul_u32_u24 v123, 81920, v123
v_lshrrev_b32 v124, 1, v122
v_lshl_add_u32 v123, v124, 9, v123
v_and_b32 v124, 1, v122
v_lshl_add_u32 v123, v124, 3, v123
v_add_u32 v123, s78, v123
v_cmp_eq_u32 vcc, 4, v122
v_mov_b32 v124, 4
s_nop 0
v_cndmask_b32 v124, v124, 3, vcc
v_mov_b32 v125, 3
v_cndmask_b32 v124, v124, v125, vcc
v_lshrrev_b32 v122, 3, v126
v_lshlrev_b32 v122, 4, v122
v_and_or_b32 v122, v126, 7, v122
v_lshlrev_b32 v125, v124, v122
v_add_u32 v112, v123, v125
v_add_u32 v122, 8, v122
v_lshlrev_b32 v125, v124, v122
v_add_u32 v113, v123, v125
s_lshl_b32 s48, s76, 5
s_lshl_b32 s49, s44, 3
s_add_u32 s48, s48, s49
s_add_u32 s48, s48, 4
s_sub_u32 s48, s48, s79
v_add_u32 v122, s48, v127
v_mul_u32_u24 v123, 13108, v122
v_lshrrev_b32 v123, 16, v123
v_mul_u32_u24 v124, 5, v123
v_sub_u32 v122, v122, v124
v_mul_u32_u24 v123, 81920, v123
v_lshrrev_b32 v124, 1, v122
v_lshl_add_u32 v123, v124, 9, v123
v_and_b32 v124, 1, v122
v_lshl_add_u32 v123, v124, 3, v123
v_add_u32 v123, s78, v123
v_cmp_eq_u32 vcc, 4, v122
v_mov_b32 v124, 4
s_nop 0
v_cndmask_b32 v124, v124, 3, vcc
v_mov_b32 v125, 3
v_cndmask_b32 v124, v124, v125, vcc
v_lshrrev_b32 v122, 3, v126
v_lshlrev_b32 v122, 4, v122
v_and_or_b32 v122, v126, 7, v122
v_lshlrev_b32 v125, v124, v122
v_add_u32 v114, v123, v125
v_add_u32 v122, 8, v122
v_lshlrev_b32 v125, v124, v122
v_add_u32 v115, v123, v125
s_lshl_b32 s48, s76, 6
s_lshl_b32 s49, s44, 4
s_add_u32 s48, s48, s49
v_add_u32 v122, s48, v126
v_mul_u32_u24 v123, 3277, v122
v_lshrrev_b32 v123, 16, v123
v_mul_u32_u24 v124, 20, v123
v_sub_u32 v122, v122, v124
v_mul_u32_u24 v123, 81920, v123
v_lshl_add_u32 v122, v122, 4, v123
v_mul_u32_u24 v123, 320, v127
v_add_u32 v122, v122, v123
v_add_u32 v116, 176160768, v122
s_mul_i32 s48, s77, 32
s_mul_i32 s55, s48, 40960
s_mul_i32 s59, s48, 1280
s_mov_b32 s60, 1280
s_mov_b32 s61, 32
s_mul_i32 s48, s44, 640
s_add_u32 s48, s48, 0
v_add_u32 v122, s48, v1
v_mul_u32_u24 v123, 52429, v122
v_lshrrev_b32 v123, 22, v123
v_mul_u32_u24 v124, 80, v123
v_sub_u32 v124, v122, v124
v_lshrrev_b32 v125, 4, v123
v_lshlrev_b32 v125, 3, v125
v_and_or_b32 v125, v123, 7, v125
v_xor_b32 v124, v124, v125
v_mul_u32_u24 v123, 1280, v123
v_lshl_add_u32 v100, v124, 4, v123
s_mul_i32 s48, s44, 640
s_add_u32 s48, s48, 64
v_add_u32 v122, s48, v1
v_mul_u32_u24 v123, 52429, v122
v_lshrrev_b32 v123, 22, v123
v_mul_u32_u24 v124, 80, v123
v_sub_u32 v124, v122, v124
v_lshrrev_b32 v125, 4, v123
v_lshlrev_b32 v125, 3, v125
v_and_or_b32 v125, v123, 7, v125
v_xor_b32 v124, v124, v125
v_mul_u32_u24 v123, 1280, v123
v_lshl_add_u32 v101, v124, 4, v123
s_mul_i32 s48, s44, 640
s_add_u32 s48, s48, 128
v_add_u32 v122, s48, v1
v_mul_u32_u24 v123, 52429, v122
v_lshrrev_b32 v123, 22, v123
v_mul_u32_u24 v124, 80, v123
v_sub_u32 v124, v122, v124
v_lshrrev_b32 v125, 4, v123
v_lshlrev_b32 v125, 3, v125
v_and_or_b32 v125, v123, 7, v125
v_xor_b32 v124, v124, v125
v_mul_u32_u24 v123, 1280, v123
v_lshl_add_u32 v102, v124, 4, v123
s_mul_i32 s48, s44, 640
s_add_u32 s48, s48, 192
v_add_u32 v122, s48, v1
v_mul_u32_u24 v123, 52429, v122
v_lshrrev_b32 v123, 22, v123
v_mul_u32_u24 v124, 80, v123
v_sub_u32 v124, v122, v124
v_lshrrev_b32 v125, 4, v123
v_lshlrev_b32 v125, 3, v125
v_and_or_b32 v125, v123, 7, v125
v_xor_b32 v124, v124, v125
v_mul_u32_u24 v123, 1280, v123
v_lshl_add_u32 v103, v124, 4, v123
s_mul_i32 s48, s44, 640
s_add_u32 s48, s48, 256
v_add_u32 v122, s48, v1
v_mul_u32_u24 v123, 52429, v122
v_lshrrev_b32 v123, 22, v123
v_mul_u32_u24 v124, 80, v123
v_sub_u32 v124, v122, v124
v_lshrrev_b32 v125, 4, v123
v_lshlrev_b32 v125, 3, v125
v_and_or_b32 v125, v123, 7, v125
v_xor_b32 v124, v124, v125
v_mul_u32_u24 v123, 1280, v123
v_lshl_add_u32 v104, v124, 4, v123
s_mul_i32 s48, s44, 640
s_add_u32 s48, s48, 320
v_add_u32 v122, s48, v1
v_mul_u32_u24 v123, 52429, v122
v_lshrrev_b32 v123, 22, v123
v_mul_u32_u24 v124, 80, v123
v_sub_u32 v124, v122, v124
v_lshrrev_b32 v125, 4, v123
v_lshlrev_b32 v125, 3, v125
v_and_or_b32 v125, v123, 7, v125
v_xor_b32 v124, v124, v125
v_mul_u32_u24 v123, 1280, v123
v_lshl_add_u32 v105, v124, 4, v123
s_mul_i32 s48, s44, 640
s_add_u32 s48, s48, 384
v_add_u32 v122, s48, v1
v_mul_u32_u24 v123, 52429, v122
v_lshrrev_b32 v123, 22, v123
v_mul_u32_u24 v124, 80, v123
v_sub_u32 v124, v122, v124
v_lshrrev_b32 v125, 4, v123
v_lshlrev_b32 v125, 3, v125
v_and_or_b32 v125, v123, 7, v125
v_xor_b32 v124, v124, v125
v_mul_u32_u24 v123, 1280, v123
v_lshl_add_u32 v106, v124, 4, v123
s_mul_i32 s48, s44, 640
s_add_u32 s48, s48, 448
v_add_u32 v122, s48, v1
v_mul_u32_u24 v123, 52429, v122
v_lshrrev_b32 v123, 22, v123
v_mul_u32_u24 v124, 80, v123
v_sub_u32 v124, v122, v124
v_lshrrev_b32 v125, 4, v123
v_lshlrev_b32 v125, 3, v125
v_and_or_b32 v125, v123, 7, v125
v_xor_b32 v124, v124, v125
v_mul_u32_u24 v123, 1280, v123
v_lshl_add_u32 v107, v124, 4, v123
s_mul_i32 s48, s44, 640
s_add_u32 s48, s48, 512
v_add_u32 v122, s48, v1
v_mul_u32_u24 v123, 52429, v122
v_lshrrev_b32 v123, 22, v123
v_mul_u32_u24 v124, 80, v123
v_sub_u32 v124, v122, v124
v_lshrrev_b32 v125, 4, v123
v_lshlrev_b32 v125, 3, v125
v_and_or_b32 v125, v123, 7, v125
v_xor_b32 v124, v124, v125
v_mul_u32_u24 v123, 1280, v123
v_lshl_add_u32 v108, v124, 4, v123
s_mul_i32 s48, s44, 640
s_add_u32 s48, s48, 576
v_add_u32 v122, s48, v1
v_mul_u32_u24 v123, 52429, v122
v_lshrrev_b32 v123, 22, v123
v_mul_u32_u24 v124, 80, v123
v_sub_u32 v124, v122, v124
v_lshrrev_b32 v125, 4, v123
v_lshlrev_b32 v125, 3, v125
v_and_or_b32 v125, v123, 7, v125
v_xor_b32 v124, v124, v125
v_mul_u32_u24 v123, 1280, v123
v_lshl_add_u32 v109, v124, 4, v123
v_and_b32 v122, 15, v1
v_lshrrev_b32 v123, 4, v1
v_xor_b32 v123, v123, v122
v_lshrrev_b32 v124, 3, v122
v_lshlrev_b32 v124, 4, v124
v_and_or_b32 v122, v122, 7, v124
v_mul_u32_u24 v122, 1280, v122
v_xor_b32 v124, 0, v123
v_lshl_add_u32 v96, v124, 4, v122
v_xor_b32 v124, 4, v123
v_lshl_add_u32 v97, v124, 4, v122
v_xor_b32 v124, 8, v123
v_lshl_add_u32 v98, v124, 4, v122
v_xor_b32 v124, 12, v123
v_lshl_add_u32 v99, v124, 4, v122
s_mul_i32 s50, s44, 2048
s_add_u32 m0, s50, 81920
s_add_u32 s49, s62, 0
buffer_load_dwordx4 v128, s[8:11], s49 offen nt lds
s_mul_i32 s50, s44, 2048
s_add_u32 m0, s50, 82944
s_add_u32 s49, s62, 15360
buffer_load_dwordx4 v128, s[8:11], s49 offen nt lds
s_mul_i32 s50, s44, 1024
s_add_u32 m0, s50, 90112
s_add_u32 s49, s63, 0
buffer_load_dwordx4 v131, s[8:11], s49 offen nt lds
s_mul_i32 s50, s44, 2048
s_add_u32 m0, s50, 94208
s_add_u32 s49, s62, 122880
buffer_load_dwordx4 v128, s[8:11], s49 offen nt lds
s_mul_i32 s50, s44, 2048
s_add_u32 m0, s50, 95232
s_add_u32 s49, s62, 138240
buffer_load_dwordx4 v128, s[8:11], s49 offen nt lds
s_mul_i32 s50, s44, 1024
s_add_u32 m0, s50, 102400
s_add_u32 s49, s63, 122880
buffer_load_dwordx4 v131, s[8:11], s49 offen nt lds
s_mul_i32 s50, s44, 2048
s_add_u32 m0, s50, 106496
s_add_u32 s49, s62, 245760
buffer_load_dwordx4 v128, s[8:11], s49 offen nt lds
s_mul_i32 s50, s44, 2048
s_add_u32 m0, s50, 107520
s_add_u32 s49, s62, 261120
buffer_load_dwordx4 v128, s[8:11], s49 offen nt lds
s_mul_i32 s50, s44, 1024
s_add_u32 m0, s50, 114688
s_add_u32 s49, s63, 245760
buffer_load_dwordx4 v131, s[8:11], s49 offen nt lds
s_mul_i32 s50, s44, 2048
s_add_u32 m0, s50, 118784
s_add_u32 s49, s62, 368640
buffer_load_dwordx4 v128, s[8:11], s49 offen nt lds
s_mul_i32 s50, s44, 2048
s_add_u32 m0, s50, 119808
s_add_u32 s49, s62, 384000
buffer_load_dwordx4 v128, s[8:11], s49 offen nt lds
s_mul_i32 s50, s44, 1024
s_add_u32 m0, s50, 126976
s_add_u32 s49, s63, 368640
buffer_load_dwordx4 v131, s[8:11], s49 offen nt lds
s_mul_i32 s57, s44, 10240
s_mov_b32 s58, 0
s_mov_b32 s56, 1879048192
s_mov_b32 s54, -2
s_mov_b32 s64, 40960
s_add_u32 m0, s57, 0
s_nop 0
buffer_load_dwordx4 v100, s[72:75], s55 offen  lds
s_add_u32 m0, s57, 1024
s_nop 0
buffer_load_dwordx4 v101, s[72:75], s55 offen  lds
s_add_u32 m0, s57, 2048
s_nop 0
buffer_load_dwordx4 v102, s[72:75], s55 offen  lds
s_add_u32 m0, s57, 3072
s_nop 0
buffer_load_dwordx4 v103, s[72:75], s55 offen  lds
s_add_u32 m0, s57, 4096
s_nop 0
buffer_load_dwordx4 v104, s[72:75], s55 offen  lds
s_add_u32 m0, s57, 5120
s_nop 0
buffer_load_dwordx4 v105, s[72:75], s55 offen  lds
s_add_u32 m0, s57, 6144
s_nop 0
buffer_load_dwordx4 v106, s[72:75], s55 offen  lds
s_add_u32 m0, s57, 7168
s_nop 0
buffer_load_dwordx4 v107, s[72:75], s55 offen  lds
s_add_u32 m0, s57, 8192
s_nop 0
buffer_load_dwordx4 v108, s[72:75], s55 offen  lds
s_add_u32 m0, s57, 9216
s_nop 0
buffer_load_dwordx4 v109, s[72:75], s55 offen  lds
s_add_u32 s55, s55, 40960
s_add_u32 s57, s57, 40960
s_cmp_ge_u32 s57, 122880
s_cselect_b32 s49, 122880, 0
s_sub_u32 s57, s57, s49
s_add_u32 s54, s54, 1
s_add_u32 m0, s57, 0
s_nop 0
buffer_load_dwordx4 v100, s[72:75], s55 offen  lds
s_add_u32 m0, s57, 1024
s_nop 0
buffer_load_dwordx4 v101, s[72:75], s55 offen  lds
s_add_u32 m0, s57, 2048
s_nop 0
buffer_load_dwordx4 v102, s[72:75], s55 offen  lds
s_add_u32 m0, s57, 3072
s_nop 0
buffer_load_dwordx4 v103, s[72:75], s55 offen  lds
s_add_u32 m0, s57, 4096
s_nop 0
buffer_load_dwordx4 v104, s[72:75], s55 offen  lds
s_add_u32 m0, s57, 5120
s_nop 0
buffer_load_dwordx4 v105, s[72:75], s55 offen  lds
s_add_u32 m0, s57, 6144
s_nop 0
buffer_load_dwordx4 v106, s[72:75], s55 offen  lds
s_add_u32 m0, s57, 7168
s_nop 0
buffer_load_dwordx4 v107, s[72:75], s55 offen  lds
s_add_u32 m0, s57, 8192
s_nop 0
buffer_load_dwordx4 v108, s[72:75], s55 offen  lds
s_add_u32 m0, s57, 9216
s_nop 0
buffer_load_dwordx4 v109, s[72:75], s55 offen  lds
s_add_u32 s55, s55, 40960
s_add_u32 s57, s57, 40960
s_cmp_ge_u32 s57, 122880
s_cselect_b32 s49, 122880, 0
s_sub_u32 s57, s57, s49
s_add_u32 s54, s54, 1
s_waitcnt vmcnt(29) lgkmcnt(0)
s_barrier
s_mul_i32 s50, s44, 2048
s_add_u32 m0, s50, 131072
s_add_u32 s49, s62, 491520
buffer_load_dwordx4 v128, s[8:11], s49 offen nt lds
s_mul_i32 s50, s44, 2048
s_add_u32 m0, s50, 132096
s_add_u32 s49, s62, 506880
buffer_load_dwordx4 v128, s[8:11], s49 offen nt lds
s_mul_i32 s50, s44, 1024
s_add_u32 m0, s50, 139264
s_add_u32 s49, s63, 491520
buffer_load_dwordx4 v131, s[8:11], s49 offen nt lds
ds_read_b64_tr_b16 a[0:1], v129 offset:0
ds_read_b64_tr_b16 a[2:3], v129 offset:1024
ds_read_b64_tr_b16 a[4:5], v129 offset:32
ds_read_b64_tr_b16 a[6:7], v129 offset:1056
ds_read_b64_tr_b16 a[8:9], v130 offset:0
ds_read_b64_tr_b16 a[10:11], v130 offset:512
s_waitcnt vmcnt(29) lgkmcnt(0)
s_barrier
s_mul_i32 s50, s44, 2048
s_add_u32 m0, s50, 81920
s_add_u32 s49, s62, 614400
buffer_load_dwordx4 v128, s[8:11], s49 offen nt lds
s_mul_i32 s50, s44, 2048
s_add_u32 m0, s50, 82944
s_add_u32 s49, s62, 629760
buffer_load_dwordx4 v128, s[8:11], s49 offen nt lds
s_mul_i32 s50, s44, 1024
s_add_u32 m0, s50, 90112
s_add_u32 s49, s63, 614400
buffer_load_dwordx4 v131, s[8:11], s49 offen nt lds
ds_read_b64_tr_b16 a[12:13], v129 offset:12288
ds_read_b64_tr_b16 a[14:15], v129 offset:13312
ds_read_b64_tr_b16 a[16:17], v129 offset:12320
ds_read_b64_tr_b16 a[18:19], v129 offset:13344
ds_read_b64_tr_b16 a[20:21], v130 offset:12288
ds_read_b64_tr_b16 a[22:23], v130 offset:12800
s_waitcnt vmcnt(29) lgkmcnt(0)
s_barrier
s_mul_i32 s50, s44, 2048
s_add_u32 m0, s50, 94208
s_add_u32 s49, s62, 737280
buffer_load_dwordx4 v128, s[8:11], s49 offen nt lds
s_mul_i32 s50, s44, 2048
s_add_u32 m0, s50, 95232
s_add_u32 s49, s62, 752640
buffer_load_dwordx4 v128, s[8:11], s49 offen nt lds
s_mul_i32 s50, s44, 1024
s_add_u32 m0, s50, 102400
s_add_u32 s49, s63, 737280
buffer_load_dwordx4 v131, s[8:11], s49 offen nt lds
ds_read_b64_tr_b16 a[24:25], v129 offset:24576
ds_read_b64_tr_b16 a[26:27], v129 offset:25600
ds_read_b64_tr_b16 a[28:29], v129 offset:24608
ds_read_b64_tr_b16 a[30:31], v129 offset:25632
ds_read_b64_tr_b16 a[32:33], v130 offset:24576
ds_read_b64_tr_b16 a[34:35], v130 offset:25088
s_waitcnt vmcnt(29) lgkmcnt(0)
s_barrier
s_mul_i32 s50, s44, 2048
s_add_u32 m0, s50, 106496
s_add_u32 s49, s62, 860160
buffer_load_dwordx4 v128, s[8:11], s49 offen nt lds
s_mul_i32 s50, s44, 2048
s_add_u32 m0, s50, 107520
s_add_u32 s49, s62, 875520
buffer_load_dwordx4 v128, s[8:11], s49 offen nt lds
s_mul_i32 s50, s44, 1024
s_add_u32 m0, s50, 114688
s_add_u32 s49, s63, 860160
buffer_load_dwordx4 v131, s[8:11], s49 offen nt lds
ds_read_b64_tr_b16 a[36:37], v129 offset:36864
ds_read_b64_tr_b16 a[38:39], v129 offset:37888
ds_read_b64_tr_b16 a[40:41], v129 offset:36896
ds_read_b64_tr_b16 a[42:43], v129 offset:37920
ds_read_b64_tr_b16 a[44:45], v130 offset:36864
ds_read_b64_tr_b16 a[46:47], v130 offset:37376
s_waitcnt vmcnt(9) lgkmcnt(0)
s_barrier
s_mul_i32 s50, s44, 2048
s_add_u32 m0, s50, 118784
s_add_u32 s49, s62, 983040
buffer_load_dwordx4 v128, s[8:11], s49 offen nt lds
s_mul_i32 s50, s44, 2048
s_add_u32 m0, s50, 119808
s_add_u32 s49, s62, 998400
buffer_load_dwordx4 v128, s[8:11], s49 offen nt lds
s_mul_i32 s50, s44, 1024
s_add_u32 m0, s50, 126976
s_add_u32 s49, s63, 983040
buffer_load_dwordx4 v131, s[8:11], s49 offen nt lds
ds_read_b64_tr_b16 a[48:49], v129 offset:49152
ds_read_b64_tr_b16 a[50:51], v129 offset:50176
ds_read_b64_tr_b16 a[52:53], v129 offset:49184
ds_read_b64_tr_b16 a[54:55], v129 offset:50208
ds_read_b64_tr_b16 a[56:57], v130 offset:49152
ds_read_b64_tr_b16 a[58:59], v130 offset:49664
s_waitcnt vmcnt(9) lgkmcnt(0)
s_barrier
s_mul_i32 s50, s44, 2048
s_add_u32 m0, s50, 131072
s_add_u32 s49, s62, 1105920
buffer_load_dwordx4 v128, s[8:11], s49 offen nt lds
s_mul_i32 s50, s44, 2048
s_add_u32 m0, s50, 132096
s_add_u32 s49, s62, 1121280
buffer_load_dwordx4 v128, s[8:11], s49 offen nt lds
s_mul_i32 s50, s44, 1024
s_add_u32 m0, s50, 139264
s_add_u32 s49, s63, 1105920
buffer_load_dwordx4 v131, s[8:11], s49 offen nt lds
ds_read_b64_tr_b16 a[60:61], v129 offset:0
ds_read_b64_tr_b16 a[62:63], v129 offset:1024
ds_read_b64_tr_b16 a[64:65], v129 offset:32
ds_read_b64_tr_b16 a[66:67], v129 offset:1056
ds_read_b64_tr_b16 a[68:69], v130 offset:0
ds_read_b64_tr_b16 a[70:71], v130 offset:512
s_waitcnt vmcnt(9) lgkmcnt(0)
s_barrier
s_mul_i32 s50, s44, 2048
s_add_u32 m0, s50, 81920
s_add_u32 s49, s62, 1228800
buffer_load_dwordx4 v128, s[8:11], s49 offen nt lds
s_mul_i32 s50, s44, 2048
s_add_u32 m0, s50, 82944
s_add_u32 s49, s62, 1244160
buffer_load_dwordx4 v128, s[8:11], s49 offen nt lds
s_mul_i32 s50, s44, 1024
s_add_u32 m0, s50, 90112
s_add_u32 s49, s63, 1228800
buffer_load_dwordx4 v131, s[8:11], s49 offen nt lds
ds_read_b64_tr_b16 a[72:73], v129 offset:12288
ds_read_b64_tr_b16 a[74:75], v129 offset:13312
ds_read_b64_tr_b16 a[76:77], v129 offset:12320
ds_read_b64_tr_b16 a[78:79], v129 offset:13344
ds_read_b64_tr_b16 a[80:81], v130 offset:12288
ds_read_b64_tr_b16 a[82:83], v130 offset:12800
s_waitcnt vmcnt(9) lgkmcnt(0)
s_barrier
s_mul_i32 s50, s44, 2048
s_add_u32 m0, s50, 94208
s_add_u32 s49, s62, 1351680
buffer_load_dwordx4 v128, s[8:11], s49 offen nt lds
s_mul_i32 s50, s44, 2048
s_add_u32 m0, s50, 95232
s_add_u32 s49, s62, 1367040
buffer_load_dwordx4 v128, s[8:11], s49 offen nt lds
s_mul_i32 s50, s44, 1024
s_add_u32 m0, s50, 102400
s_add_u32 s49, s63, 1351680
buffer_load_dwordx4 v131, s[8:11], s49 offen nt lds
ds_read_b64_tr_b16 a[84:85], v129 offset:24576
ds_read_b64_tr_b16 a[86:87], v129 offset:25600
ds_read_b64_tr_b16 a[88:89], v129 offset:24608
ds_read_b64_tr_b16 a[90:91], v129 offset:25632
ds_read_b64_tr_b16 a[92:93], v130 offset:24576
ds_read_b64_tr_b16 a[94:95], v130 offset:25088
s_waitcnt vmcnt(9) lgkmcnt(0)
s_barrier
s_mul_i32 s50, s44, 2048
s_add_u32 m0, s50, 106496
s_add_u32 s49, s62, 1474560
buffer_load_dwordx4 v128, s[8:11], s49 offen nt lds
s_mul_i32 s50, s44, 2048
s_add_u32 m0, s50, 107520
s_add_u32 s49, s62, 1489920
buffer_load_dwordx4 v128, s[8:11], s49 offen nt lds
s_mul_i32 s50, s44, 1024
s_add_u32 m0, s50, 114688
s_add_u32 s49, s63, 1474560
buffer_load_dwordx4 v131, s[8:11], s49 offen nt lds
ds_read_b64_tr_b16 a[96:97], v129 offset:36864
ds_read_b64_tr_b16 a[98:99], v129 offset:37888
ds_read_b64_tr_b16 a[100:101], v129 offset:36896
ds_read_b64_tr_b16 a[102:103], v129 offset:37920
ds_read_b64_tr_b16 a[104:105], v130 offset:36864
ds_read_b64_tr_b16 a[106:107], v130 offset:37376
s_waitcnt vmcnt(9) lgkmcnt(0)
s_barrier
s_mul_i32 s50, s44, 2048
s_add_u32 m0, s50, 118784
s_add_u32 s49, s62, 1597440
buffer_load_dwordx4 v128, s[8:11], s49 offen nt lds
s_mul_i32 s50, s44, 2048
s_add_u32 m0, s50, 119808
s_add_u32 s49, s62, 1612800
buffer_load_dwordx4 v128, s[8:11], s49 offen nt lds
s_mul_i32 s50, s44, 1024
s_add_u32 m0, s50, 126976
s_add_u32 s49, s63, 1597440
buffer_load_dwordx4 v131, s[8:11], s49 offen nt lds
ds_read_b64_tr_b16 a[108:109], v129 offset:49152
ds_read_b64_tr_b16 a[110:111], v129 offset:50176
ds_read_b64_tr_b16 a[112:113], v129 offset:49184
ds_read_b64_tr_b16 a[114:115], v129 offset:50208
ds_read_b64_tr_b16 a[116:117], v130 offset:49152
ds_read_b64_tr_b16 a[118:119], v130 offset:49664
s_waitcnt vmcnt(9) lgkmcnt(0)
s_barrier
s_mul_i32 s50, s44, 2048
s_add_u32 m0, s50, 131072
s_add_u32 s49, s62, 1720320
buffer_load_dwordx4 v128, s[8:11], s49 offen nt lds
s_mul_i32 s50, s44, 2048
s_add_u32 m0, s50, 132096
s_add_u32 s49, s62, 1735680
buffer_load_dwordx4 v128, s[8:11], s49 offen nt lds
s_mul_i32 s50, s44, 1024
s_add_u32 m0, s50, 139264
s_add_u32 s49, s63, 1720320
buffer_load_dwordx4 v131, s[8:11], s49 offen nt lds
ds_read_b64_tr_b16 a[120:121], v129 offset:0
ds_read_b64_tr_b16 a[122:123], v129 offset:1024
ds_read_b64_tr_b16 a[124:125], v129 offset:32
ds_read_b64_tr_b16 a[126:127], v129 offset:1056
ds_read_b64_tr_b16 a[128:129], v130 offset:0
ds_read_b64_tr_b16 a[130:131], v130 offset:512
s_waitcnt vmcnt(9) lgkmcnt(0)
s_barrier
s_mul_i32 s50, s44, 2048
s_add_u32 m0, s50, 81920
s_add_u32 s49, s62, 1843200
buffer_load_dwordx4 v128, s[8:11], s49 offen nt lds
s_mul_i32 s50, s44, 2048
s_add_u32 m0, s50, 82944
s_add_u32 s49, s62, 1858560
buffer_load_dwordx4 v128, s[8:11], s49 offen nt lds
s_mul_i32 s50, s44, 1024
s_add_u32 m0, s50, 90112
s_add_u32 s49, s63, 1843200
buffer_load_dwordx4 v131, s[8:11], s49 offen nt lds
ds_read_b64_tr_b16 a[132:133], v129 offset:12288
ds_read_b64_tr_b16 a[134:135], v129 offset:13312
ds_read_b64_tr_b16 a[136:137], v129 offset:12320
ds_read_b64_tr_b16 a[138:139], v129 offset:13344
ds_read_b64_tr_b16 a[140:141], v130 offset:12288
ds_read_b64_tr_b16 a[142:143], v130 offset:12800
s_waitcnt vmcnt(9) lgkmcnt(0)
s_barrier
s_mul_i32 s50, s44, 2048
s_add_u32 m0, s50, 94208
s_add_u32 s49, s62, 1966080
buffer_load_dwordx4 v128, s[8:11], s49 offen nt lds
s_mul_i32 s50, s44, 2048
s_add_u32 m0, s50, 95232
s_add_u32 s49, s62, 1981440
buffer_load_dwordx4 v128, s[8:11], s49 offen nt lds
s_mul_i32 s50, s44, 1024
s_add_u32 m0, s50, 102400
s_add_u32 s49, s63, 1966080
buffer_load_dwordx4 v131, s[8:11], s49 offen nt lds
ds_read_b64_tr_b16 a[144:145], v129 offset:24576
ds_read_b64_tr_b16 a[146:147], v129 offset:25600
ds_read_b64_tr_b16 a[148:149], v129 offset:24608
ds_read_b64_tr_b16 a[150:151], v129 offset:25632
ds_read_b64_tr_b16 a[152:153], v130 offset:24576
ds_read_b64_tr_b16 a[154:155], v130 offset:25088
s_waitcnt vmcnt(9) lgkmcnt(0)
s_barrier
s_mul_i32 s50, s44, 2048
s_add_u32 m0, s50, 106496
s_add_u32 s49, s62, 2088960
buffer_load_dwordx4 v128, s[8:11], s49 offen nt lds
s_mul_i32 s50, s44, 2048
s_add_u32 m0, s50, 107520
s_add_u32 s49, s62, 2104320
buffer_load_dwordx4 v128, s[8:11], s49 offen nt lds
s_mul_i32 s50, s44, 1024
s_add_u32 m0, s50, 114688
s_add_u32 s49, s63, 2088960
buffer_load_dwordx4 v131, s[8:11], s49 offen nt lds
ds_read_b64_tr_b16 a[156:157], v129 offset:36864
ds_read_b64_tr_b16 a[158:159], v129 offset:37888
ds_read_b64_tr_b16 a[160:161], v129 offset:36896
ds_read_b64_tr_b16 a[162:163], v129 offset:37920
ds_read_b64_tr_b16 a[164:165], v130 offset:36864
ds_read_b64_tr_b16 a[166:167], v130 offset:37376
s_waitcnt vmcnt(9) lgkmcnt(0)
s_barrier
s_mul_i32 s50, s44, 2048
s_add_u32 m0, s50, 118784
s_add_u32 s49, s62, 2211840
buffer_load_dwordx4 v128, s[8:11], s49 offen nt lds
s_mul_i32 s50, s44, 2048
s_add_u32 m0, s50, 119808
s_add_u32 s49, s62, 2227200
buffer_load_dwordx4 v128, s[8:11], s49 offen nt lds
s_mul_i32 s50, s44, 1024
s_add_u32 m0, s50, 126976
s_add_u32 s49, s63, 2211840
buffer_load_dwordx4 v131, s[8:11], s49 offen nt lds
ds_read_b64_tr_b16 a[168:169], v129 offset:49152
ds_read_b64_tr_b16 a[170:171], v129 offset:50176
ds_read_b64_tr_b16 a[172:173], v129 offset:49184
ds_read_b64_tr_b16 a[174:175], v129 offset:50208
ds_read_b64_tr_b16 a[176:177], v130 offset:49152
ds_read_b64_tr_b16 a[178:179], v130 offset:49664
s_waitcnt vmcnt(9) lgkmcnt(0)
s_barrier
s_mul_i32 s50, s44, 2048
s_add_u32 m0, s50, 131072
s_add_u32 s49, s62, 2334720
buffer_load_dwordx4 v128, s[8:11], s49 offen nt lds
s_mul_i32 s50, s44, 2048
s_add_u32 m0, s50, 132096
s_add_u32 s49, s62, 2350080
buffer_load_dwordx4 v128, s[8:11], s49 offen nt lds
s_mul_i32 s50, s44, 1024
s_add_u32 m0, s50, 139264
s_add_u32 s49, s63, 2334720
buffer_load_dwordx4 v131, s[8:11], s49 offen nt lds
ds_read_b64_tr_b16 a[180:181], v129 offset:0
ds_read_b64_tr_b16 a[182:183], v129 offset:1024
ds_read_b64_tr_b16 a[184:185], v129 offset:32
ds_read_b64_tr_b16 a[186:187], v129 offset:1056
ds_read_b64_tr_b16 a[188:189], v130 offset:0
ds_read_b64_tr_b16 a[190:191], v130 offset:512
s_waitcnt vmcnt(9) lgkmcnt(0)
s_barrier
ds_read_b64_tr_b16 a[192:193], v129 offset:12288
ds_read_b64_tr_b16 a[194:195], v129 offset:13312
ds_read_b64_tr_b16 a[196:197], v129 offset:12320
ds_read_b64_tr_b16 a[198:199], v129 offset:13344
ds_read_b64_tr_b16 a[200:201], v130 offset:12288
ds_read_b64_tr_b16 a[202:203], v130 offset:12800
s_waitcnt vmcnt(6) lgkmcnt(0)
s_barrier
ds_read_b64_tr_b16 a[204:205], v129 offset:24576
ds_read_b64_tr_b16 a[206:207], v129 offset:25600
ds_read_b64_tr_b16 a[208:209], v129 offset:24608
ds_read_b64_tr_b16 a[210:211], v129 offset:25632
ds_read_b64_tr_b16 a[212:213], v130 offset:24576
ds_read_b64_tr_b16 a[214:215], v130 offset:25088
s_waitcnt vmcnt(3) lgkmcnt(0)
s_barrier
ds_read_b64_tr_b16 a[216:217], v129 offset:36864
ds_read_b64_tr_b16 a[218:219], v129 offset:37888
ds_read_b64_tr_b16 a[220:221], v129 offset:36896
ds_read_b64_tr_b16 a[222:223], v129 offset:37920
ds_read_b64_tr_b16 a[224:225], v130 offset:36864
ds_read_b64_tr_b16 a[226:227], v130 offset:37376
s_waitcnt vmcnt(0) lgkmcnt(0)
s_barrier
ds_read_b64_tr_b16 a[228:229], v129 offset:49152
ds_read_b64_tr_b16 a[230:231], v129 offset:50176
ds_read_b64_tr_b16 a[232:233], v129 offset:49184
ds_read_b64_tr_b16 a[234:235], v129 offset:50208
ds_read_b64_tr_b16 a[236:237], v130 offset:49152
ds_read_b64_tr_b16 a[238:239], v130 offset:49664
s_waitcnt lgkmcnt(0)
s_waitcnt vmcnt(0)
s_barrier
ds_read_b128 v[64:67], v96 offset:0
ds_read_b128 v[68:71], v96 offset:10240
ds_read_b128 v[72:75], v97 offset:0
ds_read_b128 v[76:79], v97 offset:10240
ds_read_b128 v[80:83], v98 offset:0
ds_read_b128 v[84:87], v98 offset:10240
ds_read_b128 v[88:91], v99 offset:0
ds_read_b128 v[92:95], v99 offset:10240
L_t2_loop_35:
s_waitcnt lgkmcnt(7)
v_mfma_f32_16x16x32_bf16 v[16:19], a[0:3], v[64:67], 0
s_add_u32 m0, s57, 0
v_mfma_f32_16x16x32_bf16 v[24:27], a[4:7], v[64:67], 0
buffer_load_dwordx4 v100, s[72:75], s55 offen  lds
v_mfma_f32_16x16x32_bf16 v[32:35], v[64:67], a[8:11], 0
ds_read_b128 v[64:67], v96 offset:256
s_waitcnt lgkmcnt(7)
v_mfma_f32_16x16x32_bf16 v[20:23], a[0:3], v[68:71], 0
v_mfma_f32_16x16x32_bf16 v[28:31], a[4:7], v[68:71], 0
v_mfma_f32_16x16x32_bf16 v[36:39], v[68:71], a[8:11], 0
ds_read_b128 v[68:71], v96 offset:10496
s_waitcnt lgkmcnt(7)
v_mfma_f32_16x16x32_bf16 v[16:19], a[12:15], v[72:75], v[16:19]
v_mfma_f32_16x16x32_bf16 v[24:27], a[16:19], v[72:75], v[24:27]
v_mfma_f32_16x16x32_bf16 v[32:35], v[72:75], a[20:23], v[32:35]
ds_read_b128 v[72:75], v97 offset:256
s_waitcnt lgkmcnt(7)
v_mfma_f32_16x16x32_bf16 v[20:23], a[12:15], v[76:79], v[20:23]
s_add_u32 m0, s57, 1024
v_mul_f32 v40, s66, v40
v_mfma_f32_16x16x32_bf16 v[28:31], a[16:19], v[76:79], v[28:31]
buffer_load_dwordx4 v101, s[72:75], s55 offen  lds
v_mul_f32 v41, s66, v41
v_mfma_f32_16x16x32_bf16 v[36:39], v[76:79], a[20:23], v[36:39]
ds_read_b128 v[76:79], v97 offset:10496
s_waitcnt lgkmcnt(7)
v_mfma_f32_16x16x32_bf16 v[16:19], a[24:27], v[80:83], v[16:19]
v_mul_f32 v42, s66, v42
v_mfma_f32_16x16x32_bf16 v[24:27], a[28:31], v[80:83], v[24:27]
v_mfma_f32_16x16x32_bf16 v[32:35], v[80:83], a[32:35], v[32:35]
ds_read_b128 v[80:83], v98 offset:256
s_waitcnt lgkmcnt(7)
v_mfma_f32_16x16x32_bf16 v[20:23], a[24:27], v[84:87], v[20:23]
v_mul_f32 v43, s66, v43
v_mfma_f32_16x16x32_bf16 v[28:31], a[28:31], v[84:87], v[28:31]
v_mfma_f32_16x16x32_bf16 v[36:39], v[84:87], a[32:35], v[36:39]
ds_read_b128 v[84:87], v98 offset:10496
s_waitcnt lgkmcnt(7)
v_mfma_f32_16x16x32_bf16 v[16:19], a[36:39], v[88:91], v[16:19]
s_add_u32 m0, s57, 2048
v_cvt_pk_bf16_f32 v128, v40, v41
v_mfma_f32_16x16x32_bf16 v[24:27], a[40:43], v[88:91], v[24:27]
buffer_load_dwordx4 v102, s[72:75], s55 offen  lds
v_cvt_pk_bf16_f32 v129, v42, v43
v_mfma_f32_16x16x32_bf16 v[32:35], v[88:91], a[44:47], v[32:35]
ds_read_b128 v[88:91], v99 offset:256
s_waitcnt lgkmcnt(7)
v_mfma_f32_16x16x32_bf16 v[20:23], a[36:39], v[92:95], v[20:23]
buffer_store_dwordx2 v[128:129], v112, s[4:7], s56 offen sc1
v_mfma_f32_16x16x32_bf16 v[28:31], a[40:43], v[92:95], v[28:31]
v_mfma_f32_16x16x32_bf16 v[36:39], v[92:95], a[44:47], v[36:39]
ds_read_b128 v[92:95], v99 offset:10496
s_waitcnt lgkmcnt(7)
v_mfma_f32_16x16x32_bf16 v[16:19], a[48:51], v[64:67], v[16:19]
v_mul_f32 v44, s66, v44
v_mfma_f32_16x16x32_bf16 v[24:27], a[52:55], v[64:67], v[24:27]
v_mfma_f32_16x16x32_bf16 v[32:35], v[64:67], a[56:59], v[32:35]
ds_read_b128 v[64:67], v96 offset:512
s_waitcnt lgkmcnt(7)
v_mfma_f32_16x16x32_bf16 v[20:23], a[48:51], v[68:71], v[20:23]
s_add_u32 m0, s57, 3072
v_mul_f32 v45, s66, v45
v_mfma_f32_16x16x32_bf16 v[28:31], a[52:55], v[68:71], v[28:31]
buffer_load_dwordx4 v103, s[72:75], s55 offen  lds
v_mul_f32 v46, s66, v46
v_mfma_f32_16x16x32_bf16 v[36:39], v[68:71], a[56:59], v[36:39]
ds_read_b128 v[68:71], v96 offset:10752
s_waitcnt lgkmcnt(7)
v_mfma_f32_16x16x32_bf16 v[16:19], a[60:63], v[72:75], v[16:19]
v_mul_f32 v47, s66, v47
v_mfma_f32_16x16x32_bf16 v[24:27], a[64:67], v[72:75], v[24:27]
v_mfma_f32_16x16x32_bf16 v[32:35], v[72:75], a[68:71], v[32:35]
ds_read_b128 v[72:75], v97 offset:512
s_waitcnt lgkmcnt(7)
v_mfma_f32_16x16x32_bf16 v[20:23], a[60:63], v[76:79], v[20:23]
v_cvt_pk_bf16_f32 v130, v44, v45
v_mfma_f32_16x16x32_bf16 v[28:31], a[64:67], v[76:79], v[28:31]
v_mfma_f32_16x16x32_bf16 v[36:39], v[76:79], a[68:71], v[36:39]
ds_read_b128 v[76:79], v97 offset:10752
s_waitcnt lgkmcnt(7)
v_mfma_f32_16x16x32_bf16 v[16:19], a[72:75], v[80:83], v[16:19]
s_add_u32 m0, s57, 4096
v_cvt_pk_bf16_f32 v131, v46, v47
v_mfma_f32_16x16x32_bf16 v[24:27], a[76:79], v[80:83], v[24:27]
buffer_load_dwordx4 v104, s[72:75], s55 offen  lds
v_mfma_f32_16x16x32_bf16 v[32:35], v[80:83], a[80:83], v[32:35]
ds_read_b128 v[80:83], v98 offset:512
s_waitcnt lgkmcnt(7)
v_mfma_f32_16x16x32_bf16 v[20:23], a[72:75], v[84:87], v[20:23]
buffer_store_dwordx2 v[130:131], v113, s[4:7], s56 offen sc1
v_mul_f32 v48, s66, v48
v_mfma_f32_16x16x32_bf16 v[28:31], a[76:79], v[84:87], v[28:31]
v_mfma_f32_16x16x32_bf16 v[36:39], v[84:87], a[80:83], v[36:39]
ds_read_b128 v[84:87], v98 offset:10752
s_waitcnt lgkmcnt(7)
v_mfma_f32_16x16x32_bf16 v[16:19], a[84:87], v[88:91], v[16:19]
v_mul_f32 v49, s66, v49
v_mfma_f32_16x16x32_bf16 v[24:27], a[88:91], v[88:91], v[24:27]
v_mfma_f32_16x16x32_bf16 v[32:35], v[88:91], a[92:95], v[32:35]
ds_read_b128 v[88:91], v99 offset:512
s_waitcnt lgkmcnt(7)
v_mfma_f32_16x16x32_bf16 v[20:23], a[84:87], v[92:95], v[20:23]
s_add_u32 m0, s57, 5120
v_mul_f32 v50, s66, v50
v_mfma_f32_16x16x32_bf16 v[28:31], a[88:91], v[92:95], v[28:31]
buffer_load_dwordx4 v105, s[72:75], s55 offen  lds
v_mfma_f32_16x16x32_bf16 v[36:39], v[92:95], a[92:95], v[36:39]
ds_read_b128 v[92:95], v99 offset:10752
s_waitcnt lgkmcnt(7)
v_mfma_f32_16x16x32_bf16 v[16:19], a[96:99], v[64:67], v[16:19]
v_mul_f32 v51, s66, v51
v_cvt_pk_bf16_f32 v132, v48, v49
v_mfma_f32_16x16x32_bf16 v[24:27], a[100:103], v[64:67], v[24:27]
v_mfma_f32_16x16x32_bf16 v[32:35], v[64:67], a[104:107], v[32:35]
ds_read_b128 v[64:67], v96 offset:768
s_waitcnt lgkmcnt(7)
v_mfma_f32_16x16x32_bf16 v[20:23], a[96:99], v[68:71], v[20:23]
v_cvt_pk_bf16_f32 v133, v50, v51
v_mfma_f32_16x16x32_bf16 v[28:31], a[100:103], v[68:71], v[28:31]
v_mfma_f32_16x16x32_bf16 v[36:39], v[68:71], a[104:107], v[36:39]
ds_read_b128 v[68:71], v96 offset:11008
s_waitcnt lgkmcnt(7)
v_mfma_f32_16x16x32_bf16 v[16:19], a[108:111], v[72:75], v[16:19]
s_add_u32 m0, s57, 6144
buffer_store_dwordx2 v[132:133], v114, s[4:7], s56 offen sc1
v_mfma_f32_16x16x32_bf16 v[24:27], a[112:115], v[72:75], v[24:27]
buffer_load_dwordx4 v106, s[72:75], s55 offen  lds
v_mfma_f32_16x16x32_bf16 v[32:35], v[72:75], a[116:119], v[32:35]
ds_read_b128 v[72:75], v97 offset:768
s_waitcnt lgkmcnt(7)
v_mfma_f32_16x16x32_bf16 v[20:23], a[108:111], v[76:79], v[20:23]
v_mul_f32 v52, s66, v52
v_mul_f32 v53, s66, v53
v_mfma_f32_16x16x32_bf16 v[28:31], a[112:115], v[76:79], v[28:31]
v_mfma_f32_16x16x32_bf16 v[36:39], v[76:79], a[116:119], v[36:39]
ds_read_b128 v[76:79], v97 offset:11008
s_waitcnt lgkmcnt(7)
v_mfma_f32_16x16x32_bf16 v[16:19], a[120:123], v[80:83], v[16:19]
v_mul_f32 v54, s66, v54
v_mfma_f32_16x16x32_bf16 v[24:27], a[124:127], v[80:83], v[24:27]
v_mfma_f32_16x16x32_bf16 v[32:35], v[80:83], a[128:131], v[32:35]
ds_read_b128 v[80:83], v98 offset:768
s_waitcnt lgkmcnt(7)
v_mfma_f32_16x16x32_bf16 v[20:23], a[120:123], v[84:87], v[20:23]
s_add_u32 m0, s57, 7168
v_mul_f32 v55, s66, v55
v_mfma_f32_16x16x32_bf16 v[28:31], a[124:127], v[84:87], v[28:31]
buffer_load_dwordx4 v107, s[72:75], s55 offen  lds
v_mfma_f32_16x16x32_bf16 v[36:39], v[84:87], a[128:131], v[36:39]
ds_read_b128 v[84:87], v98 offset:11008
s_waitcnt lgkmcnt(7)
v_mfma_f32_16x16x32_bf16 v[16:19], a[132:135], v[88:91], v[16:19]
v_cvt_pk_bf16_f32 v134, v52, v53
v_mfma_f32_16x16x32_bf16 v[24:27], a[136:139], v[88:91], v[24:27]
v_mfma_f32_16x16x32_bf16 v[32:35], v[88:91], a[140:143], v[32:35]
ds_read_b128 v[88:91], v99 offset:768
s_waitcnt lgkmcnt(7)
v_mfma_f32_16x16x32_bf16 v[20:23], a[132:135], v[92:95], v[20:23]
v_cvt_pk_bf16_f32 v135, v54, v55
buffer_store_dwordx2 v[134:135], v115, s[4:7], s56 offen sc1
v_mfma_f32_16x16x32_bf16 v[28:31], a[136:139], v[92:95], v[28:31]
v_mfma_f32_16x16x32_bf16 v[36:39], v[92:95], a[140:143], v[36:39]
ds_read_b128 v[92:95], v99 offset:11008
s_waitcnt lgkmcnt(7)
v_mfma_f32_16x16x32_bf16 v[16:19], a[144:147], v[64:67], v[16:19]
s_add_u32 m0, s57, 8192
v_cvt_pk_bf16_f32 v136, v56, v57
v_mfma_f32_16x16x32_bf16 v[24:27], a[148:151], v[64:67], v[24:27]
buffer_load_dwordx4 v108, s[72:75], s55 offen  lds
v_mfma_f32_16x16x32_bf16 v[32:35], v[64:67], a[152:155], v[32:35]
ds_read_b128 v[64:67], v96 offset:1024
s_waitcnt lgkmcnt(7)
v_mfma_f32_16x16x32_bf16 v[20:23], a[144:147], v[68:71], v[20:23]
v_cvt_pk_bf16_f32 v137, v58, v59
v_mfma_f32_16x16x32_bf16 v[28:31], a[148:151], v[68:71], v[28:31]
v_mfma_f32_16x16x32_bf16 v[36:39], v[68:71], a[152:155], v[36:39]
ds_read_b128 v[68:71], v96 offset:11264
s_waitcnt lgkmcnt(7)
v_mfma_f32_16x16x32_bf16 v[16:19], a[156:159], v[72:75], v[16:19]
v_cvt_pk_bf16_f32 v138, v60, v61
v_cvt_pk_bf16_f32 v139, v62, v63
v_mfma_f32_16x16x32_bf16 v[24:27], a[160:163], v[72:75], v[24:27]
v_mfma_f32_16x16x32_bf16 v[32:35], v[72:75], a[164:167], v[32:35]
ds_read_b128 v[72:75], v97 offset:1024
s_waitcnt lgkmcnt(7)
v_mfma_f32_16x16x32_bf16 v[20:23], a[156:159], v[76:79], v[20:23]
s_add_u32 m0, s57, 9216
buffer_store_dwordx4 v[136:139], v116, s[4:7], s56 offen sc1
v_mfma_f32_16x16x32_bf16 v[28:31], a[160:163], v[76:79], v[28:31]
buffer_load_dwordx4 v109, s[72:75], s55 offen  lds
v_mfma_f32_16x16x32_bf16 v[36:39], v[76:79], a[164:167], v[36:39]
ds_read_b128 v[76:79], v97 offset:11264
s_waitcnt lgkmcnt(7)
v_mfma_f32_16x16x32_bf16 v[16:19], a[168:171], v[80:83], v[16:19]
s_add_u32 s55, s55, 40960
s_add_u32 s57, s57, 40960
v_mfma_f32_16x16x32_bf16 v[24:27], a[172:175], v[80:83], v[24:27]
s_cmp_ge_u32 s57, 122880
s_cselect_b32 s49, 122880, 0
v_mfma_f32_16x16x32_bf16 v[32:35], v[80:83], a[176:179], v[32:35]
ds_read_b128 v[80:83], v98 offset:1024
s_waitcnt lgkmcnt(7)
v_mfma_f32_16x16x32_bf16 v[20:23], a[168:171], v[84:87], v[20:23]
s_sub_u32 s57, s57, s49
s_mov_b32 s56, s59
v_mfma_f32_16x16x32_bf16 v[28:31], a[172:175], v[84:87], v[28:31]
s_add_u32 s59, s59, s60
v_mfma_f32_16x16x32_bf16 v[36:39], v[84:87], a[176:179], v[36:39]
ds_read_b128 v[84:87], v98 offset:11264
s_waitcnt lgkmcnt(7)
v_mfma_f32_16x16x32_bf16 v[16:19], a[180:183], v[88:91], v[16:19]
s_add_u32 s54, s54, 1
s_add_u32 s58, s58, 40960
v_mfma_f32_16x16x32_bf16 v[24:27], a[184:187], v[88:91], v[24:27]
s_cmp_ge_u32 s58, 122880
s_cselect_b32 s50, -81920, s64
v_mfma_f32_16x16x32_bf16 v[32:35], v[88:91], a[188:191], v[32:35]
ds_read_b128 v[88:91], v99 offset:1024
s_waitcnt lgkmcnt(7)
v_mfma_f32_16x16x32_bf16 v[20:23], a[180:183], v[92:95], v[20:23]
s_cselect_b32 s58, 0, s58
v_mfma_f32_16x16x32_bf16 v[28:31], a[184:187], v[92:95], v[28:31]
v_mfma_f32_16x16x32_bf16 v[36:39], v[92:95], a[188:191], v[36:39]
ds_read_b128 v[92:95], v99 offset:11264
s_waitcnt lgkmcnt(7)
v_mfma_f32_16x16x32_bf16 v[16:19], a[192:195], v[64:67], v[16:19]
v_add_u32 v96, s50, v96
v_add_u32 v97, s50, v97
v_mfma_f32_16x16x32_bf16 v[24:27], a[196:199], v[64:67], v[24:27]
v_add_u32 v98, s50, v98
v_add_u32 v99, s50, v99
v_mfma_f32_16x16x32_bf16 v[32:35], v[64:67], a[200:203], v[32:35]
s_waitcnt lgkmcnt(6)
v_mfma_f32_16x16x32_bf16 v[20:23], a[192:195], v[68:71], v[20:23]
v_mfma_f32_16x16x32_bf16 v[28:31], a[196:199], v[68:71], v[28:31]
v_mfma_f32_16x16x32_bf16 v[36:39], v[68:71], a[200:203], v[36:39]
s_waitcnt vmcnt(15) lgkmcnt(0)
s_barrier
ds_read_b128 v[64:67], v96 offset:0
ds_read_b128 v[68:71], v96 offset:10240
v_mfma_f32_16x16x32_bf16 v[16:19], a[204:207], v[72:75], v[16:19]
v_mfma_f32_16x16x32_bf16 v[24:27], a[208:211], v[72:75], v[24:27]
v_mfma_f32_16x16x32_bf16 v[32:35], v[72:75], a[212:215], v[32:35]
ds_read_b128 v[72:75], v97 offset:0
v_mfma_f32_16x16x32_bf16 v[20:23], a[204:207], v[76:79], v[20:23]
v_mfma_f32_16x16x32_bf16 v[28:31], a[208:211], v[76:79], v[28:31]
v_mfma_f32_16x16x32_bf16 v[36:39], v[76:79], a[212:215], v[36:39]
ds_read_b128 v[76:79], v97 offset:10240
v_mfma_f32_16x16x32_bf16 v[16:19], a[216:219], v[80:83], v[16:19]
v_mfma_f32_16x16x32_bf16 v[24:27], a[220:223], v[80:83], v[24:27]
v_mfma_f32_16x16x32_bf16 v[32:35], v[80:83], a[224:227], v[32:35]
ds_read_b128 v[80:83], v98 offset:0
v_mfma_f32_16x16x32_bf16 v[20:23], a[216:219], v[84:87], v[20:23]
v_mfma_f32_16x16x32_bf16 v[28:31], a[220:223], v[84:87], v[28:31]
v_mfma_f32_16x16x32_bf16 v[36:39], v[84:87], a[224:227], v[36:39]
ds_read_b128 v[84:87], v98 offset:10240
v_mfma_f32_16x16x32_bf16 v[16:19], a[228:231], v[88:91], v[16:19]
v_mfma_f32_16x16x32_bf16 v[24:27], a[232:235], v[88:91], v[24:27]
v_mfma_f32_16x16x32_bf16 v[32:35], v[88:91], a[236:239], v[32:35]
ds_read_b128 v[88:91], v99 offset:0
v_mfma_f32_16x16x32_bf16 v[20:23], a[228:231], v[92:95], v[20:23]
v_mfma_f32_16x16x32_bf16 v[28:31], a[232:235], v[92:95], v[28:31]
v_mfma_f32_16x16x32_bf16 v[36:39], v[92:95], a[236:239], v[36:39]
ds_read_b128 v[92:95], v99 offset:10240
s_waitcnt lgkmcnt(7)
v_mfma_f32_16x16x32_bf16 v[40:43], a[0:3], v[64:67], 0
s_add_u32 m0, s57, 0
v_mfma_f32_16x16x32_bf16 v[48:51], a[4:7], v[64:67], 0
buffer_load_dwordx4 v100, s[72:75], s55 offen  lds
v_mfma_f32_16x16x32_bf16 v[56:59], v[64:67], a[8:11], 0
ds_read_b128 v[64:67], v96 offset:256
s_waitcnt lgkmcnt(7)
v_mfma_f32_16x16x32_bf16 v[44:47], a[0:3], v[68:71], 0
v_mfma_f32_16x16x32_bf16 v[52:55], a[4:7], v[68:71], 0
v_mfma_f32_16x16x32_bf16 v[60:63], v[68:71], a[8:11], 0
ds_read_b128 v[68:71], v96 offset:10496
s_waitcnt lgkmcnt(7)
v_mfma_f32_16x16x32_bf16 v[40:43], a[12:15], v[72:75], v[40:43]
v_mfma_f32_16x16x32_bf16 v[48:51], a[16:19], v[72:75], v[48:51]
v_mfma_f32_16x16x32_bf16 v[56:59], v[72:75], a[20:23], v[56:59]
ds_read_b128 v[72:75], v97 offset:256
s_waitcnt lgkmcnt(7)
v_mfma_f32_16x16x32_bf16 v[44:47], a[12:15], v[76:79], v[44:47]
s_add_u32 m0, s57, 1024
v_mul_f32 v16, s66, v16
v_mfma_f32_16x16x32_bf16 v[52:55], a[16:19], v[76:79], v[52:55]
buffer_load_dwordx4 v101, s[72:75], s55 offen  lds
v_mul_f32 v17, s66, v17
v_mfma_f32_16x16x32_bf16 v[60:63], v[76:79], a[20:23], v[60:63]
ds_read_b128 v[76:79], v97 offset:10496
s_waitcnt lgkmcnt(7)
v_mfma_f32_16x16x32_bf16 v[40:43], a[24:27], v[80:83], v[40:43]
v_mul_f32 v18, s66, v18
v_mfma_f32_16x16x32_bf16 v[48:51], a[28:31], v[80:83], v[48:51]
v_mfma_f32_16x16x32_bf16 v[56:59], v[80:83], a[32:35], v[56:59]
ds_read_b128 v[80:83], v98 offset:256
s_waitcnt lgkmcnt(7)
v_mfma_f32_16x16x32_bf16 v[44:47], a[24:27], v[84:87], v[44:47]
v_mul_f32 v19, s66, v19
v_mfma_f32_16x16x32_bf16 v[52:55], a[28:31], v[84:87], v[52:55]
v_mfma_f32_16x16x32_bf16 v[60:63], v[84:87], a[32:35], v[60:63]
ds_read_b128 v[84:87], v98 offset:10496
s_waitcnt lgkmcnt(7)
v_mfma_f32_16x16x32_bf16 v[40:43], a[36:39], v[88:91], v[40:43]
s_add_u32 m0, s57, 2048
v_cvt_pk_bf16_f32 v128, v16, v17
v_mfma_f32_16x16x32_bf16 v[48:51], a[40:43], v[88:91], v[48:51]
buffer_load_dwordx4 v102, s[72:75], s55 offen  lds
v_cvt_pk_bf16_f32 v129, v18, v19
v_mfma_f32_16x16x32_bf16 v[56:59], v[88:91], a[44:47], v[56:59]
ds_read_b128 v[88:91], v99 offset:256
s_waitcnt lgkmcnt(7)
v_mfma_f32_16x16x32_bf16 v[44:47], a[36:39], v[92:95], v[44:47]
buffer_store_dwordx2 v[128:129], v112, s[4:7], s56 offen sc1
v_mfma_f32_16x16x32_bf16 v[52:55], a[40:43], v[92:95], v[52:55]
v_mfma_f32_16x16x32_bf16 v[60:63], v[92:95], a[44:47], v[60:63]
ds_read_b128 v[92:95], v99 offset:10496
s_waitcnt lgkmcnt(7)
v_mfma_f32_16x16x32_bf16 v[40:43], a[48:51], v[64:67], v[40:43]
v_mul_f32 v20, s66, v20
v_mfma_f32_16x16x32_bf16 v[48:51], a[52:55], v[64:67], v[48:51]
v_mfma_f32_16x16x32_bf16 v[56:59], v[64:67], a[56:59], v[56:59]
ds_read_b128 v[64:67], v96 offset:512
s_waitcnt lgkmcnt(7)
v_mfma_f32_16x16x32_bf16 v[44:47], a[48:51], v[68:71], v[44:47]
s_add_u32 m0, s57, 3072
v_mul_f32 v21, s66, v21
v_mfma_f32_16x16x32_bf16 v[52:55], a[52:55], v[68:71], v[52:55]
buffer_load_dwordx4 v103, s[72:75], s55 offen  lds
v_mul_f32 v22, s66, v22
v_mfma_f32_16x16x32_bf16 v[60:63], v[68:71], a[56:59], v[60:63]
ds_read_b128 v[68:71], v96 offset:10752
s_waitcnt lgkmcnt(7)
v_mfma_f32_16x16x32_bf16 v[40:43], a[60:63], v[72:75], v[40:43]
v_mul_f32 v23, s66, v23
v_mfma_f32_16x16x32_bf16 v[48:51], a[64:67], v[72:75], v[48:51]
v_mfma_f32_16x16x32_bf16 v[56:59], v[72:75], a[68:71], v[56:59]
ds_read_b128 v[72:75], v97 offset:512
s_waitcnt lgkmcnt(7)
v_mfma_f32_16x16x32_bf16 v[44:47], a[60:63], v[76:79], v[44:47]
v_cvt_pk_bf16_f32 v130, v20, v21
v_mfma_f32_16x16x32_bf16 v[52:55], a[64:67], v[76:79], v[52:55]
v_mfma_f32_16x16x32_bf16 v[60:63], v[76:79], a[68:71], v[60:63]
ds_read_b128 v[76:79], v97 offset:10752
s_waitcnt lgkmcnt(7)
v_mfma_f32_16x16x32_bf16 v[40:43], a[72:75], v[80:83], v[40:43]
s_add_u32 m0, s57, 4096
v_cvt_pk_bf16_f32 v131, v22, v23
v_mfma_f32_16x16x32_bf16 v[48:51], a[76:79], v[80:83], v[48:51]
buffer_load_dwordx4 v104, s[72:75], s55 offen  lds
v_mfma_f32_16x16x32_bf16 v[56:59], v[80:83], a[80:83], v[56:59]
ds_read_b128 v[80:83], v98 offset:512
s_waitcnt lgkmcnt(7)
v_mfma_f32_16x16x32_bf16 v[44:47], a[72:75], v[84:87], v[44:47]
buffer_store_dwordx2 v[130:131], v113, s[4:7], s56 offen sc1
v_mul_f32 v24, s66, v24
v_mfma_f32_16x16x32_bf16 v[52:55], a[76:79], v[84:87], v[52:55]
v_mfma_f32_16x16x32_bf16 v[60:63], v[84:87], a[80:83], v[60:63]
ds_read_b128 v[84:87], v98 offset:10752
s_waitcnt lgkmcnt(7)
v_mfma_f32_16x16x32_bf16 v[40:43], a[84:87], v[88:91], v[40:43]
v_mul_f32 v25, s66, v25
v_mfma_f32_16x16x32_bf16 v[48:51], a[88:91], v[88:91], v[48:51]
v_mfma_f32_16x16x32_bf16 v[56:59], v[88:91], a[92:95], v[56:59]
ds_read_b128 v[88:91], v99 offset:512
s_waitcnt lgkmcnt(7)
v_mfma_f32_16x16x32_bf16 v[44:47], a[84:87], v[92:95], v[44:47]
s_add_u32 m0, s57, 5120
v_mul_f32 v26, s66, v26
v_mfma_f32_16x16x32_bf16 v[52:55], a[88:91], v[92:95], v[52:55]
buffer_load_dwordx4 v105, s[72:75], s55 offen  lds
v_mfma_f32_16x16x32_bf16 v[60:63], v[92:95], a[92:95], v[60:63]
ds_read_b128 v[92:95], v99 offset:10752
s_waitcnt lgkmcnt(7)
v_mfma_f32_16x16x32_bf16 v[40:43], a[96:99], v[64:67], v[40:43]
v_mul_f32 v27, s66, v27
v_cvt_pk_bf16_f32 v132, v24, v25
v_mfma_f32_16x16x32_bf16 v[48:51], a[100:103], v[64:67], v[48:51]
v_mfma_f32_16x16x32_bf16 v[56:59], v[64:67], a[104:107], v[56:59]
ds_read_b128 v[64:67], v96 offset:768
s_waitcnt lgkmcnt(7)
v_mfma_f32_16x16x32_bf16 v[44:47], a[96:99], v[68:71], v[44:47]
v_cvt_pk_bf16_f32 v133, v26, v27
v_mfma_f32_16x16x32_bf16 v[52:55], a[100:103], v[68:71], v[52:55]
v_mfma_f32_16x16x32_bf16 v[60:63], v[68:71], a[104:107], v[60:63]
ds_read_b128 v[68:71], v96 offset:11008
s_waitcnt lgkmcnt(7)
v_mfma_f32_16x16x32_bf16 v[40:43], a[108:111], v[72:75], v[40:43]
s_add_u32 m0, s57, 6144
buffer_store_dwordx2 v[132:133], v114, s[4:7], s56 offen sc1
v_mfma_f32_16x16x32_bf16 v[48:51], a[112:115], v[72:75], v[48:51]
buffer_load_dwordx4 v106, s[72:75], s55 offen  lds
v_mfma_f32_16x16x32_bf16 v[56:59], v[72:75], a[116:119], v[56:59]
ds_read_b128 v[72:75], v97 offset:768
s_waitcnt lgkmcnt(7)
v_mfma_f32_16x16x32_bf16 v[44:47], a[108:111], v[76:79], v[44:47]
v_mul_f32 v28, s66, v28
v_mul_f32 v29, s66, v29
v_mfma_f32_16x16x32_bf16 v[52:55], a[112:115], v[76:79], v[52:55]
v_mfma_f32_16x16x32_bf16 v[60:63], v[76:79], a[116:119], v[60:63]
ds_read_b128 v[76:79], v97 offset:11008
s_waitcnt lgkmcnt(7)
v_mfma_f32_16x16x32_bf16 v[40:43], a[120:123], v[80:83], v[40:43]
v_mul_f32 v30, s66, v30
v_mfma_f32_16x16x32_bf16 v[48:51], a[124:127], v[80:83], v[48:51]
v_mfma_f32_16x16x32_bf16 v[56:59], v[80:83], a[128:131], v[56:59]
ds_read_b128 v[80:83], v98 offset:768
s_waitcnt lgkmcnt(7)
v_mfma_f32_16x16x32_bf16 v[44:47], a[120:123], v[84:87], v[44:47]
s_add_u32 m0, s57, 7168
v_mul_f32 v31, s66, v31
v_mfma_f32_16x16x32_bf16 v[52:55], a[124:127], v[84:87], v[52:55]
buffer_load_dwordx4 v107, s[72:75], s55 offen  lds
v_mfma_f32_16x16x32_bf16 v[60:63], v[84:87], a[128:131], v[60:63]
ds_read_b128 v[84:87], v98 offset:11008
s_waitcnt lgkmcnt(7)
v_mfma_f32_16x16x32_bf16 v[40:43], a[132:135], v[88:91], v[40:43]
v_cvt_pk_bf16_f32 v134, v28, v29
v_mfma_f32_16x16x32_bf16 v[48:51], a[136:139], v[88:91], v[48:51]
v_mfma_f32_16x16x32_bf16 v[56:59], v[88:91], a[140:143], v[56:59]
ds_read_b128 v[88:91], v99 offset:768
s_waitcnt lgkmcnt(7)
v_mfma_f32_16x16x32_bf16 v[44:47], a[132:135], v[92:95], v[44:47]
v_cvt_pk_bf16_f32 v135, v30, v31
buffer_store_dwordx2 v[134:135], v115, s[4:7], s56 offen sc1
v_mfma_f32_16x16x32_bf16 v[52:55], a[136:139], v[92:95], v[52:55]
v_mfma_f32_16x16x32_bf16 v[60:63], v[92:95], a[140:143], v[60:63]
ds_read_b128 v[92:95], v99 offset:11008
s_waitcnt lgkmcnt(7)
v_mfma_f32_16x16x32_bf16 v[40:43], a[144:147], v[64:67], v[40:43]
s_add_u32 m0, s57, 8192
v_cvt_pk_bf16_f32 v136, v32, v33
v_mfma_f32_16x16x32_bf16 v[48:51], a[148:151], v[64:67], v[48:51]
buffer_load_dwordx4 v108, s[72:75], s55 offen  lds
v_mfma_f32_16x16x32_bf16 v[56:59], v[64:67], a[152:155], v[56:59]
ds_read_b128 v[64:67], v96 offset:1024
s_waitcnt lgkmcnt(7)
v_mfma_f32_16x16x32_bf16 v[44:47], a[144:147], v[68:71], v[44:47]
v_cvt_pk_bf16_f32 v137, v34, v35
v_mfma_f32_16x16x32_bf16 v[52:55], a[148:151], v[68:71], v[52:55]
v_mfma_f32_16x16x32_bf16 v[60:63], v[68:71], a[152:155], v[60:63]
ds_read_b128 v[68:71], v96 offset:11264
s_waitcnt lgkmcnt(7)
v_mfma_f32_16x16x32_bf16 v[40:43], a[156:159], v[72:75], v[40:43]
v_cvt_pk_bf16_f32 v138, v36, v37
v_cvt_pk_bf16_f32 v139, v38, v39
v_mfma_f32_16x16x32_bf16 v[48:51], a[160:163], v[72:75], v[48:51]
v_mfma_f32_16x16x32_bf16 v[56:59], v[72:75], a[164:167], v[56:59]
ds_read_b128 v[72:75], v97 offset:1024
s_waitcnt lgkmcnt(7)
v_mfma_f32_16x16x32_bf16 v[44:47], a[156:159], v[76:79], v[44:47]
s_add_u32 m0, s57, 9216
buffer_store_dwordx4 v[136:139], v116, s[4:7], s56 offen sc1
v_mfma_f32_16x16x32_bf16 v[52:55], a[160:163], v[76:79], v[52:55]
buffer_load_dwordx4 v109, s[72:75], s55 offen  lds
v_mfma_f32_16x16x32_bf16 v[60:63], v[76:79], a[164:167], v[60:63]
ds_read_b128 v[76:79], v97 offset:11264
s_waitcnt lgkmcnt(7)
v_mfma_f32_16x16x32_bf16 v[40:43], a[168:171], v[80:83], v[40:43]
s_add_u32 s55, s55, 40960
s_add_u32 s57, s57, 40960
v_mfma_f32_16x16x32_bf16 v[48:51], a[172:175], v[80:83], v[48:51]
s_cmp_ge_u32 s57, 122880
s_cselect_b32 s49, 122880, 0
v_mfma_f32_16x16x32_bf16 v[56:59], v[80:83], a[176:179], v[56:59]
ds_read_b128 v[80:83], v98 offset:1024
s_waitcnt lgkmcnt(7)
v_mfma_f32_16x16x32_bf16 v[44:47], a[168:171], v[84:87], v[44:47]
s_sub_u32 s57, s57, s49
s_mov_b32 s56, s59
v_mfma_f32_16x16x32_bf16 v[52:55], a[172:175], v[84:87], v[52:55]
s_add_u32 s59, s59, s60
v_mfma_f32_16x16x32_bf16 v[60:63], v[84:87], a[176:179], v[60:63]
ds_read_b128 v[84:87], v98 offset:11264
s_waitcnt lgkmcnt(7)
v_mfma_f32_16x16x32_bf16 v[40:43], a[180:183], v[88:91], v[40:43]
s_add_u32 s54, s54, 1
s_add_u32 s58, s58, 40960
v_mfma_f32_16x16x32_bf16 v[48:51], a[184:187], v[88:91], v[48:51]
s_cmp_ge_u32 s58, 122880
s_cselect_b32 s50, -81920, s64
v_mfma_f32_16x16x32_bf16 v[56:59], v[88:91], a[188:191], v[56:59]
ds_read_b128 v[88:91], v99 offset:1024
s_waitcnt lgkmcnt(7)
v_mfma_f32_16x16x32_bf16 v[44:47], a[180:183], v[92:95], v[44:47]
s_cselect_b32 s58, 0, s58
v_mfma_f32_16x16x32_bf16 v[52:55], a[184:187], v[92:95], v[52:55]
v_mfma_f32_16x16x32_bf16 v[60:63], v[92:95], a[188:191], v[60:63]
ds_read_b128 v[92:95], v99 offset:11264
s_waitcnt lgkmcnt(7)
v_mfma_f32_16x16x32_bf16 v[40:43], a[192:195], v[64:67], v[40:43]
v_add_u32 v96, s50, v96
v_add_u32 v97, s50, v97
v_mfma_f32_16x16x32_bf16 v[48:51], a[196:199], v[64:67], v[48:51]
v_add_u32 v98, s50, v98
v_add_u32 v99, s50, v99
v_mfma_f32_16x16x32_bf16 v[56:59], v[64:67], a[200:203], v[56:59]
s_waitcnt lgkmcnt(6)
v_mfma_f32_16x16x32_bf16 v[44:47], a[192:195], v[68:71], v[44:47]
v_mfma_f32_16x16x32_bf16 v[52:55], a[196:199], v[68:71], v[52:55]
v_mfma_f32_16x16x32_bf16 v[60:63], v[68:71], a[200:203], v[60:63]
s_cmp_ge_u32 s54, s61
s_cbranch_scc1 L_t2_end_36
s_waitcnt vmcnt(15) lgkmcnt(0)
s_barrier
ds_read_b128 v[64:67], v96 offset:0
ds_read_b128 v[68:71], v96 offset:10240
v_mfma_f32_16x16x32_bf16 v[40:43], a[204:207], v[72:75], v[40:43]
v_mfma_f32_16x16x32_bf16 v[48:51], a[208:211], v[72:75], v[48:51]
v_mfma_f32_16x16x32_bf16 v[56:59], v[72:75], a[212:215], v[56:59]
ds_read_b128 v[72:75], v97 offset:0
v_mfma_f32_16x16x32_bf16 v[44:47], a[204:207], v[76:79], v[44:47]
v_mfma_f32_16x16x32_bf16 v[52:55], a[208:211], v[76:79], v[52:55]
v_mfma_f32_16x16x32_bf16 v[60:63], v[76:79], a[212:215], v[60:63]
ds_read_b128 v[76:79], v97 offset:10240
v_mfma_f32_16x16x32_bf16 v[40:43], a[216:219], v[80:83], v[40:43]
v_mfma_f32_16x16x32_bf16 v[48:51], a[220:223], v[80:83], v[48:51]
v_mfma_f32_16x16x32_bf16 v[56:59], v[80:83], a[224:227], v[56:59]
ds_read_b128 v[80:83], v98 offset:0
v_mfma_f32_16x16x32_bf16 v[44:47], a[216:219], v[84:87], v[44:47]
v_mfma_f32_16x16x32_bf16 v[52:55], a[220:223], v[84:87], v[52:55]
v_mfma_f32_16x16x32_bf16 v[60:63], v[84:87], a[224:227], v[60:63]
ds_read_b128 v[84:87], v98 offset:10240
v_mfma_f32_16x16x32_bf16 v[40:43], a[228:231], v[88:91], v[40:43]
v_mfma_f32_16x16x32_bf16 v[48:51], a[232:235], v[88:91], v[48:51]
v_mfma_f32_16x16x32_bf16 v[56:59], v[88:91], a[236:239], v[56:59]
ds_read_b128 v[88:91], v99 offset:0
v_mfma_f32_16x16x32_bf16 v[44:47], a[228:231], v[92:95], v[44:47]
v_mfma_f32_16x16x32_bf16 v[52:55], a[232:235], v[92:95], v[52:55]
v_mfma_f32_16x16x32_bf16 v[60:63], v[92:95], a[236:239], v[60:63]
ds_read_b128 v[92:95], v99 offset:10240
s_branch L_t2_loop_35
L_t2_end_36:
s_waitcnt lgkmcnt(0)
v_mfma_f32_16x16x32_bf16 v[40:43], a[204:207], v[72:75], v[40:43]
v_mfma_f32_16x16x32_bf16 v[48:51], a[208:211], v[72:75], v[48:51]
v_mfma_f32_16x16x32_bf16 v[56:59], v[72:75], a[212:215], v[56:59]
v_mfma_f32_16x16x32_bf16 v[44:47], a[204:207], v[76:79], v[44:47]
v_mfma_f32_16x16x32_bf16 v[52:55], a[208:211], v[76:79], v[52:55]
v_mfma_f32_16x16x32_bf16 v[60:63], v[76:79], a[212:215], v[60:63]
v_mfma_f32_16x16x32_bf16 v[40:43], a[216:219], v[80:83], v[40:43]
v_mfma_f32_16x16x32_bf16 v[48:51], a[220:223], v[80:83], v[48:51]
v_mfma_f32_16x16x32_bf16 v[56:59], v[80:83], a[224:227], v[56:59]
v_mfma_f32_16x16x32_bf16 v[44:47], a[216:219], v[84:87], v[44:47]
v_mfma_f32_16x16x32_bf16 v[52:55], a[220:223], v[84:87], v[52:55]
v_mfma_f32_16x16x32_bf16 v[60:63], v[84:87], a[224:227], v[60:63]
v_mfma_f32_16x16x32_bf16 v[40:43], a[228:231], v[88:91], v[40:43]
v_mfma_f32_16x16x32_bf16 v[48:51], a[232:235], v[88:91], v[48:51]
v_mfma_f32_16x16x32_bf16 v[56:59], v[88:91], a[236:239], v[56:59]
v_mfma_f32_16x16x32_bf16 v[44:47], a[228:231], v[92:95], v[44:47]
v_mfma_f32_16x16x32_bf16 v[52:55], a[232:235], v[92:95], v[52:55]
v_mfma_f32_16x16x32_bf16 v[60:63], v[92:95], a[236:239], v[60:63]
s_nop 2
v_mul_f32 v40, s66, v40
v_mul_f32 v41, s66, v41
v_mul_f32 v42, s66, v42
v_mul_f32 v43, s66, v43
v_cvt_pk_bf16_f32 v128, v40, v41
v_cvt_pk_bf16_f32 v129, v42, v43
buffer_store_dwordx2 v[128:129], v112, s[4:7], s56 offen sc1
v_mul_f32 v44, s66, v44
v_mul_f32 v45, s66, v45
v_mul_f32 v46, s66, v46
v_mul_f32 v47, s66, v47
v_cvt_pk_bf16_f32 v130, v44, v45
v_cvt_pk_bf16_f32 v131, v46, v47
buffer_store_dwordx2 v[130:131], v113, s[4:7], s56 offen sc1
v_mul_f32 v48, s66, v48
v_mul_f32 v49, s66, v49
v_mul_f32 v50, s66, v50
v_mul_f32 v51, s66, v51
v_cvt_pk_bf16_f32 v132, v48, v49
v_cvt_pk_bf16_f32 v133, v50, v51
buffer_store_dwordx2 v[132:133], v114, s[4:7], s56 offen sc1
v_mul_f32 v52, s66, v52
v_mul_f32 v53, s66, v53
v_mul_f32 v54, s66, v54
v_mul_f32 v55, s66, v55
v_cvt_pk_bf16_f32 v134, v52, v53
v_cvt_pk_bf16_f32 v135, v54, v55
buffer_store_dwordx2 v[134:135], v115, s[4:7], s56 offen sc1
v_cvt_pk_bf16_f32 v136, v56, v57
v_cvt_pk_bf16_f32 v137, v58, v59
v_cvt_pk_bf16_f32 v138, v60, v61
v_cvt_pk_bf16_f32 v139, v62, v63
buffer_store_dwordx4 v[136:139], v116, s[4:7], s56 offen sc1
s_waitcnt vmcnt(0)
s_barrier
L_b2_24:
s_waitcnt vmcnt(0)
s_barrier
s_cmp_lg_u32 s44, 0
s_cbranch_scc1 L_da_37
v_mov_b32 v122, 160
v_mov_b32 v123, 1
s_mov_b64 exec, 1
global_atomic_add v122, v123, s[40:41] sc1
s_mov_b64 exec, -1
L_da_37:
s_branch L_exit
L_t3:
v_mov_b32 v240, 160
s_cmp_lg_u32 s44, 0
s_cbranch_scc1 L_pdx_39
s_mov_b32 s53, 0
L_pd_38:
global_load_dword v241, v240, s[40:41] sc1
s_add_u32 s53, s53, 1
s_cmp_gt_u32 s53, 100000
s_cbranch_scc1 L_pdx_39
s_waitcnt vmcnt(0)
v_readfirstlane_b32 s48, v241
s_cmp_ge_u32 s48, 32
s_cbranch_scc1 L_pdx_39
s_sleep 16
s_branch L_pd_38
L_pdx_39:
s_waitcnt vmcnt(0)
s_barrier
v_mov_b32 v240, 168
s_cmp_lg_u32 s44, 0
s_cbranch_scc1 L_pdx_41
s_mov_b32 s53, 0
L_pd_40:
global_load_dword v241, v240, s[40:41] sc1
s_add_u32 s53, s53, 1
s_cmp_gt_u32 s53, 100000
s_cbranch_scc1 L_pdx_41
s_waitcnt vmcnt(0)
v_readfirstlane_b32 s48, v241
s_cmp_ge_u32 s48, 8
s_cbranch_scc1 L_pdx_41
s_sleep 16
s_branch L_pd_40
L_pdx_41:
s_waitcnt vmcnt(0)
s_barrier
v_lshlrev_b32 v2, 4, v1
v_lshlrev_b32 v240, 4, v0
v_add_u32 v240, 81920, v240
v_mov_b32 v244, 0x3f803f80
v_mov_b32 v245, 0x3f803f80
v_mov_b32 v246, 0x3f803f80
v_mov_b32 v247, 0x3f803f80
ds_write_b128 v240, v[244:247] offset:0
ds_write_b128 v240, v[244:247] offset:4096
ds_write_b128 v240, v[244:247] offset:8192
v_and_b32 v240, 31, v1
v_lshrrev_b32 v241, 5, v1
v_lshlrev_b32 v24, 3, v240
s_mov_b32 s67, 0x07060302
s_mov_b32 s68, 0x40004000
v_mul_u32_u24 v242, 320, v241
v_lshl_add_u32 v242, v240, 4, v242
v_add_u32 v242, 10240, v242
v_mov_b32 v243, 81920
v_cmp_gt_u32 vcc, 20, v240
s_nop 1
v_cndmask_b32 v6, v243, v242, vcc
v_mov_b32 v243, 20480
v_cndmask_b32 v7, 0, v243, vcc
v_lshrrev_b32 v25, 3, v7
s_mov_b32 s64, 0
s_mov_b32 s65, -1
v_mov_b32 v214, 0x3f803f80
v_mov_b32 v215, 0x3f80
v_mov_b32 v230, 0x3f803f80
v_mov_b32 v231, 0x3f80
s_mul_i32 s55, s45, 21846
s_lshr_b32 s55, s55, 16
s_mul_i32 s48, s55, 3
s_sub_u32 s48, s45, s48
s_lshl_b32 s48, s48, 2
s_add_u32 s48, s48, s44
s_mul_i32 s56, s48, 6
s_min_u32 s56, s56, 58
s_and_b32 s48, s44, 1
s_mul_i32 s48, s48, 5120
s_cmp_lt_u32 s44, 2
s_mov_b32 s49, 176160768
s_cselect_b32 s57, 171966464, s49
s_add_u32 s57, s57, s48
s_mul_i32 s66, s44, 5120
s_mul_i32 s48, s55, 81920
s_add_u32 s57, s57, s48
s_mul_i32 s49, s56, 1280
s_add_u32 s49, s49, s48
s_add_u32 s49, s49, 167772160
s_lshl_b32 s50, s56, 8
s_add_u32 s50, s50, 184549380
v_mov_b32 v247, 1879048192
v_cndmask_b32 v247, v24, v247, s[64:65]
buffer_load_dwordx4 a[0:3], v2, s[4:7], s49 offen sc1
buffer_load_dwordx2 a[4:5], v247, s[4:7], s49 offen offset:1024 sc1
buffer_load_dword v16, v24, s[4:7], s50 offen offset:0 sc1
s_add_u32 s49, s49, 1280
buffer_load_dwordx4 a[8:11], v2, s[4:7], s49 offen sc1
buffer_load_dwordx2 a[12:13], v247, s[4:7], s49 offen offset:1024 sc1
buffer_load_dword v17, v24, s[4:7], s50 offen offset:256 sc1
s_add_u32 s49, s49, 1280
buffer_load_dwordx4 a[16:19], v2, s[4:7], s49 offen sc1
buffer_load_dwordx2 a[20:21], v247, s[4:7], s49 offen offset:1024 sc1
buffer_load_dword v18, v24, s[4:7], s50 offen offset:512 sc1
s_add_u32 s49, s49, 1280
buffer_load_dwordx4 a[24:27], v2, s[4:7], s49 offen sc1
buffer_load_dwordx2 a[28:29], v247, s[4:7], s49 offen offset:1024 sc1
buffer_load_dword v19, v24, s[4:7], s50 offen offset:768 sc1
s_add_u32 s49, s49, 1280
buffer_load_dwordx4 a[32:35], v2, s[4:7], s49 offen sc1
buffer_load_dwordx2 a[36:37], v247, s[4:7], s49 offen offset:1024 sc1
buffer_load_dword v20, v24, s[4:7], s50 offen offset:1024 sc1
s_add_u32 s49, s49, 1280
buffer_load_dwordx4 a[40:43], v2, s[4:7], s49 offen sc1
buffer_load_dwordx2 a[44:45], v247, s[4:7], s49 offen offset:1024 sc1
buffer_load_dword v21, v24, s[4:7], s50 offen offset:1280 sc1
s_add_u32 s49, s49, 1280
s_mov_b32 s70, s57
v_accvgpr_write_b32 a6, 0
v_accvgpr_write_b32 a7, 0
v_mov_b32 v8, 0
v_mov_b32 v32, 0
v_mov_b32 v33, 0
v_mov_b32 v34, 0
v_mov_b32 v35, 0
v_mov_b32 v36, 0
v_mov_b32 v37, 0
v_mov_b32 v38, 0
v_mov_b32 v39, 0
v_mov_b32 v40, 0
v_mov_b32 v41, 0
v_mov_b32 v42, 0
v_mov_b32 v43, 0
v_mov_b32 v44, 0
v_mov_b32 v45, 0
v_mov_b32 v46, 0
v_mov_b32 v47, 0
v_accvgpr_write_b32 a14, 0
v_accvgpr_write_b32 a15, 0
v_mov_b32 v9, 0
v_mov_b32 v48, 0
v_mov_b32 v49, 0
v_mov_b32 v50, 0
v_mov_b32 v51, 0
v_mov_b32 v52, 0
v_mov_b32 v53, 0
v_mov_b32 v54, 0
v_mov_b32 v55, 0
v_mov_b32 v56, 0
v_mov_b32 v57, 0
v_mov_b32 v58, 0
v_mov_b32 v59, 0
v_mov_b32 v60, 0
v_mov_b32 v61, 0
v_mov_b32 v62, 0
v_mov_b32 v63, 0
v_accvgpr_write_b32 a22, 0
v_accvgpr_write_b32 a23, 0
v_mov_b32 v10, 0
v_mov_b32 v64, 0
v_mov_b32 v65, 0
v_mov_b32 v66, 0
v_mov_b32 v67, 0
v_mov_b32 v68, 0
v_mov_b32 v69, 0
v_mov_b32 v70, 0
v_mov_b32 v71, 0
v_mov_b32 v72, 0
v_mov_b32 v73, 0
v_mov_b32 v74, 0
v_mov_b32 v75, 0
v_mov_b32 v76, 0
v_mov_b32 v77, 0
v_mov_b32 v78, 0
v_mov_b32 v79, 0
v_accvgpr_write_b32 a30, 0
v_accvgpr_write_b32 a31, 0
v_mov_b32 v11, 0
v_mov_b32 v80, 0
v_mov_b32 v81, 0
v_mov_b32 v82, 0
v_mov_b32 v83, 0
v_mov_b32 v84, 0
v_mov_b32 v85, 0
v_mov_b32 v86, 0
v_mov_b32 v87, 0
v_mov_b32 v88, 0
v_mov_b32 v89, 0
v_mov_b32 v90, 0
v_mov_b32 v91, 0
v_mov_b32 v92, 0
v_mov_b32 v93, 0
v_mov_b32 v94, 0
v_mov_b32 v95, 0
v_accvgpr_write_b32 a38, 0
v_accvgpr_write_b32 a39, 0
v_mov_b32 v12, 0
v_mov_b32 v96, 0
v_mov_b32 v97, 0
v_mov_b32 v98, 0
v_mov_b32 v99, 0
v_mov_b32 v100, 0
v_mov_b32 v101, 0
v_mov_b32 v102, 0
v_mov_b32 v103, 0
v_mov_b32 v104, 0
v_mov_b32 v105, 0
v_mov_b32 v106, 0
v_mov_b32 v107, 0
v_mov_b32 v108, 0
v_mov_b32 v109, 0
v_mov_b32 v110, 0
v_mov_b32 v111, 0
v_accvgpr_write_b32 a46, 0
v_accvgpr_write_b32 a47, 0
v_mov_b32 v13, 0
v_mov_b32 v112, 0
v_mov_b32 v113, 0
v_mov_b32 v114, 0
v_mov_b32 v115, 0
v_mov_b32 v116, 0
v_mov_b32 v117, 0
v_mov_b32 v118, 0
v_mov_b32 v119, 0
v_mov_b32 v120, 0
v_mov_b32 v121, 0
v_mov_b32 v122, 0
v_mov_b32 v123, 0
v_mov_b32 v124, 0
v_mov_b32 v125, 0
v_mov_b32 v126, 0
v_mov_b32 v127, 0
s_mov_b32 s57, s70
v_mov_b32 v200, 0
v_mov_b32 v232, 0
v_mov_b32 v201, 0
v_mov_b32 v233, 0
v_mov_b32 v202, 0
v_mov_b32 v234, 0
v_mov_b32 v203, 0
v_mov_b32 v235, 0
v_mov_b32 v204, 0
v_mov_b32 v236, 0
v_mov_b32 v205, 0
v_mov_b32 v237, 0
v_mov_b32 v206, 0
v_mov_b32 v238, 0
v_mov_b32 v207, 0
v_mov_b32 v239, 0
s_mov_b32 s58, 0
s_mov_b32 s60, s66
s_mov_b32 s59, 0
s_mov_b32 s61, 0
s_mov_b32 m0, s60
s_add_u32 s49, s57, 4096
buffer_load_dwordx4 v2, s[4:7], s57 offen sc1 lds
buffer_load_dwordx4 v2, s[4:7], s57 offen offset:1024 sc1 lds
buffer_load_dwordx4 v2, s[4:7], s57 offen offset:2048 sc1 lds
buffer_load_dwordx4 v2, s[4:7], s57 offen offset:3072 sc1 lds
s_add_u32 m0, s60, 4096
s_add_u32 s57, s57, 10240
buffer_load_dwordx4 v2, s[4:7], s49 offen sc1 lds
s_add_u32 s58, s58, 1
s_and_b32 s49, s58, 3
s_mul_i32 s49, s49, 20480
s_add_u32 s60, s66, s49
s_mov_b32 m0, s60
s_add_u32 s49, s57, 4096
buffer_load_dwordx4 v2, s[4:7], s57 offen sc1 lds
buffer_load_dwordx4 v2, s[4:7], s57 offen offset:1024 sc1 lds
buffer_load_dwordx4 v2, s[4:7], s57 offen offset:2048 sc1 lds
buffer_load_dwordx4 v2, s[4:7], s57 offen offset:3072 sc1 lds
s_add_u32 m0, s60, 4096
s_add_u32 s57, s57, 10240
buffer_load_dwordx4 v2, s[4:7], s49 offen sc1 lds
s_add_u32 s58, s58, 1
s_and_b32 s49, s58, 3
s_mul_i32 s49, s49, 20480
s_add_u32 s60, s66, s49
v_mov_b32 v3, v2
v_mov_b32 v4, v6
v_mov_b32 v5, v24
s_waitcnt vmcnt(5) lgkmcnt(0)
s_barrier
ds_read_b128 v[208:211], v3 offset:0
ds_read_b64 v[212:213], v5 offset:1024
ds_read_b128 v[216:219], v4 offset:0
ds_read_b128 v[220:223], v4 offset:640
s_waitcnt lgkmcnt(0)
v_mfma_f32_32x32x16_bf16 v[144:159], v[208:211], a[8:11], 0
v_mfma_f32_32x32x16_bf16 v[144:159], v[212:215], a[12:15], v[144:159]
s_nop 10
s_nop 0
v_max3_f32 v240, v144, v145, v146
v_max3_f32 v240, v240, v147, v148
v_max3_f32 v240, v240, v149, v150
v_max3_f32 v240, v240, v151, v152
v_max3_f32 v240, v240, v153, v154
v_max3_f32 v240, v240, v155, v156
v_max3_f32 v240, v240, v157, v158
v_max_f32 v240, v240, v159
v_mov_b32 v241, v240
s_nop 0
s_nop 0
v_permlane32_swap_b32 v240, v241
v_max_f32 v240, v240, v241
v_add_f32 v240, 0x41400000, v240
v_add_f32 v240, v240, v9
v_sub_f32 v242, v240, v9
v_mov_b32 v9, v240
v_xor_b32 v240, 0x80000000, v240
v_and_b32 v241, 0xffff0000, v240
v_sub_f32 v240, v240, v241
v_and_b32 v242, 0xffff0000, v240
v_sub_f32 v240, v240, v242
v_perm_b32 v241, v242, v241, s67
v_lshrrev_b32 v240, 16, v240
v_cndmask_b32 v241, v241, 0, s[64:65]
v_cndmask_b32 v240, v240, 0, s[64:65]
v_accvgpr_write_b32 a14, v241
v_accvgpr_write_b32 a15, v240
v_mfma_f32_32x32x16_bf16 v[128:143], v[208:211], a[16:19], 0
v_mfma_f32_32x32x16_bf16 v[128:143], v[212:215], a[20:23], v[128:143]
s_nop 10
s_nop 0
v_max3_f32 v240, v128, v129, v130
v_max3_f32 v240, v240, v131, v132
v_max3_f32 v240, v240, v133, v134
v_max3_f32 v240, v240, v135, v136
v_max3_f32 v240, v240, v137, v138
v_max3_f32 v240, v240, v139, v140
v_max3_f32 v240, v240, v141, v142
v_max_f32 v240, v240, v143
v_mov_b32 v241, v240
s_nop 0
s_nop 0
v_permlane32_swap_b32 v240, v241
v_max_f32 v240, v240, v241
v_add_f32 v240, 0x41400000, v240
v_add_f32 v240, v240, v10
v_sub_f32 v242, v240, v10
v_mov_b32 v10, v240
v_xor_b32 v240, 0x80000000, v240
v_and_b32 v241, 0xffff0000, v240
v_sub_f32 v240, v240, v241
v_and_b32 v242, 0xffff0000, v240
v_sub_f32 v240, v240, v242
v_perm_b32 v241, v242, v241, s67
v_lshrrev_b32 v240, 16, v240
v_cndmask_b32 v241, v241, 0, s[64:65]
v_cndmask_b32 v240, v240, 0, s[64:65]
v_accvgpr_write_b32 a22, v241
v_accvgpr_write_b32 a23, v240
v_mfma_f32_32x32x16_bf16 v[144:159], v[208:211], a[24:27], 0
v_mfma_f32_32x32x16_bf16 v[144:159], v[212:215], a[28:31], v[144:159]
s_nop 10
s_nop 0
v_max3_f32 v240, v144, v145, v146
v_max3_f32 v240, v240, v147, v148
v_max3_f32 v240, v240, v149, v150
v_max3_f32 v240, v240, v151, v152
v_max3_f32 v240, v240, v153, v154
v_max3_f32 v240, v240, v155, v156
v_max3_f32 v240, v240, v157, v158
v_max_f32 v240, v240, v159
v_mov_b32 v241, v240
s_nop 0
s_nop 0
v_permlane32_swap_b32 v240, v241
v_max_f32 v240, v240, v241
v_add_f32 v240, 0x41400000, v240
v_add_f32 v240, v240, v11
v_sub_f32 v242, v240, v11
v_mov_b32 v11, v240
v_xor_b32 v240, 0x80000000, v240
v_and_b32 v241, 0xffff0000, v240
v_sub_f32 v240, v240, v241
v_and_b32 v242, 0xffff0000, v240
v_sub_f32 v240, v240, v242
v_perm_b32 v241, v242, v241, s67
v_lshrrev_b32 v240, 16, v240
v_cndmask_b32 v241, v241, 0, s[64:65]
v_cndmask_b32 v240, v240, 0, s[64:65]
v_accvgpr_write_b32 a30, v241
v_accvgpr_write_b32 a31, v240
v_mfma_f32_32x32x16_bf16 v[128:143], v[208:211], a[32:35], 0
v_mfma_f32_32x32x16_bf16 v[128:143], v[212:215], a[36:39], v[128:143]
s_nop 10
s_nop 0
v_max3_f32 v240, v128, v129, v130
v_max3_f32 v240, v240, v131, v132
v_max3_f32 v240, v240, v133, v134
v_max3_f32 v240, v240, v135, v136
v_max3_f32 v240, v240, v137, v138
v_max3_f32 v240, v240, v139, v140
v_max3_f32 v240, v240, v141, v142
v_max_f32 v240, v240, v143
v_mov_b32 v241, v240
s_nop 0
s_nop 0
v_permlane32_swap_b32 v240, v241
v_max_f32 v240, v240, v241
v_add_f32 v240, 0x41400000, v240
v_add_f32 v240, v240, v12
v_sub_f32 v242, v240, v12
v_mov_b32 v12, v240
v_xor_b32 v240, 0x80000000, v240
v_and_b32 v241, 0xffff0000, v240
v_sub_f32 v240, v240, v241
v_and_b32 v242, 0xffff0000, v240
v_sub_f32 v240, v240, v242
v_perm_b32 v241, v242, v241, s67
v_lshrrev_b32 v240, 16, v240
v_cndmask_b32 v241, v241, 0, s[64:65]
v_cndmask_b32 v240, v240, 0, s[64:65]
v_accvgpr_write_b32 a38, v241
v_accvgpr_write_b32 a39, v240
v_mfma_f32_32x32x16_bf16 v[144:159], v[208:211], a[40:43], 0
v_mfma_f32_32x32x16_bf16 v[144:159], v[212:215], a[44:47], v[144:159]
s_nop 10
s_nop 0
v_max3_f32 v240, v144, v145, v146
v_max3_f32 v240, v240, v147, v148
v_max3_f32 v240, v240, v149, v150
v_max3_f32 v240, v240, v151, v152
v_max3_f32 v240, v240, v153, v154
v_max3_f32 v240, v240, v155, v156
v_max3_f32 v240, v240, v157, v158
v_max_f32 v240, v240, v159
v_mov_b32 v241, v240
s_nop 0
s_nop 0
v_permlane32_swap_b32 v240, v241
v_max_f32 v240, v240, v241
v_add_f32 v240, 0x41400000, v240
v_add_f32 v240, v240, v13
v_sub_f32 v242, v240, v13
v_mov_b32 v13, v240
v_xor_b32 v240, 0x80000000, v240
v_and_b32 v241, 0xffff0000, v240
v_sub_f32 v240, v240, v241
v_and_b32 v242, 0xffff0000, v240
v_sub_f32 v240, v240, v242
v_perm_b32 v241, v242, v241, s67
v_lshrrev_b32 v240, 16, v240
v_cndmask_b32 v241, v241, 0, s[64:65]
v_cndmask_b32 v240, v240, 0, s[64:65]
v_accvgpr_write_b32 a46, v241
v_accvgpr_write_b32 a47, v240
v_mfma_f32_32x32x16_bf16 v[128:143], v[208:211], a[0:3], 0
v_mfma_f32_32x32x16_bf16 v[128:143], v[212:215], a[4:7], v[128:143]
s_nop 10
s_nop 0
v_max3_f32 v240, v128, v129, v130
v_max3_f32 v240, v240, v131, v132
v_max3_f32 v240, v240, v133, v134
v_max3_f32 v240, v240, v135, v136
v_max3_f32 v240, v240, v137, v138
v_max3_f32 v240, v240, v139, v140
v_max3_f32 v240, v240, v141, v142
v_max_f32 v240, v240, v143
v_mov_b32 v241, v240
s_nop 0
s_nop 0
v_permlane32_swap_b32 v240, v241
v_max_f32 v240, v240, v241
v_add_f32 v240, 0x41400000, v240
v_add_f32 v240, v240, v8
v_sub_f32 v242, v240, v8
v_mov_b32 v8, v240
v_xor_b32 v240, 0x80000000, v240
v_and_b32 v241, 0xffff0000, v240
v_sub_f32 v240, v240, v241
v_and_b32 v242, 0xffff0000, v240
v_sub_f32 v240, v240, v242
v_perm_b32 v241, v242, v241, s67
v_lshrrev_b32 v240, 16, v240
v_cndmask_b32 v241, v241, 0, s[64:65]
v_cndmask_b32 v240, v240, 0, s[64:65]
v_accvgpr_write_b32 a6, v241
v_accvgpr_write_b32 a7, v240
v_mfma_f32_32x32x16_bf16 v[128:143], v[208:211], a[0:3], 0
s_nop 0
v_mfma_f32_32x32x16_bf16 v[128:143], v[212:215], a[4:7], v[128:143]
s_mov_b64 vcc, 0
s_mov_b32 s69, 0
L_t3ch_42:
s_nop 7
s_nop 1
v_exp_f32 v160, v128
v_exp_f32 v161, v129
v_exp_f32 v162, v130
v_exp_f32 v163, v131
v_mfma_f32_32x32x16_bf16 v[144:159], v[208:211], a[8:11], 0
v_perm_b32 v192, v161, v160, s67
v_exp_f32 v164, v132
v_exp_f32 v165, v133
v_perm_b32 v193, v163, v162, s67
v_exp_f32 v166, v134
v_mfma_f32_32x32x16_bf16 v[144:159], v[212:215], a[12:15], v[144:159]
v_exp_f32 v167, v135
v_perm_b32 v194, v165, v164, s67
v_exp_f32 v168, v136
v_exp_f32 v169, v137
v_perm_b32 v195, v167, v166, s67
v_mfma_f32_32x32x16_bf16 v[112:127], v[232:235], v[200:203], v[112:127]
v_exp_f32 v170, v138
v_exp_f32 v171, v139
v_perm_b32 v196, v169, v168, s67
v_exp_f32 v172, v140
v_exp_f32 v173, v141
v_mfma_f32_32x32x16_bf16 v[112:127], v[236:239], v[204:207], v[112:127]
v_perm_b32 v197, v171, v170, s67
v_exp_f32 v174, v142
v_exp_f32 v175, v143
v_perm_b32 v198, v173, v172, s67
v_perm_b32 v199, v175, v174, s67
s_cmp_eq_u32 s69, 0
s_cbranch_scc1 L_t3d_43
L_t3d2_44:
v_exp_f32 v176, v144
ds_read_b128 v[224:227], v3 offset:1280
v_exp_f32 v177, v145
ds_read_b64 v[228:229], v5 offset:2304
v_exp_f32 v178, v146
v_exp_f32 v179, v147
v_mfma_f32_32x32x16_bf16 v[128:143], v[208:211], a[16:19], 0
v_perm_b32 v200, v177, v176, s67
v_exp_f32 v180, v148
v_exp_f32 v181, v149
ds_read_b128 v[232:235], v4 offset:1280
v_perm_b32 v201, v179, v178, s67
v_exp_f32 v182, v150
v_mfma_f32_32x32x16_bf16 v[128:143], v[212:215], a[20:23], v[128:143]
v_exp_f32 v183, v151
v_perm_b32 v202, v181, v180, s67
v_exp_f32 v184, v152
v_exp_f32 v185, v153
ds_read_b128 v[236:239], v4 offset:1920
v_perm_b32 v203, v183, v182, s67
v_mfma_f32_32x32x16_bf16 v[32:47], v[216:219], v[192:195], v[32:47]
v_exp_f32 v186, v154
v_exp_f32 v187, v155
v_perm_b32 v204, v185, v184, s67
v_exp_f32 v188, v156
v_exp_f32 v189, v157
v_mfma_f32_32x32x16_bf16 v[32:47], v[220:223], v[196:199], v[32:47]
v_perm_b32 v205, v187, v186, s67
v_exp_f32 v190, v158
v_exp_f32 v191, v159
v_perm_b32 v206, v189, v188, s67
v_perm_b32 v207, v191, v190, s67
v_exp_f32 v160, v128
v_exp_f32 v161, v129
v_exp_f32 v162, v130
v_exp_f32 v163, v131
v_mfma_f32_32x32x16_bf16 v[144:159], v[208:211], a[24:27], 0
v_perm_b32 v192, v161, v160, s67
v_exp_f32 v164, v132
v_exp_f32 v165, v133
v_perm_b32 v193, v163, v162, s67
v_exp_f32 v166, v134
v_mfma_f32_32x32x16_bf16 v[144:159], v[212:215], a[28:31], v[144:159]
v_exp_f32 v167, v135
v_perm_b32 v194, v165, v164, s67
v_exp_f32 v168, v136
v_exp_f32 v169, v137
v_perm_b32 v195, v167, v166, s67
v_mfma_f32_32x32x16_bf16 v[48:63], v[216:219], v[200:203], v[48:63]
v_exp_f32 v170, v138
v_exp_f32 v171, v139
v_perm_b32 v196, v169, v168, s67
v_exp_f32 v172, v140
v_exp_f32 v173, v141
v_mfma_f32_32x32x16_bf16 v[48:63], v[220:223], v[204:207], v[48:63]
v_perm_b32 v197, v171, v170, s67
v_exp_f32 v174, v142
v_exp_f32 v175, v143
v_perm_b32 v198, v173, v172, s67
v_perm_b32 v199, v175, v174, s67
v_exp_f32 v176, v144
v_exp_f32 v177, v145
v_exp_f32 v178, v146
v_exp_f32 v179, v147
v_mfma_f32_32x32x16_bf16 v[128:143], v[208:211], a[32:35], 0
v_perm_b32 v200, v177, v176, s67
v_exp_f32 v180, v148
v_exp_f32 v181, v149
v_perm_b32 v201, v179, v178, s67
v_exp_f32 v182, v150
v_mfma_f32_32x32x16_bf16 v[128:143], v[212:215], a[36:39], v[128:143]
v_exp_f32 v183, v151
v_perm_b32 v202, v181, v180, s67
v_exp_f32 v184, v152
v_exp_f32 v185, v153
v_perm_b32 v203, v183, v182, s67
v_mfma_f32_32x32x16_bf16 v[64:79], v[216:219], v[192:195], v[64:79]
v_exp_f32 v186, v154
v_exp_f32 v187, v155
v_perm_b32 v204, v185, v184, s67
v_exp_f32 v188, v156
v_exp_f32 v189, v157
v_mfma_f32_32x32x16_bf16 v[64:79], v[220:223], v[196:199], v[64:79]
v_perm_b32 v205, v187, v186, s67
v_exp_f32 v190, v158
v_exp_f32 v191, v159
v_perm_b32 v206, v189, v188, s67
v_perm_b32 v207, v191, v190, s67
v_exp_f32 v160, v128
v_exp_f32 v161, v129
v_exp_f32 v162, v130
v_exp_f32 v163, v131
v_mfma_f32_32x32x16_bf16 v[144:159], v[208:211], a[40:43], 0
v_perm_b32 v192, v161, v160, s67
v_exp_f32 v164, v132
v_exp_f32 v165, v133
v_perm_b32 v193, v163, v162, s67
v_exp_f32 v166, v134
v_mfma_f32_32x32x16_bf16 v[144:159], v[212:215], a[44:47], v[144:159]
v_exp_f32 v167, v135
v_perm_b32 v194, v165, v164, s67
v_exp_f32 v168, v136
v_exp_f32 v169, v137
v_perm_b32 v195, v167, v166, s67
v_mfma_f32_32x32x16_bf16 v[80:95], v[216:219], v[200:203], v[80:95]
v_exp_f32 v170, v138
v_exp_f32 v171, v139
v_perm_b32 v196, v169, v168, s67
v_exp_f32 v172, v140
v_exp_f32 v173, v141
v_mfma_f32_32x32x16_bf16 v[80:95], v[220:223], v[204:207], v[80:95]
v_perm_b32 v197, v171, v170, s67
v_exp_f32 v174, v142
v_exp_f32 v175, v143
v_perm_b32 v198, v173, v172, s67
v_perm_b32 v199, v175, v174, s67
v_exp_f32 v176, v144
v_exp_f32 v177, v145
v_exp_f32 v178, v146
v_exp_f32 v179, v147
s_waitcnt lgkmcnt(0)
v_mfma_f32_32x32x16_bf16 v[128:143], v[224:227], a[0:3], 0
v_perm_b32 v200, v177, v176, s67
v_exp_f32 v180, v148
v_exp_f32 v181, v149
v_perm_b32 v201, v179, v178, s67
v_exp_f32 v182, v150
v_mfma_f32_32x32x16_bf16 v[128:143], v[228:231], a[4:7], v[128:143]
v_exp_f32 v183, v151
v_perm_b32 v202, v181, v180, s67
v_exp_f32 v184, v152
v_exp_f32 v185, v153
v_perm_b32 v203, v183, v182, s67
v_mfma_f32_32x32x16_bf16 v[96:111], v[216:219], v[192:195], v[96:111]
v_exp_f32 v186, v154
v_exp_f32 v187, v155
v_perm_b32 v204, v185, v184, s67
v_exp_f32 v188, v156
v_exp_f32 v189, v157
v_mfma_f32_32x32x16_bf16 v[96:111], v[220:223], v[196:199], v[96:111]
v_perm_b32 v205, v187, v186, s67
v_exp_f32 v190, v158
v_exp_f32 v191, v159
v_perm_b32 v206, v189, v188, s67
v_perm_b32 v207, v191, v190, s67
v_exp_f32 v160, v128
v_exp_f32 v161, v129
v_exp_f32 v162, v130
v_exp_f32 v163, v131
v_mfma_f32_32x32x16_bf16 v[144:159], v[224:227], a[8:11], 0
v_perm_b32 v192, v161, v160, s67
v_exp_f32 v164, v132
v_exp_f32 v165, v133
v_perm_b32 v193, v163, v162, s67
v_exp_f32 v166, v134
v_mfma_f32_32x32x16_bf16 v[144:159], v[228:231], a[12:15], v[144:159]
v_exp_f32 v167, v135
v_perm_b32 v194, v165, v164, s67
v_exp_f32 v168, v136
v_exp_f32 v169, v137
v_perm_b32 v195, v167, v166, s67
v_mfma_f32_32x32x16_bf16 v[112:127], v[216:219], v[200:203], v[112:127]
v_exp_f32 v170, v138
v_exp_f32 v171, v139
v_perm_b32 v196, v169, v168, s67
v_exp_f32 v172, v140
v_exp_f32 v173, v141
v_mfma_f32_32x32x16_bf16 v[112:127], v[220:223], v[204:207], v[112:127]
v_perm_b32 v197, v171, v170, s67
v_exp_f32 v174, v142
v_exp_f32 v175, v143
v_perm_b32 v198, v173, v172, s67
v_perm_b32 v199, v175, v174, s67
s_add_u32 s69, s69, 1
s_and_b32 s69, s69, 3
s_cbranch_scc0 L_t3s_45
v_add_u32 v3, 2560, v3
v_add_u32 v5, 2560, v5
v_add_u32 v4, v25, v4
L_t3s2_46:
v_exp_f32 v176, v144
ds_read_b128 v[208:211], v3 offset:0
v_exp_f32 v177, v145
ds_read_b64 v[212:213], v5 offset:1024
v_exp_f32 v178, v146
v_exp_f32 v179, v147
v_mfma_f32_32x32x16_bf16 v[128:143], v[224:227], a[16:19], 0
v_perm_b32 v200, v177, v176, s67
v_exp_f32 v180, v148
v_exp_f32 v181, v149
ds_read_b128 v[216:219], v4 offset:0
v_perm_b32 v201, v179, v178, s67
v_exp_f32 v182, v150
v_mfma_f32_32x32x16_bf16 v[128:143], v[228:231], a[20:23], v[128:143]
v_exp_f32 v183, v151
v_perm_b32 v202, v181, v180, s67
v_exp_f32 v184, v152
v_exp_f32 v185, v153
ds_read_b128 v[220:223], v4 offset:640
v_perm_b32 v203, v183, v182, s67
v_mfma_f32_32x32x16_bf16 v[32:47], v[232:235], v[192:195], v[32:47]
v_exp_f32 v186, v154
v_exp_f32 v187, v155
v_perm_b32 v204, v185, v184, s67
v_exp_f32 v188, v156
v_exp_f32 v189, v157
v_mfma_f32_32x32x16_bf16 v[32:47], v[236:239], v[196:199], v[32:47]
v_perm_b32 v205, v187, v186, s67
v_exp_f32 v190, v158
v_exp_f32 v191, v159
v_perm_b32 v206, v189, v188, s67
v_perm_b32 v207, v191, v190, s67
v_exp_f32 v160, v128
v_exp_f32 v161, v129
v_exp_f32 v162, v130
v_exp_f32 v163, v131
v_mfma_f32_32x32x16_bf16 v[144:159], v[224:227], a[24:27], 0
v_perm_b32 v192, v161, v160, s67
v_exp_f32 v164, v132
v_exp_f32 v165, v133
v_perm_b32 v193, v163, v162, s67
v_exp_f32 v166, v134
v_mfma_f32_32x32x16_bf16 v[144:159], v[228:231], a[28:31], v[144:159]
v_exp_f32 v167, v135
v_perm_b32 v194, v165, v164, s67
v_exp_f32 v168, v136
v_exp_f32 v169, v137
v_perm_b32 v195, v167, v166, s67
v_mfma_f32_32x32x16_bf16 v[48:63], v[232:235], v[200:203], v[48:63]
v_exp_f32 v170, v138
v_exp_f32 v171, v139
v_perm_b32 v196, v169, v168, s67
v_exp_f32 v172, v140
v_exp_f32 v173, v141
v_mfma_f32_32x32x16_bf16 v[48:63], v[236:239], v[204:207], v[48:63]
v_perm_b32 v197, v171, v170, s67
v_exp_f32 v174, v142
v_exp_f32 v175, v143
v_perm_b32 v198, v173, v172, s67
v_perm_b32 v199, v175, v174, s67
v_exp_f32 v176, v144
v_exp_f32 v177, v145
v_exp_f32 v178, v146
v_exp_f32 v179, v147
v_mfma_f32_32x32x16_bf16 v[128:143], v[224:227], a[32:35], 0
v_perm_b32 v200, v177, v176, s67
v_exp_f32 v180, v148
v_exp_f32 v181, v149
v_perm_b32 v201, v179, v178, s67
v_exp_f32 v182, v150
v_mfma_f32_32x32x16_bf16 v[128:143], v[228:231], a[36:39], v[128:143]
v_exp_f32 v183, v151
v_perm_b32 v202, v181, v180, s67
v_exp_f32 v184, v152
v_exp_f32 v185, v153
v_perm_b32 v203, v183, v182, s67
v_mfma_f32_32x32x16_bf16 v[64:79], v[232:235], v[192:195], v[64:79]
v_exp_f32 v186, v154
v_exp_f32 v187, v155
v_perm_b32 v204, v185, v184, s67
v_exp_f32 v188, v156
v_exp_f32 v189, v157
v_mfma_f32_32x32x16_bf16 v[64:79], v[236:239], v[196:199], v[64:79]
v_perm_b32 v205, v187, v186, s67
v_exp_f32 v190, v158
v_exp_f32 v191, v159
v_perm_b32 v206, v189, v188, s67
v_perm_b32 v207, v191, v190, s67
v_exp_f32 v160, v128
v_exp_f32 v161, v129
v_exp_f32 v162, v130
v_exp_f32 v163, v131
v_mfma_f32_32x32x16_bf16 v[144:159], v[224:227], a[40:43], 0
v_perm_b32 v192, v161, v160, s67
v_exp_f32 v164, v132
v_exp_f32 v165, v133
v_perm_b32 v193, v163, v162, s67
v_exp_f32 v166, v134
v_mfma_f32_32x32x16_bf16 v[144:159], v[228:231], a[44:47], v[144:159]
v_exp_f32 v167, v135
v_perm_b32 v194, v165, v164, s67
v_exp_f32 v168, v136
v_exp_f32 v169, v137
v_perm_b32 v195, v167, v166, s67
v_mfma_f32_32x32x16_bf16 v[80:95], v[232:235], v[200:203], v[80:95]
v_exp_f32 v170, v138
v_exp_f32 v171, v139
v_perm_b32 v196, v169, v168, s67
v_exp_f32 v172, v140
v_exp_f32 v173, v141
v_mfma_f32_32x32x16_bf16 v[80:95], v[236:239], v[204:207], v[80:95]
v_perm_b32 v197, v171, v170, s67
v_exp_f32 v174, v142
v_exp_f32 v175, v143
v_perm_b32 v198, v173, v172, s67
v_perm_b32 v199, v175, v174, s67
v_exp_f32 v176, v144
v_exp_f32 v177, v145
v_exp_f32 v178, v146
v_exp_f32 v179, v147
s_waitcnt lgkmcnt(0)
v_mfma_f32_32x32x16_bf16 v[128:143], v[208:211], a[0:3], 0
v_perm_b32 v200, v177, v176, s67
v_exp_f32 v180, v148
v_exp_f32 v181, v149
v_perm_b32 v201, v179, v178, s67
v_exp_f32 v182, v150
v_mfma_f32_32x32x16_bf16 v[128:143], v[212:215], a[4:7], v[128:143]
v_exp_f32 v183, v151
v_perm_b32 v202, v181, v180, s67
v_exp_f32 v184, v152
v_exp_f32 v185, v153
v_perm_b32 v203, v183, v182, s67
v_mfma_f32_32x32x16_bf16 v[96:111], v[232:235], v[192:195], v[96:111]
v_exp_f32 v186, v154
v_exp_f32 v187, v155
v_perm_b32 v204, v185, v184, s67
v_exp_f32 v188, v156
v_exp_f32 v189, v157
v_mfma_f32_32x32x16_bf16 v[96:111], v[236:239], v[196:199], v[96:111]
v_perm_b32 v205, v187, v186, s67
v_exp_f32 v190, v158
v_exp_f32 v191, v159
v_perm_b32 v206, v189, v188, s67
v_perm_b32 v207, v191, v190, s67
s_add_u32 s61, s61, 1
s_cmp_lt_u32 s61, 32
s_cbranch_scc1 L_t3ch_42
v_mfma_f32_32x32x16_bf16 v[112:127], v[232:235], v[200:203], v[112:127]
v_mfma_f32_32x32x16_bf16 v[112:127], v[236:239], v[204:207], v[112:127]
s_mov_b64 s[72:73], 0
v_mov_b32 v240, 0x5f800000
v_cmp_nlt_f32 vcc, v40, v240
s_or_b64 s[72:73], s[72:73], vcc
v_cmp_nlt_f32 vcc, v56, v240
s_or_b64 s[72:73], s[72:73], vcc
v_cmp_nlt_f32 vcc, v72, v240
s_or_b64 s[72:73], s[72:73], vcc
v_cmp_nlt_f32 vcc, v88, v240
s_or_b64 s[72:73], s[72:73], vcc
v_cmp_nlt_f32 vcc, v104, v240
s_or_b64 s[72:73], s[72:73], vcc
v_cmp_nlt_f32 vcc, v120, v240
s_or_b64 s[72:73], s[72:73], vcc
s_cmp_lg_u32 s73, 0
s_cselect_b32 s48, 1, 0
s_lshl_b32 s49, s44, 2
s_add_u32 s49, s49, 98304
v_mov_b32 v240, s49
v_mov_b32 v241, s48
ds_write_b32 v240, v241
v_mov_b32 v240, 98304
s_waitcnt vmcnt(0) lgkmcnt(0)
s_barrier
ds_read_b128 v[244:247], v240
s_waitcnt lgkmcnt(0)
v_or3_b32 v240, v244, v245, v246
v_or_b32 v240, v240, v247
s_nop 0
v_readfirstlane_b32 s48, v240
s_cmp_eq_u32 s48, 0
s_cbranch_scc1 L_t3ok_47
v_accvgpr_write_b32 a6, 0
v_accvgpr_write_b32 a7, 0
v_mov_b32 v8, 0
v_mov_b32 v32, 0
v_mov_b32 v33, 0
v_mov_b32 v34, 0
v_mov_b32 v35, 0
v_mov_b32 v36, 0
v_mov_b32 v37, 0
v_mov_b32 v38, 0
v_mov_b32 v39, 0
v_mov_b32 v40, 0
v_mov_b32 v41, 0
v_mov_b32 v42, 0
v_mov_b32 v43, 0
v_mov_b32 v44, 0
v_mov_b32 v45, 0
v_mov_b32 v46, 0
v_mov_b32 v47, 0
v_accvgpr_write_b32 a14, 0
v_accvgpr_write_b32 a15, 0
v_mov_b32 v9, 0
v_mov_b32 v48, 0
v_mov_b32 v49, 0
v_mov_b32 v50, 0
v_mov_b32 v51, 0
v_mov_b32 v52, 0
v_mov_b32 v53, 0
v_mov_b32 v54, 0
v_mov_b32 v55, 0
v_mov_b32 v56, 0
v_mov_b32 v57, 0
v_mov_b32 v58, 0
v_mov_b32 v59, 0
v_mov_b32 v60, 0
v_mov_b32 v61, 0
v_mov_b32 v62, 0
v_mov_b32 v63, 0
v_accvgpr_write_b32 a22, 0
v_accvgpr_write_b32 a23, 0
v_mov_b32 v10, 0
v_mov_b32 v64, 0
v_mov_b32 v65, 0
v_mov_b32 v66, 0
v_mov_b32 v67, 0
v_mov_b32 v68, 0
v_mov_b32 v69, 0
v_mov_b32 v70, 0
v_mov_b32 v71, 0
v_mov_b32 v72, 0
v_mov_b32 v73, 0
v_mov_b32 v74, 0
v_mov_b32 v75, 0
v_mov_b32 v76, 0
v_mov_b32 v77, 0
v_mov_b32 v78, 0
v_mov_b32 v79, 0
v_accvgpr_write_b32 a30, 0
v_accvgpr_write_b32 a31, 0
v_mov_b32 v11, 0
v_mov_b32 v80, 0
v_mov_b32 v81, 0
v_mov_b32 v82, 0
v_mov_b32 v83, 0
v_mov_b32 v84, 0
v_mov_b32 v85, 0
v_mov_b32 v86, 0
v_mov_b32 v87, 0
v_mov_b32 v88, 0
v_mov_b32 v89, 0
v_mov_b32 v90, 0
v_mov_b32 v91, 0
v_mov_b32 v92, 0
v_mov_b32 v93, 0
v_mov_b32 v94, 0
v_mov_b32 v95, 0
v_accvgpr_write_b32 a38, 0
v_accvgpr_write_b32 a39, 0
v_mov_b32 v12, 0
v_mov_b32 v96, 0
v_mov_b32 v97, 0
v_mov_b32 v98, 0
v_mov_b32 v99, 0
v_mov_b32 v100, 0
v_mov_b32 v101, 0
v_mov_b32 v102, 0
v_mov_b32 v103, 0
v_mov_b32 v104, 0
v_mov_b32 v105, 0
v_mov_b32 v106, 0
v_mov_b32 v107, 0
v_mov_b32 v108, 0
v_mov_b32 v109, 0
v_mov_b32 v110, 0
v_mov_b32 v111, 0
v_accvgpr_write_b32 a46, 0
v_accvgpr_write_b32 a47, 0
v_mov_b32 v13, 0
v_mov_b32 v112, 0
v_mov_b32 v113, 0
v_mov_b32 v114, 0
v_mov_b32 v115, 0
v_mov_b32 v116, 0
v_mov_b32 v117, 0
v_mov_b32 v118, 0
v_mov_b32 v119, 0
v_mov_b32 v120, 0
v_mov_b32 v121, 0
v_mov_b32 v122, 0
v_mov_b32 v123, 0
v_mov_b32 v124, 0
v_mov_b32 v125, 0
v_mov_b32 v126, 0
v_mov_b32 v127, 0
s_mov_b32 s57, s70
v_mov_b32 v200, 0
v_mov_b32 v232, 0
v_mov_b32 v201, 0
v_mov_b32 v233, 0
v_mov_b32 v202, 0
v_mov_b32 v234, 0
v_mov_b32 v203, 0
v_mov_b32 v235, 0
v_mov_b32 v204, 0
v_mov_b32 v236, 0
v_mov_b32 v205, 0
v_mov_b32 v237, 0
v_mov_b32 v206, 0
v_mov_b32 v238, 0
v_mov_b32 v207, 0
v_mov_b32 v239, 0
s_mov_b32 s58, 0
s_mov_b32 s60, s66
s_mov_b32 s59, 0
s_mov_b32 s61, 0
s_mov_b32 m0, s60
s_add_u32 s49, s57, 4096
buffer_load_dwordx4 v2, s[4:7], s57 offen sc1 lds
buffer_load_dwordx4 v2, s[4:7], s57 offen offset:1024 sc1 lds
buffer_load_dwordx4 v2, s[4:7], s57 offen offset:2048 sc1 lds
buffer_load_dwordx4 v2, s[4:7], s57 offen offset:3072 sc1 lds
s_add_u32 m0, s60, 4096
s_add_u32 s57, s57, 10240
buffer_load_dwordx4 v2, s[4:7], s49 offen sc1 lds
s_add_u32 s58, s58, 1
s_and_b32 s49, s58, 3
s_mul_i32 s49, s49, 20480
s_add_u32 s60, s66, s49
s_mov_b32 m0, s60
s_add_u32 s49, s57, 4096
buffer_load_dwordx4 v2, s[4:7], s57 offen sc1 lds
buffer_load_dwordx4 v2, s[4:7], s57 offen offset:1024 sc1 lds
buffer_load_dwordx4 v2, s[4:7], s57 offen offset:2048 sc1 lds
buffer_load_dwordx4 v2, s[4:7], s57 offen offset:3072 sc1 lds
s_add_u32 m0, s60, 4096
s_add_u32 s57, s57, 10240
buffer_load_dwordx4 v2, s[4:7], s49 offen sc1 lds
s_add_u32 s58, s58, 1
s_and_b32 s49, s58, 3
s_mul_i32 s49, s49, 20480
s_add_u32 s60, s66, s49
v_mov_b32 v3, v2
v_mov_b32 v4, v6
v_mov_b32 v5, v24
s_waitcnt vmcnt(5) lgkmcnt(0)
s_barrier
ds_read_b128 v[208:211], v3 offset:0
ds_read_b64 v[212:213], v5 offset:1024
ds_read_b128 v[216:219], v4 offset:0
ds_read_b128 v[220:223], v4 offset:640
s_waitcnt lgkmcnt(0)
v_mfma_f32_32x32x16_bf16 v[144:159], v[208:211], a[8:11], 0
v_mfma_f32_32x32x16_bf16 v[144:159], v[212:215], a[12:15], v[144:159]
s_nop 10
s_nop 0
v_max3_f32 v240, v144, v145, v146
v_max3_f32 v240, v240, v147, v148
v_max3_f32 v240, v240, v149, v150
v_max3_f32 v240, v240, v151, v152
v_max3_f32 v240, v240, v153, v154
v_max3_f32 v240, v240, v155, v156
v_max3_f32 v240, v240, v157, v158
v_max_f32 v240, v240, v159
v_mov_b32 v241, v240
s_nop 0
s_nop 0
v_permlane32_swap_b32 v240, v241
v_max_f32 v240, v240, v241
v_add_f32 v240, 0x41400000, v240
v_add_f32 v240, v240, v9
v_sub_f32 v242, v240, v9
v_mov_b32 v9, v240
v_xor_b32 v240, 0x80000000, v240
v_and_b32 v241, 0xffff0000, v240
v_sub_f32 v240, v240, v241
v_and_b32 v242, 0xffff0000, v240
v_sub_f32 v240, v240, v242
v_perm_b32 v241, v242, v241, s67
v_lshrrev_b32 v240, 16, v240
v_cndmask_b32 v241, v241, 0, s[64:65]
v_cndmask_b32 v240, v240, 0, s[64:65]
v_accvgpr_write_b32 a14, v241
v_accvgpr_write_b32 a15, v240
v_mfma_f32_32x32x16_bf16 v[128:143], v[208:211], a[16:19], 0
v_mfma_f32_32x32x16_bf16 v[128:143], v[212:215], a[20:23], v[128:143]
s_nop 10
s_nop 0
v_max3_f32 v240, v128, v129, v130
v_max3_f32 v240, v240, v131, v132
v_max3_f32 v240, v240, v133, v134
v_max3_f32 v240, v240, v135, v136
v_max3_f32 v240, v240, v137, v138
v_max3_f32 v240, v240, v139, v140
v_max3_f32 v240, v240, v141, v142
v_max_f32 v240, v240, v143
v_mov_b32 v241, v240
s_nop 0
s_nop 0
v_permlane32_swap_b32 v240, v241
v_max_f32 v240, v240, v241
v_add_f32 v240, 0x41400000, v240
v_add_f32 v240, v240, v10
v_sub_f32 v242, v240, v10
v_mov_b32 v10, v240
v_xor_b32 v240, 0x80000000, v240
v_and_b32 v241, 0xffff0000, v240
v_sub_f32 v240, v240, v241
v_and_b32 v242, 0xffff0000, v240
v_sub_f32 v240, v240, v242
v_perm_b32 v241, v242, v241, s67
v_lshrrev_b32 v240, 16, v240
v_cndmask_b32 v241, v241, 0, s[64:65]
v_cndmask_b32 v240, v240, 0, s[64:65]
v_accvgpr_write_b32 a22, v241
v_accvgpr_write_b32 a23, v240
v_mfma_f32_32x32x16_bf16 v[144:159], v[208:211], a[24:27], 0
v_mfma_f32_32x32x16_bf16 v[144:159], v[212:215], a[28:31], v[144:159]
s_nop 10
s_nop 0
v_max3_f32 v240, v144, v145, v146
v_max3_f32 v240, v240, v147, v148
v_max3_f32 v240, v240, v149, v150
v_max3_f32 v240, v240, v151, v152
v_max3_f32 v240, v240, v153, v154
v_max3_f32 v240, v240, v155, v156
v_max3_f32 v240, v240, v157, v158
v_max_f32 v240, v240, v159
v_mov_b32 v241, v240
s_nop 0
s_nop 0
v_permlane32_swap_b32 v240, v241
v_max_f32 v240, v240, v241
v_add_f32 v240, 0x41400000, v240
v_add_f32 v240, v240, v11
v_sub_f32 v242, v240, v11
v_mov_b32 v11, v240
v_xor_b32 v240, 0x80000000, v240
v_and_b32 v241, 0xffff0000, v240
v_sub_f32 v240, v240, v241
v_and_b32 v242, 0xffff0000, v240
v_sub_f32 v240, v240, v242
v_perm_b32 v241, v242, v241, s67
v_lshrrev_b32 v240, 16, v240
v_cndmask_b32 v241, v241, 0, s[64:65]
v_cndmask_b32 v240, v240, 0, s[64:65]
v_accvgpr_write_b32 a30, v241
v_accvgpr_write_b32 a31, v240
v_mfma_f32_32x32x16_bf16 v[128:143], v[208:211], a[32:35], 0
v_mfma_f32_32x32x16_bf16 v[128:143], v[212:215], a[36:39], v[128:143]
s_nop 10
s_nop 0
v_max3_f32 v240, v128, v129, v130
v_max3_f32 v240, v240, v131, v132
v_max3_f32 v240, v240, v133, v134
v_max3_f32 v240, v240, v135, v136
v_max3_f32 v240, v240, v137, v138
v_max3_f32 v240, v240, v139, v140
v_max3_f32 v240, v240, v141, v142
v_max_f32 v240, v240, v143
v_mov_b32 v241, v240
s_nop 0
s_nop 0
v_permlane32_swap_b32 v240, v241
v_max_f32 v240, v240, v241
v_add_f32 v240, 0x41400000, v240
v_add_f32 v240, v240, v12
v_sub_f32 v242, v240, v12
v_mov_b32 v12, v240
v_xor_b32 v240, 0x80000000, v240
v_and_b32 v241, 0xffff0000, v240
v_sub_f32 v240, v240, v241
v_and_b32 v242, 0xffff0000, v240
v_sub_f32 v240, v240, v242
v_perm_b32 v241, v242, v241, s67
v_lshrrev_b32 v240, 16, v240
v_cndmask_b32 v241, v241, 0, s[64:65]
v_cndmask_b32 v240, v240, 0, s[64:65]
v_accvgpr_write_b32 a38, v241
v_accvgpr_write_b32 a39, v240
v_mfma_f32_32x32x16_bf16 v[144:159], v[208:211], a[40:43], 0
v_mfma_f32_32x32x16_bf16 v[144:159], v[212:215], a[44:47], v[144:159]
s_nop 10
s_nop 0
v_max3_f32 v240, v144, v145, v146
v_max3_f32 v240, v240, v147, v148
v_max3_f32 v240, v240, v149, v150
v_max3_f32 v240, v240, v151, v152
v_max3_f32 v240, v240, v153, v154
v_max3_f32 v240, v240, v155, v156
v_max3_f32 v240, v240, v157, v158
v_max_f32 v240, v240, v159
v_mov_b32 v241, v240
s_nop 0
s_nop 0
v_permlane32_swap_b32 v240, v241
v_max_f32 v240, v240, v241
v_add_f32 v240, 0x41400000, v240
v_add_f32 v240, v240, v13
v_sub_f32 v242, v240, v13
v_mov_b32 v13, v240
v_xor_b32 v240, 0x80000000, v240
v_and_b32 v241, 0xffff0000, v240
v_sub_f32 v240, v240, v241
v_and_b32 v242, 0xffff0000, v240
v_sub_f32 v240, v240, v242
v_perm_b32 v241, v242, v241, s67
v_lshrrev_b32 v240, 16, v240
v_cndmask_b32 v241, v241, 0, s[64:65]
v_cndmask_b32 v240, v240, 0, s[64:65]
v_accvgpr_write_b32 a46, v241
v_accvgpr_write_b32 a47, v240
v_mfma_f32_32x32x16_bf16 v[128:143], v[208:211], a[0:3], 0
v_mfma_f32_32x32x16_bf16 v[128:143], v[212:215], a[4:7], v[128:143]
s_nop 10
s_nop 0
v_max3_f32 v240, v128, v129, v130
v_max3_f32 v240, v240, v131, v132
v_max3_f32 v240, v240, v133, v134
v_max3_f32 v240, v240, v135, v136
v_max3_f32 v240, v240, v137, v138
v_max3_f32 v240, v240, v139, v140
v_max3_f32 v240, v240, v141, v142
v_max_f32 v240, v240, v143
v_mov_b32 v241, v240
s_nop 0
s_nop 0
v_permlane32_swap_b32 v240, v241
v_max_f32 v240, v240, v241
v_add_f32 v240, 0x41400000, v240
v_add_f32 v240, v240, v8
v_sub_f32 v242, v240, v8
v_mov_b32 v8, v240
v_xor_b32 v240, 0x80000000, v240
v_and_b32 v241, 0xffff0000, v240
v_sub_f32 v240, v240, v241
v_and_b32 v242, 0xffff0000, v240
v_sub_f32 v240, v240, v242
v_perm_b32 v241, v242, v241, s67
v_lshrrev_b32 v240, 16, v240
v_cndmask_b32 v241, v241, 0, s[64:65]
v_cndmask_b32 v240, v240, 0, s[64:65]
v_accvgpr_write_b32 a6, v241
v_accvgpr_write_b32 a7, v240
v_mfma_f32_32x32x16_bf16 v[128:143], v[208:211], a[0:3], 0
s_nop 0
v_mfma_f32_32x32x16_bf16 v[128:143], v[212:215], a[4:7], v[128:143]
s_mov_b64 vcc, 0
s_mov_b32 s69, 0
L_t3ch_48:
s_nop 7
s_nop 1
v_exp_f32 v160, v128
v_exp_f32 v161, v129
v_exp_f32 v162, v130
v_exp_f32 v163, v131
s_cbranch_vccnz L_t3r_49
L_t3b_50:
v_mfma_f32_32x32x16_bf16 v[144:159], v[208:211], a[8:11], 0
v_perm_b32 v192, v161, v160, s67
v_exp_f32 v164, v132
v_exp_f32 v165, v133
v_perm_b32 v193, v163, v162, s67
v_exp_f32 v166, v134
v_exp_f32 v167, v135
v_mfma_f32_32x32x16_bf16 v[144:159], v[212:215], a[12:15], v[144:159]
v_perm_b32 v194, v165, v164, s67
v_or3_b32 v244, v192, v193, v194
v_exp_f32 v168, v136
v_exp_f32 v169, v137
v_perm_b32 v195, v167, v166, s67
v_exp_f32 v170, v138
v_mfma_f32_32x32x16_bf16 v[112:127], v[232:235], v[200:203], v[112:127]
v_exp_f32 v171, v139
v_perm_b32 v196, v169, v168, s67
v_or3_b32 v244, v244, v195, v196
v_exp_f32 v172, v140
v_exp_f32 v173, v141
v_perm_b32 v197, v171, v170, s67
v_mfma_f32_32x32x16_bf16 v[112:127], v[236:239], v[204:207], v[112:127]
v_exp_f32 v174, v142
v_exp_f32 v175, v143
v_perm_b32 v198, v173, v172, s67
v_or3_b32 v244, v244, v197, v198
v_perm_b32 v199, v175, v174, s67
v_bitop3_b32 v244, v244, v199, s68 bitop3:0xa8
v_cmp_ne_u32 vcc, 0, v244
s_cmp_eq_u32 s69, 0
s_cbranch_scc1 L_t3d_51
L_t3d2_52:
v_exp_f32 v176, v144
ds_read_b128 v[224:227], v3 offset:1280
v_exp_f32 v177, v145
ds_read_b64 v[228:229], v5 offset:2304
v_exp_f32 v178, v146
v_exp_f32 v179, v147
s_cbranch_vccnz L_t3r_53
L_t3b_54:
v_mfma_f32_32x32x16_bf16 v[128:143], v[208:211], a[16:19], 0
v_perm_b32 v200, v177, v176, s67
v_exp_f32 v180, v148
v_exp_f32 v181, v149
ds_read_b128 v[232:235], v4 offset:1280
v_perm_b32 v201, v179, v178, s67
v_exp_f32 v182, v150
v_exp_f32 v183, v151
v_mfma_f32_32x32x16_bf16 v[128:143], v[212:215], a[20:23], v[128:143]
v_perm_b32 v202, v181, v180, s67
v_or3_b32 v244, v200, v201, v202
v_exp_f32 v184, v152
ds_read_b128 v[236:239], v4 offset:1920
v_exp_f32 v185, v153
v_perm_b32 v203, v183, v182, s67
v_exp_f32 v186, v154
v_mfma_f32_32x32x16_bf16 v[32:47], v[216:219], v[192:195], v[32:47]
v_exp_f32 v187, v155
v_perm_b32 v204, v185, v184, s67
v_or3_b32 v244, v244, v203, v204
v_exp_f32 v188, v156
v_exp_f32 v189, v157
v_perm_b32 v205, v187, v186, s67
v_mfma_f32_32x32x16_bf16 v[32:47], v[220:223], v[196:199], v[32:47]
v_exp_f32 v190, v158
v_exp_f32 v191, v159
v_perm_b32 v206, v189, v188, s67
v_or3_b32 v244, v244, v205, v206
v_perm_b32 v207, v191, v190, s67
v_bitop3_b32 v244, v244, v207, s68 bitop3:0xa8
v_cmp_ne_u32 vcc, 0, v244
v_exp_f32 v160, v128
v_exp_f32 v161, v129
v_exp_f32 v162, v130
v_exp_f32 v163, v131
s_cbranch_vccnz L_t3r_55
L_t3b_56:
v_mfma_f32_32x32x16_bf16 v[144:159], v[208:211], a[24:27], 0
v_perm_b32 v192, v161, v160, s67
v_exp_f32 v164, v132
v_exp_f32 v165, v133
v_perm_b32 v193, v163, v162, s67
v_exp_f32 v166, v134
v_exp_f32 v167, v135
v_mfma_f32_32x32x16_bf16 v[144:159], v[212:215], a[28:31], v[144:159]
v_perm_b32 v194, v165, v164, s67
v_or3_b32 v244, v192, v193, v194
v_exp_f32 v168, v136
v_exp_f32 v169, v137
v_perm_b32 v195, v167, v166, s67
v_exp_f32 v170, v138
v_mfma_f32_32x32x16_bf16 v[48:63], v[216:219], v[200:203], v[48:63]
v_exp_f32 v171, v139
v_perm_b32 v196, v169, v168, s67
v_or3_b32 v244, v244, v195, v196
v_exp_f32 v172, v140
v_exp_f32 v173, v141
v_perm_b32 v197, v171, v170, s67
v_mfma_f32_32x32x16_bf16 v[48:63], v[220:223], v[204:207], v[48:63]
v_exp_f32 v174, v142
v_exp_f32 v175, v143
v_perm_b32 v198, v173, v172, s67
v_or3_b32 v244, v244, v197, v198
v_perm_b32 v199, v175, v174, s67
v_bitop3_b32 v244, v244, v199, s68 bitop3:0xa8
v_cmp_ne_u32 vcc, 0, v244
v_exp_f32 v176, v144
v_exp_f32 v177, v145
v_exp_f32 v178, v146
v_exp_f32 v179, v147
s_cbranch_vccnz L_t3r_57
L_t3b_58:
v_mfma_f32_32x32x16_bf16 v[128:143], v[208:211], a[32:35], 0
v_perm_b32 v200, v177, v176, s67
v_exp_f32 v180, v148
v_exp_f32 v181, v149
v_perm_b32 v201, v179, v178, s67
v_exp_f32 v182, v150
v_exp_f32 v183, v151
v_mfma_f32_32x32x16_bf16 v[128:143], v[212:215], a[36:39], v[128:143]
v_perm_b32 v202, v181, v180, s67
v_or3_b32 v244, v200, v201, v202
v_exp_f32 v184, v152
v_exp_f32 v185, v153
v_perm_b32 v203, v183, v182, s67
v_exp_f32 v186, v154
v_mfma_f32_32x32x16_bf16 v[64:79], v[216:219], v[192:195], v[64:79]
v_exp_f32 v187, v155
v_perm_b32 v204, v185, v184, s67
v_or3_b32 v244, v244, v203, v204
v_exp_f32 v188, v156
v_exp_f32 v189, v157
v_perm_b32 v205, v187, v186, s67
v_mfma_f32_32x32x16_bf16 v[64:79], v[220:223], v[196:199], v[64:79]
v_exp_f32 v190, v158
v_exp_f32 v191, v159
v_perm_b32 v206, v189, v188, s67
v_or3_b32 v244, v244, v205, v206
v_perm_b32 v207, v191, v190, s67
v_bitop3_b32 v244, v244, v207, s68 bitop3:0xa8
v_cmp_ne_u32 vcc, 0, v244
v_exp_f32 v160, v128
v_exp_f32 v161, v129
v_exp_f32 v162, v130
v_exp_f32 v163, v131
s_cbranch_vccnz L_t3r_59
L_t3b_60:
v_mfma_f32_32x32x16_bf16 v[144:159], v[208:211], a[40:43], 0
v_perm_b32 v192, v161, v160, s67
v_exp_f32 v164, v132
v_exp_f32 v165, v133
v_perm_b32 v193, v163, v162, s67
v_exp_f32 v166, v134
v_exp_f32 v167, v135
v_mfma_f32_32x32x16_bf16 v[144:159], v[212:215], a[44:47], v[144:159]
v_perm_b32 v194, v165, v164, s67
v_or3_b32 v244, v192, v193, v194
v_exp_f32 v168, v136
v_exp_f32 v169, v137
v_perm_b32 v195, v167, v166, s67
v_exp_f32 v170, v138
v_mfma_f32_32x32x16_bf16 v[80:95], v[216:219], v[200:203], v[80:95]
v_exp_f32 v171, v139
v_perm_b32 v196, v169, v168, s67
v_or3_b32 v244, v244, v195, v196
v_exp_f32 v172, v140
v_exp_f32 v173, v141
v_perm_b32 v197, v171, v170, s67
v_mfma_f32_32x32x16_bf16 v[80:95], v[220:223], v[204:207], v[80:95]
v_exp_f32 v174, v142
v_exp_f32 v175, v143
v_perm_b32 v198, v173, v172, s67
v_or3_b32 v244, v244, v197, v198
v_perm_b32 v199, v175, v174, s67
v_bitop3_b32 v244, v244, v199, s68 bitop3:0xa8
v_cmp_ne_u32 vcc, 0, v244
v_exp_f32 v176, v144
v_exp_f32 v177, v145
v_exp_f32 v178, v146
v_exp_f32 v179, v147
s_cbranch_vccnz L_t3r_61
L_t3b_62:
s_waitcnt lgkmcnt(0)
v_mfma_f32_32x32x16_bf16 v[128:143], v[224:227], a[0:3], 0
v_perm_b32 v200, v177, v176, s67
v_exp_f32 v180, v148
v_exp_f32 v181, v149
v_perm_b32 v201, v179, v178, s67
v_exp_f32 v182, v150
v_exp_f32 v183, v151
v_mfma_f32_32x32x16_bf16 v[128:143], v[228:231], a[4:7], v[128:143]
v_perm_b32 v202, v181, v180, s67
v_or3_b32 v244, v200, v201, v202
v_exp_f32 v184, v152
v_exp_f32 v185, v153
v_perm_b32 v203, v183, v182, s67
v_exp_f32 v186, v154
v_mfma_f32_32x32x16_bf16 v[96:111], v[216:219], v[192:195], v[96:111]
v_exp_f32 v187, v155
v_perm_b32 v204, v185, v184, s67
v_or3_b32 v244, v244, v203, v204
v_exp_f32 v188, v156
v_exp_f32 v189, v157
v_perm_b32 v205, v187, v186, s67
v_mfma_f32_32x32x16_bf16 v[96:111], v[220:223], v[196:199], v[96:111]
v_exp_f32 v190, v158
v_exp_f32 v191, v159
v_perm_b32 v206, v189, v188, s67
v_or3_b32 v244, v244, v205, v206
v_perm_b32 v207, v191, v190, s67
v_bitop3_b32 v244, v244, v207, s68 bitop3:0xa8
v_cmp_ne_u32 vcc, 0, v244
v_exp_f32 v160, v128
v_exp_f32 v161, v129
v_exp_f32 v162, v130
v_exp_f32 v163, v131
s_cbranch_vccnz L_t3r_63
L_t3b_64:
v_mfma_f32_32x32x16_bf16 v[144:159], v[224:227], a[8:11], 0
v_perm_b32 v192, v161, v160, s67
v_exp_f32 v164, v132
v_exp_f32 v165, v133
v_perm_b32 v193, v163, v162, s67
v_exp_f32 v166, v134
v_exp_f32 v167, v135
v_mfma_f32_32x32x16_bf16 v[144:159], v[228:231], a[12:15], v[144:159]
v_perm_b32 v194, v165, v164, s67
v_or3_b32 v244, v192, v193, v194
v_exp_f32 v168, v136
v_exp_f32 v169, v137
v_perm_b32 v195, v167, v166, s67
v_exp_f32 v170, v138
v_mfma_f32_32x32x16_bf16 v[112:127], v[216:219], v[200:203], v[112:127]
v_exp_f32 v171, v139
v_perm_b32 v196, v169, v168, s67
v_or3_b32 v244, v244, v195, v196
v_exp_f32 v172, v140
v_exp_f32 v173, v141
v_perm_b32 v197, v171, v170, s67
v_mfma_f32_32x32x16_bf16 v[112:127], v[220:223], v[204:207], v[112:127]
v_exp_f32 v174, v142
v_exp_f32 v175, v143
v_perm_b32 v198, v173, v172, s67
v_or3_b32 v244, v244, v197, v198
v_perm_b32 v199, v175, v174, s67
v_bitop3_b32 v244, v244, v199, s68 bitop3:0xa8
v_cmp_ne_u32 vcc, 0, v244
s_add_u32 s69, s69, 1
s_and_b32 s69, s69, 3
s_cbranch_scc0 L_t3s_65
v_add_u32 v3, 2560, v3
v_add_u32 v5, 2560, v5
v_add_u32 v4, v25, v4
L_t3s2_66:
v_exp_f32 v176, v144
ds_read_b128 v[208:211], v3 offset:0
v_exp_f32 v177, v145
ds_read_b64 v[212:213], v5 offset:1024
v_exp_f32 v178, v146
v_exp_f32 v179, v147
s_cbranch_vccnz L_t3r_67
L_t3b_68:
v_mfma_f32_32x32x16_bf16 v[128:143], v[224:227], a[16:19], 0
v_perm_b32 v200, v177, v176, s67
v_exp_f32 v180, v148
v_exp_f32 v181, v149
ds_read_b128 v[216:219], v4 offset:0
v_perm_b32 v201, v179, v178, s67
v_exp_f32 v182, v150
v_exp_f32 v183, v151
v_mfma_f32_32x32x16_bf16 v[128:143], v[228:231], a[20:23], v[128:143]
v_perm_b32 v202, v181, v180, s67
v_or3_b32 v244, v200, v201, v202
v_exp_f32 v184, v152
ds_read_b128 v[220:223], v4 offset:640
v_exp_f32 v185, v153
v_perm_b32 v203, v183, v182, s67
v_exp_f32 v186, v154
v_mfma_f32_32x32x16_bf16 v[32:47], v[232:235], v[192:195], v[32:47]
v_exp_f32 v187, v155
v_perm_b32 v204, v185, v184, s67
v_or3_b32 v244, v244, v203, v204
v_exp_f32 v188, v156
v_exp_f32 v189, v157
v_perm_b32 v205, v187, v186, s67
v_mfma_f32_32x32x16_bf16 v[32:47], v[236:239], v[196:199], v[32:47]
v_exp_f32 v190, v158
v_exp_f32 v191, v159
v_perm_b32 v206, v189, v188, s67
v_or3_b32 v244, v244, v205, v206
v_perm_b32 v207, v191, v190, s67
v_bitop3_b32 v244, v244, v207, s68 bitop3:0xa8
v_cmp_ne_u32 vcc, 0, v244
v_exp_f32 v160, v128
v_exp_f32 v161, v129
v_exp_f32 v162, v130
v_exp_f32 v163, v131
s_cbranch_vccnz L_t3r_69
L_t3b_70:
v_mfma_f32_32x32x16_bf16 v[144:159], v[224:227], a[24:27], 0
v_perm_b32 v192, v161, v160, s67
v_exp_f32 v164, v132
v_exp_f32 v165, v133
v_perm_b32 v193, v163, v162, s67
v_exp_f32 v166, v134
v_exp_f32 v167, v135
v_mfma_f32_32x32x16_bf16 v[144:159], v[228:231], a[28:31], v[144:159]
v_perm_b32 v194, v165, v164, s67
v_or3_b32 v244, v192, v193, v194
v_exp_f32 v168, v136
v_exp_f32 v169, v137
v_perm_b32 v195, v167, v166, s67
v_exp_f32 v170, v138
v_mfma_f32_32x32x16_bf16 v[48:63], v[232:235], v[200:203], v[48:63]
v_exp_f32 v171, v139
v_perm_b32 v196, v169, v168, s67
v_or3_b32 v244, v244, v195, v196
v_exp_f32 v172, v140
v_exp_f32 v173, v141
v_perm_b32 v197, v171, v170, s67
v_mfma_f32_32x32x16_bf16 v[48:63], v[236:239], v[204:207], v[48:63]
v_exp_f32 v174, v142
v_exp_f32 v175, v143
v_perm_b32 v198, v173, v172, s67
v_or3_b32 v244, v244, v197, v198
v_perm_b32 v199, v175, v174, s67
v_bitop3_b32 v244, v244, v199, s68 bitop3:0xa8
v_cmp_ne_u32 vcc, 0, v244
v_exp_f32 v176, v144
v_exp_f32 v177, v145
v_exp_f32 v178, v146
v_exp_f32 v179, v147
s_cbranch_vccnz L_t3r_71
L_t3b_72:
v_mfma_f32_32x32x16_bf16 v[128:143], v[224:227], a[32:35], 0
v_perm_b32 v200, v177, v176, s67
v_exp_f32 v180, v148
v_exp_f32 v181, v149
v_perm_b32 v201, v179, v178, s67
v_exp_f32 v182, v150
v_exp_f32 v183, v151
v_mfma_f32_32x32x16_bf16 v[128:143], v[228:231], a[36:39], v[128:143]
v_perm_b32 v202, v181, v180, s67
v_or3_b32 v244, v200, v201, v202
v_exp_f32 v184, v152
v_exp_f32 v185, v153
v_perm_b32 v203, v183, v182, s67
v_exp_f32 v186, v154
v_mfma_f32_32x32x16_bf16 v[64:79], v[232:235], v[192:195], v[64:79]
v_exp_f32 v187, v155
v_perm_b32 v204, v185, v184, s67
v_or3_b32 v244, v244, v203, v204
v_exp_f32 v188, v156
v_exp_f32 v189, v157
v_perm_b32 v205, v187, v186, s67
v_mfma_f32_32x32x16_bf16 v[64:79], v[236:239], v[196:199], v[64:79]
v_exp_f32 v190, v158
v_exp_f32 v191, v159
v_perm_b32 v206, v189, v188, s67
v_or3_b32 v244, v244, v205, v206
v_perm_b32 v207, v191, v190, s67
v_bitop3_b32 v244, v244, v207, s68 bitop3:0xa8
v_cmp_ne_u32 vcc, 0, v244
v_exp_f32 v160, v128
v_exp_f32 v161, v129
v_exp_f32 v162, v130
v_exp_f32 v163, v131
s_cbranch_vccnz L_t3r_73
L_t3b_74:
v_mfma_f32_32x32x16_bf16 v[144:159], v[224:227], a[40:43], 0
v_perm_b32 v192, v161, v160, s67
v_exp_f32 v164, v132
v_exp_f32 v165, v133
v_perm_b32 v193, v163, v162, s67
v_exp_f32 v166, v134
v_exp_f32 v167, v135
v_mfma_f32_32x32x16_bf16 v[144:159], v[228:231], a[44:47], v[144:159]
v_perm_b32 v194, v165, v164, s67
v_or3_b32 v244, v192, v193, v194
v_exp_f32 v168, v136
v_exp_f32 v169, v137
v_perm_b32 v195, v167, v166, s67
v_exp_f32 v170, v138
v_mfma_f32_32x32x16_bf16 v[80:95], v[232:235], v[200:203], v[80:95]
v_exp_f32 v171, v139
v_perm_b32 v196, v169, v168, s67
v_or3_b32 v244, v244, v195, v196
v_exp_f32 v172, v140
v_exp_f32 v173, v141
v_perm_b32 v197, v171, v170, s67
v_mfma_f32_32x32x16_bf16 v[80:95], v[236:239], v[204:207], v[80:95]
v_exp_f32 v174, v142
v_exp_f32 v175, v143
v_perm_b32 v198, v173, v172, s67
v_or3_b32 v244, v244, v197, v198
v_perm_b32 v199, v175, v174, s67
v_bitop3_b32 v244, v244, v199, s68 bitop3:0xa8
v_cmp_ne_u32 vcc, 0, v244
v_exp_f32 v176, v144
v_exp_f32 v177, v145
v_exp_f32 v178, v146
v_exp_f32 v179, v147
s_cbranch_vccnz L_t3r_75
L_t3b_76:
s_waitcnt lgkmcnt(0)
v_mfma_f32_32x32x16_bf16 v[128:143], v[208:211], a[0:3], 0
v_perm_b32 v200, v177, v176, s67
v_exp_f32 v180, v148
v_exp_f32 v181, v149
v_perm_b32 v201, v179, v178, s67
v_exp_f32 v182, v150
v_exp_f32 v183, v151
v_mfma_f32_32x32x16_bf16 v[128:143], v[212:215], a[4:7], v[128:143]
v_perm_b32 v202, v181, v180, s67
v_or3_b32 v244, v200, v201, v202
v_exp_f32 v184, v152
v_exp_f32 v185, v153
v_perm_b32 v203, v183, v182, s67
v_exp_f32 v186, v154
v_mfma_f32_32x32x16_bf16 v[96:111], v[232:235], v[192:195], v[96:111]
v_exp_f32 v187, v155
v_perm_b32 v204, v185, v184, s67
v_or3_b32 v244, v244, v203, v204
v_exp_f32 v188, v156
v_exp_f32 v189, v157
v_perm_b32 v205, v187, v186, s67
v_mfma_f32_32x32x16_bf16 v[96:111], v[236:239], v[196:199], v[96:111]
v_exp_f32 v190, v158
v_exp_f32 v191, v159
v_perm_b32 v206, v189, v188, s67
v_or3_b32 v244, v244, v205, v206
v_perm_b32 v207, v191, v190, s67
v_bitop3_b32 v244, v244, v207, s68 bitop3:0xa8
v_cmp_ne_u32 vcc, 0, v244
s_add_u32 s61, s61, 1
s_cmp_lt_u32 s61, 32
s_cbranch_scc1 L_t3ch_48
s_cbranch_vccnz L_t3r_77
L_t3b_78:
v_mfma_f32_32x32x16_bf16 v[112:127], v[232:235], v[200:203], v[112:127]
v_mfma_f32_32x32x16_bf16 v[112:127], v[236:239], v[204:207], v[112:127]
L_t3ok_47:
s_mul_i32 s48, s56, 49152
s_mul_i32 s49, s55, 1536
s_add_u32 s48, s48, s49
s_add_u32 s48, s48, 180355072
v_mov_b32 v246, 1879048192
v_cndmask_b32 v246, v2, v246, s[64:65]
v_mov_b32 v240, v40
v_mov_b32 v242, v40
s_nop 0
s_nop 0
v_permlane32_swap_b32 v240, v242
v_rcp_f32 v242, v242
s_nop 0
v_mul_f32 v242, v242, v16
v_pk_mul_f32 v[32:33], v[32:33], v[242:243] op_sel_hi:[1,0]
v_pk_mul_f32 v[34:35], v[34:35], v[242:243] op_sel_hi:[1,0]
v_cvt_pk_bf16_f32 v160, v32, v33
v_cvt_pk_bf16_f32 v161, v34, v35
v_pk_mul_f32 v[36:37], v[36:37], v[242:243] op_sel_hi:[1,0]
v_pk_mul_f32 v[38:39], v[38:39], v[242:243] op_sel_hi:[1,0]
v_cvt_pk_bf16_f32 v162, v36, v37
v_cvt_pk_bf16_f32 v163, v38, v39
v_pk_mul_f32 v[40:41], v[40:41], v[242:243] op_sel_hi:[1,0]
v_pk_mul_f32 v[42:43], v[42:43], v[242:243] op_sel_hi:[1,0]
v_cvt_pk_bf16_f32 v164, v40, v41
v_cvt_pk_bf16_f32 v165, v42, v43
v_mov_b32 v166, 0
v_mov_b32 v167, 0
v_permlane32_swap_b32 v160, v162
v_permlane32_swap_b32 v161, v163
buffer_store_dwordx4 v[160:163], v2, s[4:7], s48 offen sc1
buffer_store_dwordx4 v[164:167], v246, s[4:7], s48 offen offset:1024 sc1
s_add_u32 s48, s48, 49152
v_mov_b32 v240, v56
v_mov_b32 v242, v56
s_nop 0
s_nop 0
v_permlane32_swap_b32 v240, v242
v_rcp_f32 v242, v242
s_nop 0
v_mul_f32 v242, v242, v17
v_pk_mul_f32 v[48:49], v[48:49], v[242:243] op_sel_hi:[1,0]
v_pk_mul_f32 v[50:51], v[50:51], v[242:243] op_sel_hi:[1,0]
v_cvt_pk_bf16_f32 v176, v48, v49
v_cvt_pk_bf16_f32 v177, v50, v51
v_pk_mul_f32 v[52:53], v[52:53], v[242:243] op_sel_hi:[1,0]
v_pk_mul_f32 v[54:55], v[54:55], v[242:243] op_sel_hi:[1,0]
v_cvt_pk_bf16_f32 v178, v52, v53
v_cvt_pk_bf16_f32 v179, v54, v55
v_pk_mul_f32 v[56:57], v[56:57], v[242:243] op_sel_hi:[1,0]
v_pk_mul_f32 v[58:59], v[58:59], v[242:243] op_sel_hi:[1,0]
v_cvt_pk_bf16_f32 v180, v56, v57
v_cvt_pk_bf16_f32 v181, v58, v59
v_mov_b32 v182, 0
v_mov_b32 v183, 0
v_permlane32_swap_b32 v176, v178
v_permlane32_swap_b32 v177, v179
buffer_store_dwordx4 v[176:179], v2, s[4:7], s48 offen sc1
buffer_store_dwordx4 v[180:183], v246, s[4:7], s48 offen offset:1024 sc1
s_add_u32 s48, s48, 49152
v_mov_b32 v240, v72
v_mov_b32 v242, v72
s_nop 0
s_nop 0
v_permlane32_swap_b32 v240, v242
v_rcp_f32 v242, v242
s_nop 0
v_mul_f32 v242, v242, v18
v_pk_mul_f32 v[64:65], v[64:65], v[242:243] op_sel_hi:[1,0]
v_pk_mul_f32 v[66:67], v[66:67], v[242:243] op_sel_hi:[1,0]
v_cvt_pk_bf16_f32 v160, v64, v65
v_cvt_pk_bf16_f32 v161, v66, v67
v_pk_mul_f32 v[68:69], v[68:69], v[242:243] op_sel_hi:[1,0]
v_pk_mul_f32 v[70:71], v[70:71], v[242:243] op_sel_hi:[1,0]
v_cvt_pk_bf16_f32 v162, v68, v69
v_cvt_pk_bf16_f32 v163, v70, v71
v_pk_mul_f32 v[72:73], v[72:73], v[242:243] op_sel_hi:[1,0]
v_pk_mul_f32 v[74:75], v[74:75], v[242:243] op_sel_hi:[1,0]
v_cvt_pk_bf16_f32 v164, v72, v73
v_cvt_pk_bf16_f32 v165, v74, v75
v_mov_b32 v166, 0
v_mov_b32 v167, 0
v_permlane32_swap_b32 v160, v162
v_permlane32_swap_b32 v161, v163
buffer_store_dwordx4 v[160:163], v2, s[4:7], s48 offen sc1
buffer_store_dwordx4 v[164:167], v246, s[4:7], s48 offen offset:1024 sc1
s_add_u32 s48, s48, 49152
v_mov_b32 v240, v88
v_mov_b32 v242, v88
s_nop 0
s_nop 0
v_permlane32_swap_b32 v240, v242
v_rcp_f32 v242, v242
s_nop 0
v_mul_f32 v242, v242, v19
v_pk_mul_f32 v[80:81], v[80:81], v[242:243] op_sel_hi:[1,0]
v_pk_mul_f32 v[82:83], v[82:83], v[242:243] op_sel_hi:[1,0]
v_cvt_pk_bf16_f32 v176, v80, v81
v_cvt_pk_bf16_f32 v177, v82, v83
v_pk_mul_f32 v[84:85], v[84:85], v[242:243] op_sel_hi:[1,0]
v_pk_mul_f32 v[86:87], v[86:87], v[242:243] op_sel_hi:[1,0]
v_cvt_pk_bf16_f32 v178, v84, v85
v_cvt_pk_bf16_f32 v179, v86, v87
v_pk_mul_f32 v[88:89], v[88:89], v[242:243] op_sel_hi:[1,0]
v_pk_mul_f32 v[90:91], v[90:91], v[242:243] op_sel_hi:[1,0]
v_cvt_pk_bf16_f32 v180, v88, v89
v_cvt_pk_bf16_f32 v181, v90, v91
v_mov_b32 v182, 0
v_mov_b32 v183, 0
v_permlane32_swap_b32 v176, v178
v_permlane32_swap_b32 v177, v179
buffer_store_dwordx4 v[176:179], v2, s[4:7], s48 offen sc1
buffer_store_dwordx4 v[180:183], v246, s[4:7], s48 offen offset:1024 sc1
s_add_u32 s48, s48, 49152
v_mov_b32 v240, v104
v_mov_b32 v242, v104
s_nop 0
s_nop 0
v_permlane32_swap_b32 v240, v242
v_rcp_f32 v242, v242
s_nop 0
v_mul_f32 v242, v242, v20
v_pk_mul_f32 v[96:97], v[96:97], v[242:243] op_sel_hi:[1,0]
v_pk_mul_f32 v[98:99], v[98:99], v[242:243] op_sel_hi:[1,0]
v_cvt_pk_bf16_f32 v160, v96, v97
v_cvt_pk_bf16_f32 v161, v98, v99
v_pk_mul_f32 v[100:101], v[100:101], v[242:243] op_sel_hi:[1,0]
v_pk_mul_f32 v[102:103], v[102:103], v[242:243] op_sel_hi:[1,0]
v_cvt_pk_bf16_f32 v162, v100, v101
v_cvt_pk_bf16_f32 v163, v102, v103
v_pk_mul_f32 v[104:105], v[104:105], v[242:243] op_sel_hi:[1,0]
v_pk_mul_f32 v[106:107], v[106:107], v[242:243] op_sel_hi:[1,0]
v_cvt_pk_bf16_f32 v164, v104, v105
v_cvt_pk_bf16_f32 v165, v106, v107
v_mov_b32 v166, 0
v_mov_b32 v167, 0
v_permlane32_swap_b32 v160, v162
v_permlane32_swap_b32 v161, v163
buffer_store_dwordx4 v[160:163], v2, s[4:7], s48 offen sc1
buffer_store_dwordx4 v[164:167], v246, s[4:7], s48 offen offset:1024 sc1
s_add_u32 s48, s48, 49152
v_mov_b32 v240, v120
v_mov_b32 v242, v120
s_nop 0
s_nop 0
v_permlane32_swap_b32 v240, v242
v_rcp_f32 v242, v242
s_nop 0
v_mul_f32 v242, v242, v21
v_pk_mul_f32 v[112:113], v[112:113], v[242:243] op_sel_hi:[1,0]
v_pk_mul_f32 v[114:115], v[114:115], v[242:243] op_sel_hi:[1,0]
v_cvt_pk_bf16_f32 v176, v112, v113
v_cvt_pk_bf16_f32 v177, v114, v115
v_pk_mul_f32 v[116:117], v[116:117], v[242:243] op_sel_hi:[1,0]
v_pk_mul_f32 v[118:119], v[118:119], v[242:243] op_sel_hi:[1,0]
v_cvt_pk_bf16_f32 v178, v116, v117
v_cvt_pk_bf16_f32 v179, v118, v119
v_pk_mul_f32 v[120:121], v[120:121], v[242:243] op_sel_hi:[1,0]
v_pk_mul_f32 v[122:123], v[122:123], v[242:243] op_sel_hi:[1,0]
v_cvt_pk_bf16_f32 v180, v120, v121
v_cvt_pk_bf16_f32 v181, v122, v123
v_mov_b32 v182, 0
v_mov_b32 v183, 0
v_permlane32_swap_b32 v176, v178
v_permlane32_swap_b32 v177, v179
buffer_store_dwordx4 v[176:179], v2, s[4:7], s48 offen sc1
buffer_store_dwordx4 v[180:183], v246, s[4:7], s48 offen offset:1024 sc1
s_add_u32 s48, s48, 49152
s_branch L_t3end_79
L_t3d_43:
s_mov_b32 m0, s60
s_add_u32 s49, s57, 4096
buffer_load_dwordx4 v2, s[4:7], s57 offen sc1 lds
buffer_load_dwordx4 v2, s[4:7], s57 offen offset:1024 sc1 lds
buffer_load_dwordx4 v2, s[4:7], s57 offen offset:2048 sc1 lds
buffer_load_dwordx4 v2, s[4:7], s57 offen offset:3072 sc1 lds
s_add_u32 m0, s60, 4096
s_add_u32 s57, s57, 10240
buffer_load_dwordx4 v2, s[4:7], s49 offen sc1 lds
s_add_u32 s58, s58, 1
s_and_b32 s49, s58, 3
s_mul_i32 s49, s49, 20480
s_add_u32 s60, s66, s49
s_branch L_t3d2_44
L_t3s_45:
s_add_u32 s59, s59, 1
s_and_b32 s59, s59, 3
s_mul_i32 s48, s59, 20480
v_add_u32 v3, s48, v2
v_add_u32 v5, s48, v24
v_mad_u32_u24 v4, v7, s59, v6
s_waitcnt vmcnt(5)
s_barrier
s_branch L_t3s2_46
L_t3d_51:
s_mov_b32 m0, s60
s_add_u32 s49, s57, 4096
buffer_load_dwordx4 v2, s[4:7], s57 offen sc1 lds
buffer_load_dwordx4 v2, s[4:7], s57 offen offset:1024 sc1 lds
buffer_load_dwordx4 v2, s[4:7], s57 offen offset:2048 sc1 lds
buffer_load_dwordx4 v2, s[4:7], s57 offen offset:3072 sc1 lds
s_add_u32 m0, s60, 4096
s_add_u32 s57, s57, 10240
buffer_load_dwordx4 v2, s[4:7], s49 offen sc1 lds
s_add_u32 s58, s58, 1
s_and_b32 s49, s58, 3
s_mul_i32 s49, s49, 20480
s_add_u32 s60, s66, s49
s_branch L_t3d2_52
L_t3s_65:
s_add_u32 s59, s59, 1
s_and_b32 s59, s59, 3
s_mul_i32 s48, s59, 20480
v_add_u32 v3, s48, v2
v_add_u32 v5, s48, v24
v_mad_u32_u24 v4, v7, s59, v6
s_waitcnt vmcnt(5)
s_barrier
s_branch L_t3s2_66
L_t3r_49:
v_max3_f32 v240, v144, v145, v146
v_max3_f32 v240, v240, v147, v148
v_max3_f32 v240, v240, v149, v150
v_max3_f32 v240, v240, v151, v152
v_max3_f32 v240, v240, v153, v154
v_max3_f32 v240, v240, v155, v156
v_max3_f32 v240, v240, v157, v158
v_max_f32 v240, v240, v159
v_mov_b32 v241, v240
s_nop 0
s_nop 0
v_permlane32_swap_b32 v240, v241
v_max_f32 v240, v240, v241
v_add_f32 v240, 0x41400000, v240
v_add_f32 v240, v240, v13
v_max_f32 v240, v240, v13
v_sub_f32 v242, v240, v13
v_mov_b32 v13, v240
v_pk_add_f32 v[144:145], v[144:145], v[242:243] op_sel_hi:[1,0] neg_lo:[0,1] neg_hi:[0,1]
v_pk_add_f32 v[146:147], v[146:147], v[242:243] op_sel_hi:[1,0] neg_lo:[0,1] neg_hi:[0,1]
v_pk_add_f32 v[148:149], v[148:149], v[242:243] op_sel_hi:[1,0] neg_lo:[0,1] neg_hi:[0,1]
v_pk_add_f32 v[150:151], v[150:151], v[242:243] op_sel_hi:[1,0] neg_lo:[0,1] neg_hi:[0,1]
v_pk_add_f32 v[152:153], v[152:153], v[242:243] op_sel_hi:[1,0] neg_lo:[0,1] neg_hi:[0,1]
v_pk_add_f32 v[154:155], v[154:155], v[242:243] op_sel_hi:[1,0] neg_lo:[0,1] neg_hi:[0,1]
v_pk_add_f32 v[156:157], v[156:157], v[242:243] op_sel_hi:[1,0] neg_lo:[0,1] neg_hi:[0,1]
v_pk_add_f32 v[158:159], v[158:159], v[242:243] op_sel_hi:[1,0] neg_lo:[0,1] neg_hi:[0,1]
v_exp_f32 v242, -v242
s_nop 0
v_pk_mul_f32 v[112:113], v[112:113], v[242:243] op_sel_hi:[1,0]
v_pk_mul_f32 v[114:115], v[114:115], v[242:243] op_sel_hi:[1,0]
v_pk_mul_f32 v[116:117], v[116:117], v[242:243] op_sel_hi:[1,0]
v_pk_mul_f32 v[118:119], v[118:119], v[242:243] op_sel_hi:[1,0]
v_pk_mul_f32 v[120:121], v[120:121], v[242:243] op_sel_hi:[1,0]
v_pk_mul_f32 v[122:123], v[122:123], v[242:243] op_sel_hi:[1,0]
v_pk_mul_f32 v[124:125], v[124:125], v[242:243] op_sel_hi:[1,0]
v_pk_mul_f32 v[126:127], v[126:127], v[242:243] op_sel_hi:[1,0]
v_xor_b32 v240, 0x80000000, v240
v_and_b32 v241, 0xffff0000, v240
v_sub_f32 v240, v240, v241
v_and_b32 v242, 0xffff0000, v240
v_sub_f32 v240, v240, v242
v_perm_b32 v241, v242, v241, s67
v_lshrrev_b32 v240, 16, v240
v_cndmask_b32 v241, v241, 0, s[64:65]
v_cndmask_b32 v240, v240, 0, s[64:65]
v_accvgpr_write_b32 a46, v241
v_accvgpr_write_b32 a47, v240
v_exp_f32 v176, v144
v_exp_f32 v177, v145
v_exp_f32 v178, v146
v_exp_f32 v179, v147
v_exp_f32 v180, v148
v_exp_f32 v181, v149
v_exp_f32 v182, v150
v_exp_f32 v183, v151
v_exp_f32 v184, v152
v_exp_f32 v185, v153
v_exp_f32 v186, v154
v_exp_f32 v187, v155
v_exp_f32 v188, v156
v_exp_f32 v189, v157
v_exp_f32 v190, v158
v_exp_f32 v191, v159
v_perm_b32 v200, v177, v176, s67
v_perm_b32 v201, v179, v178, s67
v_perm_b32 v202, v181, v180, s67
v_perm_b32 v203, v183, v182, s67
v_perm_b32 v204, v185, v184, s67
v_perm_b32 v205, v187, v186, s67
v_perm_b32 v206, v189, v188, s67
v_perm_b32 v207, v191, v190, s67
s_branch L_t3b_50
L_t3r_53:
v_max3_f32 v240, v128, v129, v130
v_max3_f32 v240, v240, v131, v132
v_max3_f32 v240, v240, v133, v134
v_max3_f32 v240, v240, v135, v136
v_max3_f32 v240, v240, v137, v138
v_max3_f32 v240, v240, v139, v140
v_max3_f32 v240, v240, v141, v142
v_max_f32 v240, v240, v143
v_mov_b32 v241, v240
s_nop 0
s_nop 0
v_permlane32_swap_b32 v240, v241
v_max_f32 v240, v240, v241
v_add_f32 v240, 0x41400000, v240
v_add_f32 v240, v240, v8
v_max_f32 v240, v240, v8
v_sub_f32 v242, v240, v8
v_mov_b32 v8, v240
v_pk_add_f32 v[128:129], v[128:129], v[242:243] op_sel_hi:[1,0] neg_lo:[0,1] neg_hi:[0,1]
v_pk_add_f32 v[130:131], v[130:131], v[242:243] op_sel_hi:[1,0] neg_lo:[0,1] neg_hi:[0,1]
v_pk_add_f32 v[132:133], v[132:133], v[242:243] op_sel_hi:[1,0] neg_lo:[0,1] neg_hi:[0,1]
v_pk_add_f32 v[134:135], v[134:135], v[242:243] op_sel_hi:[1,0] neg_lo:[0,1] neg_hi:[0,1]
v_pk_add_f32 v[136:137], v[136:137], v[242:243] op_sel_hi:[1,0] neg_lo:[0,1] neg_hi:[0,1]
v_pk_add_f32 v[138:139], v[138:139], v[242:243] op_sel_hi:[1,0] neg_lo:[0,1] neg_hi:[0,1]
v_pk_add_f32 v[140:141], v[140:141], v[242:243] op_sel_hi:[1,0] neg_lo:[0,1] neg_hi:[0,1]
v_pk_add_f32 v[142:143], v[142:143], v[242:243] op_sel_hi:[1,0] neg_lo:[0,1] neg_hi:[0,1]
v_exp_f32 v242, -v242
s_nop 0
v_pk_mul_f32 v[32:33], v[32:33], v[242:243] op_sel_hi:[1,0]
v_pk_mul_f32 v[34:35], v[34:35], v[242:243] op_sel_hi:[1,0]
v_pk_mul_f32 v[36:37], v[36:37], v[242:243] op_sel_hi:[1,0]
v_pk_mul_f32 v[38:39], v[38:39], v[242:243] op_sel_hi:[1,0]
v_pk_mul_f32 v[40:41], v[40:41], v[242:243] op_sel_hi:[1,0]
v_pk_mul_f32 v[42:43], v[42:43], v[242:243] op_sel_hi:[1,0]
v_pk_mul_f32 v[44:45], v[44:45], v[242:243] op_sel_hi:[1,0]
v_pk_mul_f32 v[46:47], v[46:47], v[242:243] op_sel_hi:[1,0]
v_xor_b32 v240, 0x80000000, v240
v_and_b32 v241, 0xffff0000, v240
v_sub_f32 v240, v240, v241
v_and_b32 v242, 0xffff0000, v240
v_sub_f32 v240, v240, v242
v_perm_b32 v241, v242, v241, s67
v_lshrrev_b32 v240, 16, v240
v_cndmask_b32 v241, v241, 0, s[64:65]
v_cndmask_b32 v240, v240, 0, s[64:65]
v_accvgpr_write_b32 a6, v241
v_accvgpr_write_b32 a7, v240
v_exp_f32 v160, v128
v_exp_f32 v161, v129
v_exp_f32 v162, v130
v_exp_f32 v163, v131
v_exp_f32 v164, v132
v_exp_f32 v165, v133
v_exp_f32 v166, v134
v_exp_f32 v167, v135
v_exp_f32 v168, v136
v_exp_f32 v169, v137
v_exp_f32 v170, v138
v_exp_f32 v171, v139
v_exp_f32 v172, v140
v_exp_f32 v173, v141
v_exp_f32 v174, v142
v_exp_f32 v175, v143
v_perm_b32 v192, v161, v160, s67
v_perm_b32 v193, v163, v162, s67
v_perm_b32 v194, v165, v164, s67
v_perm_b32 v195, v167, v166, s67
v_perm_b32 v196, v169, v168, s67
v_perm_b32 v197, v171, v170, s67
v_perm_b32 v198, v173, v172, s67
v_perm_b32 v199, v175, v174, s67
s_branch L_t3b_54
L_t3r_55:
v_max3_f32 v240, v144, v145, v146
v_max3_f32 v240, v240, v147, v148
v_max3_f32 v240, v240, v149, v150
v_max3_f32 v240, v240, v151, v152
v_max3_f32 v240, v240, v153, v154
v_max3_f32 v240, v240, v155, v156
v_max3_f32 v240, v240, v157, v158
v_max_f32 v240, v240, v159
v_mov_b32 v241, v240
s_nop 0
s_nop 0
v_permlane32_swap_b32 v240, v241
v_max_f32 v240, v240, v241
v_add_f32 v240, 0x41400000, v240
v_add_f32 v240, v240, v9
v_max_f32 v240, v240, v9
v_sub_f32 v242, v240, v9
v_mov_b32 v9, v240
v_pk_add_f32 v[144:145], v[144:145], v[242:243] op_sel_hi:[1,0] neg_lo:[0,1] neg_hi:[0,1]
v_pk_add_f32 v[146:147], v[146:147], v[242:243] op_sel_hi:[1,0] neg_lo:[0,1] neg_hi:[0,1]
v_pk_add_f32 v[148:149], v[148:149], v[242:243] op_sel_hi:[1,0] neg_lo:[0,1] neg_hi:[0,1]
v_pk_add_f32 v[150:151], v[150:151], v[242:243] op_sel_hi:[1,0] neg_lo:[0,1] neg_hi:[0,1]
v_pk_add_f32 v[152:153], v[152:153], v[242:243] op_sel_hi:[1,0] neg_lo:[0,1] neg_hi:[0,1]
v_pk_add_f32 v[154:155], v[154:155], v[242:243] op_sel_hi:[1,0] neg_lo:[0,1] neg_hi:[0,1]
v_pk_add_f32 v[156:157], v[156:157], v[242:243] op_sel_hi:[1,0] neg_lo:[0,1] neg_hi:[0,1]
v_pk_add_f32 v[158:159], v[158:159], v[242:243] op_sel_hi:[1,0] neg_lo:[0,1] neg_hi:[0,1]
v_exp_f32 v242, -v242
s_nop 0
v_pk_mul_f32 v[48:49], v[48:49], v[242:243] op_sel_hi:[1,0]
v_pk_mul_f32 v[50:51], v[50:51], v[242:243] op_sel_hi:[1,0]
v_pk_mul_f32 v[52:53], v[52:53], v[242:243] op_sel_hi:[1,0]
v_pk_mul_f32 v[54:55], v[54:55], v[242:243] op_sel_hi:[1,0]
v_pk_mul_f32 v[56:57], v[56:57], v[242:243] op_sel_hi:[1,0]
v_pk_mul_f32 v[58:59], v[58:59], v[242:243] op_sel_hi:[1,0]
v_pk_mul_f32 v[60:61], v[60:61], v[242:243] op_sel_hi:[1,0]
v_pk_mul_f32 v[62:63], v[62:63], v[242:243] op_sel_hi:[1,0]
v_xor_b32 v240, 0x80000000, v240
v_and_b32 v241, 0xffff0000, v240
v_sub_f32 v240, v240, v241
v_and_b32 v242, 0xffff0000, v240
v_sub_f32 v240, v240, v242
v_perm_b32 v241, v242, v241, s67
v_lshrrev_b32 v240, 16, v240
v_cndmask_b32 v241, v241, 0, s[64:65]
v_cndmask_b32 v240, v240, 0, s[64:65]
v_accvgpr_write_b32 a14, v241
v_accvgpr_write_b32 a15, v240
v_exp_f32 v176, v144
v_exp_f32 v177, v145
v_exp_f32 v178, v146
v_exp_f32 v179, v147
v_exp_f32 v180, v148
v_exp_f32 v181, v149
v_exp_f32 v182, v150
v_exp_f32 v183, v151
v_exp_f32 v184, v152
v_exp_f32 v185, v153
v_exp_f32 v186, v154
v_exp_f32 v187, v155
v_exp_f32 v188, v156
v_exp_f32 v189, v157
v_exp_f32 v190, v158
v_exp_f32 v191, v159
v_perm_b32 v200, v177, v176, s67
v_perm_b32 v201, v179, v178, s67
v_perm_b32 v202, v181, v180, s67
v_perm_b32 v203, v183, v182, s67
v_perm_b32 v204, v185, v184, s67
v_perm_b32 v205, v187, v186, s67
v_perm_b32 v206, v189, v188, s67
v_perm_b32 v207, v191, v190, s67
s_branch L_t3b_56
L_t3r_57:
v_max3_f32 v240, v128, v129, v130
v_max3_f32 v240, v240, v131, v132
v_max3_f32 v240, v240, v133, v134
v_max3_f32 v240, v240, v135, v136
v_max3_f32 v240, v240, v137, v138
v_max3_f32 v240, v240, v139, v140
v_max3_f32 v240, v240, v141, v142
v_max_f32 v240, v240, v143
v_mov_b32 v241, v240
s_nop 0
s_nop 0
v_permlane32_swap_b32 v240, v241
v_max_f32 v240, v240, v241
v_add_f32 v240, 0x41400000, v240
v_add_f32 v240, v240, v10
v_max_f32 v240, v240, v10
v_sub_f32 v242, v240, v10
v_mov_b32 v10, v240
v_pk_add_f32 v[128:129], v[128:129], v[242:243] op_sel_hi:[1,0] neg_lo:[0,1] neg_hi:[0,1]
v_pk_add_f32 v[130:131], v[130:131], v[242:243] op_sel_hi:[1,0] neg_lo:[0,1] neg_hi:[0,1]
v_pk_add_f32 v[132:133], v[132:133], v[242:243] op_sel_hi:[1,0] neg_lo:[0,1] neg_hi:[0,1]
v_pk_add_f32 v[134:135], v[134:135], v[242:243] op_sel_hi:[1,0] neg_lo:[0,1] neg_hi:[0,1]
v_pk_add_f32 v[136:137], v[136:137], v[242:243] op_sel_hi:[1,0] neg_lo:[0,1] neg_hi:[0,1]
v_pk_add_f32 v[138:139], v[138:139], v[242:243] op_sel_hi:[1,0] neg_lo:[0,1] neg_hi:[0,1]
v_pk_add_f32 v[140:141], v[140:141], v[242:243] op_sel_hi:[1,0] neg_lo:[0,1] neg_hi:[0,1]
v_pk_add_f32 v[142:143], v[142:143], v[242:243] op_sel_hi:[1,0] neg_lo:[0,1] neg_hi:[0,1]
v_exp_f32 v242, -v242
s_nop 0
v_pk_mul_f32 v[64:65], v[64:65], v[242:243] op_sel_hi:[1,0]
v_pk_mul_f32 v[66:67], v[66:67], v[242:243] op_sel_hi:[1,0]
v_pk_mul_f32 v[68:69], v[68:69], v[242:243] op_sel_hi:[1,0]
v_pk_mul_f32 v[70:71], v[70:71], v[242:243] op_sel_hi:[1,0]
v_pk_mul_f32 v[72:73], v[72:73], v[242:243] op_sel_hi:[1,0]
v_pk_mul_f32 v[74:75], v[74:75], v[242:243] op_sel_hi:[1,0]
v_pk_mul_f32 v[76:77], v[76:77], v[242:243] op_sel_hi:[1,0]
v_pk_mul_f32 v[78:79], v[78:79], v[242:243] op_sel_hi:[1,0]
v_xor_b32 v240, 0x80000000, v240
v_and_b32 v241, 0xffff0000, v240
v_sub_f32 v240, v240, v241
v_and_b32 v242, 0xffff0000, v240
v_sub_f32 v240, v240, v242
v_perm_b32 v241, v242, v241, s67
v_lshrrev_b32 v240, 16, v240
v_cndmask_b32 v241, v241, 0, s[64:65]
v_cndmask_b32 v240, v240, 0, s[64:65]
v_accvgpr_write_b32 a22, v241
v_accvgpr_write_b32 a23, v240
v_exp_f32 v160, v128
v_exp_f32 v161, v129
v_exp_f32 v162, v130
v_exp_f32 v163, v131
v_exp_f32 v164, v132
v_exp_f32 v165, v133
v_exp_f32 v166, v134
v_exp_f32 v167, v135
v_exp_f32 v168, v136
v_exp_f32 v169, v137
v_exp_f32 v170, v138
v_exp_f32 v171, v139
v_exp_f32 v172, v140
v_exp_f32 v173, v141
v_exp_f32 v174, v142
v_exp_f32 v175, v143
v_perm_b32 v192, v161, v160, s67
v_perm_b32 v193, v163, v162, s67
v_perm_b32 v194, v165, v164, s67
v_perm_b32 v195, v167, v166, s67
v_perm_b32 v196, v169, v168, s67
v_perm_b32 v197, v171, v170, s67
v_perm_b32 v198, v173, v172, s67
v_perm_b32 v199, v175, v174, s67
s_branch L_t3b_58
L_t3r_59:
v_max3_f32 v240, v144, v145, v146
v_max3_f32 v240, v240, v147, v148
v_max3_f32 v240, v240, v149, v150
v_max3_f32 v240, v240, v151, v152
v_max3_f32 v240, v240, v153, v154
v_max3_f32 v240, v240, v155, v156
v_max3_f32 v240, v240, v157, v158
v_max_f32 v240, v240, v159
v_mov_b32 v241, v240
s_nop 0
s_nop 0
v_permlane32_swap_b32 v240, v241
v_max_f32 v240, v240, v241
v_add_f32 v240, 0x41400000, v240
v_add_f32 v240, v240, v11
v_max_f32 v240, v240, v11
v_sub_f32 v242, v240, v11
v_mov_b32 v11, v240
v_pk_add_f32 v[144:145], v[144:145], v[242:243] op_sel_hi:[1,0] neg_lo:[0,1] neg_hi:[0,1]
v_pk_add_f32 v[146:147], v[146:147], v[242:243] op_sel_hi:[1,0] neg_lo:[0,1] neg_hi:[0,1]
v_pk_add_f32 v[148:149], v[148:149], v[242:243] op_sel_hi:[1,0] neg_lo:[0,1] neg_hi:[0,1]
v_pk_add_f32 v[150:151], v[150:151], v[242:243] op_sel_hi:[1,0] neg_lo:[0,1] neg_hi:[0,1]
v_pk_add_f32 v[152:153], v[152:153], v[242:243] op_sel_hi:[1,0] neg_lo:[0,1] neg_hi:[0,1]
v_pk_add_f32 v[154:155], v[154:155], v[242:243] op_sel_hi:[1,0] neg_lo:[0,1] neg_hi:[0,1]
v_pk_add_f32 v[156:157], v[156:157], v[242:243] op_sel_hi:[1,0] neg_lo:[0,1] neg_hi:[0,1]
v_pk_add_f32 v[158:159], v[158:159], v[242:243] op_sel_hi:[1,0] neg_lo:[0,1] neg_hi:[0,1]
v_exp_f32 v242, -v242
s_nop 0
v_pk_mul_f32 v[80:81], v[80:81], v[242:243] op_sel_hi:[1,0]
v_pk_mul_f32 v[82:83], v[82:83], v[242:243] op_sel_hi:[1,0]
v_pk_mul_f32 v[84:85], v[84:85], v[242:243] op_sel_hi:[1,0]
v_pk_mul_f32 v[86:87], v[86:87], v[242:243] op_sel_hi:[1,0]
v_pk_mul_f32 v[88:89], v[88:89], v[242:243] op_sel_hi:[1,0]
v_pk_mul_f32 v[90:91], v[90:91], v[242:243] op_sel_hi:[1,0]
v_pk_mul_f32 v[92:93], v[92:93], v[242:243] op_sel_hi:[1,0]
v_pk_mul_f32 v[94:95], v[94:95], v[242:243] op_sel_hi:[1,0]
v_xor_b32 v240, 0x80000000, v240
v_and_b32 v241, 0xffff0000, v240
v_sub_f32 v240, v240, v241
v_and_b32 v242, 0xffff0000, v240
v_sub_f32 v240, v240, v242
v_perm_b32 v241, v242, v241, s67
v_lshrrev_b32 v240, 16, v240
v_cndmask_b32 v241, v241, 0, s[64:65]
v_cndmask_b32 v240, v240, 0, s[64:65]
v_accvgpr_write_b32 a30, v241
v_accvgpr_write_b32 a31, v240
v_exp_f32 v176, v144
v_exp_f32 v177, v145
v_exp_f32 v178, v146
v_exp_f32 v179, v147
v_exp_f32 v180, v148
v_exp_f32 v181, v149
v_exp_f32 v182, v150
v_exp_f32 v183, v151
v_exp_f32 v184, v152
v_exp_f32 v185, v153
v_exp_f32 v186, v154
v_exp_f32 v187, v155
v_exp_f32 v188, v156
v_exp_f32 v189, v157
v_exp_f32 v190, v158
v_exp_f32 v191, v159
v_perm_b32 v200, v177, v176, s67
v_perm_b32 v201, v179, v178, s67
v_perm_b32 v202, v181, v180, s67
v_perm_b32 v203, v183, v182, s67
v_perm_b32 v204, v185, v184, s67
v_perm_b32 v205, v187, v186, s67
v_perm_b32 v206, v189, v188, s67
v_perm_b32 v207, v191, v190, s67
s_branch L_t3b_60
L_t3r_61:
v_max3_f32 v240, v128, v129, v130
v_max3_f32 v240, v240, v131, v132
v_max3_f32 v240, v240, v133, v134
v_max3_f32 v240, v240, v135, v136
v_max3_f32 v240, v240, v137, v138
v_max3_f32 v240, v240, v139, v140
v_max3_f32 v240, v240, v141, v142
v_max_f32 v240, v240, v143
v_mov_b32 v241, v240
s_nop 0
s_nop 0
v_permlane32_swap_b32 v240, v241
v_max_f32 v240, v240, v241
v_add_f32 v240, 0x41400000, v240
v_add_f32 v240, v240, v12
v_max_f32 v240, v240, v12
v_sub_f32 v242, v240, v12
v_mov_b32 v12, v240
v_pk_add_f32 v[128:129], v[128:129], v[242:243] op_sel_hi:[1,0] neg_lo:[0,1] neg_hi:[0,1]
v_pk_add_f32 v[130:131], v[130:131], v[242:243] op_sel_hi:[1,0] neg_lo:[0,1] neg_hi:[0,1]
v_pk_add_f32 v[132:133], v[132:133], v[242:243] op_sel_hi:[1,0] neg_lo:[0,1] neg_hi:[0,1]
v_pk_add_f32 v[134:135], v[134:135], v[242:243] op_sel_hi:[1,0] neg_lo:[0,1] neg_hi:[0,1]
v_pk_add_f32 v[136:137], v[136:137], v[242:243] op_sel_hi:[1,0] neg_lo:[0,1] neg_hi:[0,1]
v_pk_add_f32 v[138:139], v[138:139], v[242:243] op_sel_hi:[1,0] neg_lo:[0,1] neg_hi:[0,1]
v_pk_add_f32 v[140:141], v[140:141], v[242:243] op_sel_hi:[1,0] neg_lo:[0,1] neg_hi:[0,1]
v_pk_add_f32 v[142:143], v[142:143], v[242:243] op_sel_hi:[1,0] neg_lo:[0,1] neg_hi:[0,1]
v_exp_f32 v242, -v242
s_nop 0
v_pk_mul_f32 v[96:97], v[96:97], v[242:243] op_sel_hi:[1,0]
v_pk_mul_f32 v[98:99], v[98:99], v[242:243] op_sel_hi:[1,0]
v_pk_mul_f32 v[100:101], v[100:101], v[242:243] op_sel_hi:[1,0]
v_pk_mul_f32 v[102:103], v[102:103], v[242:243] op_sel_hi:[1,0]
v_pk_mul_f32 v[104:105], v[104:105], v[242:243] op_sel_hi:[1,0]
v_pk_mul_f32 v[106:107], v[106:107], v[242:243] op_sel_hi:[1,0]
v_pk_mul_f32 v[108:109], v[108:109], v[242:243] op_sel_hi:[1,0]
v_pk_mul_f32 v[110:111], v[110:111], v[242:243] op_sel_hi:[1,0]
v_xor_b32 v240, 0x80000000, v240
v_and_b32 v241, 0xffff0000, v240
v_sub_f32 v240, v240, v241
v_and_b32 v242, 0xffff0000, v240
v_sub_f32 v240, v240, v242
v_perm_b32 v241, v242, v241, s67
v_lshrrev_b32 v240, 16, v240
v_cndmask_b32 v241, v241, 0, s[64:65]
v_cndmask_b32 v240, v240, 0, s[64:65]
v_accvgpr_write_b32 a38, v241
v_accvgpr_write_b32 a39, v240
v_exp_f32 v160, v128
v_exp_f32 v161, v129
v_exp_f32 v162, v130
v_exp_f32 v163, v131
v_exp_f32 v164, v132
v_exp_f32 v165, v133
v_exp_f32 v166, v134
v_exp_f32 v167, v135
v_exp_f32 v168, v136
v_exp_f32 v169, v137
v_exp_f32 v170, v138
v_exp_f32 v171, v139
v_exp_f32 v172, v140
v_exp_f32 v173, v141
v_exp_f32 v174, v142
v_exp_f32 v175, v143
v_perm_b32 v192, v161, v160, s67
v_perm_b32 v193, v163, v162, s67
v_perm_b32 v194, v165, v164, s67
v_perm_b32 v195, v167, v166, s67
v_perm_b32 v196, v169, v168, s67
v_perm_b32 v197, v171, v170, s67
v_perm_b32 v198, v173, v172, s67
v_perm_b32 v199, v175, v174, s67
s_branch L_t3b_62
L_t3r_63:
v_max3_f32 v240, v144, v145, v146
v_max3_f32 v240, v240, v147, v148
v_max3_f32 v240, v240, v149, v150
v_max3_f32 v240, v240, v151, v152
v_max3_f32 v240, v240, v153, v154
v_max3_f32 v240, v240, v155, v156
v_max3_f32 v240, v240, v157, v158
v_max_f32 v240, v240, v159
v_mov_b32 v241, v240
s_nop 0
s_nop 0
v_permlane32_swap_b32 v240, v241
v_max_f32 v240, v240, v241
v_add_f32 v240, 0x41400000, v240
v_add_f32 v240, v240, v13
v_max_f32 v240, v240, v13
v_sub_f32 v242, v240, v13
v_mov_b32 v13, v240
v_pk_add_f32 v[144:145], v[144:145], v[242:243] op_sel_hi:[1,0] neg_lo:[0,1] neg_hi:[0,1]
v_pk_add_f32 v[146:147], v[146:147], v[242:243] op_sel_hi:[1,0] neg_lo:[0,1] neg_hi:[0,1]
v_pk_add_f32 v[148:149], v[148:149], v[242:243] op_sel_hi:[1,0] neg_lo:[0,1] neg_hi:[0,1]
v_pk_add_f32 v[150:151], v[150:151], v[242:243] op_sel_hi:[1,0] neg_lo:[0,1] neg_hi:[0,1]
v_pk_add_f32 v[152:153], v[152:153], v[242:243] op_sel_hi:[1,0] neg_lo:[0,1] neg_hi:[0,1]
v_pk_add_f32 v[154:155], v[154:155], v[242:243] op_sel_hi:[1,0] neg_lo:[0,1] neg_hi:[0,1]
v_pk_add_f32 v[156:157], v[156:157], v[242:243] op_sel_hi:[1,0] neg_lo:[0,1] neg_hi:[0,1]
v_pk_add_f32 v[158:159], v[158:159], v[242:243] op_sel_hi:[1,0] neg_lo:[0,1] neg_hi:[0,1]
v_exp_f32 v242, -v242
s_nop 0
v_pk_mul_f32 v[112:113], v[112:113], v[242:243] op_sel_hi:[1,0]
v_pk_mul_f32 v[114:115], v[114:115], v[242:243] op_sel_hi:[1,0]
v_pk_mul_f32 v[116:117], v[116:117], v[242:243] op_sel_hi:[1,0]
v_pk_mul_f32 v[118:119], v[118:119], v[242:243] op_sel_hi:[1,0]
v_pk_mul_f32 v[120:121], v[120:121], v[242:243] op_sel_hi:[1,0]
v_pk_mul_f32 v[122:123], v[122:123], v[242:243] op_sel_hi:[1,0]
v_pk_mul_f32 v[124:125], v[124:125], v[242:243] op_sel_hi:[1,0]
v_pk_mul_f32 v[126:127], v[126:127], v[242:243] op_sel_hi:[1,0]
v_xor_b32 v240, 0x80000000, v240
v_and_b32 v241, 0xffff0000, v240
v_sub_f32 v240, v240, v241
v_and_b32 v242, 0xffff0000, v240
v_sub_f32 v240, v240, v242
v_perm_b32 v241, v242, v241, s67
v_lshrrev_b32 v240, 16, v240
v_cndmask_b32 v241, v241, 0, s[64:65]
v_cndmask_b32 v240, v240, 0, s[64:65]
v_accvgpr_write_b32 a46, v241
v_accvgpr_write_b32 a47, v240
v_exp_f32 v176, v144
v_exp_f32 v177, v145
v_exp_f32 v178, v146
v_exp_f32 v179, v147
v_exp_f32 v180, v148
v_exp_f32 v181, v149
v_exp_f32 v182, v150
v_exp_f32 v183, v151
v_exp_f32 v184, v152
v_exp_f32 v185, v153
v_exp_f32 v186, v154
v_exp_f32 v187, v155
v_exp_f32 v188, v156
v_exp_f32 v189, v157
v_exp_f32 v190, v158
v_exp_f32 v191, v159
v_perm_b32 v200, v177, v176, s67
v_perm_b32 v201, v179, v178, s67
v_perm_b32 v202, v181, v180, s67
v_perm_b32 v203, v183, v182, s67
v_perm_b32 v204, v185, v184, s67
v_perm_b32 v205, v187, v186, s67
v_perm_b32 v206, v189, v188, s67
v_perm_b32 v207, v191, v190, s67
s_branch L_t3b_64
L_t3r_67:
v_max3_f32 v240, v128, v129, v130
v_max3_f32 v240, v240, v131, v132
v_max3_f32 v240, v240, v133, v134
v_max3_f32 v240, v240, v135, v136
v_max3_f32 v240, v240, v137, v138
v_max3_f32 v240, v240, v139, v140
v_max3_f32 v240, v240, v141, v142
v_max_f32 v240, v240, v143
v_mov_b32 v241, v240
s_nop 0
s_nop 0
v_permlane32_swap_b32 v240, v241
v_max_f32 v240, v240, v241
v_add_f32 v240, 0x41400000, v240
v_add_f32 v240, v240, v8
v_max_f32 v240, v240, v8
v_sub_f32 v242, v240, v8
v_mov_b32 v8, v240
v_pk_add_f32 v[128:129], v[128:129], v[242:243] op_sel_hi:[1,0] neg_lo:[0,1] neg_hi:[0,1]
v_pk_add_f32 v[130:131], v[130:131], v[242:243] op_sel_hi:[1,0] neg_lo:[0,1] neg_hi:[0,1]
v_pk_add_f32 v[132:133], v[132:133], v[242:243] op_sel_hi:[1,0] neg_lo:[0,1] neg_hi:[0,1]
v_pk_add_f32 v[134:135], v[134:135], v[242:243] op_sel_hi:[1,0] neg_lo:[0,1] neg_hi:[0,1]
v_pk_add_f32 v[136:137], v[136:137], v[242:243] op_sel_hi:[1,0] neg_lo:[0,1] neg_hi:[0,1]
v_pk_add_f32 v[138:139], v[138:139], v[242:243] op_sel_hi:[1,0] neg_lo:[0,1] neg_hi:[0,1]
v_pk_add_f32 v[140:141], v[140:141], v[242:243] op_sel_hi:[1,0] neg_lo:[0,1] neg_hi:[0,1]
v_pk_add_f32 v[142:143], v[142:143], v[242:243] op_sel_hi:[1,0] neg_lo:[0,1] neg_hi:[0,1]
v_exp_f32 v242, -v242
s_nop 0
v_pk_mul_f32 v[32:33], v[32:33], v[242:243] op_sel_hi:[1,0]
v_pk_mul_f32 v[34:35], v[34:35], v[242:243] op_sel_hi:[1,0]
v_pk_mul_f32 v[36:37], v[36:37], v[242:243] op_sel_hi:[1,0]
v_pk_mul_f32 v[38:39], v[38:39], v[242:243] op_sel_hi:[1,0]
v_pk_mul_f32 v[40:41], v[40:41], v[242:243] op_sel_hi:[1,0]
v_pk_mul_f32 v[42:43], v[42:43], v[242:243] op_sel_hi:[1,0]
v_pk_mul_f32 v[44:45], v[44:45], v[242:243] op_sel_hi:[1,0]
v_pk_mul_f32 v[46:47], v[46:47], v[242:243] op_sel_hi:[1,0]
v_xor_b32 v240, 0x80000000, v240
v_and_b32 v241, 0xffff0000, v240
v_sub_f32 v240, v240, v241
v_and_b32 v242, 0xffff0000, v240
v_sub_f32 v240, v240, v242
v_perm_b32 v241, v242, v241, s67
v_lshrrev_b32 v240, 16, v240
v_cndmask_b32 v241, v241, 0, s[64:65]
v_cndmask_b32 v240, v240, 0, s[64:65]
v_accvgpr_write_b32 a6, v241
v_accvgpr_write_b32 a7, v240
v_exp_f32 v160, v128
v_exp_f32 v161, v129
v_exp_f32 v162, v130
v_exp_f32 v163, v131
v_exp_f32 v164, v132
v_exp_f32 v165, v133
v_exp_f32 v166, v134
v_exp_f32 v167, v135
v_exp_f32 v168, v136
v_exp_f32 v169, v137
v_exp_f32 v170, v138
v_exp_f32 v171, v139
v_exp_f32 v172, v140
v_exp_f32 v173, v141
v_exp_f32 v174, v142
v_exp_f32 v175, v143
v_perm_b32 v192, v161, v160, s67
v_perm_b32 v193, v163, v162, s67
v_perm_b32 v194, v165, v164, s67
v_perm_b32 v195, v167, v166, s67
v_perm_b32 v196, v169, v168, s67
v_perm_b32 v197, v171, v170, s67
v_perm_b32 v198, v173, v172, s67
v_perm_b32 v199, v175, v174, s67
s_branch L_t3b_68
L_t3r_69:
v_max3_f32 v240, v144, v145, v146
v_max3_f32 v240, v240, v147, v148
v_max3_f32 v240, v240, v149, v150
v_max3_f32 v240, v240, v151, v152
v_max3_f32 v240, v240, v153, v154
v_max3_f32 v240, v240, v155, v156
v_max3_f32 v240, v240, v157, v158
v_max_f32 v240, v240, v159
v_mov_b32 v241, v240
s_nop 0
s_nop 0
v_permlane32_swap_b32 v240, v241
v_max_f32 v240, v240, v241
v_add_f32 v240, 0x41400000, v240
v_add_f32 v240, v240, v9
v_max_f32 v240, v240, v9
v_sub_f32 v242, v240, v9
v_mov_b32 v9, v240
v_pk_add_f32 v[144:145], v[144:145], v[242:243] op_sel_hi:[1,0] neg_lo:[0,1] neg_hi:[0,1]
v_pk_add_f32 v[146:147], v[146:147], v[242:243] op_sel_hi:[1,0] neg_lo:[0,1] neg_hi:[0,1]
v_pk_add_f32 v[148:149], v[148:149], v[242:243] op_sel_hi:[1,0] neg_lo:[0,1] neg_hi:[0,1]
v_pk_add_f32 v[150:151], v[150:151], v[242:243] op_sel_hi:[1,0] neg_lo:[0,1] neg_hi:[0,1]
v_pk_add_f32 v[152:153], v[152:153], v[242:243] op_sel_hi:[1,0] neg_lo:[0,1] neg_hi:[0,1]
v_pk_add_f32 v[154:155], v[154:155], v[242:243] op_sel_hi:[1,0] neg_lo:[0,1] neg_hi:[0,1]
v_pk_add_f32 v[156:157], v[156:157], v[242:243] op_sel_hi:[1,0] neg_lo:[0,1] neg_hi:[0,1]
v_pk_add_f32 v[158:159], v[158:159], v[242:243] op_sel_hi:[1,0] neg_lo:[0,1] neg_hi:[0,1]
v_exp_f32 v242, -v242
s_nop 0
v_pk_mul_f32 v[48:49], v[48:49], v[242:243] op_sel_hi:[1,0]
v_pk_mul_f32 v[50:51], v[50:51], v[242:243] op_sel_hi:[1,0]
v_pk_mul_f32 v[52:53], v[52:53], v[242:243] op_sel_hi:[1,0]
v_pk_mul_f32 v[54:55], v[54:55], v[242:243] op_sel_hi:[1,0]
v_pk_mul_f32 v[56:57], v[56:57], v[242:243] op_sel_hi:[1,0]
v_pk_mul_f32 v[58:59], v[58:59], v[242:243] op_sel_hi:[1,0]
v_pk_mul_f32 v[60:61], v[60:61], v[242:243] op_sel_hi:[1,0]
v_pk_mul_f32 v[62:63], v[62:63], v[242:243] op_sel_hi:[1,0]
v_xor_b32 v240, 0x80000000, v240
v_and_b32 v241, 0xffff0000, v240
v_sub_f32 v240, v240, v241
v_and_b32 v242, 0xffff0000, v240
v_sub_f32 v240, v240, v242
v_perm_b32 v241, v242, v241, s67
v_lshrrev_b32 v240, 16, v240
v_cndmask_b32 v241, v241, 0, s[64:65]
v_cndmask_b32 v240, v240, 0, s[64:65]
v_accvgpr_write_b32 a14, v241
v_accvgpr_write_b32 a15, v240
v_exp_f32 v176, v144
v_exp_f32 v177, v145
v_exp_f32 v178, v146
v_exp_f32 v179, v147
v_exp_f32 v180, v148
v_exp_f32 v181, v149
v_exp_f32 v182, v150
v_exp_f32 v183, v151
v_exp_f32 v184, v152
v_exp_f32 v185, v153
v_exp_f32 v186, v154
v_exp_f32 v187, v155
v_exp_f32 v188, v156
v_exp_f32 v189, v157
v_exp_f32 v190, v158
v_exp_f32 v191, v159
v_perm_b32 v200, v177, v176, s67
v_perm_b32 v201, v179, v178, s67
v_perm_b32 v202, v181, v180, s67
v_perm_b32 v203, v183, v182, s67
v_perm_b32 v204, v185, v184, s67
v_perm_b32 v205, v187, v186, s67
v_perm_b32 v206, v189, v188, s67
v_perm_b32 v207, v191, v190, s67
s_branch L_t3b_70
L_t3r_71:
v_max3_f32 v240, v128, v129, v130
v_max3_f32 v240, v240, v131, v132
v_max3_f32 v240, v240, v133, v134
v_max3_f32 v240, v240, v135, v136
v_max3_f32 v240, v240, v137, v138
v_max3_f32 v240, v240, v139, v140
v_max3_f32 v240, v240, v141, v142
v_max_f32 v240, v240, v143
v_mov_b32 v241, v240
s_nop 0
s_nop 0
v_permlane32_swap_b32 v240, v241
v_max_f32 v240, v240, v241
v_add_f32 v240, 0x41400000, v240
v_add_f32 v240, v240, v10
v_max_f32 v240, v240, v10
v_sub_f32 v242, v240, v10
v_mov_b32 v10, v240
v_pk_add_f32 v[128:129], v[128:129], v[242:243] op_sel_hi:[1,0] neg_lo:[0,1] neg_hi:[0,1]
v_pk_add_f32 v[130:131], v[130:131], v[242:243] op_sel_hi:[1,0] neg_lo:[0,1] neg_hi:[0,1]
v_pk_add_f32 v[132:133], v[132:133], v[242:243] op_sel_hi:[1,0] neg_lo:[0,1] neg_hi:[0,1]
v_pk_add_f32 v[134:135], v[134:135], v[242:243] op_sel_hi:[1,0] neg_lo:[0,1] neg_hi:[0,1]
v_pk_add_f32 v[136:137], v[136:137], v[242:243] op_sel_hi:[1,0] neg_lo:[0,1] neg_hi:[0,1]
v_pk_add_f32 v[138:139], v[138:139], v[242:243] op_sel_hi:[1,0] neg_lo:[0,1] neg_hi:[0,1]
v_pk_add_f32 v[140:141], v[140:141], v[242:243] op_sel_hi:[1,0] neg_lo:[0,1] neg_hi:[0,1]
v_pk_add_f32 v[142:143], v[142:143], v[242:243] op_sel_hi:[1,0] neg_lo:[0,1] neg_hi:[0,1]
v_exp_f32 v242, -v242
s_nop 0
v_pk_mul_f32 v[64:65], v[64:65], v[242:243] op_sel_hi:[1,0]
v_pk_mul_f32 v[66:67], v[66:67], v[242:243] op_sel_hi:[1,0]
v_pk_mul_f32 v[68:69], v[68:69], v[242:243] op_sel_hi:[1,0]
v_pk_mul_f32 v[70:71], v[70:71], v[242:243] op_sel_hi:[1,0]
v_pk_mul_f32 v[72:73], v[72:73], v[242:243] op_sel_hi:[1,0]
v_pk_mul_f32 v[74:75], v[74:75], v[242:243] op_sel_hi:[1,0]
v_pk_mul_f32 v[76:77], v[76:77], v[242:243] op_sel_hi:[1,0]
v_pk_mul_f32 v[78:79], v[78:79], v[242:243] op_sel_hi:[1,0]
v_xor_b32 v240, 0x80000000, v240
v_and_b32 v241, 0xffff0000, v240
v_sub_f32 v240, v240, v241
v_and_b32 v242, 0xffff0000, v240
v_sub_f32 v240, v240, v242
v_perm_b32 v241, v242, v241, s67
v_lshrrev_b32 v240, 16, v240
v_cndmask_b32 v241, v241, 0, s[64:65]
v_cndmask_b32 v240, v240, 0, s[64:65]
v_accvgpr_write_b32 a22, v241
v_accvgpr_write_b32 a23, v240
v_exp_f32 v160, v128
v_exp_f32 v161, v129
v_exp_f32 v162, v130
v_exp_f32 v163, v131
v_exp_f32 v164, v132
v_exp_f32 v165, v133
v_exp_f32 v166, v134
v_exp_f32 v167, v135
v_exp_f32 v168, v136
v_exp_f32 v169, v137
v_exp_f32 v170, v138
v_exp_f32 v171, v139
v_exp_f32 v172, v140
v_exp_f32 v173, v141
v_exp_f32 v174, v142
v_exp_f32 v175, v143
v_perm_b32 v192, v161, v160, s67
v_perm_b32 v193, v163, v162, s67
v_perm_b32 v194, v165, v164, s67
v_perm_b32 v195, v167, v166, s67
v_perm_b32 v196, v169, v168, s67
v_perm_b32 v197, v171, v170, s67
v_perm_b32 v198, v173, v172, s67
v_perm_b32 v199, v175, v174, s67
s_branch L_t3b_72
L_t3r_73:
v_max3_f32 v240, v144, v145, v146
v_max3_f32 v240, v240, v147, v148
v_max3_f32 v240, v240, v149, v150
v_max3_f32 v240, v240, v151, v152
v_max3_f32 v240, v240, v153, v154
v_max3_f32 v240, v240, v155, v156
v_max3_f32 v240, v240, v157, v158
v_max_f32 v240, v240, v159
v_mov_b32 v241, v240
s_nop 0
s_nop 0
v_permlane32_swap_b32 v240, v241
v_max_f32 v240, v240, v241
v_add_f32 v240, 0x41400000, v240
v_add_f32 v240, v240, v11
v_max_f32 v240, v240, v11
v_sub_f32 v242, v240, v11
v_mov_b32 v11, v240
v_pk_add_f32 v[144:145], v[144:145], v[242:243] op_sel_hi:[1,0] neg_lo:[0,1] neg_hi:[0,1]
v_pk_add_f32 v[146:147], v[146:147], v[242:243] op_sel_hi:[1,0] neg_lo:[0,1] neg_hi:[0,1]
v_pk_add_f32 v[148:149], v[148:149], v[242:243] op_sel_hi:[1,0] neg_lo:[0,1] neg_hi:[0,1]
v_pk_add_f32 v[150:151], v[150:151], v[242:243] op_sel_hi:[1,0] neg_lo:[0,1] neg_hi:[0,1]
v_pk_add_f32 v[152:153], v[152:153], v[242:243] op_sel_hi:[1,0] neg_lo:[0,1] neg_hi:[0,1]
v_pk_add_f32 v[154:155], v[154:155], v[242:243] op_sel_hi:[1,0] neg_lo:[0,1] neg_hi:[0,1]
v_pk_add_f32 v[156:157], v[156:157], v[242:243] op_sel_hi:[1,0] neg_lo:[0,1] neg_hi:[0,1]
v_pk_add_f32 v[158:159], v[158:159], v[242:243] op_sel_hi:[1,0] neg_lo:[0,1] neg_hi:[0,1]
v_exp_f32 v242, -v242
s_nop 0
v_pk_mul_f32 v[80:81], v[80:81], v[242:243] op_sel_hi:[1,0]
v_pk_mul_f32 v[82:83], v[82:83], v[242:243] op_sel_hi:[1,0]
v_pk_mul_f32 v[84:85], v[84:85], v[242:243] op_sel_hi:[1,0]
v_pk_mul_f32 v[86:87], v[86:87], v[242:243] op_sel_hi:[1,0]
v_pk_mul_f32 v[88:89], v[88:89], v[242:243] op_sel_hi:[1,0]
v_pk_mul_f32 v[90:91], v[90:91], v[242:243] op_sel_hi:[1,0]
v_pk_mul_f32 v[92:93], v[92:93], v[242:243] op_sel_hi:[1,0]
v_pk_mul_f32 v[94:95], v[94:95], v[242:243] op_sel_hi:[1,0]
v_xor_b32 v240, 0x80000000, v240
v_and_b32 v241, 0xffff0000, v240
v_sub_f32 v240, v240, v241
v_and_b32 v242, 0xffff0000, v240
v_sub_f32 v240, v240, v242
v_perm_b32 v241, v242, v241, s67
v_lshrrev_b32 v240, 16, v240
v_cndmask_b32 v241, v241, 0, s[64:65]
v_cndmask_b32 v240, v240, 0, s[64:65]
v_accvgpr_write_b32 a30, v241
v_accvgpr_write_b32 a31, v240
v_exp_f32 v176, v144
v_exp_f32 v177, v145
v_exp_f32 v178, v146
v_exp_f32 v179, v147
v_exp_f32 v180, v148
v_exp_f32 v181, v149
v_exp_f32 v182, v150
v_exp_f32 v183, v151
v_exp_f32 v184, v152
v_exp_f32 v185, v153
v_exp_f32 v186, v154
v_exp_f32 v187, v155
v_exp_f32 v188, v156
v_exp_f32 v189, v157
v_exp_f32 v190, v158
v_exp_f32 v191, v159
v_perm_b32 v200, v177, v176, s67
v_perm_b32 v201, v179, v178, s67
v_perm_b32 v202, v181, v180, s67
v_perm_b32 v203, v183, v182, s67
v_perm_b32 v204, v185, v184, s67
v_perm_b32 v205, v187, v186, s67
v_perm_b32 v206, v189, v188, s67
v_perm_b32 v207, v191, v190, s67
s_branch L_t3b_74
L_t3r_75:
v_max3_f32 v240, v128, v129, v130
v_max3_f32 v240, v240, v131, v132
v_max3_f32 v240, v240, v133, v134
v_max3_f32 v240, v240, v135, v136
v_max3_f32 v240, v240, v137, v138
v_max3_f32 v240, v240, v139, v140
v_max3_f32 v240, v240, v141, v142
v_max_f32 v240, v240, v143
v_mov_b32 v241, v240
s_nop 0
s_nop 0
v_permlane32_swap_b32 v240, v241
v_max_f32 v240, v240, v241
v_add_f32 v240, 0x41400000, v240
v_add_f32 v240, v240, v12
v_max_f32 v240, v240, v12
v_sub_f32 v242, v240, v12
v_mov_b32 v12, v240
v_pk_add_f32 v[128:129], v[128:129], v[242:243] op_sel_hi:[1,0] neg_lo:[0,1] neg_hi:[0,1]
v_pk_add_f32 v[130:131], v[130:131], v[242:243] op_sel_hi:[1,0] neg_lo:[0,1] neg_hi:[0,1]
v_pk_add_f32 v[132:133], v[132:133], v[242:243] op_sel_hi:[1,0] neg_lo:[0,1] neg_hi:[0,1]
v_pk_add_f32 v[134:135], v[134:135], v[242:243] op_sel_hi:[1,0] neg_lo:[0,1] neg_hi:[0,1]
v_pk_add_f32 v[136:137], v[136:137], v[242:243] op_sel_hi:[1,0] neg_lo:[0,1] neg_hi:[0,1]
v_pk_add_f32 v[138:139], v[138:139], v[242:243] op_sel_hi:[1,0] neg_lo:[0,1] neg_hi:[0,1]
v_pk_add_f32 v[140:141], v[140:141], v[242:243] op_sel_hi:[1,0] neg_lo:[0,1] neg_hi:[0,1]
v_pk_add_f32 v[142:143], v[142:143], v[242:243] op_sel_hi:[1,0] neg_lo:[0,1] neg_hi:[0,1]
v_exp_f32 v242, -v242
s_nop 0
v_pk_mul_f32 v[96:97], v[96:97], v[242:243] op_sel_hi:[1,0]
v_pk_mul_f32 v[98:99], v[98:99], v[242:243] op_sel_hi:[1,0]
v_pk_mul_f32 v[100:101], v[100:101], v[242:243] op_sel_hi:[1,0]
v_pk_mul_f32 v[102:103], v[102:103], v[242:243] op_sel_hi:[1,0]
v_pk_mul_f32 v[104:105], v[104:105], v[242:243] op_sel_hi:[1,0]
v_pk_mul_f32 v[106:107], v[106:107], v[242:243] op_sel_hi:[1,0]
v_pk_mul_f32 v[108:109], v[108:109], v[242:243] op_sel_hi:[1,0]
v_pk_mul_f32 v[110:111], v[110:111], v[242:243] op_sel_hi:[1,0]
v_xor_b32 v240, 0x80000000, v240
v_and_b32 v241, 0xffff0000, v240
v_sub_f32 v240, v240, v241
v_and_b32 v242, 0xffff0000, v240
v_sub_f32 v240, v240, v242
v_perm_b32 v241, v242, v241, s67
v_lshrrev_b32 v240, 16, v240
v_cndmask_b32 v241, v241, 0, s[64:65]
v_cndmask_b32 v240, v240, 0, s[64:65]
v_accvgpr_write_b32 a38, v241
v_accvgpr_write_b32 a39, v240
v_exp_f32 v160, v128
v_exp_f32 v161, v129
v_exp_f32 v162, v130
v_exp_f32 v163, v131
v_exp_f32 v164, v132
v_exp_f32 v165, v133
v_exp_f32 v166, v134
v_exp_f32 v167, v135
v_exp_f32 v168, v136
v_exp_f32 v169, v137
v_exp_f32 v170, v138
v_exp_f32 v171, v139
v_exp_f32 v172, v140
v_exp_f32 v173, v141
v_exp_f32 v174, v142
v_exp_f32 v175, v143
v_perm_b32 v192, v161, v160, s67
v_perm_b32 v193, v163, v162, s67
v_perm_b32 v194, v165, v164, s67
v_perm_b32 v195, v167, v166, s67
v_perm_b32 v196, v169, v168, s67
v_perm_b32 v197, v171, v170, s67
v_perm_b32 v198, v173, v172, s67
v_perm_b32 v199, v175, v174, s67
s_branch L_t3b_76
L_t3r_77:
v_max3_f32 v240, v144, v145, v146
v_max3_f32 v240, v240, v147, v148
v_max3_f32 v240, v240, v149, v150
v_max3_f32 v240, v240, v151, v152
v_max3_f32 v240, v240, v153, v154
v_max3_f32 v240, v240, v155, v156
v_max3_f32 v240, v240, v157, v158
v_max_f32 v240, v240, v159
v_mov_b32 v241, v240
s_nop 0
s_nop 0
v_permlane32_swap_b32 v240, v241
v_max_f32 v240, v240, v241
v_add_f32 v240, 0x41400000, v240
v_add_f32 v240, v240, v13
v_max_f32 v240, v240, v13
v_sub_f32 v242, v240, v13
v_mov_b32 v13, v240
v_pk_add_f32 v[144:145], v[144:145], v[242:243] op_sel_hi:[1,0] neg_lo:[0,1] neg_hi:[0,1]
v_pk_add_f32 v[146:147], v[146:147], v[242:243] op_sel_hi:[1,0] neg_lo:[0,1] neg_hi:[0,1]
v_pk_add_f32 v[148:149], v[148:149], v[242:243] op_sel_hi:[1,0] neg_lo:[0,1] neg_hi:[0,1]
v_pk_add_f32 v[150:151], v[150:151], v[242:243] op_sel_hi:[1,0] neg_lo:[0,1] neg_hi:[0,1]
v_pk_add_f32 v[152:153], v[152:153], v[242:243] op_sel_hi:[1,0] neg_lo:[0,1] neg_hi:[0,1]
v_pk_add_f32 v[154:155], v[154:155], v[242:243] op_sel_hi:[1,0] neg_lo:[0,1] neg_hi:[0,1]
v_pk_add_f32 v[156:157], v[156:157], v[242:243] op_sel_hi:[1,0] neg_lo:[0,1] neg_hi:[0,1]
v_pk_add_f32 v[158:159], v[158:159], v[242:243] op_sel_hi:[1,0] neg_lo:[0,1] neg_hi:[0,1]
v_exp_f32 v242, -v242
s_nop 0
v_pk_mul_f32 v[112:113], v[112:113], v[242:243] op_sel_hi:[1,0]
v_pk_mul_f32 v[114:115], v[114:115], v[242:243] op_sel_hi:[1,0]
v_pk_mul_f32 v[116:117], v[116:117], v[242:243] op_sel_hi:[1,0]
v_pk_mul_f32 v[118:119], v[118:119], v[242:243] op_sel_hi:[1,0]
v_pk_mul_f32 v[120:121], v[120:121], v[242:243] op_sel_hi:[1,0]
v_pk_mul_f32 v[122:123], v[122:123], v[242:243] op_sel_hi:[1,0]
v_pk_mul_f32 v[124:125], v[124:125], v[242:243] op_sel_hi:[1,0]
v_pk_mul_f32 v[126:127], v[126:127], v[242:243] op_sel_hi:[1,0]
v_xor_b32 v240, 0x80000000, v240
v_and_b32 v241, 0xffff0000, v240
v_sub_f32 v240, v240, v241
v_and_b32 v242, 0xffff0000, v240
v_sub_f32 v240, v240, v242
v_perm_b32 v241, v242, v241, s67
v_lshrrev_b32 v240, 16, v240
v_cndmask_b32 v241, v241, 0, s[64:65]
v_cndmask_b32 v240, v240, 0, s[64:65]
v_accvgpr_write_b32 a46, v241
v_accvgpr_write_b32 a47, v240
v_exp_f32 v176, v144
v_exp_f32 v177, v145
v_exp_f32 v178, v146
v_exp_f32 v179, v147
v_exp_f32 v180, v148
v_exp_f32 v181, v149
v_exp_f32 v182, v150
v_exp_f32 v183, v151
v_exp_f32 v184, v152
v_exp_f32 v185, v153
v_exp_f32 v186, v154
v_exp_f32 v187, v155
v_exp_f32 v188, v156
v_exp_f32 v189, v157
v_exp_f32 v190, v158
v_exp_f32 v191, v159
v_perm_b32 v200, v177, v176, s67
v_perm_b32 v201, v179, v178, s67
v_perm_b32 v202, v181, v180, s67
v_perm_b32 v203, v183, v182, s67
v_perm_b32 v204, v185, v184, s67
v_perm_b32 v205, v187, v186, s67
v_perm_b32 v206, v189, v188, s67
v_perm_b32 v207, v191, v190, s67
s_branch L_t3b_78
L_t3end_79:
s_waitcnt vmcnt(0)
s_barrier
s_cmp_lg_u32 s44, 0
s_cbranch_scc1 L_da_80
v_mov_b32 v240, 36
v_mov_b32 v241, 1
s_mov_b64 exec, 1
global_atomic_add v240, v241, s[40:41] sc1
s_mov_b64 exec, -1
L_da_80:
s_cmp_ge_u32 s45, 96
s_cbranch_scc1 L_exit
s_cmp_ge_u32 s45, 40
s_cbranch_scc1 L_tails
s_mov_b32 s51, s45
s_mul_i32 s77, s51, 13108
s_lshr_b32 s77, s77, 16
s_mul_i32 s48, s77, 5
s_sub_u32 s76, s51, s48
s_mov_b32 s8, s34
s_mov_b32 s9, s35
s_mov_b32 s10, 819200
s_mov_b32 s11, 0x20000
s_mov_b32 s12, s38
s_mov_b32 s13, s39
s_mov_b32 s14, 2621440
s_mov_b32 s15, 0x20000
v_lshrrev_b32 v122, 4, v1
v_mul_u32_u24 v122, 1280, v122
v_and_b32 v112, 15, v1
v_lshl_add_u32 v112, v112, 4, v122
s_add_u32 s48, s44, 0
s_mul_i32 s49, s48, 21846
s_lshr_b32 s49, s49, 16
s_mul_i32 s50, s49, 3
s_sub_u32 s48, s48, s50
s_mul_i32 s49, s49, 25600
s_mul_i32 s50, s48, 10240
s_add_u32 s49, s49, s50
s_lshl_b32 s50, s76, 8
s_add_u32 s80, s49, s50
s_add_u32 s49, s80, 5120
s_cmp_eq_u32 s48, 2
s_cselect_b32 s81, 1879048192, s49
s_add_u32 s48, s44, 4
s_mul_i32 s49, s48, 21846
s_lshr_b32 s49, s49, 16
s_mul_i32 s50, s49, 3
s_sub_u32 s48, s48, s50
s_mul_i32 s49, s49, 25600
s_mul_i32 s50, s48, 10240
s_add_u32 s49, s49, s50
s_lshl_b32 s50, s76, 8
s_add_u32 s82, s49, s50
s_add_u32 s49, s82, 5120
s_cmp_eq_u32 s48, 2
s_cselect_b32 s83, 1879048192, s49
s_add_u32 s48, s44, 8
s_mul_i32 s49, s48, 21846
s_lshr_b32 s49, s49, 16
s_mul_i32 s50, s49, 3
s_sub_u32 s48, s48, s50
s_mul_i32 s49, s49, 25600
s_mul_i32 s50, s48, 10240
s_add_u32 s49, s49, s50
s_lshl_b32 s50, s76, 8
s_add_u32 s84, s49, s50
s_add_u32 s49, s84, 5120
s_cmp_eq_u32 s48, 2
s_cselect_b32 s85, 1879048192, s49
s_lshl_b32 s48, s44, 6
v_lshrrev_b32 v122, 4, v1
v_lshlrev_b32 v122, 3, v122
v_bfe_u32 v123, v1, 2, 2
v_add_u32 v122, v122, v123
v_and_b32 v123, 3, v1
v_lshlrev_b32 v122, 8, v122
v_lshl_add_u32 v122, v123, 4, v122
v_add_u32 v113, s48, v122
s_barrier
s_mul_i32 s50, s44, 2048
s_add_u32 m0, s50, 0
s_add_u32 s49, s80, 0
buffer_load_dwordx4 v112, s[8:11], s49 offen nt lds
s_mul_i32 s50, s44, 2048
s_add_u32 m0, s50, 1024
s_add_u32 s49, s81, 0
buffer_load_dwordx4 v112, s[8:11], s49 offen nt lds
s_mul_i32 s50, s44, 2048
s_add_u32 m0, s50, 8192
s_add_u32 s49, s82, 0
buffer_load_dwordx4 v112, s[8:11], s49 offen nt lds
s_mul_i32 s50, s44, 2048
s_add_u32 m0, s50, 9216
s_add_u32 s49, s83, 0
buffer_load_dwordx4 v112, s[8:11], s49 offen nt lds
s_mul_i32 s50, s44, 2048
s_add_u32 m0, s50, 16384
s_add_u32 s49, s84, 0
buffer_load_dwordx4 v112, s[8:11], s49 offen nt lds
s_mul_i32 s50, s44, 2048
s_add_u32 m0, s50, 17408
s_add_u32 s49, s85, 0
buffer_load_dwordx4 v112, s[8:11], s49 offen nt lds
s_mul_i32 s50, s44, 2048
s_add_u32 m0, s50, 24576
s_add_u32 s49, s80, 102400
buffer_load_dwordx4 v112, s[8:11], s49 offen nt lds
s_mul_i32 s50, s44, 2048
s_add_u32 m0, s50, 25600
s_add_u32 s49, s81, 102400
buffer_load_dwordx4 v112, s[8:11], s49 offen nt lds
s_mul_i32 s50, s44, 2048
s_add_u32 m0, s50, 32768
s_add_u32 s49, s82, 102400
buffer_load_dwordx4 v112, s[8:11], s49 offen nt lds
s_mul_i32 s50, s44, 2048
s_add_u32 m0, s50, 33792
s_add_u32 s49, s83, 102400
buffer_load_dwordx4 v112, s[8:11], s49 offen nt lds
s_waitcnt vmcnt(8) lgkmcnt(0)
s_barrier
s_mul_i32 s50, s44, 2048
s_add_u32 m0, s50, 40960
s_add_u32 s49, s84, 102400
buffer_load_dwordx4 v112, s[8:11], s49 offen nt lds
s_mul_i32 s50, s44, 2048
s_add_u32 m0, s50, 41984
s_add_u32 s49, s85, 102400
buffer_load_dwordx4 v112, s[8:11], s49 offen nt lds
ds_read_b64_tr_b16 a[0:1], v113 offset:0
ds_read_b64_tr_b16 a[2:3], v113 offset:1024
ds_read_b64_tr_b16 a[4:5], v113 offset:8
ds_read_b64_tr_b16 a[6:7], v113 offset:1032
s_waitcnt vmcnt(8) lgkmcnt(0)
s_barrier
s_mul_i32 s50, s44, 2048
s_add_u32 m0, s50, 0
s_add_u32 s49, s80, 204800
buffer_load_dwordx4 v112, s[8:11], s49 offen nt lds
s_mul_i32 s50, s44, 2048
s_add_u32 m0, s50, 1024
s_add_u32 s49, s81, 204800
buffer_load_dwordx4 v112, s[8:11], s49 offen nt lds
ds_read_b64_tr_b16 a[8:9], v113 offset:8192
ds_read_b64_tr_b16 a[10:11], v113 offset:9216
ds_read_b64_tr_b16 a[12:13], v113 offset:8200
ds_read_b64_tr_b16 a[14:15], v113 offset:9224
s_waitcnt vmcnt(8) lgkmcnt(0)
s_barrier
s_mul_i32 s50, s44, 2048
s_add_u32 m0, s50, 8192
s_add_u32 s49, s82, 204800
buffer_load_dwordx4 v112, s[8:11], s49 offen nt lds
s_mul_i32 s50, s44, 2048
s_add_u32 m0, s50, 9216
s_add_u32 s49, s83, 204800
buffer_load_dwordx4 v112, s[8:11], s49 offen nt lds
ds_read_b64_tr_b16 a[16:17], v113 offset:16384
ds_read_b64_tr_b16 a[18:19], v113 offset:17408
ds_read_b64_tr_b16 a[20:21], v113 offset:16392
ds_read_b64_tr_b16 a[22:23], v113 offset:17416
s_waitcnt vmcnt(8) lgkmcnt(0)
s_barrier
s_mul_i32 s50, s44, 2048
s_add_u32 m0, s50, 16384
s_add_u32 s49, s84, 204800
buffer_load_dwordx4 v112, s[8:11], s49 offen nt lds
s_mul_i32 s50, s44, 2048
s_add_u32 m0, s50, 17408
s_add_u32 s49, s85, 204800
buffer_load_dwordx4 v112, s[8:11], s49 offen nt lds
ds_read_b64_tr_b16 a[24:25], v113 offset:24576
ds_read_b64_tr_b16 a[26:27], v113 offset:25600
ds_read_b64_tr_b16 a[28:29], v113 offset:24584
ds_read_b64_tr_b16 a[30:31], v113 offset:25608
s_waitcnt vmcnt(8) lgkmcnt(0)
s_barrier
s_mul_i32 s50, s44, 2048
s_add_u32 m0, s50, 24576
s_add_u32 s49, s80, 307200
buffer_load_dwordx4 v112, s[8:11], s49 offen nt lds
s_mul_i32 s50, s44, 2048
s_add_u32 m0, s50, 25600
s_add_u32 s49, s81, 307200
buffer_load_dwordx4 v112, s[8:11], s49 offen nt lds
ds_read_b64_tr_b16 a[32:33], v113 offset:32768
ds_read_b64_tr_b16 a[34:35], v113 offset:33792
ds_read_b64_tr_b16 a[36:37], v113 offset:32776
ds_read_b64_tr_b16 a[38:39], v113 offset:33800
s_waitcnt vmcnt(8) lgkmcnt(0)
s_barrier
s_mul_i32 s50, s44, 2048
s_add_u32 m0, s50, 32768
s_add_u32 s49, s82, 307200
buffer_load_dwordx4 v112, s[8:11], s49 offen nt lds
s_mul_i32 s50, s44, 2048
s_add_u32 m0, s50, 33792
s_add_u32 s49, s83, 307200
buffer_load_dwordx4 v112, s[8:11], s49 offen nt lds
ds_read_b64_tr_b16 a[40:41], v113 offset:40960
ds_read_b64_tr_b16 a[42:43], v113 offset:41984
ds_read_b64_tr_b16 a[44:45], v113 offset:40968
ds_read_b64_tr_b16 a[46:47], v113 offset:41992
s_waitcnt vmcnt(8) lgkmcnt(0)
s_barrier
s_mul_i32 s50, s44, 2048
s_add_u32 m0, s50, 40960
s_add_u32 s49, s84, 307200
buffer_load_dwordx4 v112, s[8:11], s49 offen nt lds
s_mul_i32 s50, s44, 2048
s_add_u32 m0, s50, 41984
s_add_u32 s49, s85, 307200
buffer_load_dwordx4 v112, s[8:11], s49 offen nt lds
ds_read_b64_tr_b16 a[48:49], v113 offset:0
ds_read_b64_tr_b16 a[50:51], v113 offset:1024
ds_read_b64_tr_b16 a[52:53], v113 offset:8
ds_read_b64_tr_b16 a[54:55], v113 offset:1032
s_waitcnt vmcnt(8) lgkmcnt(0)
s_barrier
s_mul_i32 s50, s44, 2048
s_add_u32 m0, s50, 0
s_add_u32 s49, s80, 409600
buffer_load_dwordx4 v112, s[8:11], s49 offen nt lds
s_mul_i32 s50, s44, 2048
s_add_u32 m0, s50, 1024
s_add_u32 s49, s81, 409600
buffer_load_dwordx4 v112, s[8:11], s49 offen nt lds
ds_read_b64_tr_b16 a[56:57], v113 offset:8192
ds_read_b64_tr_b16 a[58:59], v113 offset:9216
ds_read_b64_tr_b16 a[60:61], v113 offset:8200
ds_read_b64_tr_b16 a[62:63], v113 offset:9224
s_waitcnt vmcnt(8) lgkmcnt(0)
s_barrier
s_mul_i32 s50, s44, 2048
s_add_u32 m0, s50, 8192
s_add_u32 s49, s82, 409600
buffer_load_dwordx4 v112, s[8:11], s49 offen nt lds
s_mul_i32 s50, s44, 2048
s_add_u32 m0, s50, 9216
s_add_u32 s49, s83, 409600
buffer_load_dwordx4 v112, s[8:11], s49 offen nt lds
ds_read_b64_tr_b16 a[64:65], v113 offset:16384
ds_read_b64_tr_b16 a[66:67], v113 offset:17408
ds_read_b64_tr_b16 a[68:69], v113 offset:16392
ds_read_b64_tr_b16 a[70:71], v113 offset:17416
s_waitcnt vmcnt(8) lgkmcnt(0)
s_barrier
s_mul_i32 s50, s44, 2048
s_add_u32 m0, s50, 16384
s_add_u32 s49, s84, 409600
buffer_load_dwordx4 v112, s[8:11], s49 offen nt lds
s_mul_i32 s50, s44, 2048
s_add_u32 m0, s50, 17408
s_add_u32 s49, s85, 409600
buffer_load_dwordx4 v112, s[8:11], s49 offen nt lds
ds_read_b64_tr_b16 a[72:73], v113 offset:24576
ds_read_b64_tr_b16 a[74:75], v113 offset:25600
ds_read_b64_tr_b16 a[76:77], v113 offset:24584
ds_read_b64_tr_b16 a[78:79], v113 offset:25608
s_waitcnt vmcnt(8) lgkmcnt(0)
s_barrier
s_mul_i32 s50, s44, 2048
s_add_u32 m0, s50, 24576
s_add_u32 s49, s80, 512000
buffer_load_dwordx4 v112, s[8:11], s49 offen nt lds
s_mul_i32 s50, s44, 2048
s_add_u32 m0, s50, 25600
s_add_u32 s49, s81, 512000
buffer_load_dwordx4 v112, s[8:11], s49 offen nt lds
ds_read_b64_tr_b16 a[80:81], v113 offset:32768
ds_read_b64_tr_b16 a[82:83], v113 offset:33792
ds_read_b64_tr_b16 a[84:85], v113 offset:32776
ds_read_b64_tr_b16 a[86:87], v113 offset:33800
s_waitcnt vmcnt(8) lgkmcnt(0)
s_barrier
s_mul_i32 s50, s44, 2048
s_add_u32 m0, s50, 32768
s_add_u32 s49, s82, 512000
buffer_load_dwordx4 v112, s[8:11], s49 offen nt lds
s_mul_i32 s50, s44, 2048
s_add_u32 m0, s50, 33792
s_add_u32 s49, s83, 512000
buffer_load_dwordx4 v112, s[8:11], s49 offen nt lds
ds_read_b64_tr_b16 a[88:89], v113 offset:40960
ds_read_b64_tr_b16 a[90:91], v113 offset:41984
ds_read_b64_tr_b16 a[92:93], v113 offset:40968
ds_read_b64_tr_b16 a[94:95], v113 offset:41992
s_waitcnt vmcnt(8) lgkmcnt(0)
s_barrier
s_mul_i32 s50, s44, 2048
s_add_u32 m0, s50, 40960
s_add_u32 s49, s84, 512000
buffer_load_dwordx4 v112, s[8:11], s49 offen nt lds
s_mul_i32 s50, s44, 2048
s_add_u32 m0, s50, 41984
s_add_u32 s49, s85, 512000
buffer_load_dwordx4 v112, s[8:11], s49 offen nt lds
ds_read_b64_tr_b16 a[96:97], v113 offset:0
ds_read_b64_tr_b16 a[98:99], v113 offset:1024
ds_read_b64_tr_b16 a[100:101], v113 offset:8
ds_read_b64_tr_b16 a[102:103], v113 offset:1032
s_waitcnt vmcnt(8) lgkmcnt(0)
s_barrier
s_mul_i32 s50, s44, 2048
s_add_u32 m0, s50, 0
s_add_u32 s49, s80, 614400
buffer_load_dwordx4 v112, s[8:11], s49 offen nt lds
s_mul_i32 s50, s44, 2048
s_add_u32 m0, s50, 1024
s_add_u32 s49, s81, 614400
buffer_load_dwordx4 v112, s[8:11], s49 offen nt lds
ds_read_b64_tr_b16 a[104:105], v113 offset:8192
ds_read_b64_tr_b16 a[106:107], v113 offset:9216
ds_read_b64_tr_b16 a[108:109], v113 offset:8200
ds_read_b64_tr_b16 a[110:111], v113 offset:9224
s_waitcnt vmcnt(8) lgkmcnt(0)
s_barrier
s_mul_i32 s50, s44, 2048
s_add_u32 m0, s50, 8192
s_add_u32 s49, s82, 614400
buffer_load_dwordx4 v112, s[8:11], s49 offen nt lds
s_mul_i32 s50, s44, 2048
s_add_u32 m0, s50, 9216
s_add_u32 s49, s83, 614400
buffer_load_dwordx4 v112, s[8:11], s49 offen nt lds
ds_read_b64_tr_b16 a[112:113], v113 offset:16384
ds_read_b64_tr_b16 a[114:115], v113 offset:17408
ds_read_b64_tr_b16 a[116:117], v113 offset:16392
ds_read_b64_tr_b16 a[118:119], v113 offset:17416
s_waitcnt vmcnt(8) lgkmcnt(0)
s_barrier
s_mul_i32 s50, s44, 2048
s_add_u32 m0, s50, 16384
s_add_u32 s49, s84, 614400
buffer_load_dwordx4 v112, s[8:11], s49 offen nt lds
s_mul_i32 s50, s44, 2048
s_add_u32 m0, s50, 17408
s_add_u32 s49, s85, 614400
buffer_load_dwordx4 v112, s[8:11], s49 offen nt lds
ds_read_b64_tr_b16 a[120:121], v113 offset:24576
ds_read_b64_tr_b16 a[122:123], v113 offset:25600
ds_read_b64_tr_b16 a[124:125], v113 offset:24584
ds_read_b64_tr_b16 a[126:127], v113 offset:25608
s_waitcnt vmcnt(8) lgkmcnt(0)
s_barrier
s_mul_i32 s50, s44, 2048
s_add_u32 m0, s50, 24576
s_add_u32 s49, s80, 716800
buffer_load_dwordx4 v112, s[8:11], s49 offen nt lds
s_mul_i32 s50, s44, 2048
s_add_u32 m0, s50, 25600
s_add_u32 s49, s81, 716800
buffer_load_dwordx4 v112, s[8:11], s49 offen nt lds
ds_read_b64_tr_b16 a[128:129], v113 offset:32768
ds_read_b64_tr_b16 a[130:131], v113 offset:33792
ds_read_b64_tr_b16 a[132:133], v113 offset:32776
ds_read_b64_tr_b16 a[134:135], v113 offset:33800
s_waitcnt vmcnt(8) lgkmcnt(0)
s_barrier
s_mul_i32 s50, s44, 2048
s_add_u32 m0, s50, 32768
s_add_u32 s49, s82, 716800
buffer_load_dwordx4 v112, s[8:11], s49 offen nt lds
s_mul_i32 s50, s44, 2048
s_add_u32 m0, s50, 33792
s_add_u32 s49, s83, 716800
buffer_load_dwordx4 v112, s[8:11], s49 offen nt lds
ds_read_b64_tr_b16 a[136:137], v113 offset:40960
ds_read_b64_tr_b16 a[138:139], v113 offset:41984
ds_read_b64_tr_b16 a[140:141], v113 offset:40968
ds_read_b64_tr_b16 a[142:143], v113 offset:41992
s_waitcnt vmcnt(8) lgkmcnt(0)
s_barrier
s_mul_i32 s50, s44, 2048
s_add_u32 m0, s50, 40960
s_add_u32 s49, s84, 716800
buffer_load_dwordx4 v112, s[8:11], s49 offen nt lds
s_mul_i32 s50, s44, 2048
s_add_u32 m0, s50, 41984
s_add_u32 s49, s85, 716800
buffer_load_dwordx4 v112, s[8:11], s49 offen nt lds
ds_read_b64_tr_b16 a[144:145], v113 offset:0
ds_read_b64_tr_b16 a[146:147], v113 offset:1024
ds_read_b64_tr_b16 a[148:149], v113 offset:8
ds_read_b64_tr_b16 a[150:151], v113 offset:1032
s_waitcnt vmcnt(8) lgkmcnt(0)
s_barrier
ds_read_b64_tr_b16 a[152:153], v113 offset:8192
ds_read_b64_tr_b16 a[154:155], v113 offset:9216
ds_read_b64_tr_b16 a[156:157], v113 offset:8200
ds_read_b64_tr_b16 a[158:159], v113 offset:9224
s_waitcnt vmcnt(6) lgkmcnt(0)
s_barrier
ds_read_b64_tr_b16 a[160:161], v113 offset:16384
ds_read_b64_tr_b16 a[162:163], v113 offset:17408
ds_read_b64_tr_b16 a[164:165], v113 offset:16392
ds_read_b64_tr_b16 a[166:167], v113 offset:17416
s_waitcnt vmcnt(4) lgkmcnt(0)
s_barrier
ds_read_b64_tr_b16 a[168:169], v113 offset:24576
ds_read_b64_tr_b16 a[170:171], v113 offset:25600
ds_read_b64_tr_b16 a[172:173], v113 offset:24584
ds_read_b64_tr_b16 a[174:175], v113 offset:25608
s_waitcnt vmcnt(2) lgkmcnt(0)
s_barrier
ds_read_b64_tr_b16 a[176:177], v113 offset:32768
ds_read_b64_tr_b16 a[178:179], v113 offset:33792
ds_read_b64_tr_b16 a[180:181], v113 offset:32776
ds_read_b64_tr_b16 a[182:183], v113 offset:33800
s_waitcnt vmcnt(0) lgkmcnt(0)
s_barrier
ds_read_b64_tr_b16 a[184:185], v113 offset:40960
ds_read_b64_tr_b16 a[186:187], v113 offset:41984
ds_read_b64_tr_b16 a[188:189], v113 offset:40968
ds_read_b64_tr_b16 a[190:191], v113 offset:41992
s_waitcnt lgkmcnt(0)
s_mul_i32 s48, s44, 12288
v_lshlrev_b32 v100, 4, v1
v_add_u32 v100, s48, v100
v_lshrrev_b32 v122, 4, v1
v_and_b32 v123, 15, v1
v_lshlrev_b32 v122, 9, v122
v_lshl_add_u32 v96, v123, 4, v122
s_mul_i32 s48, s77, 49152
s_add_u32 s55, s48, 180355072
s_mul_i32 s59, s77, 40960
s_mov_b32 s60, 327680
s_mov_b32 s61, 8
s_sub_u32 s78, s77, 8
s_mov_b32 s79, 0
s_lshl_b32 s48, s76, 8
s_lshl_b32 s49, s44, 6
s_add_u32 s48, s48, s49
v_and_b32 v122, 15, v1
v_mul_u32_u24 v122, 1280, v122
v_lshrrev_b32 v123, 4, v1
v_lshl_add_u32 v122, v123, 4, v122
v_add_u32 v112, s48, v122
v_add_u32 v113, 20480, v112
s_lshl_b32 s48, s44, 12
v_lshlrev_b32 v122, 4, v1
v_add_u32 v114, s48, v122
s_lshl_b32 s48, s76, 9
s_add_u32 s48, s48, 49152
v_min_u32 v122, 3, v1
v_lshl_add_u32 v115, v122, 7, s48
v_mov_b32 v122, 36
s_cmp_lg_u32 s44, 0
s_cbranch_scc1 L_pdx_82
s_mov_b32 s53, 0
L_pd_81:
global_load_dword v123, v122, s[40:41] sc1
s_add_u32 s53, s53, 1
s_cmp_gt_u32 s53, 100000
s_cbranch_scc1 L_pdx_82
s_waitcnt vmcnt(0)
v_readfirstlane_b32 s48, v123
s_cmp_ge_u32 s48, 96
s_cbranch_scc1 L_pdx_82
s_sleep 16
s_branch L_pd_81
L_pdx_82:
s_waitcnt vmcnt(0)
s_barrier
s_barrier
s_mul_i32 s57, s44, 12288
s_mov_b32 s58, 0
s_mov_b32 s56, 1879048192
s_mov_b32 s54, -2
s_mov_b32 s64, 49152
s_add_u32 m0, s57, 0
s_add_u32 s49, s55, 0
buffer_load_dwordx4 v100, s[4:7], s49 offen offset:0 sc1 lds
buffer_load_dwordx4 v100, s[4:7], s49 offen offset:1024 sc1 lds
buffer_load_dwordx4 v100, s[4:7], s49 offen offset:2048 sc1 lds
buffer_load_dwordx4 v100, s[4:7], s49 offen offset:3072 sc1 lds
s_add_u32 m0, s57, 4096
s_add_u32 s49, s55, 4096
buffer_load_dwordx4 v100, s[4:7], s49 offen offset:0 sc1 lds
buffer_load_dwordx4 v100, s[4:7], s49 offen offset:1024 sc1 lds
buffer_load_dwordx4 v100, s[4:7], s49 offen offset:2048 sc1 lds
buffer_load_dwordx4 v100, s[4:7], s49 offen offset:3072 sc1 lds
s_add_u32 m0, s57, 8192
s_add_u32 s49, s55, 8192
buffer_load_dwordx4 v100, s[4:7], s49 offen offset:0 sc1 lds
buffer_load_dwordx4 v100, s[4:7], s49 offen offset:1024 sc1 lds
buffer_load_dwordx4 v100, s[4:7], s49 offen offset:2048 sc1 lds
buffer_load_dwordx4 v100, s[4:7], s49 offen offset:3072 sc1 lds
s_add_u32 s55, s55, 393216
s_add_u32 s57, s57, 49152
s_cmp_ge_u32 s57, 147456
s_cselect_b32 s49, 147456, 0
s_sub_u32 s57, s57, s49
s_add_u32 s54, s54, 1
s_add_u32 m0, s57, 0
s_add_u32 s49, s55, 0
buffer_load_dwordx4 v100, s[4:7], s49 offen offset:0 sc1 lds
buffer_load_dwordx4 v100, s[4:7], s49 offen offset:1024 sc1 lds
buffer_load_dwordx4 v100, s[4:7], s49 offen offset:2048 sc1 lds
buffer_load_dwordx4 v100, s[4:7], s49 offen offset:3072 sc1 lds
s_add_u32 m0, s57, 4096
s_add_u32 s49, s55, 4096
buffer_load_dwordx4 v100, s[4:7], s49 offen offset:0 sc1 lds
buffer_load_dwordx4 v100, s[4:7], s49 offen offset:1024 sc1 lds
buffer_load_dwordx4 v100, s[4:7], s49 offen offset:2048 sc1 lds
buffer_load_dwordx4 v100, s[4:7], s49 offen offset:3072 sc1 lds
s_add_u32 m0, s57, 8192
s_add_u32 s49, s55, 8192
buffer_load_dwordx4 v100, s[4:7], s49 offen offset:0 sc1 lds
buffer_load_dwordx4 v100, s[4:7], s49 offen offset:1024 sc1 lds
buffer_load_dwordx4 v100, s[4:7], s49 offen offset:2048 sc1 lds
buffer_load_dwordx4 v100, s[4:7], s49 offen offset:3072 sc1 lds
s_add_u32 s55, s55, 393216
s_add_u32 s57, s57, 49152
s_cmp_ge_u32 s57, 147456
s_cselect_b32 s49, 147456, 0
s_sub_u32 s57, s57, s49
s_add_u32 s54, s54, 1
s_waitcnt vmcnt(12)
s_barrier
ds_read_b128 v[64:67], v96 offset:0
ds_read_b128 v[68:71], v96 offset:256
ds_read_b128 v[72:75], v96 offset:2048
ds_read_b128 v[76:79], v96 offset:2304
ds_read_b128 v[80:83], v96 offset:4096
ds_read_b128 v[84:87], v96 offset:4352
ds_read_b128 v[88:91], v96 offset:6144
ds_read_b128 v[92:95], v96 offset:6400
L_t3b_loop_83:
s_cmp_lt_i32 s78, 0
s_cbranch_scc1 L_t3bs_85
s_cmp_gt_u32 s79, s78
s_cbranch_scc1 L_p3x_87
s_mov_b32 s53, 0
L_p3_86:
buffer_load_dword v122, v115, s[4:7], 0 offen sc1
s_add_u32 s53, s53, 1
s_cmp_gt_u32 s53, 100000
s_cbranch_scc1 L_p3x_87
s_waitcnt vmcnt(0)
v_readlane_b32 s79, v122, 0
v_readlane_b32 s48, v122, 1
s_min_u32 s79, s79, s48
v_readlane_b32 s48, v122, 2
s_min_u32 s79, s79, s48
v_readlane_b32 s48, v122, 3
s_min_u32 s79, s79, s48
s_cmp_gt_u32 s79, s78
s_cbranch_scc1 L_p3x_87
s_sleep 3
s_branch L_p3_86
L_p3x_87:
s_mov_b32 s86, s56
s_mul_i32 s48, s78, 5
s_add_u32 s48, s48, s76
s_lshl_b32 s48, s48, 16
s_add_u32 s48, s48, 201326592
buffer_load_dwordx4 v[128:131], v114, s[4:7], s48 offen offset:0 sc1
buffer_load_dwordx4 v[132:135], v114, s[4:7], s48 offen offset:1024 sc1
buffer_load_dwordx4 v[136:139], v114, s[4:7], s48 offen offset:2048 sc1
buffer_load_dwordx4 v[140:143], v114, s[4:7], s48 offen offset:3072 sc1
s_add_u32 s48, s48, 16384
buffer_load_dwordx4 v[144:147], v114, s[4:7], s48 offen offset:0 sc1
buffer_load_dwordx4 v[148:151], v114, s[4:7], s48 offen offset:1024 sc1
buffer_load_dwordx4 v[152:155], v114, s[4:7], s48 offen offset:2048 sc1
buffer_load_dwordx4 v[156:159], v114, s[4:7], s48 offen offset:3072 sc1
s_add_u32 s48, s48, 16384
buffer_load_dwordx4 v[160:163], v114, s[4:7], s48 offen offset:0 sc1
buffer_load_dwordx4 v[164:167], v114, s[4:7], s48 offen offset:1024 sc1
buffer_load_dwordx4 v[168:171], v114, s[4:7], s48 offen offset:2048 sc1
buffer_load_dwordx4 v[172:175], v114, s[4:7], s48 offen offset:3072 sc1
s_add_u32 s48, s48, 16384
buffer_load_dwordx4 v[176:179], v114, s[4:7], s48 offen offset:0 sc1
buffer_load_dwordx4 v[180:183], v114, s[4:7], s48 offen offset:1024 sc1
buffer_load_dwordx4 v[184:187], v114, s[4:7], s48 offen offset:2048 sc1
buffer_load_dwordx4 v[188:191], v114, s[4:7], s48 offen offset:3072 sc1
L_t3bs_85:
s_waitcnt lgkmcnt(7)
v_mfma_f32_16x16x32_bf16 v[16:19], a[0:3], v[64:67], 0
s_add_u32 m0, s57, 0
s_add_u32 s49, s55, 0
v_mfma_f32_16x16x32_bf16 v[24:27], a[4:7], v[64:67], 0
ds_read_b128 v[64:67], v96 offset:8192
s_waitcnt lgkmcnt(7)
v_mfma_f32_16x16x32_bf16 v[20:23], a[0:3], v[68:71], 0
buffer_load_dwordx4 v100, s[4:7], s49 offen offset:0 sc1 lds
v_mfma_f32_16x16x32_bf16 v[28:31], a[4:7], v[68:71], 0
ds_read_b128 v[68:71], v96 offset:8448
s_waitcnt lgkmcnt(7)
v_mfma_f32_16x16x32_bf16 v[16:19], a[8:11], v[72:75], v[16:19]
v_mfma_f32_16x16x32_bf16 v[24:27], a[12:15], v[72:75], v[24:27]
ds_read_b128 v[72:75], v96 offset:10240
s_waitcnt lgkmcnt(7)
v_mfma_f32_16x16x32_bf16 v[20:23], a[8:11], v[76:79], v[20:23]
buffer_load_dwordx4 v100, s[4:7], s49 offen offset:1024 sc1 lds
s_mov_b32 s56, s59
v_mfma_f32_16x16x32_bf16 v[28:31], a[12:15], v[76:79], v[28:31]
ds_read_b128 v[76:79], v96 offset:10496
s_waitcnt lgkmcnt(7)
v_mfma_f32_16x16x32_bf16 v[16:19], a[16:19], v[80:83], v[16:19]
v_mfma_f32_16x16x32_bf16 v[24:27], a[20:23], v[80:83], v[24:27]
ds_read_b128 v[80:83], v96 offset:12288
s_waitcnt lgkmcnt(7)
v_mfma_f32_16x16x32_bf16 v[20:23], a[16:19], v[84:87], v[20:23]
v_mfma_f32_16x16x32_bf16 v[28:31], a[20:23], v[84:87], v[28:31]
ds_read_b128 v[84:87], v96 offset:12544
s_waitcnt lgkmcnt(7)
v_mfma_f32_16x16x32_bf16 v[16:19], a[24:27], v[88:91], v[16:19]
buffer_load_dwordx4 v100, s[4:7], s49 offen offset:2048 sc1 lds
v_mfma_f32_16x16x32_bf16 v[24:27], a[28:31], v[88:91], v[24:27]
ds_read_b128 v[88:91], v96 offset:14336
s_waitcnt lgkmcnt(7)
v_mfma_f32_16x16x32_bf16 v[20:23], a[24:27], v[92:95], v[20:23]
v_mfma_f32_16x16x32_bf16 v[28:31], a[28:31], v[92:95], v[28:31]
ds_read_b128 v[92:95], v96 offset:14592
s_waitcnt lgkmcnt(7)
v_mfma_f32_16x16x32_bf16 v[16:19], a[32:35], v[64:67], v[16:19]
v_mfma_f32_16x16x32_bf16 v[24:27], a[36:39], v[64:67], v[24:27]
ds_read_b128 v[64:67], v96 offset:16384
s_waitcnt lgkmcnt(7)
v_mfma_f32_16x16x32_bf16 v[20:23], a[32:35], v[68:71], v[20:23]
buffer_load_dwordx4 v100, s[4:7], s49 offen offset:3072 sc1 lds
v_mfma_f32_16x16x32_bf16 v[28:31], a[36:39], v[68:71], v[28:31]
ds_read_b128 v[68:71], v96 offset:16640
s_waitcnt lgkmcnt(7)
v_mfma_f32_16x16x32_bf16 v[16:19], a[40:43], v[72:75], v[16:19]
v_mfma_f32_16x16x32_bf16 v[24:27], a[44:47], v[72:75], v[24:27]
ds_read_b128 v[72:75], v96 offset:18432
s_waitcnt lgkmcnt(7)
v_mfma_f32_16x16x32_bf16 v[20:23], a[40:43], v[76:79], v[20:23]
v_mfma_f32_16x16x32_bf16 v[28:31], a[44:47], v[76:79], v[28:31]
ds_read_b128 v[76:79], v96 offset:18688
s_waitcnt lgkmcnt(7)
v_mfma_f32_16x16x32_bf16 v[16:19], a[48:51], v[80:83], v[16:19]
s_add_u32 m0, s57, 4096
s_add_u32 s49, s55, 4096
v_mfma_f32_16x16x32_bf16 v[24:27], a[52:55], v[80:83], v[24:27]
ds_read_b128 v[80:83], v96 offset:20480
s_waitcnt lgkmcnt(7)
v_mfma_f32_16x16x32_bf16 v[20:23], a[48:51], v[84:87], v[20:23]
buffer_load_dwordx4 v100, s[4:7], s49 offen offset:0 sc1 lds
v_mfma_f32_16x16x32_bf16 v[28:31], a[52:55], v[84:87], v[28:31]
ds_read_b128 v[84:87], v96 offset:20736
s_waitcnt lgkmcnt(7)
v_mfma_f32_16x16x32_bf16 v[16:19], a[56:59], v[88:91], v[16:19]
v_mfma_f32_16x16x32_bf16 v[24:27], a[60:63], v[88:91], v[24:27]
ds_read_b128 v[88:91], v96 offset:22528
s_waitcnt lgkmcnt(7)
v_mfma_f32_16x16x32_bf16 v[20:23], a[56:59], v[92:95], v[20:23]
buffer_load_dwordx4 v100, s[4:7], s49 offen offset:1024 sc1 lds
v_mfma_f32_16x16x32_bf16 v[28:31], a[60:63], v[92:95], v[28:31]
ds_read_b128 v[92:95], v96 offset:22784
s_waitcnt lgkmcnt(7)
v_mfma_f32_16x16x32_bf16 v[16:19], a[64:67], v[64:67], v[16:19]
v_mfma_f32_16x16x32_bf16 v[24:27], a[68:71], v[64:67], v[24:27]
ds_read_b128 v[64:67], v96 offset:24576
s_waitcnt lgkmcnt(7)
v_mfma_f32_16x16x32_bf16 v[20:23], a[64:67], v[68:71], v[20:23]
v_mfma_f32_16x16x32_bf16 v[28:31], a[68:71], v[68:71], v[28:31]
ds_read_b128 v[68:71], v96 offset:24832
s_waitcnt lgkmcnt(7)
v_mfma_f32_16x16x32_bf16 v[16:19], a[72:75], v[72:75], v[16:19]
buffer_load_dwordx4 v100, s[4:7], s49 offen offset:2048 sc1 lds
v_mfma_f32_16x16x32_bf16 v[24:27], a[76:79], v[72:75], v[24:27]
ds_read_b128 v[72:75], v96 offset:26624
s_waitcnt lgkmcnt(7)
v_mfma_f32_16x16x32_bf16 v[20:23], a[72:75], v[76:79], v[20:23]
v_mfma_f32_16x16x32_bf16 v[28:31], a[76:79], v[76:79], v[28:31]
ds_read_b128 v[76:79], v96 offset:26880
s_waitcnt lgkmcnt(7)
v_mfma_f32_16x16x32_bf16 v[16:19], a[80:83], v[80:83], v[16:19]
s_add_u32 s59, s59, s60
v_mfma_f32_16x16x32_bf16 v[24:27], a[84:87], v[80:83], v[24:27]
ds_read_b128 v[80:83], v96 offset:28672
s_waitcnt lgkmcnt(7)
v_mfma_f32_16x16x32_bf16 v[20:23], a[80:83], v[84:87], v[20:23]
buffer_load_dwordx4 v100, s[4:7], s49 offen offset:3072 sc1 lds
v_mfma_f32_16x16x32_bf16 v[28:31], a[84:87], v[84:87], v[28:31]
ds_read_b128 v[84:87], v96 offset:28928
s_waitcnt lgkmcnt(7)
v_mfma_f32_16x16x32_bf16 v[16:19], a[88:91], v[88:91], v[16:19]
v_mfma_f32_16x16x32_bf16 v[24:27], a[92:95], v[88:91], v[24:27]
ds_read_b128 v[88:91], v96 offset:30720
s_waitcnt lgkmcnt(7)
v_mfma_f32_16x16x32_bf16 v[20:23], a[88:91], v[92:95], v[20:23]
v_mfma_f32_16x16x32_bf16 v[28:31], a[92:95], v[92:95], v[28:31]
ds_read_b128 v[92:95], v96 offset:30976
s_waitcnt lgkmcnt(7)
v_mfma_f32_16x16x32_bf16 v[16:19], a[96:99], v[64:67], v[16:19]
s_add_u32 m0, s57, 8192
s_add_u32 s49, s55, 8192
v_mfma_f32_16x16x32_bf16 v[24:27], a[100:103], v[64:67], v[24:27]
ds_read_b128 v[64:67], v96 offset:32768
s_waitcnt lgkmcnt(7)
v_mfma_f32_16x16x32_bf16 v[20:23], a[96:99], v[68:71], v[20:23]
buffer_load_dwordx4 v100, s[4:7], s49 offen offset:0 sc1 lds
v_mfma_f32_16x16x32_bf16 v[28:31], a[100:103], v[68:71], v[28:31]
ds_read_b128 v[68:71], v96 offset:33024
s_waitcnt lgkmcnt(7)
v_mfma_f32_16x16x32_bf16 v[16:19], a[104:107], v[72:75], v[16:19]
v_mfma_f32_16x16x32_bf16 v[24:27], a[108:111], v[72:75], v[24:27]
ds_read_b128 v[72:75], v96 offset:34816
s_waitcnt lgkmcnt(7)
v_mfma_f32_16x16x32_bf16 v[20:23], a[104:107], v[76:79], v[20:23]
buffer_load_dwordx4 v100, s[4:7], s49 offen offset:1024 sc1 lds
v_mfma_f32_16x16x32_bf16 v[28:31], a[108:111], v[76:79], v[28:31]
ds_read_b128 v[76:79], v96 offset:35072
s_waitcnt lgkmcnt(7)
v_mfma_f32_16x16x32_bf16 v[16:19], a[112:115], v[80:83], v[16:19]
v_mfma_f32_16x16x32_bf16 v[24:27], a[116:119], v[80:83], v[24:27]
ds_read_b128 v[80:83], v96 offset:36864
s_waitcnt lgkmcnt(7)
v_mfma_f32_16x16x32_bf16 v[20:23], a[112:115], v[84:87], v[20:23]
v_mfma_f32_16x16x32_bf16 v[28:31], a[116:119], v[84:87], v[28:31]
ds_read_b128 v[84:87], v96 offset:37120
s_waitcnt lgkmcnt(7)
v_mfma_f32_16x16x32_bf16 v[16:19], a[120:123], v[88:91], v[16:19]
buffer_load_dwordx4 v100, s[4:7], s49 offen offset:2048 sc1 lds
v_mfma_f32_16x16x32_bf16 v[24:27], a[124:127], v[88:91], v[24:27]
ds_read_b128 v[88:91], v96 offset:38912
s_waitcnt lgkmcnt(7)
v_mfma_f32_16x16x32_bf16 v[20:23], a[120:123], v[92:95], v[20:23]
v_mfma_f32_16x16x32_bf16 v[28:31], a[124:127], v[92:95], v[28:31]
ds_read_b128 v[92:95], v96 offset:39168
s_waitcnt lgkmcnt(7)
v_mfma_f32_16x16x32_bf16 v[16:19], a[128:131], v[64:67], v[16:19]
v_mfma_f32_16x16x32_bf16 v[24:27], a[132:135], v[64:67], v[24:27]
ds_read_b128 v[64:67], v96 offset:40960
s_waitcnt lgkmcnt(7)
v_mfma_f32_16x16x32_bf16 v[20:23], a[128:131], v[68:71], v[20:23]
buffer_load_dwordx4 v100, s[4:7], s49 offen offset:3072 sc1 lds
v_mfma_f32_16x16x32_bf16 v[28:31], a[132:135], v[68:71], v[28:31]
ds_read_b128 v[68:71], v96 offset:41216
s_waitcnt lgkmcnt(7)
v_mfma_f32_16x16x32_bf16 v[16:19], a[136:139], v[72:75], v[16:19]
s_add_u32 s55, s55, 393216
s_add_u32 s57, s57, 49152
v_mfma_f32_16x16x32_bf16 v[24:27], a[140:143], v[72:75], v[24:27]
ds_read_b128 v[72:75], v96 offset:43008
s_waitcnt lgkmcnt(7)
v_mfma_f32_16x16x32_bf16 v[20:23], a[136:139], v[76:79], v[20:23]
s_cmp_ge_u32 s57, 147456
s_cselect_b32 s49, 147456, 0
v_mfma_f32_16x16x32_bf16 v[28:31], a[140:143], v[76:79], v[28:31]
ds_read_b128 v[76:79], v96 offset:43264
s_waitcnt lgkmcnt(7)
v_mfma_f32_16x16x32_bf16 v[16:19], a[144:147], v[80:83], v[16:19]
s_sub_u32 s57, s57, s49
v_mfma_f32_16x16x32_bf16 v[24:27], a[148:151], v[80:83], v[24:27]
ds_read_b128 v[80:83], v96 offset:45056
s_waitcnt lgkmcnt(7)
v_mfma_f32_16x16x32_bf16 v[20:23], a[144:147], v[84:87], v[20:23]
v_mfma_f32_16x16x32_bf16 v[28:31], a[148:151], v[84:87], v[28:31]
ds_read_b128 v[84:87], v96 offset:45312
s_waitcnt lgkmcnt(7)
v_mfma_f32_16x16x32_bf16 v[16:19], a[152:155], v[88:91], v[16:19]
s_add_u32 s54, s54, 1
s_add_u32 s58, s58, 49152
v_mfma_f32_16x16x32_bf16 v[24:27], a[156:159], v[88:91], v[24:27]
ds_read_b128 v[88:91], v96 offset:47104
s_waitcnt lgkmcnt(7)
v_mfma_f32_16x16x32_bf16 v[20:23], a[152:155], v[92:95], v[20:23]
s_cmp_ge_u32 s58, 147456
s_cselect_b32 s50, -98304, s64
v_mfma_f32_16x16x32_bf16 v[28:31], a[156:159], v[92:95], v[28:31]
ds_read_b128 v[92:95], v96 offset:47360
s_waitcnt lgkmcnt(7)
v_mfma_f32_16x16x32_bf16 v[16:19], a[160:163], v[64:67], v[16:19]
s_cselect_b32 s58, 0, s58
v_add_u32 v96, s50, v96
v_mfma_f32_16x16x32_bf16 v[24:27], a[164:167], v[64:67], v[24:27]
s_waitcnt lgkmcnt(6)
v_mfma_f32_16x16x32_bf16 v[20:23], a[160:163], v[68:71], v[20:23]
v_mfma_f32_16x16x32_bf16 v[28:31], a[164:167], v[68:71], v[28:31]
s_cmp_lt_i32 s78, 0
s_cbranch_scc1 L_t3bs_88
s_waitcnt vmcnt(24)
v_pk_add_f32 v[40:41], v[40:41], v[128:129]
v_pk_add_f32 v[42:43], v[42:43], v[130:131]
v_pk_add_f32 v[44:45], v[44:45], v[132:133]
v_pk_add_f32 v[46:47], v[46:47], v[134:135]
v_pk_add_f32 v[48:49], v[48:49], v[136:137]
v_pk_add_f32 v[50:51], v[50:51], v[138:139]
v_pk_add_f32 v[52:53], v[52:53], v[140:141]
v_pk_add_f32 v[54:55], v[54:55], v[142:143]
s_waitcnt vmcnt(20)
v_pk_add_f32 v[40:41], v[40:41], v[144:145]
v_pk_add_f32 v[42:43], v[42:43], v[146:147]
v_pk_add_f32 v[44:45], v[44:45], v[148:149]
v_pk_add_f32 v[46:47], v[46:47], v[150:151]
v_pk_add_f32 v[48:49], v[48:49], v[152:153]
v_pk_add_f32 v[50:51], v[50:51], v[154:155]
v_pk_add_f32 v[52:53], v[52:53], v[156:157]
v_pk_add_f32 v[54:55], v[54:55], v[158:159]
s_waitcnt vmcnt(16)
v_pk_add_f32 v[40:41], v[40:41], v[160:161]
v_pk_add_f32 v[42:43], v[42:43], v[162:163]
v_pk_add_f32 v[44:45], v[44:45], v[164:165]
v_pk_add_f32 v[46:47], v[46:47], v[166:167]
v_pk_add_f32 v[48:49], v[48:49], v[168:169]
v_pk_add_f32 v[50:51], v[50:51], v[170:171]
v_pk_add_f32 v[52:53], v[52:53], v[172:173]
v_pk_add_f32 v[54:55], v[54:55], v[174:175]
s_waitcnt vmcnt(12)
v_pk_add_f32 v[40:41], v[40:41], v[176:177]
v_pk_add_f32 v[42:43], v[42:43], v[178:179]
v_pk_add_f32 v[44:45], v[44:45], v[180:181]
v_pk_add_f32 v[46:47], v[46:47], v[182:183]
v_pk_add_f32 v[48:49], v[48:49], v[184:185]
v_pk_add_f32 v[50:51], v[50:51], v[186:187]
v_pk_add_f32 v[52:53], v[52:53], v[188:189]
v_pk_add_f32 v[54:55], v[54:55], v[190:191]
v_cvt_pk_bf16_f32 v128, v40, v41
v_cvt_pk_bf16_f32 v129, v42, v43
v_cvt_pk_bf16_f32 v130, v48, v49
v_cvt_pk_bf16_f32 v131, v50, v51
buffer_store_dwordx4 v[128:131], v112, s[12:15], s86 offen
v_cvt_pk_bf16_f32 v132, v44, v45
v_cvt_pk_bf16_f32 v133, v46, v47
v_cvt_pk_bf16_f32 v134, v52, v53
v_cvt_pk_bf16_f32 v135, v54, v55
buffer_store_dwordx4 v[132:135], v113, s[12:15], s86 offen
L_t3bs_88:
s_add_u32 s78, s78, 8
s_waitcnt vmcnt(12) lgkmcnt(0)
s_barrier
ds_read_b128 v[64:67], v96 offset:0
ds_read_b128 v[68:71], v96 offset:256
v_mfma_f32_16x16x32_bf16 v[16:19], a[168:171], v[72:75], v[16:19]
v_mfma_f32_16x16x32_bf16 v[24:27], a[172:175], v[72:75], v[24:27]
ds_read_b128 v[72:75], v96 offset:2048
v_mfma_f32_16x16x32_bf16 v[20:23], a[168:171], v[76:79], v[20:23]
v_mfma_f32_16x16x32_bf16 v[28:31], a[172:175], v[76:79], v[28:31]
ds_read_b128 v[76:79], v96 offset:2304
v_mfma_f32_16x16x32_bf16 v[16:19], a[176:179], v[80:83], v[16:19]
v_mfma_f32_16x16x32_bf16 v[24:27], a[180:183], v[80:83], v[24:27]
ds_read_b128 v[80:83], v96 offset:4096
v_mfma_f32_16x16x32_bf16 v[20:23], a[176:179], v[84:87], v[20:23]
v_mfma_f32_16x16x32_bf16 v[28:31], a[180:183], v[84:87], v[28:31]
ds_read_b128 v[84:87], v96 offset:4352
v_mfma_f32_16x16x32_bf16 v[16:19], a[184:187], v[88:91], v[16:19]
v_mfma_f32_16x16x32_bf16 v[24:27], a[188:191], v[88:91], v[24:27]
ds_read_b128 v[88:91], v96 offset:6144
v_mfma_f32_16x16x32_bf16 v[20:23], a[184:187], v[92:95], v[20:23]
v_mfma_f32_16x16x32_bf16 v[28:31], a[188:191], v[92:95], v[28:31]
ds_read_b128 v[92:95], v96 offset:6400
s_cmp_lt_i32 s78, 0
s_cbranch_scc1 L_t3bs_89
s_cmp_gt_u32 s79, s78
s_cbranch_scc1 L_p3x_91
s_mov_b32 s53, 0
L_p3_90:
buffer_load_dword v122, v115, s[4:7], 0 offen sc1
s_add_u32 s53, s53, 1
s_cmp_gt_u32 s53, 100000
s_cbranch_scc1 L_p3x_91
s_waitcnt vmcnt(0)
v_readlane_b32 s79, v122, 0
v_readlane_b32 s48, v122, 1
s_min_u32 s79, s79, s48
v_readlane_b32 s48, v122, 2
s_min_u32 s79, s79, s48
v_readlane_b32 s48, v122, 3
s_min_u32 s79, s79, s48
s_cmp_gt_u32 s79, s78
s_cbranch_scc1 L_p3x_91
s_sleep 3
s_branch L_p3_90
L_p3x_91:
s_mov_b32 s86, s56
s_mul_i32 s48, s78, 5
s_add_u32 s48, s48, s76
s_lshl_b32 s48, s48, 16
s_add_u32 s48, s48, 201326592
buffer_load_dwordx4 v[128:131], v114, s[4:7], s48 offen offset:0 sc1
buffer_load_dwordx4 v[132:135], v114, s[4:7], s48 offen offset:1024 sc1
buffer_load_dwordx4 v[136:139], v114, s[4:7], s48 offen offset:2048 sc1
buffer_load_dwordx4 v[140:143], v114, s[4:7], s48 offen offset:3072 sc1
s_add_u32 s48, s48, 16384
buffer_load_dwordx4 v[144:147], v114, s[4:7], s48 offen offset:0 sc1
buffer_load_dwordx4 v[148:151], v114, s[4:7], s48 offen offset:1024 sc1
buffer_load_dwordx4 v[152:155], v114, s[4:7], s48 offen offset:2048 sc1
buffer_load_dwordx4 v[156:159], v114, s[4:7], s48 offen offset:3072 sc1
s_add_u32 s48, s48, 16384
buffer_load_dwordx4 v[160:163], v114, s[4:7], s48 offen offset:0 sc1
buffer_load_dwordx4 v[164:167], v114, s[4:7], s48 offen offset:1024 sc1
buffer_load_dwordx4 v[168:171], v114, s[4:7], s48 offen offset:2048 sc1
buffer_load_dwordx4 v[172:175], v114, s[4:7], s48 offen offset:3072 sc1
s_add_u32 s48, s48, 16384
buffer_load_dwordx4 v[176:179], v114, s[4:7], s48 offen offset:0 sc1
buffer_load_dwordx4 v[180:183], v114, s[4:7], s48 offen offset:1024 sc1
buffer_load_dwordx4 v[184:187], v114, s[4:7], s48 offen offset:2048 sc1
buffer_load_dwordx4 v[188:191], v114, s[4:7], s48 offen offset:3072 sc1
L_t3bs_89:
s_waitcnt lgkmcnt(7)
v_mfma_f32_16x16x32_bf16 v[40:43], a[0:3], v[64:67], 0
s_add_u32 m0, s57, 0
s_add_u32 s49, s55, 0
v_mfma_f32_16x16x32_bf16 v[48:51], a[4:7], v[64:67], 0
ds_read_b128 v[64:67], v96 offset:8192
s_waitcnt lgkmcnt(7)
v_mfma_f32_16x16x32_bf16 v[44:47], a[0:3], v[68:71], 0
buffer_load_dwordx4 v100, s[4:7], s49 offen offset:0 sc1 lds
v_mfma_f32_16x16x32_bf16 v[52:55], a[4:7], v[68:71], 0
ds_read_b128 v[68:71], v96 offset:8448
s_waitcnt lgkmcnt(7)
v_mfma_f32_16x16x32_bf16 v[40:43], a[8:11], v[72:75], v[40:43]
v_mfma_f32_16x16x32_bf16 v[48:51], a[12:15], v[72:75], v[48:51]
ds_read_b128 v[72:75], v96 offset:10240
s_waitcnt lgkmcnt(7)
v_mfma_f32_16x16x32_bf16 v[44:47], a[8:11], v[76:79], v[44:47]
buffer_load_dwordx4 v100, s[4:7], s49 offen offset:1024 sc1 lds
s_mov_b32 s56, s59
v_mfma_f32_16x16x32_bf16 v[52:55], a[12:15], v[76:79], v[52:55]
ds_read_b128 v[76:79], v96 offset:10496
s_waitcnt lgkmcnt(7)
v_mfma_f32_16x16x32_bf16 v[40:43], a[16:19], v[80:83], v[40:43]
v_mfma_f32_16x16x32_bf16 v[48:51], a[20:23], v[80:83], v[48:51]
ds_read_b128 v[80:83], v96 offset:12288
s_waitcnt lgkmcnt(7)
v_mfma_f32_16x16x32_bf16 v[44:47], a[16:19], v[84:87], v[44:47]
v_mfma_f32_16x16x32_bf16 v[52:55], a[20:23], v[84:87], v[52:55]
ds_read_b128 v[84:87], v96 offset:12544
s_waitcnt lgkmcnt(7)
v_mfma_f32_16x16x32_bf16 v[40:43], a[24:27], v[88:91], v[40:43]
buffer_load_dwordx4 v100, s[4:7], s49 offen offset:2048 sc1 lds
v_mfma_f32_16x16x32_bf16 v[48:51], a[28:31], v[88:91], v[48:51]
ds_read_b128 v[88:91], v96 offset:14336
s_waitcnt lgkmcnt(7)
v_mfma_f32_16x16x32_bf16 v[44:47], a[24:27], v[92:95], v[44:47]
v_mfma_f32_16x16x32_bf16 v[52:55], a[28:31], v[92:95], v[52:55]
ds_read_b128 v[92:95], v96 offset:14592
s_waitcnt lgkmcnt(7)
v_mfma_f32_16x16x32_bf16 v[40:43], a[32:35], v[64:67], v[40:43]
v_mfma_f32_16x16x32_bf16 v[48:51], a[36:39], v[64:67], v[48:51]
ds_read_b128 v[64:67], v96 offset:16384
s_waitcnt lgkmcnt(7)
v_mfma_f32_16x16x32_bf16 v[44:47], a[32:35], v[68:71], v[44:47]
buffer_load_dwordx4 v100, s[4:7], s49 offen offset:3072 sc1 lds
v_mfma_f32_16x16x32_bf16 v[52:55], a[36:39], v[68:71], v[52:55]
ds_read_b128 v[68:71], v96 offset:16640
s_waitcnt lgkmcnt(7)
v_mfma_f32_16x16x32_bf16 v[40:43], a[40:43], v[72:75], v[40:43]
v_mfma_f32_16x16x32_bf16 v[48:51], a[44:47], v[72:75], v[48:51]
ds_read_b128 v[72:75], v96 offset:18432
s_waitcnt lgkmcnt(7)
v_mfma_f32_16x16x32_bf16 v[44:47], a[40:43], v[76:79], v[44:47]
v_mfma_f32_16x16x32_bf16 v[52:55], a[44:47], v[76:79], v[52:55]
ds_read_b128 v[76:79], v96 offset:18688
s_waitcnt lgkmcnt(7)
v_mfma_f32_16x16x32_bf16 v[40:43], a[48:51], v[80:83], v[40:43]
s_add_u32 m0, s57, 4096
s_add_u32 s49, s55, 4096
v_mfma_f32_16x16x32_bf16 v[48:51], a[52:55], v[80:83], v[48:51]
ds_read_b128 v[80:83], v96 offset:20480
s_waitcnt lgkmcnt(7)
v_mfma_f32_16x16x32_bf16 v[44:47], a[48:51], v[84:87], v[44:47]
buffer_load_dwordx4 v100, s[4:7], s49 offen offset:0 sc1 lds
v_mfma_f32_16x16x32_bf16 v[52:55], a[52:55], v[84:87], v[52:55]
ds_read_b128 v[84:87], v96 offset:20736
s_waitcnt lgkmcnt(7)
v_mfma_f32_16x16x32_bf16 v[40:43], a[56:59], v[88:91], v[40:43]
v_mfma_f32_16x16x32_bf16 v[48:51], a[60:63], v[88:91], v[48:51]
ds_read_b128 v[88:91], v96 offset:22528
s_waitcnt lgkmcnt(7)
v_mfma_f32_16x16x32_bf16 v[44:47], a[56:59], v[92:95], v[44:47]
buffer_load_dwordx4 v100, s[4:7], s49 offen offset:1024 sc1 lds
v_mfma_f32_16x16x32_bf16 v[52:55], a[60:63], v[92:95], v[52:55]
ds_read_b128 v[92:95], v96 offset:22784
s_waitcnt lgkmcnt(7)
v_mfma_f32_16x16x32_bf16 v[40:43], a[64:67], v[64:67], v[40:43]
v_mfma_f32_16x16x32_bf16 v[48:51], a[68:71], v[64:67], v[48:51]
ds_read_b128 v[64:67], v96 offset:24576
s_waitcnt lgkmcnt(7)
v_mfma_f32_16x16x32_bf16 v[44:47], a[64:67], v[68:71], v[44:47]
v_mfma_f32_16x16x32_bf16 v[52:55], a[68:71], v[68:71], v[52:55]
ds_read_b128 v[68:71], v96 offset:24832
s_waitcnt lgkmcnt(7)
v_mfma_f32_16x16x32_bf16 v[40:43], a[72:75], v[72:75], v[40:43]
buffer_load_dwordx4 v100, s[4:7], s49 offen offset:2048 sc1 lds
v_mfma_f32_16x16x32_bf16 v[48:51], a[76:79], v[72:75], v[48:51]
ds_read_b128 v[72:75], v96 offset:26624
s_waitcnt lgkmcnt(7)
v_mfma_f32_16x16x32_bf16 v[44:47], a[72:75], v[76:79], v[44:47]
v_mfma_f32_16x16x32_bf16 v[52:55], a[76:79], v[76:79], v[52:55]
ds_read_b128 v[76:79], v96 offset:26880
s_waitcnt lgkmcnt(7)
v_mfma_f32_16x16x32_bf16 v[40:43], a[80:83], v[80:83], v[40:43]
s_add_u32 s59, s59, s60
v_mfma_f32_16x16x32_bf16 v[48:51], a[84:87], v[80:83], v[48:51]
ds_read_b128 v[80:83], v96 offset:28672
s_waitcnt lgkmcnt(7)
v_mfma_f32_16x16x32_bf16 v[44:47], a[80:83], v[84:87], v[44:47]
buffer_load_dwordx4 v100, s[4:7], s49 offen offset:3072 sc1 lds
v_mfma_f32_16x16x32_bf16 v[52:55], a[84:87], v[84:87], v[52:55]
ds_read_b128 v[84:87], v96 offset:28928
s_waitcnt lgkmcnt(7)
v_mfma_f32_16x16x32_bf16 v[40:43], a[88:91], v[88:91], v[40:43]
v_mfma_f32_16x16x32_bf16 v[48:51], a[92:95], v[88:91], v[48:51]
ds_read_b128 v[88:91], v96 offset:30720
s_waitcnt lgkmcnt(7)
v_mfma_f32_16x16x32_bf16 v[44:47], a[88:91], v[92:95], v[44:47]
v_mfma_f32_16x16x32_bf16 v[52:55], a[92:95], v[92:95], v[52:55]
ds_read_b128 v[92:95], v96 offset:30976
s_waitcnt lgkmcnt(7)
v_mfma_f32_16x16x32_bf16 v[40:43], a[96:99], v[64:67], v[40:43]
s_add_u32 m0, s57, 8192
s_add_u32 s49, s55, 8192
v_mfma_f32_16x16x32_bf16 v[48:51], a[100:103], v[64:67], v[48:51]
ds_read_b128 v[64:67], v96 offset:32768
s_waitcnt lgkmcnt(7)
v_mfma_f32_16x16x32_bf16 v[44:47], a[96:99], v[68:71], v[44:47]
buffer_load_dwordx4 v100, s[4:7], s49 offen offset:0 sc1 lds
v_mfma_f32_16x16x32_bf16 v[52:55], a[100:103], v[68:71], v[52:55]
ds_read_b128 v[68:71], v96 offset:33024
s_waitcnt lgkmcnt(7)
v_mfma_f32_16x16x32_bf16 v[40:43], a[104:107], v[72:75], v[40:43]
v_mfma_f32_16x16x32_bf16 v[48:51], a[108:111], v[72:75], v[48:51]
ds_read_b128 v[72:75], v96 offset:34816
s_waitcnt lgkmcnt(7)
v_mfma_f32_16x16x32_bf16 v[44:47], a[104:107], v[76:79], v[44:47]
buffer_load_dwordx4 v100, s[4:7], s49 offen offset:1024 sc1 lds
v_mfma_f32_16x16x32_bf16 v[52:55], a[108:111], v[76:79], v[52:55]
ds_read_b128 v[76:79], v96 offset:35072
s_waitcnt lgkmcnt(7)
v_mfma_f32_16x16x32_bf16 v[40:43], a[112:115], v[80:83], v[40:43]
v_mfma_f32_16x16x32_bf16 v[48:51], a[116:119], v[80:83], v[48:51]
ds_read_b128 v[80:83], v96 offset:36864
s_waitcnt lgkmcnt(7)
v_mfma_f32_16x16x32_bf16 v[44:47], a[112:115], v[84:87], v[44:47]
v_mfma_f32_16x16x32_bf16 v[52:55], a[116:119], v[84:87], v[52:55]
ds_read_b128 v[84:87], v96 offset:37120
s_waitcnt lgkmcnt(7)
v_mfma_f32_16x16x32_bf16 v[40:43], a[120:123], v[88:91], v[40:43]
buffer_load_dwordx4 v100, s[4:7], s49 offen offset:2048 sc1 lds
v_mfma_f32_16x16x32_bf16 v[48:51], a[124:127], v[88:91], v[48:51]
ds_read_b128 v[88:91], v96 offset:38912
s_waitcnt lgkmcnt(7)
v_mfma_f32_16x16x32_bf16 v[44:47], a[120:123], v[92:95], v[44:47]
v_mfma_f32_16x16x32_bf16 v[52:55], a[124:127], v[92:95], v[52:55]
ds_read_b128 v[92:95], v96 offset:39168
s_waitcnt lgkmcnt(7)
v_mfma_f32_16x16x32_bf16 v[40:43], a[128:131], v[64:67], v[40:43]
v_mfma_f32_16x16x32_bf16 v[48:51], a[132:135], v[64:67], v[48:51]
ds_read_b128 v[64:67], v96 offset:40960
s_waitcnt lgkmcnt(7)
v_mfma_f32_16x16x32_bf16 v[44:47], a[128:131], v[68:71], v[44:47]
buffer_load_dwordx4 v100, s[4:7], s49 offen offset:3072 sc1 lds
v_mfma_f32_16x16x32_bf16 v[52:55], a[132:135], v[68:71], v[52:55]
ds_read_b128 v[68:71], v96 offset:41216
s_waitcnt lgkmcnt(7)
v_mfma_f32_16x16x32_bf16 v[40:43], a[136:139], v[72:75], v[40:43]
s_add_u32 s55, s55, 393216
s_add_u32 s57, s57, 49152
v_mfma_f32_16x16x32_bf16 v[48:51], a[140:143], v[72:75], v[48:51]
ds_read_b128 v[72:75], v96 offset:43008
s_waitcnt lgkmcnt(7)
v_mfma_f32_16x16x32_bf16 v[44:47], a[136:139], v[76:79], v[44:47]
s_cmp_ge_u32 s57, 147456
s_cselect_b32 s49, 147456, 0
v_mfma_f32_16x16x32_bf16 v[52:55], a[140:143], v[76:79], v[52:55]
ds_read_b128 v[76:79], v96 offset:43264
s_waitcnt lgkmcnt(7)
v_mfma_f32_16x16x32_bf16 v[40:43], a[144:147], v[80:83], v[40:43]
s_sub_u32 s57, s57, s49
v_mfma_f32_16x16x32_bf16 v[48:51], a[148:151], v[80:83], v[48:51]
ds_read_b128 v[80:83], v96 offset:45056
s_waitcnt lgkmcnt(7)
v_mfma_f32_16x16x32_bf16 v[44:47], a[144:147], v[84:87], v[44:47]
v_mfma_f32_16x16x32_bf16 v[52:55], a[148:151], v[84:87], v[52:55]
ds_read_b128 v[84:87], v96 offset:45312
s_waitcnt lgkmcnt(7)
v_mfma_f32_16x16x32_bf16 v[40:43], a[152:155], v[88:91], v[40:43]
s_add_u32 s54, s54, 1
s_add_u32 s58, s58, 49152
v_mfma_f32_16x16x32_bf16 v[48:51], a[156:159], v[88:91], v[48:51]
ds_read_b128 v[88:91], v96 offset:47104
s_waitcnt lgkmcnt(7)
v_mfma_f32_16x16x32_bf16 v[44:47], a[152:155], v[92:95], v[44:47]
s_cmp_ge_u32 s58, 147456
s_cselect_b32 s50, -98304, s64
v_mfma_f32_16x16x32_bf16 v[52:55], a[156:159], v[92:95], v[52:55]
ds_read_b128 v[92:95], v96 offset:47360
s_waitcnt lgkmcnt(7)
v_mfma_f32_16x16x32_bf16 v[40:43], a[160:163], v[64:67], v[40:43]
s_cselect_b32 s58, 0, s58
v_add_u32 v96, s50, v96
v_mfma_f32_16x16x32_bf16 v[48:51], a[164:167], v[64:67], v[48:51]
s_waitcnt lgkmcnt(6)
v_mfma_f32_16x16x32_bf16 v[44:47], a[160:163], v[68:71], v[44:47]
v_mfma_f32_16x16x32_bf16 v[52:55], a[164:167], v[68:71], v[52:55]
s_cmp_lt_i32 s78, 0
s_cbranch_scc1 L_t3bs_92
s_waitcnt vmcnt(24)
v_pk_add_f32 v[16:17], v[16:17], v[128:129]
v_pk_add_f32 v[18:19], v[18:19], v[130:131]
v_pk_add_f32 v[20:21], v[20:21], v[132:133]
v_pk_add_f32 v[22:23], v[22:23], v[134:135]
v_pk_add_f32 v[24:25], v[24:25], v[136:137]
v_pk_add_f32 v[26:27], v[26:27], v[138:139]
v_pk_add_f32 v[28:29], v[28:29], v[140:141]
v_pk_add_f32 v[30:31], v[30:31], v[142:143]
s_waitcnt vmcnt(20)
v_pk_add_f32 v[16:17], v[16:17], v[144:145]
v_pk_add_f32 v[18:19], v[18:19], v[146:147]
v_pk_add_f32 v[20:21], v[20:21], v[148:149]
v_pk_add_f32 v[22:23], v[22:23], v[150:151]
v_pk_add_f32 v[24:25], v[24:25], v[152:153]
v_pk_add_f32 v[26:27], v[26:27], v[154:155]
v_pk_add_f32 v[28:29], v[28:29], v[156:157]
v_pk_add_f32 v[30:31], v[30:31], v[158:159]
s_waitcnt vmcnt(16)
v_pk_add_f32 v[16:17], v[16:17], v[160:161]
v_pk_add_f32 v[18:19], v[18:19], v[162:163]
v_pk_add_f32 v[20:21], v[20:21], v[164:165]
v_pk_add_f32 v[22:23], v[22:23], v[166:167]
v_pk_add_f32 v[24:25], v[24:25], v[168:169]
v_pk_add_f32 v[26:27], v[26:27], v[170:171]
v_pk_add_f32 v[28:29], v[28:29], v[172:173]
v_pk_add_f32 v[30:31], v[30:31], v[174:175]
s_waitcnt vmcnt(12)
v_pk_add_f32 v[16:17], v[16:17], v[176:177]
v_pk_add_f32 v[18:19], v[18:19], v[178:179]
v_pk_add_f32 v[20:21], v[20:21], v[180:181]
v_pk_add_f32 v[22:23], v[22:23], v[182:183]
v_pk_add_f32 v[24:25], v[24:25], v[184:185]
v_pk_add_f32 v[26:27], v[26:27], v[186:187]
v_pk_add_f32 v[28:29], v[28:29], v[188:189]
v_pk_add_f32 v[30:31], v[30:31], v[190:191]
v_cvt_pk_bf16_f32 v128, v16, v17
v_cvt_pk_bf16_f32 v129, v18, v19
v_cvt_pk_bf16_f32 v130, v24, v25
v_cvt_pk_bf16_f32 v131, v26, v27
buffer_store_dwordx4 v[128:131], v112, s[12:15], s86 offen
v_cvt_pk_bf16_f32 v132, v20, v21
v_cvt_pk_bf16_f32 v133, v22, v23
v_cvt_pk_bf16_f32 v134, v28, v29
v_cvt_pk_bf16_f32 v135, v30, v31
buffer_store_dwordx4 v[132:135], v113, s[12:15], s86 offen
L_t3bs_92:
s_add_u32 s78, s78, 8
s_cmp_ge_u32 s54, s61
s_cbranch_scc1 L_t3b_end_84
s_waitcnt vmcnt(12) lgkmcnt(0)
s_barrier
ds_read_b128 v[64:67], v96 offset:0
ds_read_b128 v[68:71], v96 offset:256
v_mfma_f32_16x16x32_bf16 v[40:43], a[168:171], v[72:75], v[40:43]
v_mfma_f32_16x16x32_bf16 v[48:51], a[172:175], v[72:75], v[48:51]
ds_read_b128 v[72:75], v96 offset:2048
v_mfma_f32_16x16x32_bf16 v[44:47], a[168:171], v[76:79], v[44:47]
v_mfma_f32_16x16x32_bf16 v[52:55], a[172:175], v[76:79], v[52:55]
ds_read_b128 v[76:79], v96 offset:2304
v_mfma_f32_16x16x32_bf16 v[40:43], a[176:179], v[80:83], v[40:43]
v_mfma_f32_16x16x32_bf16 v[48:51], a[180:183], v[80:83], v[48:51]
ds_read_b128 v[80:83], v96 offset:4096
v_mfma_f32_16x16x32_bf16 v[44:47], a[176:179], v[84:87], v[44:47]
v_mfma_f32_16x16x32_bf16 v[52:55], a[180:183], v[84:87], v[52:55]
ds_read_b128 v[84:87], v96 offset:4352
v_mfma_f32_16x16x32_bf16 v[40:43], a[184:187], v[88:91], v[40:43]
v_mfma_f32_16x16x32_bf16 v[48:51], a[188:191], v[88:91], v[48:51]
ds_read_b128 v[88:91], v96 offset:6144
v_mfma_f32_16x16x32_bf16 v[44:47], a[184:187], v[92:95], v[44:47]
v_mfma_f32_16x16x32_bf16 v[52:55], a[188:191], v[92:95], v[52:55]
ds_read_b128 v[92:95], v96 offset:6400
s_branch L_t3b_loop_83
L_t3b_end_84:
s_waitcnt lgkmcnt(0)
v_mfma_f32_16x16x32_bf16 v[40:43], a[168:171], v[72:75], v[40:43]
v_mfma_f32_16x16x32_bf16 v[48:51], a[172:175], v[72:75], v[48:51]
v_mfma_f32_16x16x32_bf16 v[44:47], a[168:171], v[76:79], v[44:47]
v_mfma_f32_16x16x32_bf16 v[52:55], a[172:175], v[76:79], v[52:55]
v_mfma_f32_16x16x32_bf16 v[40:43], a[176:179], v[80:83], v[40:43]
v_mfma_f32_16x16x32_bf16 v[48:51], a[180:183], v[80:83], v[48:51]
v_mfma_f32_16x16x32_bf16 v[44:47], a[176:179], v[84:87], v[44:47]
v_mfma_f32_16x16x32_bf16 v[52:55], a[180:183], v[84:87], v[52:55]
v_mfma_f32_16x16x32_bf16 v[40:43], a[184:187], v[88:91], v[40:43]
v_mfma_f32_16x16x32_bf16 v[48:51], a[188:191], v[88:91], v[48:51]
v_mfma_f32_16x16x32_bf16 v[44:47], a[184:187], v[92:95], v[44:47]
v_mfma_f32_16x16x32_bf16 v[52:55], a[188:191], v[92:95], v[52:55]
s_cmp_lt_i32 s78, 0
s_cbranch_scc1 L_t3bs_93
s_cmp_lt_u32 s78, 60
s_cbranch_scc1 L_t3bt_94
s_sub_u32 s48, s78, 60
s_mul_i32 s48, s48, 5
s_add_u32 s48, s48, s76
s_mul_i32 s48, s48, 147456
s_add_u32 s48, s48, 235012096
buffer_store_dwordx4 v[40:43], v114, s[4:7], s48 offen offset:0 sc1
buffer_store_dwordx4 v[44:47], v114, s[4:7], s48 offen offset:1024 sc1
buffer_store_dwordx4 v[48:51], v114, s[4:7], s48 offen offset:2048 sc1
buffer_store_dwordx4 v[52:55], v114, s[4:7], s48 offen offset:3072 sc1
s_branch L_t3bs_93
L_t3bt_94:
s_cmp_gt_u32 s79, s78
s_cbranch_scc1 L_p3x_96
s_mov_b32 s53, 0
L_p3_95:
buffer_load_dword v122, v115, s[4:7], 0 offen sc1
s_add_u32 s53, s53, 1
s_cmp_gt_u32 s53, 100000
s_cbranch_scc1 L_p3x_96
s_waitcnt vmcnt(0)
v_readlane_b32 s79, v122, 0
v_readlane_b32 s48, v122, 1
s_min_u32 s79, s79, s48
v_readlane_b32 s48, v122, 2
s_min_u32 s79, s79, s48
v_readlane_b32 s48, v122, 3
s_min_u32 s79, s79, s48
s_cmp_gt_u32 s79, s78
s_cbranch_scc1 L_p3x_96
s_sleep 2
s_branch L_p3_95
L_p3x_96:
s_mov_b32 s86, s56
s_mul_i32 s48, s78, 5
s_add_u32 s48, s48, s76
s_lshl_b32 s48, s48, 16
s_add_u32 s48, s48, 201326592
buffer_load_dwordx4 v[128:131], v114, s[4:7], s48 offen offset:0 sc1
buffer_load_dwordx4 v[132:135], v114, s[4:7], s48 offen offset:1024 sc1
buffer_load_dwordx4 v[136:139], v114, s[4:7], s48 offen offset:2048 sc1
buffer_load_dwordx4 v[140:143], v114, s[4:7], s48 offen offset:3072 sc1
s_add_u32 s48, s48, 16384
buffer_load_dwordx4 v[144:147], v114, s[4:7], s48 offen offset:0 sc1
buffer_load_dwordx4 v[148:151], v114, s[4:7], s48 offen offset:1024 sc1
buffer_load_dwordx4 v[152:155], v114, s[4:7], s48 offen offset:2048 sc1
buffer_load_dwordx4 v[156:159], v114, s[4:7], s48 offen offset:3072 sc1
s_add_u32 s48, s48, 16384
buffer_load_dwordx4 v[160:163], v114, s[4:7], s48 offen offset:0 sc1
buffer_load_dwordx4 v[164:167], v114, s[4:7], s48 offen offset:1024 sc1
buffer_load_dwordx4 v[168:171], v114, s[4:7], s48 offen offset:2048 sc1
buffer_load_dwordx4 v[172:175], v114, s[4:7], s48 offen offset:3072 sc1
s_add_u32 s48, s48, 16384
buffer_load_dwordx4 v[176:179], v114, s[4:7], s48 offen offset:0 sc1
buffer_load_dwordx4 v[180:183], v114, s[4:7], s48 offen offset:1024 sc1
buffer_load_dwordx4 v[184:187], v114, s[4:7], s48 offen offset:2048 sc1
buffer_load_dwordx4 v[188:191], v114, s[4:7], s48 offen offset:3072 sc1
s_waitcnt vmcnt(12)
v_pk_add_f32 v[40:41], v[40:41], v[128:129]
v_pk_add_f32 v[42:43], v[42:43], v[130:131]
v_pk_add_f32 v[44:45], v[44:45], v[132:133]
v_pk_add_f32 v[46:47], v[46:47], v[134:135]
v_pk_add_f32 v[48:49], v[48:49], v[136:137]
v_pk_add_f32 v[50:51], v[50:51], v[138:139]
v_pk_add_f32 v[52:53], v[52:53], v[140:141]
v_pk_add_f32 v[54:55], v[54:55], v[142:143]
s_waitcnt vmcnt(8)
v_pk_add_f32 v[40:41], v[40:41], v[144:145]
v_pk_add_f32 v[42:43], v[42:43], v[146:147]
v_pk_add_f32 v[44:45], v[44:45], v[148:149]
v_pk_add_f32 v[46:47], v[46:47], v[150:151]
v_pk_add_f32 v[48:49], v[48:49], v[152:153]
v_pk_add_f32 v[50:51], v[50:51], v[154:155]
v_pk_add_f32 v[52:53], v[52:53], v[156:157]
v_pk_add_f32 v[54:55], v[54:55], v[158:159]
s_waitcnt vmcnt(4)
v_pk_add_f32 v[40:41], v[40:41], v[160:161]
v_pk_add_f32 v[42:43], v[42:43], v[162:163]
v_pk_add_f32 v[44:45], v[44:45], v[164:165]
v_pk_add_f32 v[46:47], v[46:47], v[166:167]
v_pk_add_f32 v[48:49], v[48:49], v[168:169]
v_pk_add_f32 v[50:51], v[50:51], v[170:171]
v_pk_add_f32 v[52:53], v[52:53], v[172:173]
v_pk_add_f32 v[54:55], v[54:55], v[174:175]
s_waitcnt vmcnt(0)
v_pk_add_f32 v[40:41], v[40:41], v[176:177]
v_pk_add_f32 v[42:43], v[42:43], v[178:179]
v_pk_add_f32 v[44:45], v[44:45], v[180:181]
v_pk_add_f32 v[46:47], v[46:47], v[182:183]
v_pk_add_f32 v[48:49], v[48:49], v[184:185]
v_pk_add_f32 v[50:51], v[50:51], v[186:187]
v_pk_add_f32 v[52:53], v[52:53], v[188:189]
v_pk_add_f32 v[54:55], v[54:55], v[190:191]
v_cvt_pk_bf16_f32 v128, v40, v41
v_cvt_pk_bf16_f32 v129, v42, v43
v_cvt_pk_bf16_f32 v130, v48, v49
v_cvt_pk_bf16_f32 v131, v50, v51
buffer_store_dwordx4 v[128:131], v112, s[12:15], s86 offen
v_cvt_pk_bf16_f32 v132, v44, v45
v_cvt_pk_bf16_f32 v133, v46, v47
v_cvt_pk_bf16_f32 v134, v52, v53
v_cvt_pk_bf16_f32 v135, v54, v55
buffer_store_dwordx4 v[132:135], v113, s[12:15], s86 offen
L_t3bs_93:
s_add_u32 s78, s78, 8
s_waitcnt vmcnt(0)
s_barrier
s_branch L_exit
L_tails:
s_cmp_ge_u32 s45, 80
s_cbranch_scc1 L_t4t
s_sub_u32 s51, s45, 40
s_mov_b32 s76, s51
s_and_b32 s51, s76, 7
s_lshr_b32 s52, s76, 3
s_mov_b32 s8, s26
s_mov_b32 s9, s27
s_mov_b32 s10, 7864320
s_mov_b32 s11, 0x20000
v_lshrrev_b32 v122, 4, v1
v_mul_u32_u24 v122, 1280, v122
v_and_b32 v112, 15, v1
v_lshl_add_u32 v112, v112, 4, v122
s_mul_i32 s62, s51, 983040
s_mul_i32 s48, s44, 5120
s_add_u32 s62, s62, s48
s_lshl_b32 s48, s52, 8
s_add_u32 s62, s62, s48
s_mul_i32 s78, s51, 49152
s_add_u32 s78, s78, 141033472
s_lshl_b32 s79, s76, 14
s_add_u32 s79, s79, 234881024
s_lshl_b32 s80, s51, 7
s_add_u32 s80, s80, 126976
s_lshl_b32 s48, s44, 6
v_lshrrev_b32 v122, 4, v1
v_lshlrev_b32 v122, 3, v122
v_bfe_u32 v123, v1, 2, 2
v_add_u32 v122, v122, v123
v_and_b32 v123, 3, v1
v_lshlrev_b32 v122, 8, v122
v_lshl_add_u32 v122, v123, 4, v122
v_add_u32 v113, s48, v122
s_barrier
s_mul_i32 s50, s44, 2048
s_add_u32 m0, s50, 0
s_add_u32 s49, s62, 0
buffer_load_dwordx4 v112, s[8:11], s49 offen nt lds
s_mul_i32 s50, s44, 2048
s_add_u32 m0, s50, 1024
s_add_u32 s49, s62, 20480
buffer_load_dwordx4 v112, s[8:11], s49 offen nt lds
s_mul_i32 s50, s44, 2048
s_add_u32 m0, s50, 8192
s_add_u32 s49, s62, 40960
buffer_load_dwordx4 v112, s[8:11], s49 offen nt lds
s_mul_i32 s50, s44, 2048
s_add_u32 m0, s50, 9216
s_add_u32 s49, s62, 61440
buffer_load_dwordx4 v112, s[8:11], s49 offen nt lds
s_mul_i32 s50, s44, 2048
s_add_u32 m0, s50, 16384
s_add_u32 s49, s62, 81920
buffer_load_dwordx4 v112, s[8:11], s49 offen nt lds
s_mul_i32 s50, s44, 2048
s_add_u32 m0, s50, 17408
s_add_u32 s49, s62, 102400
buffer_load_dwordx4 v112, s[8:11], s49 offen nt lds
s_mul_i32 s50, s44, 2048
s_add_u32 m0, s50, 24576
s_add_u32 s49, s62, 122880
buffer_load_dwordx4 v112, s[8:11], s49 offen nt lds
s_mul_i32 s50, s44, 2048
s_add_u32 m0, s50, 25600
s_add_u32 s49, s62, 143360
buffer_load_dwordx4 v112, s[8:11], s49 offen nt lds
s_mul_i32 s50, s44, 2048
s_add_u32 m0, s50, 32768
s_add_u32 s49, s62, 163840
buffer_load_dwordx4 v112, s[8:11], s49 offen nt lds
s_mul_i32 s50, s44, 2048
s_add_u32 m0, s50, 33792
s_add_u32 s49, s62, 184320
buffer_load_dwordx4 v112, s[8:11], s49 offen nt lds
s_waitcnt vmcnt(8) lgkmcnt(0)
s_barrier
s_mul_i32 s50, s44, 2048
s_add_u32 m0, s50, 40960
s_add_u32 s49, s62, 204800
buffer_load_dwordx4 v112, s[8:11], s49 offen nt lds
s_mul_i32 s50, s44, 2048
s_add_u32 m0, s50, 41984
s_add_u32 s49, s62, 225280
buffer_load_dwordx4 v112, s[8:11], s49 offen nt lds
ds_read_b64_tr_b16 a[0:1], v113 offset:0
ds_read_b64_tr_b16 a[2:3], v113 offset:1024
ds_read_b64_tr_b16 a[4:5], v113 offset:8
ds_read_b64_tr_b16 a[6:7], v113 offset:1032
s_waitcnt vmcnt(8) lgkmcnt(0)
s_barrier
s_mul_i32 s50, s44, 2048
s_add_u32 m0, s50, 0
s_add_u32 s49, s62, 245760
buffer_load_dwordx4 v112, s[8:11], s49 offen nt lds
s_mul_i32 s50, s44, 2048
s_add_u32 m0, s50, 1024
s_add_u32 s49, s62, 266240
buffer_load_dwordx4 v112, s[8:11], s49 offen nt lds
ds_read_b64_tr_b16 a[8:9], v113 offset:8192
ds_read_b64_tr_b16 a[10:11], v113 offset:9216
ds_read_b64_tr_b16 a[12:13], v113 offset:8200
ds_read_b64_tr_b16 a[14:15], v113 offset:9224
s_waitcnt vmcnt(8) lgkmcnt(0)
s_barrier
s_mul_i32 s50, s44, 2048
s_add_u32 m0, s50, 8192
s_add_u32 s49, s62, 286720
buffer_load_dwordx4 v112, s[8:11], s49 offen nt lds
s_mul_i32 s50, s44, 2048
s_add_u32 m0, s50, 9216
s_add_u32 s49, s62, 307200
buffer_load_dwordx4 v112, s[8:11], s49 offen nt lds
ds_read_b64_tr_b16 a[16:17], v113 offset:16384
ds_read_b64_tr_b16 a[18:19], v113 offset:17408
ds_read_b64_tr_b16 a[20:21], v113 offset:16392
ds_read_b64_tr_b16 a[22:23], v113 offset:17416
s_waitcnt vmcnt(8) lgkmcnt(0)
s_barrier
s_mul_i32 s50, s44, 2048
s_add_u32 m0, s50, 16384
s_add_u32 s49, s62, 327680
buffer_load_dwordx4 v112, s[8:11], s49 offen nt lds
s_mul_i32 s50, s44, 2048
s_add_u32 m0, s50, 17408
s_add_u32 s49, s62, 348160
buffer_load_dwordx4 v112, s[8:11], s49 offen nt lds
ds_read_b64_tr_b16 a[24:25], v113 offset:24576
ds_read_b64_tr_b16 a[26:27], v113 offset:25600
ds_read_b64_tr_b16 a[28:29], v113 offset:24584
ds_read_b64_tr_b16 a[30:31], v113 offset:25608
s_waitcnt vmcnt(8) lgkmcnt(0)
s_barrier
s_mul_i32 s50, s44, 2048
s_add_u32 m0, s50, 24576
s_add_u32 s49, s62, 368640
buffer_load_dwordx4 v112, s[8:11], s49 offen nt lds
s_mul_i32 s50, s44, 2048
s_add_u32 m0, s50, 25600
s_add_u32 s49, s62, 389120
buffer_load_dwordx4 v112, s[8:11], s49 offen nt lds
ds_read_b64_tr_b16 a[32:33], v113 offset:32768
ds_read_b64_tr_b16 a[34:35], v113 offset:33792
ds_read_b64_tr_b16 a[36:37], v113 offset:32776
ds_read_b64_tr_b16 a[38:39], v113 offset:33800
s_waitcnt vmcnt(8) lgkmcnt(0)
s_barrier
s_mul_i32 s50, s44, 2048
s_add_u32 m0, s50, 32768
s_add_u32 s49, s62, 409600
buffer_load_dwordx4 v112, s[8:11], s49 offen nt lds
s_mul_i32 s50, s44, 2048
s_add_u32 m0, s50, 33792
s_add_u32 s49, s62, 430080
buffer_load_dwordx4 v112, s[8:11], s49 offen nt lds
ds_read_b64_tr_b16 a[40:41], v113 offset:40960
ds_read_b64_tr_b16 a[42:43], v113 offset:41984
ds_read_b64_tr_b16 a[44:45], v113 offset:40968
ds_read_b64_tr_b16 a[46:47], v113 offset:41992
s_waitcnt vmcnt(8) lgkmcnt(0)
s_barrier
s_mul_i32 s50, s44, 2048
s_add_u32 m0, s50, 40960
s_add_u32 s49, s62, 450560
buffer_load_dwordx4 v112, s[8:11], s49 offen nt lds
s_mul_i32 s50, s44, 2048
s_add_u32 m0, s50, 41984
s_add_u32 s49, s62, 471040
buffer_load_dwordx4 v112, s[8:11], s49 offen nt lds
ds_read_b64_tr_b16 a[48:49], v113 offset:0
ds_read_b64_tr_b16 a[50:51], v113 offset:1024
ds_read_b64_tr_b16 a[52:53], v113 offset:8
ds_read_b64_tr_b16 a[54:55], v113 offset:1032
s_waitcnt vmcnt(8) lgkmcnt(0)
s_barrier
s_mul_i32 s50, s44, 2048
s_add_u32 m0, s50, 0
s_add_u32 s49, s62, 491520
buffer_load_dwordx4 v112, s[8:11], s49 offen nt lds
s_mul_i32 s50, s44, 2048
s_add_u32 m0, s50, 1024
s_add_u32 s49, s62, 512000
buffer_load_dwordx4 v112, s[8:11], s49 offen nt lds
ds_read_b64_tr_b16 a[56:57], v113 offset:8192
ds_read_b64_tr_b16 a[58:59], v113 offset:9216
ds_read_b64_tr_b16 a[60:61], v113 offset:8200
ds_read_b64_tr_b16 a[62:63], v113 offset:9224
s_waitcnt vmcnt(8) lgkmcnt(0)
s_barrier
s_mul_i32 s50, s44, 2048
s_add_u32 m0, s50, 8192
s_add_u32 s49, s62, 532480
buffer_load_dwordx4 v112, s[8:11], s49 offen nt lds
s_mul_i32 s50, s44, 2048
s_add_u32 m0, s50, 9216
s_add_u32 s49, s62, 552960
buffer_load_dwordx4 v112, s[8:11], s49 offen nt lds
ds_read_b64_tr_b16 a[64:65], v113 offset:16384
ds_read_b64_tr_b16 a[66:67], v113 offset:17408
ds_read_b64_tr_b16 a[68:69], v113 offset:16392
ds_read_b64_tr_b16 a[70:71], v113 offset:17416
s_waitcnt vmcnt(8) lgkmcnt(0)
s_barrier
s_mul_i32 s50, s44, 2048
s_add_u32 m0, s50, 16384
s_add_u32 s49, s62, 573440
buffer_load_dwordx4 v112, s[8:11], s49 offen nt lds
s_mul_i32 s50, s44, 2048
s_add_u32 m0, s50, 17408
s_add_u32 s49, s62, 593920
buffer_load_dwordx4 v112, s[8:11], s49 offen nt lds
ds_read_b64_tr_b16 a[72:73], v113 offset:24576
ds_read_b64_tr_b16 a[74:75], v113 offset:25600
ds_read_b64_tr_b16 a[76:77], v113 offset:24584
ds_read_b64_tr_b16 a[78:79], v113 offset:25608
s_waitcnt vmcnt(8) lgkmcnt(0)
s_barrier
s_mul_i32 s50, s44, 2048
s_add_u32 m0, s50, 24576
s_add_u32 s49, s62, 614400
buffer_load_dwordx4 v112, s[8:11], s49 offen nt lds
s_mul_i32 s50, s44, 2048
s_add_u32 m0, s50, 25600
s_add_u32 s49, s62, 634880
buffer_load_dwordx4 v112, s[8:11], s49 offen nt lds
ds_read_b64_tr_b16 a[80:81], v113 offset:32768
ds_read_b64_tr_b16 a[82:83], v113 offset:33792
ds_read_b64_tr_b16 a[84:85], v113 offset:32776
ds_read_b64_tr_b16 a[86:87], v113 offset:33800
s_waitcnt vmcnt(8) lgkmcnt(0)
s_barrier
s_mul_i32 s50, s44, 2048
s_add_u32 m0, s50, 32768
s_add_u32 s49, s62, 655360
buffer_load_dwordx4 v112, s[8:11], s49 offen nt lds
s_mul_i32 s50, s44, 2048
s_add_u32 m0, s50, 33792
s_add_u32 s49, s62, 675840
buffer_load_dwordx4 v112, s[8:11], s49 offen nt lds
ds_read_b64_tr_b16 a[88:89], v113 offset:40960
ds_read_b64_tr_b16 a[90:91], v113 offset:41984
ds_read_b64_tr_b16 a[92:93], v113 offset:40968
ds_read_b64_tr_b16 a[94:95], v113 offset:41992
s_waitcnt vmcnt(8) lgkmcnt(0)
s_barrier
s_mul_i32 s50, s44, 2048
s_add_u32 m0, s50, 40960
s_add_u32 s49, s62, 696320
buffer_load_dwordx4 v112, s[8:11], s49 offen nt lds
s_mul_i32 s50, s44, 2048
s_add_u32 m0, s50, 41984
s_add_u32 s49, s62, 716800
buffer_load_dwordx4 v112, s[8:11], s49 offen nt lds
ds_read_b64_tr_b16 a[96:97], v113 offset:0
ds_read_b64_tr_b16 a[98:99], v113 offset:1024
ds_read_b64_tr_b16 a[100:101], v113 offset:8
ds_read_b64_tr_b16 a[102:103], v113 offset:1032
s_waitcnt vmcnt(8) lgkmcnt(0)
s_barrier
s_mul_i32 s50, s44, 2048
s_add_u32 m0, s50, 0
s_add_u32 s49, s62, 737280
buffer_load_dwordx4 v112, s[8:11], s49 offen nt lds
s_mul_i32 s50, s44, 2048
s_add_u32 m0, s50, 1024
s_add_u32 s49, s62, 757760
buffer_load_dwordx4 v112, s[8:11], s49 offen nt lds
ds_read_b64_tr_b16 a[104:105], v113 offset:8192
ds_read_b64_tr_b16 a[106:107], v113 offset:9216
ds_read_b64_tr_b16 a[108:109], v113 offset:8200
ds_read_b64_tr_b16 a[110:111], v113 offset:9224
s_waitcnt vmcnt(8) lgkmcnt(0)
s_barrier
s_mul_i32 s50, s44, 2048
s_add_u32 m0, s50, 8192
s_add_u32 s49, s62, 778240
buffer_load_dwordx4 v112, s[8:11], s49 offen nt lds
s_mul_i32 s50, s44, 2048
s_add_u32 m0, s50, 9216
s_add_u32 s49, s62, 798720
buffer_load_dwordx4 v112, s[8:11], s49 offen nt lds
ds_read_b64_tr_b16 a[112:113], v113 offset:16384
ds_read_b64_tr_b16 a[114:115], v113 offset:17408
ds_read_b64_tr_b16 a[116:117], v113 offset:16392
ds_read_b64_tr_b16 a[118:119], v113 offset:17416
s_waitcnt vmcnt(8) lgkmcnt(0)
s_barrier
s_mul_i32 s50, s44, 2048
s_add_u32 m0, s50, 16384
s_add_u32 s49, s62, 819200
buffer_load_dwordx4 v112, s[8:11], s49 offen nt lds
s_mul_i32 s50, s44, 2048
s_add_u32 m0, s50, 17408
s_add_u32 s49, s62, 839680
buffer_load_dwordx4 v112, s[8:11], s49 offen nt lds
ds_read_b64_tr_b16 a[120:121], v113 offset:24576
ds_read_b64_tr_b16 a[122:123], v113 offset:25600
ds_read_b64_tr_b16 a[124:125], v113 offset:24584
ds_read_b64_tr_b16 a[126:127], v113 offset:25608
s_waitcnt vmcnt(8) lgkmcnt(0)
s_barrier
s_mul_i32 s50, s44, 2048
s_add_u32 m0, s50, 24576
s_add_u32 s49, s62, 860160
buffer_load_dwordx4 v112, s[8:11], s49 offen nt lds
s_mul_i32 s50, s44, 2048
s_add_u32 m0, s50, 25600
s_add_u32 s49, s62, 880640
buffer_load_dwordx4 v112, s[8:11], s49 offen nt lds
ds_read_b64_tr_b16 a[128:129], v113 offset:32768
ds_read_b64_tr_b16 a[130:131], v113 offset:33792
ds_read_b64_tr_b16 a[132:133], v113 offset:32776
ds_read_b64_tr_b16 a[134:135], v113 offset:33800
s_waitcnt vmcnt(8) lgkmcnt(0)
s_barrier
s_mul_i32 s50, s44, 2048
s_add_u32 m0, s50, 32768
s_add_u32 s49, s62, 901120
buffer_load_dwordx4 v112, s[8:11], s49 offen nt lds
s_mul_i32 s50, s44, 2048
s_add_u32 m0, s50, 33792
s_add_u32 s49, s62, 921600
buffer_load_dwordx4 v112, s[8:11], s49 offen nt lds
ds_read_b64_tr_b16 a[136:137], v113 offset:40960
ds_read_b64_tr_b16 a[138:139], v113 offset:41984
ds_read_b64_tr_b16 a[140:141], v113 offset:40968
ds_read_b64_tr_b16 a[142:143], v113 offset:41992
s_waitcnt vmcnt(8) lgkmcnt(0)
s_barrier
s_mul_i32 s50, s44, 2048
s_add_u32 m0, s50, 40960
s_add_u32 s49, s62, 942080
buffer_load_dwordx4 v112, s[8:11], s49 offen nt lds
s_mul_i32 s50, s44, 2048
s_add_u32 m0, s50, 41984
s_add_u32 s49, s62, 962560
buffer_load_dwordx4 v112, s[8:11], s49 offen nt lds
ds_read_b64_tr_b16 a[144:145], v113 offset:0
ds_read_b64_tr_b16 a[146:147], v113 offset:1024
ds_read_b64_tr_b16 a[148:149], v113 offset:8
ds_read_b64_tr_b16 a[150:151], v113 offset:1032
s_waitcnt vmcnt(8) lgkmcnt(0)
s_barrier
ds_read_b64_tr_b16 a[152:153], v113 offset:8192
ds_read_b64_tr_b16 a[154:155], v113 offset:9216
ds_read_b64_tr_b16 a[156:157], v113 offset:8200
ds_read_b64_tr_b16 a[158:159], v113 offset:9224
s_waitcnt vmcnt(6) lgkmcnt(0)
s_barrier
ds_read_b64_tr_b16 a[160:161], v113 offset:16384
ds_read_b64_tr_b16 a[162:163], v113 offset:17408
ds_read_b64_tr_b16 a[164:165], v113 offset:16392
ds_read_b64_tr_b16 a[166:167], v113 offset:17416
s_waitcnt vmcnt(4) lgkmcnt(0)
s_barrier
ds_read_b64_tr_b16 a[168:169], v113 offset:24576
ds_read_b64_tr_b16 a[170:171], v113 offset:25600
ds_read_b64_tr_b16 a[172:173], v113 offset:24584
ds_read_b64_tr_b16 a[174:175], v113 offset:25608
s_waitcnt vmcnt(2) lgkmcnt(0)
s_barrier
ds_read_b64_tr_b16 a[176:177], v113 offset:32768
ds_read_b64_tr_b16 a[178:179], v113 offset:33792
ds_read_b64_tr_b16 a[180:181], v113 offset:32776
ds_read_b64_tr_b16 a[182:183], v113 offset:33800
s_waitcnt vmcnt(0) lgkmcnt(0)
s_barrier
ds_read_b64_tr_b16 a[184:185], v113 offset:40960
ds_read_b64_tr_b16 a[186:187], v113 offset:41984
ds_read_b64_tr_b16 a[188:189], v113 offset:40968
ds_read_b64_tr_b16 a[190:191], v113 offset:41992
s_waitcnt lgkmcnt(0)
s_mul_i32 s48, s44, 12288
v_lshlrev_b32 v100, 4, v1
v_add_u32 v100, s48, v100
v_lshrrev_b32 v122, 4, v1
v_and_b32 v123, 15, v1
v_lshlrev_b32 v122, 9, v122
v_lshl_add_u32 v96, v123, 4, v122
s_lshl_b32 s48, s76, 7
s_add_u32 s48, s48, 53248
v_mov_b32 v120, s48
v_mov_b32 v122, 1879048192
v_cmp_eq_u32 vcc, 0, v0
s_nop 1
v_cndmask_b32 v120, v122, v120, vcc
s_lshl_b32 s48, s44, 12
v_lshlrev_b32 v112, 4, v1
v_add_u32 v112, s48, v112
v_mov_b32 v114, 0
s_mul_i32 s57, s44, 12288
s_mov_b32 s77, 0
s_barrier
s_mov_b32 s12, s38
s_mov_b32 s13, s39
s_mov_b32 s14, 2621440
s_mov_b32 s15, 0x20000
v_and_b32 v122, 3, v1
v_mul_u32_u24 v122, 12288, v122
v_add_u32 v114, 12272, v122
s_and_b32 s51, s76, 7
s_lshr_b32 s52, s76, 3
s_lshr_b32 s48, s51, 1
s_and_b32 s49, s51, 1
s_mul_i32 s82, s52, 147456
s_add_u32 s82, s82, 234881024
s_lshl_b32 s50, s51, 14
s_add_u32 s79, s82, s50
s_lshl_b32 s50, s48, 12
s_add_u32 s82, s82, s50
s_lshl_b32 s50, s49, 10
s_add_u32 s82, s82, s50
s_mul_i32 s81, s49, 20480
s_lshl_b32 s48, s48, 6
s_add_u32 s81, s81, s48
s_lshl_b32 s48, s52, 8
s_add_u32 s81, s81, s48
s_add_u32 s81, s81, 2457600
v_and_b32 v122, 15, v1
v_mul_u32_u24 v122, 1280, v122
v_lshrrev_b32 v123, 4, v1
v_lshl_add_u32 v115, v123, 4, v122
v_lshlrev_b32 v116, 4, v1
v_mov_b32 v117, 0
s_sub_u32 s82, s82, 737280
s_sub_u32 s81, s81, 40960
L_t5t_97:
s_mov_b32 s83, 0
L_t5tr_100:
s_cmp_ge_u32 s77, 0
s_cbranch_scc1 L_t5tf_102
s_cmp_lg_u32 s44, 0
s_cbranch_scc1 L_p4x_105
s_mov_b32 s53, 0
L_p4_103:
buffer_load_dwordx4 v[2:5], v117, s[4:7], s80 offen sc1
s_add_u32 s53, s53, 1
s_cmp_gt_u32 s53, 400000
s_cbranch_scc1 L_p4x_105
s_waitcnt vmcnt(0)
L_p4c_104:
v_and_b32 v2, v2, v3
v_bitop3_b32 v2, v2, v4, v5 bitop3:0x80
s_nop 0
v_readfirstlane_b32 s48, v2
s_cmp_eq_u32 s48, 1
s_cbranch_scc1 L_p4x_105
s_sleep 2
s_branch L_p4_103
L_p4x_105:
s_branch L_t5tx_99
L_t5tf_102:
s_cmp_lg_u32 s44, 0
s_cbranch_scc1 L_t5tx_99
s_mov_b32 s53, 0
L_t5tp_98:
buffer_load_dword v2, v114, s[4:7], s78 offen sc1
s_add_u32 s53, s53, 1
s_cmp_gt_u32 s53, 400000
s_cbranch_scc1 L_t5tx_99
s_waitcnt vmcnt(0)
v_cmp_eq_u32 vcc, -1, v2
s_cbranch_vccz L_t5tx_99
s_sleep 1
s_branch L_t5tp_98
L_t5tx_99:
s_waitcnt vmcnt(0)
s_barrier
s_add_u32 m0, s57, 0
s_add_u32 s49, s78, s57
s_add_u32 s49, s49, 0
buffer_load_dwordx4 v116, s[4:7], s49 offen offset:0 sc1 lds
buffer_load_dwordx4 v116, s[4:7], s49 offen offset:1024 sc1 lds
buffer_load_dwordx4 v116, s[4:7], s49 offen offset:2048 sc1 lds
buffer_load_dwordx4 v116, s[4:7], s49 offen offset:3072 sc1 lds
s_add_u32 m0, s57, 4096
s_add_u32 s49, s78, s57
s_add_u32 s49, s49, 4096
buffer_load_dwordx4 v116, s[4:7], s49 offen offset:0 sc1 lds
buffer_load_dwordx4 v116, s[4:7], s49 offen offset:1024 sc1 lds
buffer_load_dwordx4 v116, s[4:7], s49 offen offset:2048 sc1 lds
buffer_load_dwordx4 v116, s[4:7], s49 offen offset:3072 sc1 lds
s_add_u32 m0, s57, 8192
s_add_u32 s49, s78, s57
s_add_u32 s49, s49, 8192
buffer_load_dwordx4 v116, s[4:7], s49 offen offset:0 sc1 lds
buffer_load_dwordx4 v116, s[4:7], s49 offen offset:1024 sc1 lds
buffer_load_dwordx4 v116, s[4:7], s49 offen offset:2048 sc1 lds
buffer_load_dwordx4 v116, s[4:7], s49 offen offset:3072 sc1 lds
s_cmp_lg_u32 s44, 1
s_cbranch_scc1 L_t5tw_108
s_cmp_lg_u32 s77, 1
s_cbranch_scc1 L_t5tw_108
s_mov_b32 s53, 0
L_t5tg_106:
s_mov_b32 s48, s82
buffer_load_dwordx4 v[128:131], v116, s[4:7], s48 offen offset:0 sc1
buffer_load_dwordx4 v[132:135], v116, s[4:7], s48 offen offset:2048 sc1
s_add_u32 s48, s48, 16384
buffer_load_dwordx4 v[136:139], v116, s[4:7], s48 offen offset:0 sc1
buffer_load_dwordx4 v[140:143], v116, s[4:7], s48 offen offset:2048 sc1
s_add_u32 s48, s48, 16384
buffer_load_dwordx4 v[144:147], v116, s[4:7], s48 offen offset:0 sc1
buffer_load_dwordx4 v[148:151], v116, s[4:7], s48 offen offset:2048 sc1
s_add_u32 s48, s48, 16384
buffer_load_dwordx4 v[152:155], v116, s[4:7], s48 offen offset:0 sc1
buffer_load_dwordx4 v[156:159], v116, s[4:7], s48 offen offset:2048 sc1
s_add_u32 s48, s48, 16384
buffer_load_dwordx4 v[160:163], v116, s[4:7], s48 offen offset:0 sc1
buffer_load_dwordx4 v[164:167], v116, s[4:7], s48 offen offset:2048 sc1
s_add_u32 s48, s48, 16384
buffer_load_dwordx4 v[168:171], v116, s[4:7], s48 offen offset:0 sc1
buffer_load_dwordx4 v[172:175], v116, s[4:7], s48 offen offset:2048 sc1
s_add_u32 s48, s48, 16384
buffer_load_dwordx4 v[176:179], v116, s[4:7], s48 offen offset:0 sc1
buffer_load_dwordx4 v[180:183], v116, s[4:7], s48 offen offset:2048 sc1
s_add_u32 s48, s48, 16384
buffer_load_dwordx4 v[184:187], v116, s[4:7], s48 offen offset:0 sc1
buffer_load_dwordx4 v[188:191], v116, s[4:7], s48 offen offset:2048 sc1
s_add_u32 s48, s48, 16384
buffer_load_dwordx4 v[192:195], v116, s[4:7], s48 offen offset:0 sc1
buffer_load_dwordx4 v[196:199], v116, s[4:7], s48 offen offset:2048 sc1
s_add_u32 s53, s53, 1
s_cmp_gt_u32 s53, 100000
s_cbranch_scc1 L_t5tgx_107
s_waitcnt vmcnt(14)
v_pk_add_f32 v[128:129], v[128:129], v[136:137]
v_pk_add_f32 v[130:131], v[130:131], v[138:139]
v_pk_add_f32 v[132:133], v[132:133], v[140:141]
v_pk_add_f32 v[134:135], v[134:135], v[142:143]
s_waitcnt vmcnt(12)
v_pk_add_f32 v[128:129], v[128:129], v[144:145]
v_pk_add_f32 v[130:131], v[130:131], v[146:147]
v_pk_add_f32 v[132:133], v[132:133], v[148:149]
v_pk_add_f32 v[134:135], v[134:135], v[150:151]
s_waitcnt vmcnt(10)
v_pk_add_f32 v[128:129], v[128:129], v[152:153]
v_pk_add_f32 v[130:131], v[130:131], v[154:155]
v_pk_add_f32 v[132:133], v[132:133], v[156:157]
v_pk_add_f32 v[134:135], v[134:135], v[158:159]
s_waitcnt vmcnt(8)
v_pk_add_f32 v[128:129], v[128:129], v[160:161]
v_pk_add_f32 v[130:131], v[130:131], v[162:163]
v_pk_add_f32 v[132:133], v[132:133], v[164:165]
v_pk_add_f32 v[134:135], v[134:135], v[166:167]
s_waitcnt vmcnt(6)
v_pk_add_f32 v[128:129], v[128:129], v[168:169]
v_pk_add_f32 v[130:131], v[130:131], v[170:171]
v_pk_add_f32 v[132:133], v[132:133], v[172:173]
v_pk_add_f32 v[134:135], v[134:135], v[174:175]
s_waitcnt vmcnt(4)
v_pk_add_f32 v[128:129], v[128:129], v[176:177]
v_pk_add_f32 v[130:131], v[130:131], v[178:179]
v_pk_add_f32 v[132:133], v[132:133], v[180:181]
v_pk_add_f32 v[134:135], v[134:135], v[182:183]
s_waitcnt vmcnt(2)
v_pk_add_f32 v[128:129], v[128:129], v[184:185]
v_pk_add_f32 v[130:131], v[130:131], v[186:187]
v_pk_add_f32 v[132:133], v[132:133], v[188:189]
v_pk_add_f32 v[134:135], v[134:135], v[190:191]
s_waitcnt vmcnt(0)
v_pk_add_f32 v[128:129], v[128:129], v[192:193]
v_pk_add_f32 v[130:131], v[130:131], v[194:195]
v_pk_add_f32 v[132:133], v[132:133], v[196:197]
v_pk_add_f32 v[134:135], v[134:135], v[198:199]
v_cmp_u_f32 vcc, v128, v129
v_cmp_u_f32 s[86:87], v130, v131
v_cmp_u_f32 s[88:89], v132, v133
v_cmp_u_f32 s[90:91], v134, v135
s_or_b64 vcc, vcc, s[86:87]
s_or_b64 vcc, vcc, s[88:89]
s_or_b64 vcc, vcc, s[90:91]
s_cbranch_vccnz L_t5tg_106
L_t5tgx_107:
s_waitcnt vmcnt(0)
v_cvt_pk_bf16_f32 v136, v128, v129
v_cvt_pk_bf16_f32 v137, v130, v131
v_cvt_pk_bf16_f32 v138, v132, v133
v_cvt_pk_bf16_f32 v139, v134, v135
buffer_store_dwordx4 v[136:139], v115, s[12:15], s81 offen
L_t5tw_108:
s_waitcnt vmcnt(0)
s_barrier
ds_read_b128 v[64:67], v96 offset:0
ds_read_b128 v[68:71], v96 offset:256
ds_read_b128 v[72:75], v96 offset:2048
ds_read_b128 v[76:79], v96 offset:2304
ds_read_b128 v[80:83], v96 offset:4096
ds_read_b128 v[84:87], v96 offset:4352
ds_read_b128 v[88:91], v96 offset:6144
ds_read_b128 v[92:95], v96 offset:6400
s_waitcnt lgkmcnt(7)
v_mfma_f32_16x16x32_bf16 v[16:19], a[0:3], v[64:67], 0
v_mfma_f32_16x16x32_bf16 v[24:27], a[4:7], v[64:67], 0
ds_read_b128 v[64:67], v96 offset:8192
s_waitcnt lgkmcnt(7)
v_mfma_f32_16x16x32_bf16 v[20:23], a[0:3], v[68:71], 0
v_mfma_f32_16x16x32_bf16 v[28:31], a[4:7], v[68:71], 0
ds_read_b128 v[68:71], v96 offset:8448
s_waitcnt lgkmcnt(7)
v_mfma_f32_16x16x32_bf16 v[16:19], a[8:11], v[72:75], v[16:19]
v_mfma_f32_16x16x32_bf16 v[24:27], a[12:15], v[72:75], v[24:27]
ds_read_b128 v[72:75], v96 offset:10240
s_waitcnt lgkmcnt(7)
v_mfma_f32_16x16x32_bf16 v[20:23], a[8:11], v[76:79], v[20:23]
v_mfma_f32_16x16x32_bf16 v[28:31], a[12:15], v[76:79], v[28:31]
ds_read_b128 v[76:79], v96 offset:10496
s_waitcnt lgkmcnt(7)
v_mfma_f32_16x16x32_bf16 v[16:19], a[16:19], v[80:83], v[16:19]
v_mfma_f32_16x16x32_bf16 v[24:27], a[20:23], v[80:83], v[24:27]
ds_read_b128 v[80:83], v96 offset:12288
s_waitcnt lgkmcnt(7)
v_mfma_f32_16x16x32_bf16 v[20:23], a[16:19], v[84:87], v[20:23]
v_mfma_f32_16x16x32_bf16 v[28:31], a[20:23], v[84:87], v[28:31]
ds_read_b128 v[84:87], v96 offset:12544
s_waitcnt lgkmcnt(7)
v_mfma_f32_16x16x32_bf16 v[16:19], a[24:27], v[88:91], v[16:19]
v_mfma_f32_16x16x32_bf16 v[24:27], a[28:31], v[88:91], v[24:27]
ds_read_b128 v[88:91], v96 offset:14336
s_waitcnt lgkmcnt(7)
v_mfma_f32_16x16x32_bf16 v[20:23], a[24:27], v[92:95], v[20:23]
v_mfma_f32_16x16x32_bf16 v[28:31], a[28:31], v[92:95], v[28:31]
ds_read_b128 v[92:95], v96 offset:14592
s_waitcnt lgkmcnt(7)
v_mfma_f32_16x16x32_bf16 v[16:19], a[32:35], v[64:67], v[16:19]
v_mfma_f32_16x16x32_bf16 v[24:27], a[36:39], v[64:67], v[24:27]
ds_read_b128 v[64:67], v96 offset:16384
s_waitcnt lgkmcnt(7)
v_mfma_f32_16x16x32_bf16 v[20:23], a[32:35], v[68:71], v[20:23]
v_mfma_f32_16x16x32_bf16 v[28:31], a[36:39], v[68:71], v[28:31]
ds_read_b128 v[68:71], v96 offset:16640
s_waitcnt lgkmcnt(7)
v_mfma_f32_16x16x32_bf16 v[16:19], a[40:43], v[72:75], v[16:19]
v_mfma_f32_16x16x32_bf16 v[24:27], a[44:47], v[72:75], v[24:27]
ds_read_b128 v[72:75], v96 offset:18432
s_waitcnt lgkmcnt(7)
v_mfma_f32_16x16x32_bf16 v[20:23], a[40:43], v[76:79], v[20:23]
v_mfma_f32_16x16x32_bf16 v[28:31], a[44:47], v[76:79], v[28:31]
ds_read_b128 v[76:79], v96 offset:18688
s_waitcnt lgkmcnt(7)
v_mfma_f32_16x16x32_bf16 v[16:19], a[48:51], v[80:83], v[16:19]
v_mfma_f32_16x16x32_bf16 v[24:27], a[52:55], v[80:83], v[24:27]
ds_read_b128 v[80:83], v96 offset:20480
s_waitcnt lgkmcnt(7)
v_mfma_f32_16x16x32_bf16 v[20:23], a[48:51], v[84:87], v[20:23]
v_mfma_f32_16x16x32_bf16 v[28:31], a[52:55], v[84:87], v[28:31]
ds_read_b128 v[84:87], v96 offset:20736
s_waitcnt lgkmcnt(7)
v_mfma_f32_16x16x32_bf16 v[16:19], a[56:59], v[88:91], v[16:19]
v_mfma_f32_16x16x32_bf16 v[24:27], a[60:63], v[88:91], v[24:27]
ds_read_b128 v[88:91], v96 offset:22528
s_waitcnt lgkmcnt(7)
v_mfma_f32_16x16x32_bf16 v[20:23], a[56:59], v[92:95], v[20:23]
v_mfma_f32_16x16x32_bf16 v[28:31], a[60:63], v[92:95], v[28:31]
ds_read_b128 v[92:95], v96 offset:22784
s_waitcnt lgkmcnt(7)
v_mfma_f32_16x16x32_bf16 v[16:19], a[64:67], v[64:67], v[16:19]
v_mfma_f32_16x16x32_bf16 v[24:27], a[68:71], v[64:67], v[24:27]
ds_read_b128 v[64:67], v96 offset:24576
s_waitcnt lgkmcnt(7)
v_mfma_f32_16x16x32_bf16 v[20:23], a[64:67], v[68:71], v[20:23]
v_mfma_f32_16x16x32_bf16 v[28:31], a[68:71], v[68:71], v[28:31]
ds_read_b128 v[68:71], v96 offset:24832
s_waitcnt lgkmcnt(7)
v_mfma_f32_16x16x32_bf16 v[16:19], a[72:75], v[72:75], v[16:19]
v_mfma_f32_16x16x32_bf16 v[24:27], a[76:79], v[72:75], v[24:27]
ds_read_b128 v[72:75], v96 offset:26624
s_waitcnt lgkmcnt(7)
v_mfma_f32_16x16x32_bf16 v[20:23], a[72:75], v[76:79], v[20:23]
v_mfma_f32_16x16x32_bf16 v[28:31], a[76:79], v[76:79], v[28:31]
ds_read_b128 v[76:79], v96 offset:26880
s_waitcnt lgkmcnt(7)
v_mfma_f32_16x16x32_bf16 v[16:19], a[80:83], v[80:83], v[16:19]
v_mfma_f32_16x16x32_bf16 v[24:27], a[84:87], v[80:83], v[24:27]
ds_read_b128 v[80:83], v96 offset:28672
s_waitcnt lgkmcnt(7)
v_mfma_f32_16x16x32_bf16 v[20:23], a[80:83], v[84:87], v[20:23]
v_mfma_f32_16x16x32_bf16 v[28:31], a[84:87], v[84:87], v[28:31]
ds_read_b128 v[84:87], v96 offset:28928
s_waitcnt lgkmcnt(7)
v_mfma_f32_16x16x32_bf16 v[16:19], a[88:91], v[88:91], v[16:19]
v_mfma_f32_16x16x32_bf16 v[24:27], a[92:95], v[88:91], v[24:27]
ds_read_b128 v[88:91], v96 offset:30720
s_waitcnt lgkmcnt(7)
v_mfma_f32_16x16x32_bf16 v[20:23], a[88:91], v[92:95], v[20:23]
v_mfma_f32_16x16x32_bf16 v[28:31], a[92:95], v[92:95], v[28:31]
ds_read_b128 v[92:95], v96 offset:30976
s_waitcnt lgkmcnt(7)
v_mfma_f32_16x16x32_bf16 v[16:19], a[96:99], v[64:67], v[16:19]
v_mfma_f32_16x16x32_bf16 v[24:27], a[100:103], v[64:67], v[24:27]
ds_read_b128 v[64:67], v96 offset:32768
s_waitcnt lgkmcnt(7)
v_mfma_f32_16x16x32_bf16 v[20:23], a[96:99], v[68:71], v[20:23]
v_mfma_f32_16x16x32_bf16 v[28:31], a[100:103], v[68:71], v[28:31]
ds_read_b128 v[68:71], v96 offset:33024
s_waitcnt lgkmcnt(7)
v_mfma_f32_16x16x32_bf16 v[16:19], a[104:107], v[72:75], v[16:19]
v_mfma_f32_16x16x32_bf16 v[24:27], a[108:111], v[72:75], v[24:27]
ds_read_b128 v[72:75], v96 offset:34816
s_waitcnt lgkmcnt(7)
v_mfma_f32_16x16x32_bf16 v[20:23], a[104:107], v[76:79], v[20:23]
v_mfma_f32_16x16x32_bf16 v[28:31], a[108:111], v[76:79], v[28:31]
ds_read_b128 v[76:79], v96 offset:35072
s_waitcnt lgkmcnt(7)
v_mfma_f32_16x16x32_bf16 v[16:19], a[112:115], v[80:83], v[16:19]
v_mfma_f32_16x16x32_bf16 v[24:27], a[116:119], v[80:83], v[24:27]
ds_read_b128 v[80:83], v96 offset:36864
s_waitcnt lgkmcnt(7)
v_mfma_f32_16x16x32_bf16 v[20:23], a[112:115], v[84:87], v[20:23]
v_mfma_f32_16x16x32_bf16 v[28:31], a[116:119], v[84:87], v[28:31]
ds_read_b128 v[84:87], v96 offset:37120
s_waitcnt lgkmcnt(7)
v_mfma_f32_16x16x32_bf16 v[16:19], a[120:123], v[88:91], v[16:19]
v_mfma_f32_16x16x32_bf16 v[24:27], a[124:127], v[88:91], v[24:27]
ds_read_b128 v[88:91], v96 offset:38912
s_waitcnt lgkmcnt(7)
v_mfma_f32_16x16x32_bf16 v[20:23], a[120:123], v[92:95], v[20:23]
v_mfma_f32_16x16x32_bf16 v[28:31], a[124:127], v[92:95], v[28:31]
ds_read_b128 v[92:95], v96 offset:39168
s_waitcnt lgkmcnt(7)
v_mfma_f32_16x16x32_bf16 v[16:19], a[128:131], v[64:67], v[16:19]
v_mfma_f32_16x16x32_bf16 v[24:27], a[132:135], v[64:67], v[24:27]
ds_read_b128 v[64:67], v96 offset:40960
s_waitcnt lgkmcnt(7)
v_mfma_f32_16x16x32_bf16 v[20:23], a[128:131], v[68:71], v[20:23]
v_mfma_f32_16x16x32_bf16 v[28:31], a[132:135], v[68:71], v[28:31]
ds_read_b128 v[68:71], v96 offset:41216
s_waitcnt lgkmcnt(7)
v_mfma_f32_16x16x32_bf16 v[16:19], a[136:139], v[72:75], v[16:19]
v_mfma_f32_16x16x32_bf16 v[24:27], a[140:143], v[72:75], v[24:27]
ds_read_b128 v[72:75], v96 offset:43008
s_waitcnt lgkmcnt(7)
v_mfma_f32_16x16x32_bf16 v[20:23], a[136:139], v[76:79], v[20:23]
v_mfma_f32_16x16x32_bf16 v[28:31], a[140:143], v[76:79], v[28:31]
ds_read_b128 v[76:79], v96 offset:43264
s_waitcnt lgkmcnt(7)
v_mfma_f32_16x16x32_bf16 v[16:19], a[144:147], v[80:83], v[16:19]
v_mfma_f32_16x16x32_bf16 v[24:27], a[148:151], v[80:83], v[24:27]
ds_read_b128 v[80:83], v96 offset:45056
s_waitcnt lgkmcnt(7)
v_mfma_f32_16x16x32_bf16 v[20:23], a[144:147], v[84:87], v[20:23]
v_mfma_f32_16x16x32_bf16 v[28:31], a[148:151], v[84:87], v[28:31]
ds_read_b128 v[84:87], v96 offset:45312
s_waitcnt lgkmcnt(7)
v_mfma_f32_16x16x32_bf16 v[16:19], a[152:155], v[88:91], v[16:19]
v_mfma_f32_16x16x32_bf16 v[24:27], a[156:159], v[88:91], v[24:27]
ds_read_b128 v[88:91], v96 offset:47104
s_waitcnt lgkmcnt(7)
v_mfma_f32_16x16x32_bf16 v[20:23], a[152:155], v[92:95], v[20:23]
v_mfma_f32_16x16x32_bf16 v[28:31], a[156:159], v[92:95], v[28:31]
ds_read_b128 v[92:95], v96 offset:47360
s_waitcnt lgkmcnt(7)
v_mfma_f32_16x16x32_bf16 v[16:19], a[160:163], v[64:67], v[16:19]
v_mfma_f32_16x16x32_bf16 v[24:27], a[164:167], v[64:67], v[24:27]
s_waitcnt lgkmcnt(6)
v_mfma_f32_16x16x32_bf16 v[20:23], a[160:163], v[68:71], v[20:23]
v_mfma_f32_16x16x32_bf16 v[28:31], a[164:167], v[68:71], v[28:31]
s_waitcnt lgkmcnt(5)
v_mfma_f32_16x16x32_bf16 v[16:19], a[168:171], v[72:75], v[16:19]
v_mfma_f32_16x16x32_bf16 v[24:27], a[172:175], v[72:75], v[24:27]
s_waitcnt lgkmcnt(4)
v_mfma_f32_16x16x32_bf16 v[20:23], a[168:171], v[76:79], v[20:23]
v_mfma_f32_16x16x32_bf16 v[28:31], a[172:175], v[76:79], v[28:31]
s_waitcnt lgkmcnt(3)
v_mfma_f32_16x16x32_bf16 v[16:19], a[176:179], v[80:83], v[16:19]
v_mfma_f32_16x16x32_bf16 v[24:27], a[180:183], v[80:83], v[24:27]
s_waitcnt lgkmcnt(2)
v_mfma_f32_16x16x32_bf16 v[20:23], a[176:179], v[84:87], v[20:23]
v_mfma_f32_16x16x32_bf16 v[28:31], a[180:183], v[84:87], v[28:31]
s_waitcnt lgkmcnt(1)
v_mfma_f32_16x16x32_bf16 v[16:19], a[184:187], v[88:91], v[16:19]
v_mfma_f32_16x16x32_bf16 v[24:27], a[188:191], v[88:91], v[24:27]
s_waitcnt lgkmcnt(0)
v_mfma_f32_16x16x32_bf16 v[20:23], a[184:187], v[92:95], v[20:23]
v_mfma_f32_16x16x32_bf16 v[28:31], a[188:191], v[92:95], v[28:31]
s_add_u32 s83, s83, 1
s_cmp_gt_u32 s83, 50
s_cbranch_scc1 L_t5to_101
s_nop 0
s_nop 2
v_cmp_u_f32 vcc, v16, v20
s_cbranch_vccnz L_t5tr_100
L_t5to_101:
s_nop 0
buffer_store_dwordx4 v[16:19], v112, s[4:7], s79 offen offset:0 sc1
s_nop 1
buffer_store_dwordx4 v[20:23], v112, s[4:7], s79 offen offset:1024 sc1
buffer_store_dwordx4 v[24:27], v112, s[4:7], s79 offen offset:2048 sc1
buffer_store_dwordx4 v[28:31], v112, s[4:7], s79 offen offset:3072 sc1
s_add_u32 s77, s77, 1
s_add_u32 s78, s78, 393216
s_add_u32 s79, s79, 737280
s_add_u32 s82, s82, 737280
s_add_u32 s81, s81, 40960
s_add_u32 s80, s80, 1024
s_cmp_lt_u32 s77, 4
s_cbranch_scc1 L_t5t_97
s_cmp_eq_u32 s44, 0
s_cbranch_scc1 L_t5tw_111
s_sub_u32 s48, 3, s44
s_mul_i32 s49, s48, 737280
s_sub_u32 s82, s82, s49
s_mul_i32 s49, s48, 40960
s_sub_u32 s81, s81, s49
s_cmp_lg_u32 s44, 3
s_cbranch_scc1 L_t5ts_112
s_sleep 6
L_t5ts_112:
s_mov_b32 s53, 0
L_t5tg_109:
s_mov_b32 s48, s82
buffer_load_dwordx4 v[128:131], v116, s[4:7], s48 offen offset:0 sc1
buffer_load_dwordx4 v[132:135], v116, s[4:7], s48 offen offset:2048 sc1
s_add_u32 s48, s48, 16384
buffer_load_dwordx4 v[136:139], v116, s[4:7], s48 offen offset:0 sc1
buffer_load_dwordx4 v[140:143], v116, s[4:7], s48 offen offset:2048 sc1
s_add_u32 s48, s48, 16384
buffer_load_dwordx4 v[144:147], v116, s[4:7], s48 offen offset:0 sc1
buffer_load_dwordx4 v[148:151], v116, s[4:7], s48 offen offset:2048 sc1
s_add_u32 s48, s48, 16384
buffer_load_dwordx4 v[152:155], v116, s[4:7], s48 offen offset:0 sc1
buffer_load_dwordx4 v[156:159], v116, s[4:7], s48 offen offset:2048 sc1
s_add_u32 s48, s48, 16384
buffer_load_dwordx4 v[160:163], v116, s[4:7], s48 offen offset:0 sc1
buffer_load_dwordx4 v[164:167], v116, s[4:7], s48 offen offset:2048 sc1
s_add_u32 s48, s48, 16384
buffer_load_dwordx4 v[168:171], v116, s[4:7], s48 offen offset:0 sc1
buffer_load_dwordx4 v[172:175], v116, s[4:7], s48 offen offset:2048 sc1
s_add_u32 s48, s48, 16384
buffer_load_dwordx4 v[176:179], v116, s[4:7], s48 offen offset:0 sc1
buffer_load_dwordx4 v[180:183], v116, s[4:7], s48 offen offset:2048 sc1
s_add_u32 s48, s48, 16384
buffer_load_dwordx4 v[184:187], v116, s[4:7], s48 offen offset:0 sc1
buffer_load_dwordx4 v[188:191], v116, s[4:7], s48 offen offset:2048 sc1
s_add_u32 s48, s48, 16384
buffer_load_dwordx4 v[192:195], v116, s[4:7], s48 offen offset:0 sc1
buffer_load_dwordx4 v[196:199], v116, s[4:7], s48 offen offset:2048 sc1
s_add_u32 s53, s53, 1
s_cmp_gt_u32 s53, 100000
s_cbranch_scc1 L_t5tgx_110
s_waitcnt vmcnt(14)
v_pk_add_f32 v[128:129], v[128:129], v[136:137]
v_pk_add_f32 v[130:131], v[130:131], v[138:139]
v_pk_add_f32 v[132:133], v[132:133], v[140:141]
v_pk_add_f32 v[134:135], v[134:135], v[142:143]
s_waitcnt vmcnt(12)
v_pk_add_f32 v[128:129], v[128:129], v[144:145]
v_pk_add_f32 v[130:131], v[130:131], v[146:147]
v_pk_add_f32 v[132:133], v[132:133], v[148:149]
v_pk_add_f32 v[134:135], v[134:135], v[150:151]
s_waitcnt vmcnt(10)
v_pk_add_f32 v[128:129], v[128:129], v[152:153]
v_pk_add_f32 v[130:131], v[130:131], v[154:155]
v_pk_add_f32 v[132:133], v[132:133], v[156:157]
v_pk_add_f32 v[134:135], v[134:135], v[158:159]
s_waitcnt vmcnt(8)
v_pk_add_f32 v[128:129], v[128:129], v[160:161]
v_pk_add_f32 v[130:131], v[130:131], v[162:163]
v_pk_add_f32 v[132:133], v[132:133], v[164:165]
v_pk_add_f32 v[134:135], v[134:135], v[166:167]
s_waitcnt vmcnt(6)
v_pk_add_f32 v[128:129], v[128:129], v[168:169]
v_pk_add_f32 v[130:131], v[130:131], v[170:171]
v_pk_add_f32 v[132:133], v[132:133], v[172:173]
v_pk_add_f32 v[134:135], v[134:135], v[174:175]
s_waitcnt vmcnt(4)
v_pk_add_f32 v[128:129], v[128:129], v[176:177]
v_pk_add_f32 v[130:131], v[130:131], v[178:179]
v_pk_add_f32 v[132:133], v[132:133], v[180:181]
v_pk_add_f32 v[134:135], v[134:135], v[182:183]
s_waitcnt vmcnt(2)
v_pk_add_f32 v[128:129], v[128:129], v[184:185]
v_pk_add_f32 v[130:131], v[130:131], v[186:187]
v_pk_add_f32 v[132:133], v[132:133], v[188:189]
v_pk_add_f32 v[134:135], v[134:135], v[190:191]
s_waitcnt vmcnt(0)
v_pk_add_f32 v[128:129], v[128:129], v[192:193]
v_pk_add_f32 v[130:131], v[130:131], v[194:195]
v_pk_add_f32 v[132:133], v[132:133], v[196:197]
v_pk_add_f32 v[134:135], v[134:135], v[198:199]
v_cmp_u_f32 vcc, v128, v129
v_cmp_u_f32 s[86:87], v130, v131
v_cmp_u_f32 s[88:89], v132, v133
v_cmp_u_f32 s[90:91], v134, v135
s_or_b64 vcc, vcc, s[86:87]
s_or_b64 vcc, vcc, s[88:89]
s_or_b64 vcc, vcc, s[90:91]
s_cbranch_vccnz L_t5tg_109
L_t5tgx_110:
s_waitcnt vmcnt(0)
v_cvt_pk_bf16_f32 v136, v128, v129
v_cvt_pk_bf16_f32 v137, v130, v131
v_cvt_pk_bf16_f32 v138, v132, v133
v_cvt_pk_bf16_f32 v139, v134, v135
buffer_store_dwordx4 v[136:139], v115, s[12:15], s81 offen
L_t5tw_111:
s_branch L_exit
L_t4t:
s_sub_u32 s51, s45, 80
s_lshl_b32 s48, s51, 2
s_add_u32 s48, s48, s44
s_and_b32 s55, s48, 24
s_lshr_b32 s49, s48, 5
s_add_u32 s49, s49, 54
s_lshl_b32 s49, s49, 3
s_and_b32 s48, s48, 7
s_add_u32 s54, s49, s48
s_mov_b32 s82, 512
s_mov_b32 s87, 0
s_mov_b32 s84, 16
s_mov_b32 s85, 464
s_mov_b32 s86, 480
s_branch L_t4_entry
L_gc:
s_sub_u32 s79, s45, 128
s_lshr_b32 s51, s79, 3
s_and_b32 s52, s79, 7
s_cmp_ge_u32 s52, 5
s_cbranch_scc1 L_c4_113
s_waitcnt vmcnt(0)
s_barrier
s_cmp_lg_u32 s44, 0
s_cbranch_scc1 L_da_116
v_mov_b32 v2, 32
v_mov_b32 v3, 1
s_mov_b64 exec, 1
global_atomic_add v2, v3, s[40:41] sc1
s_mov_b64 exec, -1
L_da_116:
s_mov_b32 s76, s51
s_mov_b32 s77, s52
s_mov_b32 s8, s26
s_mov_b32 s9, s27
s_mov_b32 s10, 7864320
s_mov_b32 s11, 0x20000
v_mov_b32 v122, 32
s_cmp_lg_u32 s44, 0
s_cbranch_scc1 L_pdx_118
s_mov_b32 s53, 0
L_pd_117:
global_load_dword v123, v122, s[40:41] sc1
s_add_u32 s53, s53, 1
s_cmp_gt_u32 s53, 100000
s_cbranch_scc1 L_pdx_118
s_waitcnt vmcnt(0)
v_readfirstlane_b32 s48, v123
s_cmp_ge_u32 s48, 64
s_cbranch_scc1 L_pdx_118
s_sleep 16
s_branch L_pd_117
L_pdx_118:
s_waitcnt vmcnt(0)
s_barrier
s_and_b32 s48, s45, 63
s_lshl_b32 s48, s48, 7
s_add_u32 s48, s48, 0
v_mov_b32 v122, s48
s_cmp_lg_u32 s44, 0
s_cbranch_scc1 L_pdx_120
s_mov_b32 s53, 0
L_pd_119:
buffer_load_dword v123, v122, s[4:7], 0 offen sc1
s_add_u32 s53, s53, 1
s_cmp_gt_u32 s53, 100000
s_cbranch_scc1 L_pdx_120
s_waitcnt vmcnt(0)
v_readfirstlane_b32 s48, v123
s_cmp_ge_u32 s48, 2
s_cbranch_scc1 L_pdx_120
s_sleep 16
s_branch L_pd_119
L_pdx_120:
s_waitcnt vmcnt(0)
s_barrier
v_lshrrev_b32 v122, 4, v1
v_mul_u32_u24 v122, 1280, v122
v_and_b32 v112, 15, v1
v_lshl_add_u32 v112, v112, 4, v122
s_mul_i32 s62, s76, 1966080
s_mul_i32 s48, s44, 5120
s_add_u32 s62, s62, s48
s_lshl_b32 s48, s77, 8
s_add_u32 s62, s62, s48
v_lshrrev_b32 v122, 5, v1
v_lshlrev_b32 v122, 3, v122
v_bfe_u32 v123, v1, 2, 2
v_add_u32 v122, v122, v123
v_lshlrev_b32 v122, 8, v122
v_bfe_u32 v123, v1, 4, 1
v_lshl_add_u32 v122, v123, 5, v122
v_and_b32 v123, 3, v1
v_lshl_add_u32 v122, v123, 3, v122
s_lshl_b32 s48, s44, 6
v_add_u32 v113, s48, v122
s_mul_i32 s50, s44, 2048
s_add_u32 m0, s50, 0
s_add_u32 s49, s62, 0
buffer_load_dwordx4 v112, s[8:11], s49 offen nt lds
s_mul_i32 s50, s44, 2048
s_add_u32 m0, s50, 1024
s_add_u32 s49, s62, 20480
buffer_load_dwordx4 v112, s[8:11], s49 offen nt lds
s_mul_i32 s50, s44, 2048
s_add_u32 m0, s50, 8192
s_add_u32 s49, s62, 40960
buffer_load_dwordx4 v112, s[8:11], s49 offen nt lds
s_mul_i32 s50, s44, 2048
s_add_u32 m0, s50, 9216
s_add_u32 s49, s62, 61440
buffer_load_dwordx4 v112, s[8:11], s49 offen nt lds
s_mul_i32 s50, s44, 2048
s_add_u32 m0, s50, 16384
s_add_u32 s49, s62, 81920
buffer_load_dwordx4 v112, s[8:11], s49 offen nt lds
s_mul_i32 s50, s44, 2048
s_add_u32 m0, s50, 17408
s_add_u32 s49, s62, 102400
buffer_load_dwordx4 v112, s[8:11], s49 offen nt lds
s_mul_i32 s50, s44, 2048
s_add_u32 m0, s50, 24576
s_add_u32 s49, s62, 122880
buffer_load_dwordx4 v112, s[8:11], s49 offen nt lds
s_mul_i32 s50, s44, 2048
s_add_u32 m0, s50, 25600
s_add_u32 s49, s62, 143360
buffer_load_dwordx4 v112, s[8:11], s49 offen nt lds
s_mul_i32 s50, s44, 2048
s_add_u32 m0, s50, 32768
s_add_u32 s49, s62, 163840
buffer_load_dwordx4 v112, s[8:11], s49 offen nt lds
s_mul_i32 s50, s44, 2048
s_add_u32 m0, s50, 33792
s_add_u32 s49, s62, 184320
buffer_load_dwordx4 v112, s[8:11], s49 offen nt lds
s_waitcnt vmcnt(8) lgkmcnt(0)
s_barrier
s_mul_i32 s50, s44, 2048
s_add_u32 m0, s50, 40960
s_add_u32 s49, s62, 204800
buffer_load_dwordx4 v112, s[8:11], s49 offen nt lds
s_mul_i32 s50, s44, 2048
s_add_u32 m0, s50, 41984
s_add_u32 s49, s62, 225280
buffer_load_dwordx4 v112, s[8:11], s49 offen nt lds
ds_read_b64_tr_b16 a[0:1], v113 offset:0
ds_read_b64_tr_b16 a[2:3], v113 offset:1024
ds_read_b64_tr_b16 a[4:5], v113 offset:4096
ds_read_b64_tr_b16 a[6:7], v113 offset:5120
s_waitcnt vmcnt(8) lgkmcnt(0)
s_barrier
s_mul_i32 s50, s44, 2048
s_add_u32 m0, s50, 0
s_add_u32 s49, s62, 245760
buffer_load_dwordx4 v112, s[8:11], s49 offen nt lds
s_mul_i32 s50, s44, 2048
s_add_u32 m0, s50, 1024
s_add_u32 s49, s62, 266240
buffer_load_dwordx4 v112, s[8:11], s49 offen nt lds
ds_read_b64_tr_b16 a[8:9], v113 offset:8192
ds_read_b64_tr_b16 a[10:11], v113 offset:9216
ds_read_b64_tr_b16 a[12:13], v113 offset:12288
ds_read_b64_tr_b16 a[14:15], v113 offset:13312
s_waitcnt vmcnt(8) lgkmcnt(0)
s_barrier
s_mul_i32 s50, s44, 2048
s_add_u32 m0, s50, 8192
s_add_u32 s49, s62, 286720
buffer_load_dwordx4 v112, s[8:11], s49 offen nt lds
s_mul_i32 s50, s44, 2048
s_add_u32 m0, s50, 9216
s_add_u32 s49, s62, 307200
buffer_load_dwordx4 v112, s[8:11], s49 offen nt lds
ds_read_b64_tr_b16 a[16:17], v113 offset:16384
ds_read_b64_tr_b16 a[18:19], v113 offset:17408
ds_read_b64_tr_b16 a[20:21], v113 offset:20480
ds_read_b64_tr_b16 a[22:23], v113 offset:21504
s_waitcnt vmcnt(8) lgkmcnt(0)
s_barrier
s_mul_i32 s50, s44, 2048
s_add_u32 m0, s50, 16384
s_add_u32 s49, s62, 327680
buffer_load_dwordx4 v112, s[8:11], s49 offen nt lds
s_mul_i32 s50, s44, 2048
s_add_u32 m0, s50, 17408
s_add_u32 s49, s62, 348160
buffer_load_dwordx4 v112, s[8:11], s49 offen nt lds
ds_read_b64_tr_b16 a[24:25], v113 offset:24576
ds_read_b64_tr_b16 a[26:27], v113 offset:25600
ds_read_b64_tr_b16 a[28:29], v113 offset:28672
ds_read_b64_tr_b16 a[30:31], v113 offset:29696
s_waitcnt vmcnt(8) lgkmcnt(0)
s_barrier
s_mul_i32 s50, s44, 2048
s_add_u32 m0, s50, 24576
s_add_u32 s49, s62, 368640
buffer_load_dwordx4 v112, s[8:11], s49 offen nt lds
s_mul_i32 s50, s44, 2048
s_add_u32 m0, s50, 25600
s_add_u32 s49, s62, 389120
buffer_load_dwordx4 v112, s[8:11], s49 offen nt lds
ds_read_b64_tr_b16 a[32:33], v113 offset:32768
ds_read_b64_tr_b16 a[34:35], v113 offset:33792
ds_read_b64_tr_b16 a[36:37], v113 offset:36864
ds_read_b64_tr_b16 a[38:39], v113 offset:37888
s_waitcnt vmcnt(8) lgkmcnt(0)
s_barrier
s_mul_i32 s50, s44, 2048
s_add_u32 m0, s50, 32768
s_add_u32 s49, s62, 409600
buffer_load_dwordx4 v112, s[8:11], s49 offen nt lds
s_mul_i32 s50, s44, 2048
s_add_u32 m0, s50, 33792
s_add_u32 s49, s62, 430080
buffer_load_dwordx4 v112, s[8:11], s49 offen nt lds
ds_read_b64_tr_b16 a[40:41], v113 offset:40960
ds_read_b64_tr_b16 a[42:43], v113 offset:41984
ds_read_b64_tr_b16 a[44:45], v113 offset:45056
ds_read_b64_tr_b16 a[46:47], v113 offset:46080
s_waitcnt vmcnt(8) lgkmcnt(0)
s_barrier
s_mul_i32 s50, s44, 2048
s_add_u32 m0, s50, 40960
s_add_u32 s49, s62, 450560
buffer_load_dwordx4 v112, s[8:11], s49 offen nt lds
s_mul_i32 s50, s44, 2048
s_add_u32 m0, s50, 41984
s_add_u32 s49, s62, 471040
buffer_load_dwordx4 v112, s[8:11], s49 offen nt lds
ds_read_b64_tr_b16 a[48:49], v113 offset:0
ds_read_b64_tr_b16 a[50:51], v113 offset:1024
ds_read_b64_tr_b16 a[52:53], v113 offset:4096
ds_read_b64_tr_b16 a[54:55], v113 offset:5120
s_waitcnt vmcnt(8) lgkmcnt(0)
s_barrier
s_mul_i32 s50, s44, 2048
s_add_u32 m0, s50, 0
s_add_u32 s49, s62, 491520
buffer_load_dwordx4 v112, s[8:11], s49 offen nt lds
s_mul_i32 s50, s44, 2048
s_add_u32 m0, s50, 1024
s_add_u32 s49, s62, 512000
buffer_load_dwordx4 v112, s[8:11], s49 offen nt lds
ds_read_b64_tr_b16 a[56:57], v113 offset:8192
ds_read_b64_tr_b16 a[58:59], v113 offset:9216
ds_read_b64_tr_b16 a[60:61], v113 offset:12288
ds_read_b64_tr_b16 a[62:63], v113 offset:13312
s_waitcnt vmcnt(8) lgkmcnt(0)
s_barrier
s_mul_i32 s50, s44, 2048
s_add_u32 m0, s50, 8192
s_add_u32 s49, s62, 532480
buffer_load_dwordx4 v112, s[8:11], s49 offen nt lds
s_mul_i32 s50, s44, 2048
s_add_u32 m0, s50, 9216
s_add_u32 s49, s62, 552960
buffer_load_dwordx4 v112, s[8:11], s49 offen nt lds
ds_read_b64_tr_b16 a[64:65], v113 offset:16384
ds_read_b64_tr_b16 a[66:67], v113 offset:17408
ds_read_b64_tr_b16 a[68:69], v113 offset:20480
ds_read_b64_tr_b16 a[70:71], v113 offset:21504
s_waitcnt vmcnt(8) lgkmcnt(0)
s_barrier
s_mul_i32 s50, s44, 2048
s_add_u32 m0, s50, 16384
s_add_u32 s49, s62, 573440
buffer_load_dwordx4 v112, s[8:11], s49 offen nt lds
s_mul_i32 s50, s44, 2048
s_add_u32 m0, s50, 17408
s_add_u32 s49, s62, 593920
buffer_load_dwordx4 v112, s[8:11], s49 offen nt lds
ds_read_b64_tr_b16 a[72:73], v113 offset:24576
ds_read_b64_tr_b16 a[74:75], v113 offset:25600
ds_read_b64_tr_b16 a[76:77], v113 offset:28672
ds_read_b64_tr_b16 a[78:79], v113 offset:29696
s_waitcnt vmcnt(8) lgkmcnt(0)
s_barrier
s_mul_i32 s50, s44, 2048
s_add_u32 m0, s50, 24576
s_add_u32 s49, s62, 614400
buffer_load_dwordx4 v112, s[8:11], s49 offen nt lds
s_mul_i32 s50, s44, 2048
s_add_u32 m0, s50, 25600
s_add_u32 s49, s62, 634880
buffer_load_dwordx4 v112, s[8:11], s49 offen nt lds
ds_read_b64_tr_b16 a[80:81], v113 offset:32768
ds_read_b64_tr_b16 a[82:83], v113 offset:33792
ds_read_b64_tr_b16 a[84:85], v113 offset:36864
ds_read_b64_tr_b16 a[86:87], v113 offset:37888
s_waitcnt vmcnt(8) lgkmcnt(0)
s_barrier
s_mul_i32 s50, s44, 2048
s_add_u32 m0, s50, 32768
s_add_u32 s49, s62, 655360
buffer_load_dwordx4 v112, s[8:11], s49 offen nt lds
s_mul_i32 s50, s44, 2048
s_add_u32 m0, s50, 33792
s_add_u32 s49, s62, 675840
buffer_load_dwordx4 v112, s[8:11], s49 offen nt lds
ds_read_b64_tr_b16 a[88:89], v113 offset:40960
ds_read_b64_tr_b16 a[90:91], v113 offset:41984
ds_read_b64_tr_b16 a[92:93], v113 offset:45056
ds_read_b64_tr_b16 a[94:95], v113 offset:46080
s_waitcnt vmcnt(8) lgkmcnt(0)
s_barrier
s_mul_i32 s50, s44, 2048
s_add_u32 m0, s50, 40960
s_add_u32 s49, s62, 696320
buffer_load_dwordx4 v112, s[8:11], s49 offen nt lds
s_mul_i32 s50, s44, 2048
s_add_u32 m0, s50, 41984
s_add_u32 s49, s62, 716800
buffer_load_dwordx4 v112, s[8:11], s49 offen nt lds
ds_read_b64_tr_b16 a[96:97], v113 offset:0
ds_read_b64_tr_b16 a[98:99], v113 offset:1024
ds_read_b64_tr_b16 a[100:101], v113 offset:4096
ds_read_b64_tr_b16 a[102:103], v113 offset:5120
s_waitcnt vmcnt(8) lgkmcnt(0)
s_barrier
s_mul_i32 s50, s44, 2048
s_add_u32 m0, s50, 0
s_add_u32 s49, s62, 737280
buffer_load_dwordx4 v112, s[8:11], s49 offen nt lds
s_mul_i32 s50, s44, 2048
s_add_u32 m0, s50, 1024
s_add_u32 s49, s62, 757760
buffer_load_dwordx4 v112, s[8:11], s49 offen nt lds
ds_read_b64_tr_b16 a[104:105], v113 offset:8192
ds_read_b64_tr_b16 a[106:107], v113 offset:9216
ds_read_b64_tr_b16 a[108:109], v113 offset:12288
ds_read_b64_tr_b16 a[110:111], v113 offset:13312
s_waitcnt vmcnt(8) lgkmcnt(0)
s_barrier
s_mul_i32 s50, s44, 2048
s_add_u32 m0, s50, 8192
s_add_u32 s49, s62, 778240
buffer_load_dwordx4 v112, s[8:11], s49 offen nt lds
s_mul_i32 s50, s44, 2048
s_add_u32 m0, s50, 9216
s_add_u32 s49, s62, 798720
buffer_load_dwordx4 v112, s[8:11], s49 offen nt lds
ds_read_b64_tr_b16 a[112:113], v113 offset:16384
ds_read_b64_tr_b16 a[114:115], v113 offset:17408
ds_read_b64_tr_b16 a[116:117], v113 offset:20480
ds_read_b64_tr_b16 a[118:119], v113 offset:21504
s_waitcnt vmcnt(8) lgkmcnt(0)
s_barrier
s_mul_i32 s50, s44, 2048
s_add_u32 m0, s50, 16384
s_add_u32 s49, s62, 819200
buffer_load_dwordx4 v112, s[8:11], s49 offen nt lds
s_mul_i32 s50, s44, 2048
s_add_u32 m0, s50, 17408
s_add_u32 s49, s62, 839680
buffer_load_dwordx4 v112, s[8:11], s49 offen nt lds
ds_read_b64_tr_b16 a[120:121], v113 offset:24576
ds_read_b64_tr_b16 a[122:123], v113 offset:25600
ds_read_b64_tr_b16 a[124:125], v113 offset:28672
ds_read_b64_tr_b16 a[126:127], v113 offset:29696
s_waitcnt vmcnt(8) lgkmcnt(0)
s_barrier
s_mul_i32 s50, s44, 2048
s_add_u32 m0, s50, 24576
s_add_u32 s49, s62, 860160
buffer_load_dwordx4 v112, s[8:11], s49 offen nt lds
s_mul_i32 s50, s44, 2048
s_add_u32 m0, s50, 25600
s_add_u32 s49, s62, 880640
buffer_load_dwordx4 v112, s[8:11], s49 offen nt lds
ds_read_b64_tr_b16 a[128:129], v113 offset:32768
ds_read_b64_tr_b16 a[130:131], v113 offset:33792
ds_read_b64_tr_b16 a[132:133], v113 offset:36864
ds_read_b64_tr_b16 a[134:135], v113 offset:37888
s_waitcnt vmcnt(8) lgkmcnt(0)
s_barrier
s_mul_i32 s50, s44, 2048
s_add_u32 m0, s50, 32768
s_add_u32 s49, s62, 901120
buffer_load_dwordx4 v112, s[8:11], s49 offen nt lds
s_mul_i32 s50, s44, 2048
s_add_u32 m0, s50, 33792
s_add_u32 s49, s62, 921600
buffer_load_dwordx4 v112, s[8:11], s49 offen nt lds
ds_read_b64_tr_b16 a[136:137], v113 offset:40960
ds_read_b64_tr_b16 a[138:139], v113 offset:41984
ds_read_b64_tr_b16 a[140:141], v113 offset:45056
ds_read_b64_tr_b16 a[142:143], v113 offset:46080
s_waitcnt vmcnt(8) lgkmcnt(0)
s_barrier
s_mul_i32 s50, s44, 2048
s_add_u32 m0, s50, 40960
s_add_u32 s49, s62, 942080
buffer_load_dwordx4 v112, s[8:11], s49 offen nt lds
s_mul_i32 s50, s44, 2048
s_add_u32 m0, s50, 41984
s_add_u32 s49, s62, 962560
buffer_load_dwordx4 v112, s[8:11], s49 offen nt lds
ds_read_b64_tr_b16 a[144:145], v113 offset:0
ds_read_b64_tr_b16 a[146:147], v113 offset:1024
ds_read_b64_tr_b16 a[148:149], v113 offset:4096
ds_read_b64_tr_b16 a[150:151], v113 offset:5120
s_waitcnt vmcnt(8) lgkmcnt(0)
s_barrier
s_mul_i32 s50, s44, 2048
s_add_u32 m0, s50, 0
s_add_u32 s49, s62, 983040
buffer_load_dwordx4 v112, s[8:11], s49 offen nt lds
s_mul_i32 s50, s44, 2048
s_add_u32 m0, s50, 1024
s_add_u32 s49, s62, 1003520
buffer_load_dwordx4 v112, s[8:11], s49 offen nt lds
ds_read_b64_tr_b16 a[152:153], v113 offset:8192
ds_read_b64_tr_b16 a[154:155], v113 offset:9216
ds_read_b64_tr_b16 a[156:157], v113 offset:12288
ds_read_b64_tr_b16 a[158:159], v113 offset:13312
s_waitcnt vmcnt(8) lgkmcnt(0)
s_barrier
s_mul_i32 s50, s44, 2048
s_add_u32 m0, s50, 8192
s_add_u32 s49, s62, 1024000
buffer_load_dwordx4 v112, s[8:11], s49 offen nt lds
s_mul_i32 s50, s44, 2048
s_add_u32 m0, s50, 9216
s_add_u32 s49, s62, 1044480
buffer_load_dwordx4 v112, s[8:11], s49 offen nt lds
ds_read_b64_tr_b16 a[160:161], v113 offset:16384
ds_read_b64_tr_b16 a[162:163], v113 offset:17408
ds_read_b64_tr_b16 a[164:165], v113 offset:20480
ds_read_b64_tr_b16 a[166:167], v113 offset:21504
s_waitcnt vmcnt(8) lgkmcnt(0)
s_barrier
s_mul_i32 s50, s44, 2048
s_add_u32 m0, s50, 16384
s_add_u32 s49, s62, 1064960
buffer_load_dwordx4 v112, s[8:11], s49 offen nt lds
s_mul_i32 s50, s44, 2048
s_add_u32 m0, s50, 17408
s_add_u32 s49, s62, 1085440
buffer_load_dwordx4 v112, s[8:11], s49 offen nt lds
ds_read_b64_tr_b16 a[168:169], v113 offset:24576
ds_read_b64_tr_b16 a[170:171], v113 offset:25600
ds_read_b64_tr_b16 a[172:173], v113 offset:28672
ds_read_b64_tr_b16 a[174:175], v113 offset:29696
s_waitcnt vmcnt(8) lgkmcnt(0)
s_barrier
s_mul_i32 s50, s44, 2048
s_add_u32 m0, s50, 24576
s_add_u32 s49, s62, 1105920
buffer_load_dwordx4 v112, s[8:11], s49 offen nt lds
s_mul_i32 s50, s44, 2048
s_add_u32 m0, s50, 25600
s_add_u32 s49, s62, 1126400
buffer_load_dwordx4 v112, s[8:11], s49 offen nt lds
ds_read_b64_tr_b16 a[176:177], v113 offset:32768
ds_read_b64_tr_b16 a[178:179], v113 offset:33792
ds_read_b64_tr_b16 a[180:181], v113 offset:36864
ds_read_b64_tr_b16 a[182:183], v113 offset:37888
s_waitcnt vmcnt(8) lgkmcnt(0)
s_barrier
s_mul_i32 s50, s44, 2048
s_add_u32 m0, s50, 32768
s_add_u32 s49, s62, 1146880
buffer_load_dwordx4 v112, s[8:11], s49 offen nt lds
s_mul_i32 s50, s44, 2048
s_add_u32 m0, s50, 33792
s_add_u32 s49, s62, 1167360
buffer_load_dwordx4 v112, s[8:11], s49 offen nt lds
ds_read_b64_tr_b16 a[184:185], v113 offset:40960
ds_read_b64_tr_b16 a[186:187], v113 offset:41984
ds_read_b64_tr_b16 a[188:189], v113 offset:45056
ds_read_b64_tr_b16 a[190:191], v113 offset:46080
s_waitcnt vmcnt(8) lgkmcnt(0)
s_barrier
s_mul_i32 s50, s44, 2048
s_add_u32 m0, s50, 40960
s_add_u32 s49, s62, 1187840
buffer_load_dwordx4 v112, s[8:11], s49 offen nt lds
s_mul_i32 s50, s44, 2048
s_add_u32 m0, s50, 41984
s_add_u32 s49, s62, 1208320
buffer_load_dwordx4 v112, s[8:11], s49 offen nt lds
ds_read_b64_tr_b16 a[192:193], v113 offset:0
ds_read_b64_tr_b16 a[194:195], v113 offset:1024
ds_read_b64_tr_b16 a[196:197], v113 offset:4096
ds_read_b64_tr_b16 a[198:199], v113 offset:5120
s_waitcnt vmcnt(8) lgkmcnt(0)
s_barrier
s_mul_i32 s50, s44, 2048
s_add_u32 m0, s50, 0
s_add_u32 s49, s62, 1228800
buffer_load_dwordx4 v112, s[8:11], s49 offen nt lds
s_mul_i32 s50, s44, 2048
s_add_u32 m0, s50, 1024
s_add_u32 s49, s62, 1249280
buffer_load_dwordx4 v112, s[8:11], s49 offen nt lds
ds_read_b64_tr_b16 a[200:201], v113 offset:8192
ds_read_b64_tr_b16 a[202:203], v113 offset:9216
ds_read_b64_tr_b16 a[204:205], v113 offset:12288
ds_read_b64_tr_b16 a[206:207], v113 offset:13312
s_waitcnt vmcnt(8) lgkmcnt(0)
s_barrier
s_mul_i32 s50, s44, 2048
s_add_u32 m0, s50, 8192
s_add_u32 s49, s62, 1269760
buffer_load_dwordx4 v112, s[8:11], s49 offen nt lds
s_mul_i32 s50, s44, 2048
s_add_u32 m0, s50, 9216
s_add_u32 s49, s62, 1290240
buffer_load_dwordx4 v112, s[8:11], s49 offen nt lds
ds_read_b64_tr_b16 a[208:209], v113 offset:16384
ds_read_b64_tr_b16 a[210:211], v113 offset:17408
ds_read_b64_tr_b16 a[212:213], v113 offset:20480
ds_read_b64_tr_b16 a[214:215], v113 offset:21504
s_waitcnt vmcnt(8) lgkmcnt(0)
s_barrier
s_mul_i32 s50, s44, 2048
s_add_u32 m0, s50, 16384
s_add_u32 s49, s62, 1310720
buffer_load_dwordx4 v112, s[8:11], s49 offen nt lds
s_mul_i32 s50, s44, 2048
s_add_u32 m0, s50, 17408
s_add_u32 s49, s62, 1331200
buffer_load_dwordx4 v112, s[8:11], s49 offen nt lds
ds_read_b64_tr_b16 a[216:217], v113 offset:24576
ds_read_b64_tr_b16 a[218:219], v113 offset:25600
ds_read_b64_tr_b16 a[220:221], v113 offset:28672
ds_read_b64_tr_b16 a[222:223], v113 offset:29696
s_waitcnt vmcnt(8) lgkmcnt(0)
s_barrier
s_mul_i32 s50, s44, 2048
s_add_u32 m0, s50, 24576
s_add_u32 s49, s62, 1351680
buffer_load_dwordx4 v112, s[8:11], s49 offen nt lds
s_mul_i32 s50, s44, 2048
s_add_u32 m0, s50, 25600
s_add_u32 s49, s62, 1372160
buffer_load_dwordx4 v112, s[8:11], s49 offen nt lds
ds_read_b64_tr_b16 a[224:225], v113 offset:32768
ds_read_b64_tr_b16 a[226:227], v113 offset:33792
ds_read_b64_tr_b16 a[228:229], v113 offset:36864
ds_read_b64_tr_b16 a[230:231], v113 offset:37888
s_waitcnt vmcnt(8) lgkmcnt(0)
s_barrier
s_mul_i32 s50, s44, 2048
s_add_u32 m0, s50, 32768
s_add_u32 s49, s62, 1392640
buffer_load_dwordx4 v112, s[8:11], s49 offen nt lds
s_mul_i32 s50, s44, 2048
s_add_u32 m0, s50, 33792
s_add_u32 s49, s62, 1413120
buffer_load_dwordx4 v112, s[8:11], s49 offen nt lds
ds_read_b64_tr_b16 a[232:233], v113 offset:40960
ds_read_b64_tr_b16 a[234:235], v113 offset:41984
ds_read_b64_tr_b16 a[236:237], v113 offset:45056
ds_read_b64_tr_b16 a[238:239], v113 offset:46080
s_waitcnt vmcnt(8) lgkmcnt(0)
s_barrier
s_mul_i32 s50, s44, 2048
s_add_u32 m0, s50, 40960
s_add_u32 s49, s62, 1433600
buffer_load_dwordx4 v112, s[8:11], s49 offen nt lds
s_mul_i32 s50, s44, 2048
s_add_u32 m0, s50, 41984
s_add_u32 s49, s62, 1454080
buffer_load_dwordx4 v112, s[8:11], s49 offen nt lds
ds_read_b64_tr_b16 a[240:241], v113 offset:0
ds_read_b64_tr_b16 a[242:243], v113 offset:1024
ds_read_b64_tr_b16 a[244:245], v113 offset:4096
ds_read_b64_tr_b16 a[246:247], v113 offset:5120
s_waitcnt vmcnt(8) lgkmcnt(0)
s_barrier
s_mul_i32 s50, s44, 2048
s_add_u32 m0, s50, 0
s_add_u32 s49, s62, 1474560
buffer_load_dwordx4 v112, s[8:11], s49 offen nt lds
s_mul_i32 s50, s44, 2048
s_add_u32 m0, s50, 1024
s_add_u32 s49, s62, 1495040
buffer_load_dwordx4 v112, s[8:11], s49 offen nt lds
ds_read_b64_tr_b16 a[248:249], v113 offset:8192
ds_read_b64_tr_b16 a[250:251], v113 offset:9216
ds_read_b64_tr_b16 a[252:253], v113 offset:12288
ds_read_b64_tr_b16 a[254:255], v113 offset:13312
s_waitcnt vmcnt(8) lgkmcnt(0)
s_barrier
s_mul_i32 s50, s44, 2048
s_add_u32 m0, s50, 8192
s_add_u32 s49, s62, 1515520
buffer_load_dwordx4 v112, s[8:11], s49 offen nt lds
s_mul_i32 s50, s44, 2048
s_add_u32 m0, s50, 9216
s_add_u32 s49, s62, 1536000
buffer_load_dwordx4 v112, s[8:11], s49 offen nt lds
ds_read_b64_tr_b16 v[128:129], v113 offset:16384
ds_read_b64_tr_b16 v[130:131], v113 offset:17408
ds_read_b64_tr_b16 v[132:133], v113 offset:20480
ds_read_b64_tr_b16 v[134:135], v113 offset:21504
s_waitcnt vmcnt(8) lgkmcnt(0)
s_barrier
s_mul_i32 s50, s44, 2048
s_add_u32 m0, s50, 16384
s_add_u32 s49, s62, 1556480
buffer_load_dwordx4 v112, s[8:11], s49 offen nt lds
s_mul_i32 s50, s44, 2048
s_add_u32 m0, s50, 17408
s_add_u32 s49, s62, 1576960
buffer_load_dwordx4 v112, s[8:11], s49 offen nt lds
ds_read_b64_tr_b16 v[136:137], v113 offset:24576
ds_read_b64_tr_b16 v[138:139], v113 offset:25600
ds_read_b64_tr_b16 v[140:141], v113 offset:28672
ds_read_b64_tr_b16 v[142:143], v113 offset:29696
s_waitcnt vmcnt(8) lgkmcnt(0)
s_barrier
s_mul_i32 s50, s44, 2048
s_add_u32 m0, s50, 24576
s_add_u32 s49, s62, 1597440
buffer_load_dwordx4 v112, s[8:11], s49 offen nt lds
s_mul_i32 s50, s44, 2048
s_add_u32 m0, s50, 25600
s_add_u32 s49, s62, 1617920
buffer_load_dwordx4 v112, s[8:11], s49 offen nt lds
ds_read_b64_tr_b16 v[144:145], v113 offset:32768
ds_read_b64_tr_b16 v[146:147], v113 offset:33792
ds_read_b64_tr_b16 v[148:149], v113 offset:36864
ds_read_b64_tr_b16 v[150:151], v113 offset:37888
s_waitcnt vmcnt(8) lgkmcnt(0)
s_barrier
s_mul_i32 s50, s44, 2048
s_add_u32 m0, s50, 32768
s_add_u32 s49, s62, 1638400
buffer_load_dwordx4 v112, s[8:11], s49 offen nt lds
s_mul_i32 s50, s44, 2048
s_add_u32 m0, s50, 33792
s_add_u32 s49, s62, 1658880
buffer_load_dwordx4 v112, s[8:11], s49 offen nt lds
ds_read_b64_tr_b16 v[152:153], v113 offset:40960
ds_read_b64_tr_b16 v[154:155], v113 offset:41984
ds_read_b64_tr_b16 v[156:157], v113 offset:45056
ds_read_b64_tr_b16 v[158:159], v113 offset:46080
s_waitcnt vmcnt(8) lgkmcnt(0)
s_barrier
s_mul_i32 s50, s44, 2048
s_add_u32 m0, s50, 40960
s_add_u32 s49, s62, 1679360
buffer_load_dwordx4 v112, s[8:11], s49 offen nt lds
s_mul_i32 s50, s44, 2048
s_add_u32 m0, s50, 41984
s_add_u32 s49, s62, 1699840
buffer_load_dwordx4 v112, s[8:11], s49 offen nt lds
ds_read_b64_tr_b16 v[160:161], v113 offset:0
ds_read_b64_tr_b16 v[162:163], v113 offset:1024
ds_read_b64_tr_b16 v[164:165], v113 offset:4096
ds_read_b64_tr_b16 v[166:167], v113 offset:5120
s_waitcnt vmcnt(8) lgkmcnt(0)
s_barrier
s_mul_i32 s50, s44, 2048
s_add_u32 m0, s50, 0
s_add_u32 s49, s62, 1720320
buffer_load_dwordx4 v112, s[8:11], s49 offen nt lds
s_mul_i32 s50, s44, 2048
s_add_u32 m0, s50, 1024
s_add_u32 s49, s62, 1740800
buffer_load_dwordx4 v112, s[8:11], s49 offen nt lds
ds_read_b64_tr_b16 v[168:169], v113 offset:8192
ds_read_b64_tr_b16 v[170:171], v113 offset:9216
ds_read_b64_tr_b16 v[172:173], v113 offset:12288
ds_read_b64_tr_b16 v[174:175], v113 offset:13312
s_waitcnt vmcnt(8) lgkmcnt(0)
s_barrier
s_mul_i32 s50, s44, 2048
s_add_u32 m0, s50, 8192
s_add_u32 s49, s62, 1761280
buffer_load_dwordx4 v112, s[8:11], s49 offen nt lds
s_mul_i32 s50, s44, 2048
s_add_u32 m0, s50, 9216
s_add_u32 s49, s62, 1781760
buffer_load_dwordx4 v112, s[8:11], s49 offen nt lds
ds_read_b64_tr_b16 v[176:177], v113 offset:16384
ds_read_b64_tr_b16 v[178:179], v113 offset:17408
ds_read_b64_tr_b16 v[180:181], v113 offset:20480
ds_read_b64_tr_b16 v[182:183], v113 offset:21504
s_waitcnt vmcnt(8) lgkmcnt(0)
s_barrier
s_mul_i32 s50, s44, 2048
s_add_u32 m0, s50, 16384
s_add_u32 s49, s62, 1802240
buffer_load_dwordx4 v112, s[8:11], s49 offen nt lds
s_mul_i32 s50, s44, 2048
s_add_u32 m0, s50, 17408
s_add_u32 s49, s62, 1822720
buffer_load_dwordx4 v112, s[8:11], s49 offen nt lds
ds_read_b64_tr_b16 v[184:185], v113 offset:24576
ds_read_b64_tr_b16 v[186:187], v113 offset:25600
ds_read_b64_tr_b16 v[188:189], v113 offset:28672
ds_read_b64_tr_b16 v[190:191], v113 offset:29696
s_waitcnt vmcnt(8) lgkmcnt(0)
s_barrier
s_mul_i32 s50, s44, 2048
s_add_u32 m0, s50, 24576
s_add_u32 s49, s62, 1843200
buffer_load_dwordx4 v112, s[8:11], s49 offen nt lds
s_mul_i32 s50, s44, 2048
s_add_u32 m0, s50, 25600
s_add_u32 s49, s62, 1863680
buffer_load_dwordx4 v112, s[8:11], s49 offen nt lds
ds_read_b64_tr_b16 v[192:193], v113 offset:32768
ds_read_b64_tr_b16 v[194:195], v113 offset:33792
ds_read_b64_tr_b16 v[196:197], v113 offset:36864
ds_read_b64_tr_b16 v[198:199], v113 offset:37888
s_waitcnt vmcnt(8) lgkmcnt(0)
s_barrier
s_mul_i32 s50, s44, 2048
s_add_u32 m0, s50, 32768
s_add_u32 s49, s62, 1884160
buffer_load_dwordx4 v112, s[8:11], s49 offen nt lds
s_mul_i32 s50, s44, 2048
s_add_u32 m0, s50, 33792
s_add_u32 s49, s62, 1904640
buffer_load_dwordx4 v112, s[8:11], s49 offen nt lds
ds_read_b64_tr_b16 v[200:201], v113 offset:40960
ds_read_b64_tr_b16 v[202:203], v113 offset:41984
ds_read_b64_tr_b16 v[204:205], v113 offset:45056
ds_read_b64_tr_b16 v[206:207], v113 offset:46080
s_waitcnt vmcnt(8) lgkmcnt(0)
s_barrier
s_mul_i32 s50, s44, 2048
s_add_u32 m0, s50, 40960
s_add_u32 s49, s62, 1925120
buffer_load_dwordx4 v112, s[8:11], s49 offen nt lds
s_mul_i32 s50, s44, 2048
s_add_u32 m0, s50, 41984
s_add_u32 s49, s62, 1945600
buffer_load_dwordx4 v112, s[8:11], s49 offen nt lds
ds_read_b64_tr_b16 v[208:209], v113 offset:0
ds_read_b64_tr_b16 v[210:211], v113 offset:1024
ds_read_b64_tr_b16 v[212:213], v113 offset:4096
ds_read_b64_tr_b16 v[214:215], v113 offset:5120
s_waitcnt vmcnt(8) lgkmcnt(0)
s_barrier
ds_read_b64_tr_b16 v[216:217], v113 offset:8192
ds_read_b64_tr_b16 v[218:219], v113 offset:9216
ds_read_b64_tr_b16 v[220:221], v113 offset:12288
ds_read_b64_tr_b16 v[222:223], v113 offset:13312
s_waitcnt vmcnt(6) lgkmcnt(0)
s_barrier
ds_read_b64_tr_b16 v[224:225], v113 offset:16384
ds_read_b64_tr_b16 v[226:227], v113 offset:17408
ds_read_b64_tr_b16 v[228:229], v113 offset:20480
ds_read_b64_tr_b16 v[230:231], v113 offset:21504
s_waitcnt vmcnt(4) lgkmcnt(0)
s_barrier
ds_read_b64_tr_b16 v[232:233], v113 offset:24576
ds_read_b64_tr_b16 v[234:235], v113 offset:25600
ds_read_b64_tr_b16 v[236:237], v113 offset:28672
ds_read_b64_tr_b16 v[238:239], v113 offset:29696
s_waitcnt vmcnt(2) lgkmcnt(0)
s_barrier
ds_read_b64_tr_b16 v[240:241], v113 offset:32768
ds_read_b64_tr_b16 v[242:243], v113 offset:33792
ds_read_b64_tr_b16 v[244:245], v113 offset:36864
ds_read_b64_tr_b16 v[246:247], v113 offset:37888
s_waitcnt vmcnt(0) lgkmcnt(0)
s_barrier
ds_read_b64_tr_b16 v[248:249], v113 offset:40960
ds_read_b64_tr_b16 v[250:251], v113 offset:41984
ds_read_b64_tr_b16 v[252:253], v113 offset:45056
ds_read_b64_tr_b16 v[254:255], v113 offset:46080
s_waitcnt lgkmcnt(0)
s_mul_i32 s48, s44, 12288
v_lshlrev_b32 v100, 4, v1
v_add_u32 v100, s48, v100
v_lshrrev_b32 v122, 4, v1
v_and_b32 v123, 15, v1
v_lshlrev_b32 v122, 9, v122
v_lshl_add_u32 v96, v123, 4, v122
v_lshlrev_b32 v96, 4, v1
s_mul_i32 s55, s76, 98304
s_add_u32 s55, s55, 117440512
s_mov_b32 s61, 120
s_lshl_b32 s48, s77, 2
s_add_u32 s48, s48, s76
s_lshl_b32 s59, s48, 14
s_add_u32 s59, s59, 201326592
s_mov_b32 s60, 327680
s_lshl_b32 s48, s48, 7
s_add_u32 s48, s48, 49152
v_mov_b32 v120, s48
v_mov_b32 v122, 1879048192
v_cmp_eq_u32 vcc, 0, v0
s_nop 1
v_cndmask_b32 v120, v122, v120, vcc
s_lshl_b32 s48, s44, 12
v_lshrrev_b32 v122, 4, v1
v_lshlrev_b32 v122, 10, v122
v_and_b32 v123, 15, v1
v_lshl_add_u32 v122, v123, 4, v122
v_add_u32 v112, s48, v122
s_lshl_b32 s78, s76, 8
s_add_u32 s78, s78, 65536
v_mov_b32 v114, 0
s_barrier
s_mul_i32 s57, s44, 12288
s_mov_b32 s58, 0
s_mov_b32 s56, 1879048192
s_mov_b32 s54, -2
s_mov_b32 s64, 49152
s_add_u32 s79, s54, 2
s_min_u32 s79, s79, 119
s_lshr_b32 s48, s79, 1
s_lshl_b32 s48, s48, 10
s_and_b32 s79, s79, 1
s_lshl_b32 s79, s79, 7
s_add_u32 s79, s79, s48
s_add_u32 s79, s79, s78
s_cmp_lg_u32 s44, 0
s_cbranch_scc1 L_p4x_123
s_mov_b32 s53, 0
L_p4_121:
buffer_load_dwordx4 v[2:5], v114, s[4:7], s79 offen sc1
s_add_u32 s53, s53, 1
s_cmp_gt_u32 s53, 400000
s_cbranch_scc1 L_p4x_123
s_waitcnt vmcnt(0)
L_p4c_122:
v_and_b32 v2, v2, v3
v_bitop3_b32 v2, v2, v4, v5 bitop3:0x80
s_nop 0
v_readfirstlane_b32 s48, v2
s_cmp_eq_u32 s48, 1
s_cbranch_scc1 L_p4x_123
s_sleep 3
s_branch L_p4_121
L_p4x_123:
s_barrier
s_add_u32 m0, s57, 0
s_add_u32 s49, s55, 0
buffer_load_dwordx4 v100, s[4:7], s49 offen offset:0 sc1 lds
buffer_load_dwordx4 v100, s[4:7], s49 offen offset:1024 sc1 lds
buffer_load_dwordx4 v100, s[4:7], s49 offen offset:2048 sc1 lds
buffer_load_dwordx4 v100, s[4:7], s49 offen offset:3072 sc1 lds
s_add_u32 m0, s57, 4096
s_add_u32 s49, s55, 4096
buffer_load_dwordx4 v100, s[4:7], s49 offen offset:0 sc1 lds
buffer_load_dwordx4 v100, s[4:7], s49 offen offset:1024 sc1 lds
buffer_load_dwordx4 v100, s[4:7], s49 offen offset:2048 sc1 lds
buffer_load_dwordx4 v100, s[4:7], s49 offen offset:3072 sc1 lds
s_add_u32 m0, s57, 8192
s_add_u32 s49, s55, 8192
buffer_load_dwordx4 v100, s[4:7], s49 offen offset:0 sc1 lds
buffer_load_dwordx4 v100, s[4:7], s49 offen offset:1024 sc1 lds
buffer_load_dwordx4 v100, s[4:7], s49 offen offset:2048 sc1 lds
buffer_load_dwordx4 v100, s[4:7], s49 offen offset:3072 sc1 lds
s_add_u32 s55, s55, 49152
s_add_u32 s57, s57, 49152
s_cmp_ge_u32 s57, 147456
s_cselect_b32 s49, 147456, 0
s_sub_u32 s57, s57, s49
s_add_u32 s54, s54, 1
s_add_u32 s79, s54, 2
s_min_u32 s79, s79, 119
s_lshr_b32 s48, s79, 1
s_lshl_b32 s48, s48, 10
s_and_b32 s79, s79, 1
s_lshl_b32 s79, s79, 7
s_add_u32 s79, s79, s48
s_add_u32 s79, s79, s78
s_cmp_lg_u32 s44, 0
s_cbranch_scc1 L_p4x_126
s_mov_b32 s53, 0
L_p4_124:
buffer_load_dwordx4 v[2:5], v114, s[4:7], s79 offen sc1
s_add_u32 s53, s53, 1
s_cmp_gt_u32 s53, 400000
s_cbranch_scc1 L_p4x_126
s_waitcnt vmcnt(0)
L_p4c_125:
v_and_b32 v2, v2, v3
v_bitop3_b32 v2, v2, v4, v5 bitop3:0x80
s_nop 0
v_readfirstlane_b32 s48, v2
s_cmp_eq_u32 s48, 1
s_cbranch_scc1 L_p4x_126
s_sleep 3
s_branch L_p4_124
L_p4x_126:
s_barrier
s_add_u32 m0, s57, 0
s_add_u32 s49, s55, 0
buffer_load_dwordx4 v100, s[4:7], s49 offen offset:0 sc1 lds
buffer_load_dwordx4 v100, s[4:7], s49 offen offset:1024 sc1 lds
buffer_load_dwordx4 v100, s[4:7], s49 offen offset:2048 sc1 lds
buffer_load_dwordx4 v100, s[4:7], s49 offen offset:3072 sc1 lds
s_add_u32 m0, s57, 4096
s_add_u32 s49, s55, 4096
buffer_load_dwordx4 v100, s[4:7], s49 offen offset:0 sc1 lds
buffer_load_dwordx4 v100, s[4:7], s49 offen offset:1024 sc1 lds
buffer_load_dwordx4 v100, s[4:7], s49 offen offset:2048 sc1 lds
buffer_load_dwordx4 v100, s[4:7], s49 offen offset:3072 sc1 lds
s_add_u32 m0, s57, 8192
s_add_u32 s49, s55, 8192
buffer_load_dwordx4 v100, s[4:7], s49 offen offset:0 sc1 lds
buffer_load_dwordx4 v100, s[4:7], s49 offen offset:1024 sc1 lds
buffer_load_dwordx4 v100, s[4:7], s49 offen offset:2048 sc1 lds
buffer_load_dwordx4 v100, s[4:7], s49 offen offset:3072 sc1 lds
s_add_u32 s55, s55, 344064
s_add_u32 s57, s57, 49152
s_cmp_ge_u32 s57, 147456
s_cselect_b32 s49, 147456, 0
s_sub_u32 s57, s57, s49
s_add_u32 s54, s54, 1
s_add_u32 s79, s54, 2
s_min_u32 s79, s79, 119
s_lshr_b32 s48, s79, 1
s_lshl_b32 s48, s48, 10
s_and_b32 s79, s79, 1
s_lshl_b32 s79, s79, 7
s_add_u32 s79, s79, s48
s_add_u32 s79, s79, s78
s_cmp_lg_u32 s44, 0
s_cbranch_scc1 L_p4x_129
s_mov_b32 s53, 0
L_p4_127:
buffer_load_dwordx4 v[2:5], v114, s[4:7], s79 offen sc1
s_add_u32 s53, s53, 1
s_cmp_gt_u32 s53, 400000
s_cbranch_scc1 L_p4x_129
s_waitcnt vmcnt(0)
L_p4c_128:
v_and_b32 v2, v2, v3
v_bitop3_b32 v2, v2, v4, v5 bitop3:0x80
s_nop 0
v_readfirstlane_b32 s48, v2
s_cmp_eq_u32 s48, 1
s_cbranch_scc1 L_p4x_129
s_sleep 3
s_branch L_p4_127
L_p4x_129:
s_barrier
s_waitcnt vmcnt(12)
s_barrier
ds_read_b128 v[64:67], v96 offset:0
ds_read_b128 v[68:71], v96 offset:1024
ds_read_b128 v[72:75], v96 offset:2048
ds_read_b128 v[76:79], v96 offset:3072
ds_read_b128 v[80:83], v96 offset:4096
ds_read_b128 v[84:87], v96 offset:5120
ds_read_b128 v[88:91], v96 offset:6144
ds_read_b128 v[92:95], v96 offset:7168
L_t5_loop_130:
s_add_u32 s79, s54, 3
s_min_u32 s79, s79, 119
s_lshr_b32 s48, s79, 1
s_lshl_b32 s48, s48, 10
s_and_b32 s79, s79, 1
s_lshl_b32 s79, s79, 7
s_add_u32 s79, s79, s48
s_add_u32 s79, s79, s78
buffer_load_dwordx4 v[2:5], v114, s[4:7], s79 offen sc1
s_waitcnt lgkmcnt(7)
v_mfma_f32_32x32x16_bf16 v[16:31], a[0:3], v[64:67], 0
ds_read_b128 v[64:67], v96 offset:8192
s_add_u32 m0, s57, 0
s_add_u32 s49, s55, 0
s_waitcnt lgkmcnt(7)
v_mfma_f32_32x32x16_bf16 v[16:31], a[4:7], v[68:71], v[16:31]
ds_read_b128 v[68:71], v96 offset:9216
buffer_load_dwordx4 v100, s[4:7], s49 offen offset:0 sc1 lds
s_lshr_b32 s51, s54, 1
s_waitcnt lgkmcnt(7)
v_mfma_f32_32x32x16_bf16 v[16:31], a[8:11], v[72:75], v[16:31]
ds_read_b128 v[72:75], v96 offset:10240
s_sub_i32 s51, s51, 1
s_max_i32 s51, s51, 0
s_waitcnt lgkmcnt(7)
v_mfma_f32_32x32x16_bf16 v[16:31], a[12:15], v[76:79], v[16:31]
ds_read_b128 v[76:79], v96 offset:11264
buffer_load_dwordx4 v100, s[4:7], s49 offen offset:1024 sc1 lds
v_mov_b32 v122, s51
s_waitcnt lgkmcnt(7)
v_mfma_f32_32x32x16_bf16 v[16:31], a[16:19], v[80:83], v[16:31]
ds_read_b128 v[80:83], v96 offset:12288
buffer_store_dword v122, v120, s[4:7], 0 offen sc1
s_waitcnt lgkmcnt(7)
v_mfma_f32_32x32x16_bf16 v[16:31], a[20:23], v[84:87], v[16:31]
ds_read_b128 v[84:87], v96 offset:13312
s_waitcnt lgkmcnt(7)
v_mfma_f32_32x32x16_bf16 v[16:31], a[24:27], v[88:91], v[16:31]
ds_read_b128 v[88:91], v96 offset:14336
buffer_load_dwordx4 v100, s[4:7], s49 offen offset:2048 sc1 lds
s_waitcnt lgkmcnt(7)
v_mfma_f32_32x32x16_bf16 v[16:31], a[28:31], v[92:95], v[16:31]
ds_read_b128 v[92:95], v96 offset:15360
s_waitcnt lgkmcnt(7)
v_mfma_f32_32x32x16_bf16 v[16:31], a[32:35], v[64:67], v[16:31]
ds_read_b128 v[64:67], v96 offset:16384
s_waitcnt lgkmcnt(7)
v_mfma_f32_32x32x16_bf16 v[16:31], a[36:39], v[68:71], v[16:31]
ds_read_b128 v[68:71], v96 offset:17408
buffer_load_dwordx4 v100, s[4:7], s49 offen offset:3072 sc1 lds
s_waitcnt lgkmcnt(7)
v_mfma_f32_32x32x16_bf16 v[16:31], a[40:43], v[72:75], v[16:31]
ds_read_b128 v[72:75], v96 offset:18432
s_waitcnt lgkmcnt(7)
v_mfma_f32_32x32x16_bf16 v[16:31], a[44:47], v[76:79], v[16:31]
ds_read_b128 v[76:79], v96 offset:19456
s_waitcnt lgkmcnt(7)
v_mfma_f32_32x32x16_bf16 v[16:31], a[48:51], v[80:83], v[16:31]
ds_read_b128 v[80:83], v96 offset:20480
s_add_u32 m0, s57, 4096
s_add_u32 s49, s55, 4096
s_waitcnt lgkmcnt(7)
v_mfma_f32_32x32x16_bf16 v[16:31], a[52:55], v[84:87], v[16:31]
ds_read_b128 v[84:87], v96 offset:21504
buffer_load_dwordx4 v100, s[4:7], s49 offen offset:0 sc1 lds
s_waitcnt lgkmcnt(7)
v_mfma_f32_32x32x16_bf16 v[16:31], a[56:59], v[88:91], v[16:31]
ds_read_b128 v[88:91], v96 offset:22528
s_waitcnt lgkmcnt(7)
v_mfma_f32_32x32x16_bf16 v[16:31], a[60:63], v[92:95], v[16:31]
ds_read_b128 v[92:95], v96 offset:23552
buffer_load_dwordx4 v100, s[4:7], s49 offen offset:1024 sc1 lds
s_waitcnt lgkmcnt(7)
v_mfma_f32_32x32x16_bf16 v[16:31], a[64:67], v[64:67], v[16:31]
ds_read_b128 v[64:67], v96 offset:24576
s_waitcnt lgkmcnt(7)
v_mfma_f32_32x32x16_bf16 v[16:31], a[68:71], v[68:71], v[16:31]
ds_read_b128 v[68:71], v96 offset:25600
s_waitcnt lgkmcnt(7)
v_mfma_f32_32x32x16_bf16 v[16:31], a[72:75], v[72:75], v[16:31]
ds_read_b128 v[72:75], v96 offset:26624
buffer_load_dwordx4 v100, s[4:7], s49 offen offset:2048 sc1 lds
buffer_store_dwordx4 v[40:43], v112, s[4:7], s56 offen offset:0 sc1
s_waitcnt lgkmcnt(7)
v_mfma_f32_32x32x16_bf16 v[16:31], a[76:79], v[76:79], v[16:31]
ds_read_b128 v[76:79], v96 offset:27648
s_waitcnt lgkmcnt(7)
v_mfma_f32_32x32x16_bf16 v[16:31], a[80:83], v[80:83], v[16:31]
ds_read_b128 v[80:83], v96 offset:28672
s_waitcnt lgkmcnt(7)
v_mfma_f32_32x32x16_bf16 v[16:31], a[84:87], v[84:87], v[16:31]
ds_read_b128 v[84:87], v96 offset:29696
buffer_load_dwordx4 v100, s[4:7], s49 offen offset:3072 sc1 lds
s_waitcnt lgkmcnt(7)
v_mfma_f32_32x32x16_bf16 v[16:31], a[88:91], v[88:91], v[16:31]
ds_read_b128 v[88:91], v96 offset:30720
buffer_store_dwordx4 v[44:47], v112, s[4:7], s56 offen offset:256 sc1
s_waitcnt lgkmcnt(7)
v_mfma_f32_32x32x16_bf16 v[16:31], a[92:95], v[92:95], v[16:31]
ds_read_b128 v[92:95], v96 offset:31744
s_waitcnt lgkmcnt(7)
v_mfma_f32_32x32x16_bf16 v[16:31], a[96:99], v[64:67], v[16:31]
ds_read_b128 v[64:67], v96 offset:32768
s_add_u32 m0, s57, 8192
s_add_u32 s49, s55, 8192
s_waitcnt lgkmcnt(7)
v_mfma_f32_32x32x16_bf16 v[16:31], a[100:103], v[68:71], v[16:31]
ds_read_b128 v[68:71], v96 offset:33792
buffer_load_dwordx4 v100, s[4:7], s49 offen offset:0 sc1 lds
buffer_store_dwordx4 v[48:51], v112, s[4:7], s56 offen offset:512 sc1
s_waitcnt lgkmcnt(7)
v_mfma_f32_32x32x16_bf16 v[16:31], a[104:107], v[72:75], v[16:31]
ds_read_b128 v[72:75], v96 offset:34816
s_waitcnt lgkmcnt(7)
v_mfma_f32_32x32x16_bf16 v[16:31], a[108:111], v[76:79], v[16:31]
ds_read_b128 v[76:79], v96 offset:35840
buffer_load_dwordx4 v100, s[4:7], s49 offen offset:1024 sc1 lds
s_waitcnt lgkmcnt(7)
v_mfma_f32_32x32x16_bf16 v[16:31], a[112:115], v[80:83], v[16:31]
ds_read_b128 v[80:83], v96 offset:36864
buffer_store_dwordx4 v[52:55], v112, s[4:7], s56 offen offset:768 sc1
s_waitcnt lgkmcnt(7)
v_mfma_f32_32x32x16_bf16 v[16:31], a[116:119], v[84:87], v[16:31]
ds_read_b128 v[84:87], v96 offset:37888
s_waitcnt lgkmcnt(7)
v_mfma_f32_32x32x16_bf16 v[16:31], a[120:123], v[88:91], v[16:31]
ds_read_b128 v[88:91], v96 offset:38912
buffer_load_dwordx4 v100, s[4:7], s49 offen offset:2048 sc1 lds
s_waitcnt lgkmcnt(7)
v_mfma_f32_32x32x16_bf16 v[16:31], a[124:127], v[92:95], v[16:31]
ds_read_b128 v[92:95], v96 offset:39936
s_mov_b32 s56, s59
s_waitcnt lgkmcnt(7)
v_mfma_f32_32x32x16_bf16 v[16:31], a[128:131], v[64:67], v[16:31]
ds_read_b128 v[64:67], v96 offset:40960
s_waitcnt lgkmcnt(7)
v_mfma_f32_32x32x16_bf16 v[16:31], a[132:135], v[68:71], v[16:31]
ds_read_b128 v[68:71], v96 offset:41984
buffer_load_dwordx4 v100, s[4:7], s49 offen offset:3072 sc1 lds
s_waitcnt lgkmcnt(7)
v_mfma_f32_32x32x16_bf16 v[16:31], a[136:139], v[72:75], v[16:31]
ds_read_b128 v[72:75], v96 offset:43008
s_add_u32 s55, s55, 49152
s_add_u32 s57, s57, 49152
s_waitcnt lgkmcnt(7)
v_mfma_f32_32x32x16_bf16 v[16:31], a[140:143], v[76:79], v[16:31]
ds_read_b128 v[76:79], v96 offset:44032
s_cmp_ge_u32 s57, 147456
s_cselect_b32 s49, 147456, 0
s_waitcnt lgkmcnt(7)
v_mfma_f32_32x32x16_bf16 v[16:31], a[144:147], v[80:83], v[16:31]
ds_read_b128 v[80:83], v96 offset:45056
s_sub_u32 s57, s57, s49
s_add_u32 s59, s59, s60
s_waitcnt lgkmcnt(7)
v_mfma_f32_32x32x16_bf16 v[16:31], a[148:151], v[84:87], v[16:31]
ds_read_b128 v[84:87], v96 offset:46080
s_waitcnt lgkmcnt(7)
v_mfma_f32_32x32x16_bf16 v[16:31], a[152:155], v[88:91], v[16:31]
ds_read_b128 v[88:91], v96 offset:47104
s_add_u32 s54, s54, 1
s_add_u32 s58, s58, 49152
s_waitcnt lgkmcnt(7)
v_mfma_f32_32x32x16_bf16 v[16:31], a[156:159], v[92:95], v[16:31]
ds_read_b128 v[92:95], v96 offset:48128
s_cmp_ge_u32 s58, 147456
s_cselect_b32 s50, -98304, s64
s_waitcnt lgkmcnt(7)
v_mfma_f32_32x32x16_bf16 v[16:31], a[160:163], v[64:67], v[16:31]
s_cselect_b32 s58, 0, s58
s_waitcnt lgkmcnt(6)
v_mfma_f32_32x32x16_bf16 v[16:31], a[164:167], v[68:71], v[16:31]
v_add_u32 v96, s50, v96
s_waitcnt vmcnt(17) lgkmcnt(0)
s_cmp_lg_u32 s44, 0
s_cbranch_scc1 L_p4x_134
s_mov_b32 s53, 0
s_branch L_p4c_133
L_p4_132:
buffer_load_dwordx4 v[2:5], v114, s[4:7], s79 offen sc1
s_add_u32 s53, s53, 1
s_cmp_gt_u32 s53, 400000
s_cbranch_scc1 L_p4x_134
s_waitcnt vmcnt(0)
L_p4c_133:
v_and_b32 v2, v2, v3
v_bitop3_b32 v2, v2, v4, v5 bitop3:0x80
s_nop 0
v_readfirstlane_b32 s48, v2
s_cmp_eq_u32 s48, 1
s_cbranch_scc1 L_p4x_134
s_sleep 3
s_branch L_p4_132
L_p4x_134:
s_barrier
ds_read_b128 v[64:67], v96 offset:0
ds_read_b128 v[68:71], v96 offset:1024
v_mfma_f32_32x32x16_bf16 v[16:31], a[168:171], v[72:75], v[16:31]
ds_read_b128 v[72:75], v96 offset:2048
v_mfma_f32_32x32x16_bf16 v[16:31], a[172:175], v[76:79], v[16:31]
ds_read_b128 v[76:79], v96 offset:3072
v_mfma_f32_32x32x16_bf16 v[16:31], a[176:179], v[80:83], v[16:31]
ds_read_b128 v[80:83], v96 offset:4096
v_mfma_f32_32x32x16_bf16 v[16:31], a[180:183], v[84:87], v[16:31]
ds_read_b128 v[84:87], v96 offset:5120
v_mfma_f32_32x32x16_bf16 v[16:31], a[184:187], v[88:91], v[16:31]
ds_read_b128 v[88:91], v96 offset:6144
v_mfma_f32_32x32x16_bf16 v[16:31], a[188:191], v[92:95], v[16:31]
ds_read_b128 v[92:95], v96 offset:7168
s_add_u32 s79, s54, 3
s_min_u32 s79, s79, 119
s_lshr_b32 s48, s79, 1
s_lshl_b32 s48, s48, 10
s_and_b32 s79, s79, 1
s_lshl_b32 s79, s79, 7
s_add_u32 s79, s79, s48
s_add_u32 s79, s79, s78
buffer_load_dwordx4 v[2:5], v114, s[4:7], s79 offen sc1
s_waitcnt lgkmcnt(7)
v_mfma_f32_32x32x16_bf16 v[16:31], a[192:195], v[64:67], v[16:31]
ds_read_b128 v[64:67], v96 offset:8192
s_add_u32 m0, s57, 0
s_add_u32 s49, s55, 0
s_waitcnt lgkmcnt(7)
v_mfma_f32_32x32x16_bf16 v[16:31], a[196:199], v[68:71], v[16:31]
ds_read_b128 v[68:71], v96 offset:9216
buffer_load_dwordx4 v100, s[4:7], s49 offen offset:0 sc1 lds
s_waitcnt lgkmcnt(7)
v_mfma_f32_32x32x16_bf16 v[16:31], a[200:203], v[72:75], v[16:31]
ds_read_b128 v[72:75], v96 offset:10240
s_waitcnt lgkmcnt(7)
v_mfma_f32_32x32x16_bf16 v[16:31], a[204:207], v[76:79], v[16:31]
ds_read_b128 v[76:79], v96 offset:11264
buffer_load_dwordx4 v100, s[4:7], s49 offen offset:1024 sc1 lds
s_waitcnt lgkmcnt(7)
v_mfma_f32_32x32x16_bf16 v[16:31], a[208:211], v[80:83], v[16:31]
ds_read_b128 v[80:83], v96 offset:12288
s_waitcnt lgkmcnt(7)
v_mfma_f32_32x32x16_bf16 v[16:31], a[212:215], v[84:87], v[16:31]
ds_read_b128 v[84:87], v96 offset:13312
s_waitcnt lgkmcnt(7)
v_mfma_f32_32x32x16_bf16 v[16:31], a[216:219], v[88:91], v[16:31]
ds_read_b128 v[88:91], v96 offset:14336
buffer_load_dwordx4 v100, s[4:7], s49 offen offset:2048 sc1 lds
s_waitcnt lgkmcnt(7)
v_mfma_f32_32x32x16_bf16 v[16:31], a[220:223], v[92:95], v[16:31]
ds_read_b128 v[92:95], v96 offset:15360
s_waitcnt lgkmcnt(7)
v_mfma_f32_32x32x16_bf16 v[16:31], a[224:227], v[64:67], v[16:31]
ds_read_b128 v[64:67], v96 offset:16384
s_waitcnt lgkmcnt(7)
v_mfma_f32_32x32x16_bf16 v[16:31], a[228:231], v[68:71], v[16:31]
ds_read_b128 v[68:71], v96 offset:17408
buffer_load_dwordx4 v100, s[4:7], s49 offen offset:3072 sc1 lds
s_waitcnt lgkmcnt(7)
v_mfma_f32_32x32x16_bf16 v[16:31], a[232:235], v[72:75], v[16:31]
ds_read_b128 v[72:75], v96 offset:18432
s_waitcnt lgkmcnt(7)
v_mfma_f32_32x32x16_bf16 v[16:31], a[236:239], v[76:79], v[16:31]
ds_read_b128 v[76:79], v96 offset:19456
s_waitcnt lgkmcnt(7)
v_mfma_f32_32x32x16_bf16 v[16:31], a[240:243], v[80:83], v[16:31]
ds_read_b128 v[80:83], v96 offset:20480
s_add_u32 m0, s57, 4096
s_add_u32 s49, s55, 4096
s_waitcnt lgkmcnt(7)
v_mfma_f32_32x32x16_bf16 v[16:31], a[244:247], v[84:87], v[16:31]
ds_read_b128 v[84:87], v96 offset:21504
buffer_load_dwordx4 v100, s[4:7], s49 offen offset:0 sc1 lds
s_waitcnt lgkmcnt(7)
v_mfma_f32_32x32x16_bf16 v[16:31], a[248:251], v[88:91], v[16:31]
ds_read_b128 v[88:91], v96 offset:22528
s_waitcnt lgkmcnt(7)
v_mfma_f32_32x32x16_bf16 v[16:31], a[252:255], v[92:95], v[16:31]
ds_read_b128 v[92:95], v96 offset:23552
buffer_load_dwordx4 v100, s[4:7], s49 offen offset:1024 sc1 lds
s_waitcnt lgkmcnt(7)
v_mfma_f32_32x32x16_bf16 v[16:31], v[128:131], v[64:67], v[16:31]
ds_read_b128 v[64:67], v96 offset:24576
s_waitcnt lgkmcnt(7)
v_mfma_f32_32x32x16_bf16 v[16:31], v[132:135], v[68:71], v[16:31]
ds_read_b128 v[68:71], v96 offset:25600
s_waitcnt lgkmcnt(7)
v_mfma_f32_32x32x16_bf16 v[16:31], v[136:139], v[72:75], v[16:31]
ds_read_b128 v[72:75], v96 offset:26624
buffer_load_dwordx4 v100, s[4:7], s49 offen offset:2048 sc1 lds
s_waitcnt lgkmcnt(7)
v_mfma_f32_32x32x16_bf16 v[16:31], v[140:143], v[76:79], v[16:31]
ds_read_b128 v[76:79], v96 offset:27648
s_waitcnt lgkmcnt(7)
v_mfma_f32_32x32x16_bf16 v[16:31], v[144:147], v[80:83], v[16:31]
ds_read_b128 v[80:83], v96 offset:28672
s_waitcnt lgkmcnt(7)
v_mfma_f32_32x32x16_bf16 v[16:31], v[148:151], v[84:87], v[16:31]
ds_read_b128 v[84:87], v96 offset:29696
buffer_load_dwordx4 v100, s[4:7], s49 offen offset:3072 sc1 lds
s_waitcnt lgkmcnt(7)
v_mfma_f32_32x32x16_bf16 v[16:31], v[152:155], v[88:91], v[16:31]
ds_read_b128 v[88:91], v96 offset:30720
s_waitcnt lgkmcnt(7)
v_mfma_f32_32x32x16_bf16 v[16:31], v[156:159], v[92:95], v[16:31]
ds_read_b128 v[92:95], v96 offset:31744
s_waitcnt lgkmcnt(7)
v_mfma_f32_32x32x16_bf16 v[16:31], v[160:163], v[64:67], v[16:31]
ds_read_b128 v[64:67], v96 offset:32768
s_add_u32 m0, s57, 8192
s_add_u32 s49, s55, 8192
s_waitcnt lgkmcnt(7)
v_mfma_f32_32x32x16_bf16 v[16:31], v[164:167], v[68:71], v[16:31]
ds_read_b128 v[68:71], v96 offset:33792
buffer_load_dwordx4 v100, s[4:7], s49 offen offset:0 sc1 lds
s_waitcnt lgkmcnt(7)
v_mfma_f32_32x32x16_bf16 v[16:31], v[168:171], v[72:75], v[16:31]
ds_read_b128 v[72:75], v96 offset:34816
s_waitcnt lgkmcnt(7)
v_mfma_f32_32x32x16_bf16 v[16:31], v[172:175], v[76:79], v[16:31]
ds_read_b128 v[76:79], v96 offset:35840
buffer_load_dwordx4 v100, s[4:7], s49 offen offset:1024 sc1 lds
s_waitcnt lgkmcnt(7)
v_mfma_f32_32x32x16_bf16 v[16:31], v[176:179], v[80:83], v[16:31]
ds_read_b128 v[80:83], v96 offset:36864
s_waitcnt lgkmcnt(7)
v_mfma_f32_32x32x16_bf16 v[16:31], v[180:183], v[84:87], v[16:31]
ds_read_b128 v[84:87], v96 offset:37888
s_waitcnt lgkmcnt(7)
v_mfma_f32_32x32x16_bf16 v[16:31], v[184:187], v[88:91], v[16:31]
ds_read_b128 v[88:91], v96 offset:38912
buffer_load_dwordx4 v100, s[4:7], s49 offen offset:2048 sc1 lds
s_waitcnt lgkmcnt(7)
v_mfma_f32_32x32x16_bf16 v[16:31], v[188:191], v[92:95], v[16:31]
ds_read_b128 v[92:95], v96 offset:39936
s_waitcnt lgkmcnt(7)
v_mfma_f32_32x32x16_bf16 v[16:31], v[192:195], v[64:67], v[16:31]
ds_read_b128 v[64:67], v96 offset:40960
s_waitcnt lgkmcnt(7)
v_mfma_f32_32x32x16_bf16 v[16:31], v[196:199], v[68:71], v[16:31]
ds_read_b128 v[68:71], v96 offset:41984
buffer_load_dwordx4 v100, s[4:7], s49 offen offset:3072 sc1 lds
s_waitcnt lgkmcnt(7)
v_mfma_f32_32x32x16_bf16 v[16:31], v[200:203], v[72:75], v[16:31]
ds_read_b128 v[72:75], v96 offset:43008
s_add_u32 s55, s55, 344064
s_add_u32 s57, s57, 49152
s_waitcnt lgkmcnt(7)
v_mfma_f32_32x32x16_bf16 v[16:31], v[204:207], v[76:79], v[16:31]
ds_read_b128 v[76:79], v96 offset:44032
s_cmp_ge_u32 s57, 147456
s_cselect_b32 s49, 147456, 0
s_waitcnt lgkmcnt(7)
v_mfma_f32_32x32x16_bf16 v[16:31], v[208:211], v[80:83], v[16:31]
ds_read_b128 v[80:83], v96 offset:45056
s_sub_u32 s57, s57, s49
s_waitcnt lgkmcnt(7)
v_mfma_f32_32x32x16_bf16 v[16:31], v[212:215], v[84:87], v[16:31]
ds_read_b128 v[84:87], v96 offset:46080
s_waitcnt lgkmcnt(7)
v_mfma_f32_32x32x16_bf16 v[16:31], v[216:219], v[88:91], v[16:31]
ds_read_b128 v[88:91], v96 offset:47104
s_add_u32 s54, s54, 1
s_add_u32 s58, s58, 49152
s_waitcnt lgkmcnt(7)
v_mfma_f32_32x32x16_bf16 v[16:31], v[220:223], v[92:95], v[16:31]
ds_read_b128 v[92:95], v96 offset:48128
s_cmp_ge_u32 s58, 147456
s_cselect_b32 s50, -98304, s64
s_waitcnt lgkmcnt(7)
v_mfma_f32_32x32x16_bf16 v[16:31], v[224:227], v[64:67], v[16:31]
s_cselect_b32 s58, 0, s58
s_waitcnt lgkmcnt(6)
v_mfma_f32_32x32x16_bf16 v[16:31], v[228:231], v[68:71], v[16:31]
v_add_u32 v96, s50, v96
s_waitcnt vmcnt(12) lgkmcnt(0)
s_cmp_lg_u32 s44, 0
s_cbranch_scc1 L_p4x_137
s_mov_b32 s53, 0
s_branch L_p4c_136
L_p4_135:
buffer_load_dwordx4 v[2:5], v114, s[4:7], s79 offen sc1
s_add_u32 s53, s53, 1
s_cmp_gt_u32 s53, 400000
s_cbranch_scc1 L_p4x_137
s_waitcnt vmcnt(0)
L_p4c_136:
v_and_b32 v2, v2, v3
v_bitop3_b32 v2, v2, v4, v5 bitop3:0x80
s_nop 0
v_readfirstlane_b32 s48, v2
s_cmp_eq_u32 s48, 1
s_cbranch_scc1 L_p4x_137
s_sleep 3
s_branch L_p4_135
L_p4x_137:
s_barrier
ds_read_b128 v[64:67], v96 offset:0
ds_read_b128 v[68:71], v96 offset:1024
v_mfma_f32_32x32x16_bf16 v[16:31], v[232:235], v[72:75], v[16:31]
ds_read_b128 v[72:75], v96 offset:2048
v_mfma_f32_32x32x16_bf16 v[16:31], v[236:239], v[76:79], v[16:31]
ds_read_b128 v[76:79], v96 offset:3072
v_mfma_f32_32x32x16_bf16 v[16:31], v[240:243], v[80:83], v[16:31]
ds_read_b128 v[80:83], v96 offset:4096
v_mfma_f32_32x32x16_bf16 v[16:31], v[244:247], v[84:87], v[16:31]
ds_read_b128 v[84:87], v96 offset:5120
v_mfma_f32_32x32x16_bf16 v[16:31], v[248:251], v[88:91], v[16:31]
ds_read_b128 v[88:91], v96 offset:6144
v_mfma_f32_32x32x16_bf16 v[16:31], v[252:255], v[92:95], v[16:31]
ds_read_b128 v[92:95], v96 offset:7168
s_add_u32 s79, s54, 3
s_min_u32 s79, s79, 119
s_lshr_b32 s48, s79, 1
s_lshl_b32 s48, s48, 10
s_and_b32 s79, s79, 1
s_lshl_b32 s79, s79, 7
s_add_u32 s79, s79, s48
s_add_u32 s79, s79, s78
buffer_load_dwordx4 v[2:5], v114, s[4:7], s79 offen sc1
s_waitcnt lgkmcnt(7)
v_mfma_f32_32x32x16_bf16 v[40:55], a[0:3], v[64:67], 0
ds_read_b128 v[64:67], v96 offset:8192
s_add_u32 m0, s57, 0
s_add_u32 s49, s55, 0
s_waitcnt lgkmcnt(7)
v_mfma_f32_32x32x16_bf16 v[40:55], a[4:7], v[68:71], v[40:55]
ds_read_b128 v[68:71], v96 offset:9216
buffer_load_dwordx4 v100, s[4:7], s49 offen offset:0 sc1 lds
s_lshr_b32 s51, s54, 1
s_waitcnt lgkmcnt(7)
v_mfma_f32_32x32x16_bf16 v[40:55], a[8:11], v[72:75], v[40:55]
ds_read_b128 v[72:75], v96 offset:10240
s_sub_i32 s51, s51, 1
s_max_i32 s51, s51, 0
s_waitcnt lgkmcnt(7)
v_mfma_f32_32x32x16_bf16 v[40:55], a[12:15], v[76:79], v[40:55]
ds_read_b128 v[76:79], v96 offset:11264
buffer_load_dwordx4 v100, s[4:7], s49 offen offset:1024 sc1 lds
v_mov_b32 v122, s51
s_waitcnt lgkmcnt(7)
v_mfma_f32_32x32x16_bf16 v[40:55], a[16:19], v[80:83], v[40:55]
ds_read_b128 v[80:83], v96 offset:12288
buffer_store_dword v122, v120, s[4:7], 0 offen sc1
s_waitcnt lgkmcnt(7)
v_mfma_f32_32x32x16_bf16 v[40:55], a[20:23], v[84:87], v[40:55]
ds_read_b128 v[84:87], v96 offset:13312
s_waitcnt lgkmcnt(7)
v_mfma_f32_32x32x16_bf16 v[40:55], a[24:27], v[88:91], v[40:55]
ds_read_b128 v[88:91], v96 offset:14336
buffer_load_dwordx4 v100, s[4:7], s49 offen offset:2048 sc1 lds
s_waitcnt lgkmcnt(7)
v_mfma_f32_32x32x16_bf16 v[40:55], a[28:31], v[92:95], v[40:55]
ds_read_b128 v[92:95], v96 offset:15360
s_waitcnt lgkmcnt(7)
v_mfma_f32_32x32x16_bf16 v[40:55], a[32:35], v[64:67], v[40:55]
ds_read_b128 v[64:67], v96 offset:16384
s_waitcnt lgkmcnt(7)
v_mfma_f32_32x32x16_bf16 v[40:55], a[36:39], v[68:71], v[40:55]
ds_read_b128 v[68:71], v96 offset:17408
buffer_load_dwordx4 v100, s[4:7], s49 offen offset:3072 sc1 lds
s_waitcnt lgkmcnt(7)
v_mfma_f32_32x32x16_bf16 v[40:55], a[40:43], v[72:75], v[40:55]
ds_read_b128 v[72:75], v96 offset:18432
s_waitcnt lgkmcnt(7)
v_mfma_f32_32x32x16_bf16 v[40:55], a[44:47], v[76:79], v[40:55]
ds_read_b128 v[76:79], v96 offset:19456
s_waitcnt lgkmcnt(7)
v_mfma_f32_32x32x16_bf16 v[40:55], a[48:51], v[80:83], v[40:55]
ds_read_b128 v[80:83], v96 offset:20480
s_add_u32 m0, s57, 4096
s_add_u32 s49, s55, 4096
s_waitcnt lgkmcnt(7)
v_mfma_f32_32x32x16_bf16 v[40:55], a[52:55], v[84:87], v[40:55]
ds_read_b128 v[84:87], v96 offset:21504
buffer_load_dwordx4 v100, s[4:7], s49 offen offset:0 sc1 lds
s_waitcnt lgkmcnt(7)
v_mfma_f32_32x32x16_bf16 v[40:55], a[56:59], v[88:91], v[40:55]
ds_read_b128 v[88:91], v96 offset:22528
s_waitcnt lgkmcnt(7)
v_mfma_f32_32x32x16_bf16 v[40:55], a[60:63], v[92:95], v[40:55]
ds_read_b128 v[92:95], v96 offset:23552
buffer_load_dwordx4 v100, s[4:7], s49 offen offset:1024 sc1 lds
s_waitcnt lgkmcnt(7)
v_mfma_f32_32x32x16_bf16 v[40:55], a[64:67], v[64:67], v[40:55]
ds_read_b128 v[64:67], v96 offset:24576
s_waitcnt lgkmcnt(7)
v_mfma_f32_32x32x16_bf16 v[40:55], a[68:71], v[68:71], v[40:55]
ds_read_b128 v[68:71], v96 offset:25600
s_waitcnt lgkmcnt(7)
v_mfma_f32_32x32x16_bf16 v[40:55], a[72:75], v[72:75], v[40:55]
ds_read_b128 v[72:75], v96 offset:26624
buffer_load_dwordx4 v100, s[4:7], s49 offen offset:2048 sc1 lds
buffer_store_dwordx4 v[16:19], v112, s[4:7], s56 offen offset:0 sc1
s_waitcnt lgkmcnt(7)
v_mfma_f32_32x32x16_bf16 v[40:55], a[76:79], v[76:79], v[40:55]
ds_read_b128 v[76:79], v96 offset:27648
s_waitcnt lgkmcnt(7)
v_mfma_f32_32x32x16_bf16 v[40:55], a[80:83], v[80:83], v[40:55]
ds_read_b128 v[80:83], v96 offset:28672
s_waitcnt lgkmcnt(7)
v_mfma_f32_32x32x16_bf16 v[40:55], a[84:87], v[84:87], v[40:55]
ds_read_b128 v[84:87], v96 offset:29696
buffer_load_dwordx4 v100, s[4:7], s49 offen offset:3072 sc1 lds
s_waitcnt lgkmcnt(7)
v_mfma_f32_32x32x16_bf16 v[40:55], a[88:91], v[88:91], v[40:55]
ds_read_b128 v[88:91], v96 offset:30720
buffer_store_dwordx4 v[20:23], v112, s[4:7], s56 offen offset:256 sc1
s_waitcnt lgkmcnt(7)
v_mfma_f32_32x32x16_bf16 v[40:55], a[92:95], v[92:95], v[40:55]
ds_read_b128 v[92:95], v96 offset:31744
s_waitcnt lgkmcnt(7)
v_mfma_f32_32x32x16_bf16 v[40:55], a[96:99], v[64:67], v[40:55]
ds_read_b128 v[64:67], v96 offset:32768
s_add_u32 m0, s57, 8192
s_add_u32 s49, s55, 8192
s_waitcnt lgkmcnt(7)
v_mfma_f32_32x32x16_bf16 v[40:55], a[100:103], v[68:71], v[40:55]
ds_read_b128 v[68:71], v96 offset:33792
buffer_load_dwordx4 v100, s[4:7], s49 offen offset:0 sc1 lds
buffer_store_dwordx4 v[24:27], v112, s[4:7], s56 offen offset:512 sc1
s_waitcnt lgkmcnt(7)
v_mfma_f32_32x32x16_bf16 v[40:55], a[104:107], v[72:75], v[40:55]
ds_read_b128 v[72:75], v96 offset:34816
s_waitcnt lgkmcnt(7)
v_mfma_f32_32x32x16_bf16 v[40:55], a[108:111], v[76:79], v[40:55]
ds_read_b128 v[76:79], v96 offset:35840
buffer_load_dwordx4 v100, s[4:7], s49 offen offset:1024 sc1 lds
s_waitcnt lgkmcnt(7)
v_mfma_f32_32x32x16_bf16 v[40:55], a[112:115], v[80:83], v[40:55]
ds_read_b128 v[80:83], v96 offset:36864
buffer_store_dwordx4 v[28:31], v112, s[4:7], s56 offen offset:768 sc1
s_waitcnt lgkmcnt(7)
v_mfma_f32_32x32x16_bf16 v[40:55], a[116:119], v[84:87], v[40:55]
ds_read_b128 v[84:87], v96 offset:37888
s_waitcnt lgkmcnt(7)
v_mfma_f32_32x32x16_bf16 v[40:55], a[120:123], v[88:91], v[40:55]
ds_read_b128 v[88:91], v96 offset:38912
buffer_load_dwordx4 v100, s[4:7], s49 offen offset:2048 sc1 lds
s_waitcnt lgkmcnt(7)
v_mfma_f32_32x32x16_bf16 v[40:55], a[124:127], v[92:95], v[40:55]
ds_read_b128 v[92:95], v96 offset:39936
s_mov_b32 s56, s59
s_waitcnt lgkmcnt(7)
v_mfma_f32_32x32x16_bf16 v[40:55], a[128:131], v[64:67], v[40:55]
ds_read_b128 v[64:67], v96 offset:40960
s_waitcnt lgkmcnt(7)
v_mfma_f32_32x32x16_bf16 v[40:55], a[132:135], v[68:71], v[40:55]
ds_read_b128 v[68:71], v96 offset:41984
buffer_load_dwordx4 v100, s[4:7], s49 offen offset:3072 sc1 lds
s_waitcnt lgkmcnt(7)
v_mfma_f32_32x32x16_bf16 v[40:55], a[136:139], v[72:75], v[40:55]
ds_read_b128 v[72:75], v96 offset:43008
s_add_u32 s55, s55, 49152
s_add_u32 s57, s57, 49152
s_waitcnt lgkmcnt(7)
v_mfma_f32_32x32x16_bf16 v[40:55], a[140:143], v[76:79], v[40:55]
ds_read_b128 v[76:79], v96 offset:44032
s_cmp_ge_u32 s57, 147456
s_cselect_b32 s49, 147456, 0
s_waitcnt lgkmcnt(7)
v_mfma_f32_32x32x16_bf16 v[40:55], a[144:147], v[80:83], v[40:55]
ds_read_b128 v[80:83], v96 offset:45056
s_sub_u32 s57, s57, s49
s_add_u32 s59, s59, s60
s_waitcnt lgkmcnt(7)
v_mfma_f32_32x32x16_bf16 v[40:55], a[148:151], v[84:87], v[40:55]
ds_read_b128 v[84:87], v96 offset:46080
s_waitcnt lgkmcnt(7)
v_mfma_f32_32x32x16_bf16 v[40:55], a[152:155], v[88:91], v[40:55]
ds_read_b128 v[88:91], v96 offset:47104
s_add_u32 s54, s54, 1
s_add_u32 s58, s58, 49152
s_waitcnt lgkmcnt(7)
v_mfma_f32_32x32x16_bf16 v[40:55], a[156:159], v[92:95], v[40:55]
ds_read_b128 v[92:95], v96 offset:48128
s_cmp_ge_u32 s58, 147456
s_cselect_b32 s50, -98304, s64
s_waitcnt lgkmcnt(7)
v_mfma_f32_32x32x16_bf16 v[40:55], a[160:163], v[64:67], v[40:55]
s_cselect_b32 s58, 0, s58
s_waitcnt lgkmcnt(6)
v_mfma_f32_32x32x16_bf16 v[40:55], a[164:167], v[68:71], v[40:55]
v_add_u32 v96, s50, v96
s_waitcnt vmcnt(17) lgkmcnt(0)
s_cmp_lg_u32 s44, 0
s_cbranch_scc1 L_p4x_140
s_mov_b32 s53, 0
s_branch L_p4c_139
L_p4_138:
buffer_load_dwordx4 v[2:5], v114, s[4:7], s79 offen sc1
s_add_u32 s53, s53, 1
s_cmp_gt_u32 s53, 400000
s_cbranch_scc1 L_p4x_140
s_waitcnt vmcnt(0)
L_p4c_139:
v_and_b32 v2, v2, v3
v_bitop3_b32 v2, v2, v4, v5 bitop3:0x80
s_nop 0
v_readfirstlane_b32 s48, v2
s_cmp_eq_u32 s48, 1
s_cbranch_scc1 L_p4x_140
s_sleep 3
s_branch L_p4_138
L_p4x_140:
s_barrier
ds_read_b128 v[64:67], v96 offset:0
ds_read_b128 v[68:71], v96 offset:1024
v_mfma_f32_32x32x16_bf16 v[40:55], a[168:171], v[72:75], v[40:55]
ds_read_b128 v[72:75], v96 offset:2048
v_mfma_f32_32x32x16_bf16 v[40:55], a[172:175], v[76:79], v[40:55]
ds_read_b128 v[76:79], v96 offset:3072
v_mfma_f32_32x32x16_bf16 v[40:55], a[176:179], v[80:83], v[40:55]
ds_read_b128 v[80:83], v96 offset:4096
v_mfma_f32_32x32x16_bf16 v[40:55], a[180:183], v[84:87], v[40:55]
ds_read_b128 v[84:87], v96 offset:5120
v_mfma_f32_32x32x16_bf16 v[40:55], a[184:187], v[88:91], v[40:55]
ds_read_b128 v[88:91], v96 offset:6144
v_mfma_f32_32x32x16_bf16 v[40:55], a[188:191], v[92:95], v[40:55]
ds_read_b128 v[92:95], v96 offset:7168
s_add_u32 s79, s54, 3
s_min_u32 s79, s79, 119
s_lshr_b32 s48, s79, 1
s_lshl_b32 s48, s48, 10
s_and_b32 s79, s79, 1
s_lshl_b32 s79, s79, 7
s_add_u32 s79, s79, s48
s_add_u32 s79, s79, s78
buffer_load_dwordx4 v[2:5], v114, s[4:7], s79 offen sc1
s_waitcnt lgkmcnt(7)
v_mfma_f32_32x32x16_bf16 v[40:55], a[192:195], v[64:67], v[40:55]
ds_read_b128 v[64:67], v96 offset:8192
s_add_u32 m0, s57, 0
s_add_u32 s49, s55, 0
s_waitcnt lgkmcnt(7)
v_mfma_f32_32x32x16_bf16 v[40:55], a[196:199], v[68:71], v[40:55]
ds_read_b128 v[68:71], v96 offset:9216
buffer_load_dwordx4 v100, s[4:7], s49 offen offset:0 sc1 lds
s_waitcnt lgkmcnt(7)
v_mfma_f32_32x32x16_bf16 v[40:55], a[200:203], v[72:75], v[40:55]
ds_read_b128 v[72:75], v96 offset:10240
s_waitcnt lgkmcnt(7)
v_mfma_f32_32x32x16_bf16 v[40:55], a[204:207], v[76:79], v[40:55]
ds_read_b128 v[76:79], v96 offset:11264
buffer_load_dwordx4 v100, s[4:7], s49 offen offset:1024 sc1 lds
s_waitcnt lgkmcnt(7)
v_mfma_f32_32x32x16_bf16 v[40:55], a[208:211], v[80:83], v[40:55]
ds_read_b128 v[80:83], v96 offset:12288
s_waitcnt lgkmcnt(7)
v_mfma_f32_32x32x16_bf16 v[40:55], a[212:215], v[84:87], v[40:55]
ds_read_b128 v[84:87], v96 offset:13312
s_waitcnt lgkmcnt(7)
v_mfma_f32_32x32x16_bf16 v[40:55], a[216:219], v[88:91], v[40:55]
ds_read_b128 v[88:91], v96 offset:14336
buffer_load_dwordx4 v100, s[4:7], s49 offen offset:2048 sc1 lds
s_waitcnt lgkmcnt(7)
v_mfma_f32_32x32x16_bf16 v[40:55], a[220:223], v[92:95], v[40:55]
ds_read_b128 v[92:95], v96 offset:15360
s_waitcnt lgkmcnt(7)
v_mfma_f32_32x32x16_bf16 v[40:55], a[224:227], v[64:67], v[40:55]
ds_read_b128 v[64:67], v96 offset:16384
s_waitcnt lgkmcnt(7)
v_mfma_f32_32x32x16_bf16 v[40:55], a[228:231], v[68:71], v[40:55]
ds_read_b128 v[68:71], v96 offset:17408
buffer_load_dwordx4 v100, s[4:7], s49 offen offset:3072 sc1 lds
s_waitcnt lgkmcnt(7)
v_mfma_f32_32x32x16_bf16 v[40:55], a[232:235], v[72:75], v[40:55]
ds_read_b128 v[72:75], v96 offset:18432
s_waitcnt lgkmcnt(7)
v_mfma_f32_32x32x16_bf16 v[40:55], a[236:239], v[76:79], v[40:55]
ds_read_b128 v[76:79], v96 offset:19456
s_waitcnt lgkmcnt(7)
v_mfma_f32_32x32x16_bf16 v[40:55], a[240:243], v[80:83], v[40:55]
ds_read_b128 v[80:83], v96 offset:20480
s_add_u32 m0, s57, 4096
s_add_u32 s49, s55, 4096
s_waitcnt lgkmcnt(7)
v_mfma_f32_32x32x16_bf16 v[40:55], a[244:247], v[84:87], v[40:55]
ds_read_b128 v[84:87], v96 offset:21504
buffer_load_dwordx4 v100, s[4:7], s49 offen offset:0 sc1 lds
s_waitcnt lgkmcnt(7)
v_mfma_f32_32x32x16_bf16 v[40:55], a[248:251], v[88:91], v[40:55]
ds_read_b128 v[88:91], v96 offset:22528
s_waitcnt lgkmcnt(7)
v_mfma_f32_32x32x16_bf16 v[40:55], a[252:255], v[92:95], v[40:55]
ds_read_b128 v[92:95], v96 offset:23552
buffer_load_dwordx4 v100, s[4:7], s49 offen offset:1024 sc1 lds
s_waitcnt lgkmcnt(7)
v_mfma_f32_32x32x16_bf16 v[40:55], v[128:131], v[64:67], v[40:55]
ds_read_b128 v[64:67], v96 offset:24576
s_waitcnt lgkmcnt(7)
v_mfma_f32_32x32x16_bf16 v[40:55], v[132:135], v[68:71], v[40:55]
ds_read_b128 v[68:71], v96 offset:25600
s_waitcnt lgkmcnt(7)
v_mfma_f32_32x32x16_bf16 v[40:55], v[136:139], v[72:75], v[40:55]
ds_read_b128 v[72:75], v96 offset:26624
buffer_load_dwordx4 v100, s[4:7], s49 offen offset:2048 sc1 lds
s_waitcnt lgkmcnt(7)
v_mfma_f32_32x32x16_bf16 v[40:55], v[140:143], v[76:79], v[40:55]
ds_read_b128 v[76:79], v96 offset:27648
s_waitcnt lgkmcnt(7)
v_mfma_f32_32x32x16_bf16 v[40:55], v[144:147], v[80:83], v[40:55]
ds_read_b128 v[80:83], v96 offset:28672
s_waitcnt lgkmcnt(7)
v_mfma_f32_32x32x16_bf16 v[40:55], v[148:151], v[84:87], v[40:55]
ds_read_b128 v[84:87], v96 offset:29696
buffer_load_dwordx4 v100, s[4:7], s49 offen offset:3072 sc1 lds
s_waitcnt lgkmcnt(7)
v_mfma_f32_32x32x16_bf16 v[40:55], v[152:155], v[88:91], v[40:55]
ds_read_b128 v[88:91], v96 offset:30720
s_waitcnt lgkmcnt(7)
v_mfma_f32_32x32x16_bf16 v[40:55], v[156:159], v[92:95], v[40:55]
ds_read_b128 v[92:95], v96 offset:31744
s_waitcnt lgkmcnt(7)
v_mfma_f32_32x32x16_bf16 v[40:55], v[160:163], v[64:67], v[40:55]
ds_read_b128 v[64:67], v96 offset:32768
s_add_u32 m0, s57, 8192
s_add_u32 s49, s55, 8192
s_waitcnt lgkmcnt(7)
v_mfma_f32_32x32x16_bf16 v[40:55], v[164:167], v[68:71], v[40:55]
ds_read_b128 v[68:71], v96 offset:33792
buffer_load_dwordx4 v100, s[4:7], s49 offen offset:0 sc1 lds
s_waitcnt lgkmcnt(7)
v_mfma_f32_32x32x16_bf16 v[40:55], v[168:171], v[72:75], v[40:55]
ds_read_b128 v[72:75], v96 offset:34816
s_waitcnt lgkmcnt(7)
v_mfma_f32_32x32x16_bf16 v[40:55], v[172:175], v[76:79], v[40:55]
ds_read_b128 v[76:79], v96 offset:35840
buffer_load_dwordx4 v100, s[4:7], s49 offen offset:1024 sc1 lds
s_waitcnt lgkmcnt(7)
v_mfma_f32_32x32x16_bf16 v[40:55], v[176:179], v[80:83], v[40:55]
ds_read_b128 v[80:83], v96 offset:36864
s_waitcnt lgkmcnt(7)
v_mfma_f32_32x32x16_bf16 v[40:55], v[180:183], v[84:87], v[40:55]
ds_read_b128 v[84:87], v96 offset:37888
s_waitcnt lgkmcnt(7)
v_mfma_f32_32x32x16_bf16 v[40:55], v[184:187], v[88:91], v[40:55]
ds_read_b128 v[88:91], v96 offset:38912
buffer_load_dwordx4 v100, s[4:7], s49 offen offset:2048 sc1 lds
s_waitcnt lgkmcnt(7)
v_mfma_f32_32x32x16_bf16 v[40:55], v[188:191], v[92:95], v[40:55]
ds_read_b128 v[92:95], v96 offset:39936
s_waitcnt lgkmcnt(7)
v_mfma_f32_32x32x16_bf16 v[40:55], v[192:195], v[64:67], v[40:55]
ds_read_b128 v[64:67], v96 offset:40960
s_waitcnt lgkmcnt(7)
v_mfma_f32_32x32x16_bf16 v[40:55], v[196:199], v[68:71], v[40:55]
ds_read_b128 v[68:71], v96 offset:41984
buffer_load_dwordx4 v100, s[4:7], s49 offen offset:3072 sc1 lds
s_waitcnt lgkmcnt(7)
v_mfma_f32_32x32x16_bf16 v[40:55], v[200:203], v[72:75], v[40:55]
ds_read_b128 v[72:75], v96 offset:43008
s_add_u32 s55, s55, 344064
s_add_u32 s57, s57, 49152
s_waitcnt lgkmcnt(7)
v_mfma_f32_32x32x16_bf16 v[40:55], v[204:207], v[76:79], v[40:55]
ds_read_b128 v[76:79], v96 offset:44032
s_cmp_ge_u32 s57, 147456
s_cselect_b32 s49, 147456, 0
s_waitcnt lgkmcnt(7)
v_mfma_f32_32x32x16_bf16 v[40:55], v[208:211], v[80:83], v[40:55]
ds_read_b128 v[80:83], v96 offset:45056
s_sub_u32 s57, s57, s49
s_waitcnt lgkmcnt(7)
v_mfma_f32_32x32x16_bf16 v[40:55], v[212:215], v[84:87], v[40:55]
ds_read_b128 v[84:87], v96 offset:46080
s_waitcnt lgkmcnt(7)
v_mfma_f32_32x32x16_bf16 v[40:55], v[216:219], v[88:91], v[40:55]
ds_read_b128 v[88:91], v96 offset:47104
s_add_u32 s54, s54, 1
s_add_u32 s58, s58, 49152
s_waitcnt lgkmcnt(7)
v_mfma_f32_32x32x16_bf16 v[40:55], v[220:223], v[92:95], v[40:55]
ds_read_b128 v[92:95], v96 offset:48128
s_cmp_ge_u32 s58, 147456
s_cselect_b32 s50, -98304, s64
s_waitcnt lgkmcnt(7)
v_mfma_f32_32x32x16_bf16 v[40:55], v[224:227], v[64:67], v[40:55]
s_cselect_b32 s58, 0, s58
s_waitcnt lgkmcnt(6)
v_mfma_f32_32x32x16_bf16 v[40:55], v[228:231], v[68:71], v[40:55]
v_add_u32 v96, s50, v96
s_cmp_ge_u32 s54, s61
s_cbranch_scc1 L_t5_end_131
s_waitcnt vmcnt(12) lgkmcnt(0)
s_cmp_lg_u32 s44, 0
s_cbranch_scc1 L_p4x_143
s_mov_b32 s53, 0
s_branch L_p4c_142
L_p4_141:
buffer_load_dwordx4 v[2:5], v114, s[4:7], s79 offen sc1
s_add_u32 s53, s53, 1
s_cmp_gt_u32 s53, 400000
s_cbranch_scc1 L_p4x_143
s_waitcnt vmcnt(0)
L_p4c_142:
v_and_b32 v2, v2, v3
v_bitop3_b32 v2, v2, v4, v5 bitop3:0x80
s_nop 0
v_readfirstlane_b32 s48, v2
s_cmp_eq_u32 s48, 1
s_cbranch_scc1 L_p4x_143
s_sleep 3
s_branch L_p4_141
L_p4x_143:
s_barrier
ds_read_b128 v[64:67], v96 offset:0
ds_read_b128 v[68:71], v96 offset:1024
v_mfma_f32_32x32x16_bf16 v[40:55], v[232:235], v[72:75], v[40:55]
ds_read_b128 v[72:75], v96 offset:2048
v_mfma_f32_32x32x16_bf16 v[40:55], v[236:239], v[76:79], v[40:55]
ds_read_b128 v[76:79], v96 offset:3072
v_mfma_f32_32x32x16_bf16 v[40:55], v[240:243], v[80:83], v[40:55]
ds_read_b128 v[80:83], v96 offset:4096
v_mfma_f32_32x32x16_bf16 v[40:55], v[244:247], v[84:87], v[40:55]
ds_read_b128 v[84:87], v96 offset:5120
v_mfma_f32_32x32x16_bf16 v[40:55], v[248:251], v[88:91], v[40:55]
ds_read_b128 v[88:91], v96 offset:6144
v_mfma_f32_32x32x16_bf16 v[40:55], v[252:255], v[92:95], v[40:55]
ds_read_b128 v[92:95], v96 offset:7168
s_branch L_t5_loop_130
L_t5_end_131:
s_waitcnt lgkmcnt(0)
v_mfma_f32_32x32x16_bf16 v[40:55], v[232:235], v[72:75], v[40:55]
v_mfma_f32_32x32x16_bf16 v[40:55], v[236:239], v[76:79], v[40:55]
v_mfma_f32_32x32x16_bf16 v[40:55], v[240:243], v[80:83], v[40:55]
v_mfma_f32_32x32x16_bf16 v[40:55], v[244:247], v[84:87], v[40:55]
v_mfma_f32_32x32x16_bf16 v[40:55], v[248:251], v[88:91], v[40:55]
v_mfma_f32_32x32x16_bf16 v[40:55], v[252:255], v[92:95], v[40:55]
s_nop 1
s_nop 4
s_nop 0
s_nop 0
s_nop 0
s_nop 0
s_nop 0
buffer_store_dwordx4 v[40:43], v112, s[4:7], s56 offen offset:0 sc1
buffer_store_dwordx4 v[44:47], v112, s[4:7], s56 offen offset:256 sc1
buffer_store_dwordx4 v[48:51], v112, s[4:7], s56 offen offset:512 sc1
buffer_store_dwordx4 v[52:55], v112, s[4:7], s56 offen offset:768 sc1
s_waitcnt vmcnt(0)
s_barrier
s_lshr_b32 s49, s61, 1
s_add_u32 s49, s49, 0
v_mov_b32 v122, s49
buffer_store_dword v122, v120, s[4:7], 0 offen sc1
s_branch L_exit
L_c4_113:
s_mul_i32 s51, s51, 3
s_add_u32 s79, s51, s52
s_sub_u32 s79, s79, 5
s_waitcnt vmcnt(0)
s_barrier
s_cmp_lg_u32 s44, 0
s_cbranch_scc1 L_da_144
v_mov_b32 v2, 32
v_mov_b32 v3, 1
s_mov_b64 exec, 1
global_atomic_add v2, v3, s[40:41] sc1
s_mov_b64 exec, -1
L_da_144:
s_cmp_ge_u32 s79, 8
s_cbranch_scc1 L_ng_115
s_mov_b32 s51, s79
s_mov_b32 s8, s16
s_mov_b32 s9, s17
s_mov_b32 s10, 2621440
s_mov_b32 s11, 0x20000
s_mov_b32 s12, s36
s_mov_b32 s13, s37
s_mov_b32 s14, 1280
s_mov_b32 s15, 0x20000
v_and_b32 v2, 15, v1
v_mul_u32_u24 v2, 80, v2
v_lshrrev_b32 v3, 4, v1
v_mul_u32_u24 v4, 1280, v3
v_add_u32 v4, v4, v2
buffer_load_dwordx4 v[8:11], v2, s[12:15], 0 offen offset:0
buffer_load_dwordx4 v[12:15], v2, s[12:15], 0 offen offset:16
buffer_load_dwordx4 v[16:19], v2, s[12:15], 0 offen offset:32
buffer_load_dwordx4 v[20:23], v2, s[12:15], 0 offen offset:48
buffer_load_dwordx4 v[24:27], v2, s[12:15], 0 offen offset:64
s_lshl_b32 s51, s51, 8
s_lshl_b32 s48, s44, 6
s_add_u32 s51, s51, s48
v_lshlrev_b32 v5, 3, v3
v_mov_b32 v6, 1879048192
v_and_b32 v7, 15, v1
v_cmp_eq_u32 vcc, 0, v7
s_nop 1
v_cndmask_b32 v5, v6, v5, vcc
s_waitcnt vmcnt(0)
v_lshlrev_b32 v32, 16, v8
v_and_b32 v33, 0xffff0000, v8
v_lshlrev_b32 v34, 16, v9
v_and_b32 v35, 0xffff0000, v9
v_lshlrev_b32 v36, 16, v10
v_and_b32 v37, 0xffff0000, v10
v_lshlrev_b32 v38, 16, v11
v_and_b32 v39, 0xffff0000, v11
v_lshlrev_b32 v40, 16, v12
v_and_b32 v41, 0xffff0000, v12
v_lshlrev_b32 v42, 16, v13
v_and_b32 v43, 0xffff0000, v13
v_lshlrev_b32 v44, 16, v14
v_and_b32 v45, 0xffff0000, v14
v_lshlrev_b32 v46, 16, v15
v_and_b32 v47, 0xffff0000, v15
v_lshlrev_b32 v48, 16, v16
v_and_b32 v49, 0xffff0000, v16
v_lshlrev_b32 v50, 16, v17
v_and_b32 v51, 0xffff0000, v17
v_lshlrev_b32 v52, 16, v18
v_and_b32 v53, 0xffff0000, v18
v_lshlrev_b32 v54, 16, v19
v_and_b32 v55, 0xffff0000, v19
v_lshlrev_b32 v56, 16, v20
v_and_b32 v57, 0xffff0000, v20
v_lshlrev_b32 v58, 16, v21
v_and_b32 v59, 0xffff0000, v21
v_lshlrev_b32 v60, 16, v22
v_and_b32 v61, 0xffff0000, v22
v_lshlrev_b32 v62, 16, v23
v_and_b32 v63, 0xffff0000, v23
v_lshlrev_b32 v64, 16, v24
v_and_b32 v65, 0xffff0000, v24
v_lshlrev_b32 v66, 16, v25
v_and_b32 v67, 0xffff0000, v25
v_lshlrev_b32 v68, 16, v26
v_and_b32 v69, 0xffff0000, v26
v_lshlrev_b32 v70, 16, v27
v_and_b32 v71, 0xffff0000, v27
s_mov_b32 s52, 0
L_gate_145:
s_add_u32 s48, s51, s52
s_mul_i32 s49, s48, 1280
s_lshl_b32 s48, s48, 3
s_add_u32 s48, s48, 184549376
buffer_load_dwordx4 v[8:11], v4, s[8:11], s49 offen offset:0
buffer_load_dwordx4 v[12:15], v4, s[8:11], s49 offen offset:16
buffer_load_dwordx4 v[16:19], v4, s[8:11], s49 offen offset:32
buffer_load_dwordx4 v[20:23], v4, s[8:11], s49 offen offset:48
buffer_load_dwordx4 v[24:27], v4, s[8:11], s49 offen offset:64
v_mov_b32 v28, 0
v_mov_b32 v29, 0
s_waitcnt vmcnt(4)
v_lshlrev_b32 v30, 16, v8
v_and_b32 v31, 0xffff0000, v8
v_pk_mul_f32 v[30:31], v[30:31], v[32:33]
v_cvt_pk_bf16_f32 v72, v30, v31
v_lshlrev_b32 v30, 16, v72
v_and_b32 v31, 0xffff0000, v72
v_pk_add_f32 v[28:29], v[28:29], v[30:31]
v_lshlrev_b32 v30, 16, v9
v_and_b32 v31, 0xffff0000, v9
v_pk_mul_f32 v[30:31], v[30:31], v[34:35]
v_cvt_pk_bf16_f32 v72, v30, v31
v_lshlrev_b32 v30, 16, v72
v_and_b32 v31, 0xffff0000, v72
v_pk_add_f32 v[28:29], v[28:29], v[30:31]
v_lshlrev_b32 v30, 16, v10
v_and_b32 v31, 0xffff0000, v10
v_pk_mul_f32 v[30:31], v[30:31], v[36:37]
v_cvt_pk_bf16_f32 v72, v30, v31
v_lshlrev_b32 v30, 16, v72
v_and_b32 v31, 0xffff0000, v72
v_pk_add_f32 v[28:29], v[28:29], v[30:31]
v_lshlrev_b32 v30, 16, v11
v_and_b32 v31, 0xffff0000, v11
v_pk_mul_f32 v[30:31], v[30:31], v[38:39]
v_cvt_pk_bf16_f32 v72, v30, v31
v_lshlrev_b32 v30, 16, v72
v_and_b32 v31, 0xffff0000, v72
v_pk_add_f32 v[28:29], v[28:29], v[30:31]
s_waitcnt vmcnt(3)
v_lshlrev_b32 v30, 16, v12
v_and_b32 v31, 0xffff0000, v12
v_pk_mul_f32 v[30:31], v[30:31], v[40:41]
v_cvt_pk_bf16_f32 v72, v30, v31
v_lshlrev_b32 v30, 16, v72
v_and_b32 v31, 0xffff0000, v72
v_pk_add_f32 v[28:29], v[28:29], v[30:31]
v_lshlrev_b32 v30, 16, v13
v_and_b32 v31, 0xffff0000, v13
v_pk_mul_f32 v[30:31], v[30:31], v[42:43]
v_cvt_pk_bf16_f32 v72, v30, v31
v_lshlrev_b32 v30, 16, v72
v_and_b32 v31, 0xffff0000, v72
v_pk_add_f32 v[28:29], v[28:29], v[30:31]
v_lshlrev_b32 v30, 16, v14
v_and_b32 v31, 0xffff0000, v14
v_pk_mul_f32 v[30:31], v[30:31], v[44:45]
v_cvt_pk_bf16_f32 v72, v30, v31
v_lshlrev_b32 v30, 16, v72
v_and_b32 v31, 0xffff0000, v72
v_pk_add_f32 v[28:29], v[28:29], v[30:31]
v_lshlrev_b32 v30, 16, v15
v_and_b32 v31, 0xffff0000, v15
v_pk_mul_f32 v[30:31], v[30:31], v[46:47]
v_cvt_pk_bf16_f32 v72, v30, v31
v_lshlrev_b32 v30, 16, v72
v_and_b32 v31, 0xffff0000, v72
v_pk_add_f32 v[28:29], v[28:29], v[30:31]
s_waitcnt vmcnt(2)
v_lshlrev_b32 v30, 16, v16
v_and_b32 v31, 0xffff0000, v16
v_pk_mul_f32 v[30:31], v[30:31], v[48:49]
v_cvt_pk_bf16_f32 v72, v30, v31
v_lshlrev_b32 v30, 16, v72
v_and_b32 v31, 0xffff0000, v72
v_pk_add_f32 v[28:29], v[28:29], v[30:31]
v_lshlrev_b32 v30, 16, v17
v_and_b32 v31, 0xffff0000, v17
v_pk_mul_f32 v[30:31], v[30:31], v[50:51]
v_cvt_pk_bf16_f32 v72, v30, v31
v_lshlrev_b32 v30, 16, v72
v_and_b32 v31, 0xffff0000, v72
v_pk_add_f32 v[28:29], v[28:29], v[30:31]
v_lshlrev_b32 v30, 16, v18
v_and_b32 v31, 0xffff0000, v18
v_pk_mul_f32 v[30:31], v[30:31], v[52:53]
v_cvt_pk_bf16_f32 v72, v30, v31
v_lshlrev_b32 v30, 16, v72
v_and_b32 v31, 0xffff0000, v72
v_pk_add_f32 v[28:29], v[28:29], v[30:31]
v_lshlrev_b32 v30, 16, v19
v_and_b32 v31, 0xffff0000, v19
v_pk_mul_f32 v[30:31], v[30:31], v[54:55]
v_cvt_pk_bf16_f32 v72, v30, v31
v_lshlrev_b32 v30, 16, v72
v_and_b32 v31, 0xffff0000, v72
v_pk_add_f32 v[28:29], v[28:29], v[30:31]
s_waitcnt vmcnt(1)
v_lshlrev_b32 v30, 16, v20
v_and_b32 v31, 0xffff0000, v20
v_pk_mul_f32 v[30:31], v[30:31], v[56:57]
v_cvt_pk_bf16_f32 v72, v30, v31
v_lshlrev_b32 v30, 16, v72
v_and_b32 v31, 0xffff0000, v72
v_pk_add_f32 v[28:29], v[28:29], v[30:31]
v_lshlrev_b32 v30, 16, v21
v_and_b32 v31, 0xffff0000, v21
v_pk_mul_f32 v[30:31], v[30:31], v[58:59]
v_cvt_pk_bf16_f32 v72, v30, v31
v_lshlrev_b32 v30, 16, v72
v_and_b32 v31, 0xffff0000, v72
v_pk_add_f32 v[28:29], v[28:29], v[30:31]
v_lshlrev_b32 v30, 16, v22
v_and_b32 v31, 0xffff0000, v22
v_pk_mul_f32 v[30:31], v[30:31], v[60:61]
v_cvt_pk_bf16_f32 v72, v30, v31
v_lshlrev_b32 v30, 16, v72
v_and_b32 v31, 0xffff0000, v72
v_pk_add_f32 v[28:29], v[28:29], v[30:31]
v_lshlrev_b32 v30, 16, v23
v_and_b32 v31, 0xffff0000, v23
v_pk_mul_f32 v[30:31], v[30:31], v[62:63]
v_cvt_pk_bf16_f32 v72, v30, v31
v_lshlrev_b32 v30, 16, v72
v_and_b32 v31, 0xffff0000, v72
v_pk_add_f32 v[28:29], v[28:29], v[30:31]
s_waitcnt vmcnt(0)
v_lshlrev_b32 v30, 16, v24
v_and_b32 v31, 0xffff0000, v24
v_pk_mul_f32 v[30:31], v[30:31], v[64:65]
v_cvt_pk_bf16_f32 v72, v30, v31
v_lshlrev_b32 v30, 16, v72
v_and_b32 v31, 0xffff0000, v72
v_pk_add_f32 v[28:29], v[28:29], v[30:31]
v_lshlrev_b32 v30, 16, v25
v_and_b32 v31, 0xffff0000, v25
v_pk_mul_f32 v[30:31], v[30:31], v[66:67]
v_cvt_pk_bf16_f32 v72, v30, v31
v_lshlrev_b32 v30, 16, v72
v_and_b32 v31, 0xffff0000, v72
v_pk_add_f32 v[28:29], v[28:29], v[30:31]
v_lshlrev_b32 v30, 16, v26
v_and_b32 v31, 0xffff0000, v26
v_pk_mul_f32 v[30:31], v[30:31], v[68:69]
v_cvt_pk_bf16_f32 v72, v30, v31
v_lshlrev_b32 v30, 16, v72
v_and_b32 v31, 0xffff0000, v72
v_pk_add_f32 v[28:29], v[28:29], v[30:31]
v_lshlrev_b32 v30, 16, v27
v_and_b32 v31, 0xffff0000, v27
v_pk_mul_f32 v[30:31], v[30:31], v[70:71]
v_cvt_pk_bf16_f32 v72, v30, v31
v_lshlrev_b32 v30, 16, v72
v_and_b32 v31, 0xffff0000, v72
v_pk_add_f32 v[28:29], v[28:29], v[30:31]
v_add_f32 v28, v28, v29
s_nop 0
s_nop 0
v_add_f32_dpp v28, v28, v28 row_ror:8 row_mask:0xf bank_mask:0xf
s_nop 1
v_add_f32_dpp v28, v28, v28 row_ror:4 row_mask:0xf bank_mask:0xf
s_nop 1
v_add_f32_dpp v28, v28, v28 row_ror:2 row_mask:0xf bank_mask:0xf
s_nop 1
v_add_f32_dpp v28, v28, v28 row_ror:1 row_mask:0xf bank_mask:0xf
v_cvt_pk_bf16_f32 v28, v28, v28
v_lshlrev_b32 v28, 16, v28
v_mul_f32 v28, 3216550459, v28
v_exp_f32 v28, v28
s_nop 0
v_add_f32 v28, 1.0, v28
v_rcp_f32 v28, v28
s_nop 0
v_cvt_pk_bf16_f32 v28, v28, v28
v_lshlrev_b32 v28, 16, v28
v_sub_f32 v29, 1.0, v28
v_cvt_pk_bf16_f32 v29, v29, v29
v_lshlrev_b32 v29, 16, v29
buffer_store_dwordx2 v[28:29], v5, s[4:7], s48 offen sc1
s_add_u32 s52, s52, 4
s_cmp_lt_u32 s52, 64
s_cbranch_scc1 L_gate_145
s_waitcnt vmcnt(0)
s_barrier
s_cmp_lg_u32 s44, 0
s_cbranch_scc1 L_da_146
v_mov_b32 v2, 168
v_mov_b32 v3, 1
s_mov_b64 exec, 1
global_atomic_add v2, v3, s[40:41] sc1
s_mov_b64 exec, -1
L_da_146:
L_ng_115:
s_mov_b32 s51, s79
s_mul_i32 s48, s51, 21846
s_lshr_b32 s48, s48, 16
s_lshl_b32 s55, s48, 3
s_mul_i32 s48, s48, 3
s_sub_u32 s48, s51, s48
s_lshl_b32 s48, s48, 2
s_add_u32 s54, s48, s44
s_mov_b32 s82, 480
s_mov_b32 s84, 12
s_mov_b32 s85, 432
s_mov_b32 s86, 464
L_t4_entry0:
v_mov_b32 v152, 32
s_cmp_lg_u32 s44, 0
s_cbranch_scc1 L_pdx_148
s_mov_b32 s53, 0
L_pd_147:
global_load_dword v153, v152, s[40:41] sc1
s_add_u32 s53, s53, 1
s_cmp_gt_u32 s53, 100000
s_cbranch_scc1 L_pdx_148
s_waitcnt vmcnt(0)
v_readfirstlane_b32 s48, v153
s_cmp_ge_u32 s48, 64
s_cbranch_scc1 L_pdx_148
s_sleep 16
s_branch L_pd_147
L_pdx_148:
s_waitcnt vmcnt(0)
s_barrier
v_mov_b32 v152, 168
s_cmp_lg_u32 s44, 0
s_cbranch_scc1 L_pdx_150
s_mov_b32 s53, 0
L_pd_149:
global_load_dword v153, v152, s[40:41] sc1
s_add_u32 s53, s53, 1
s_cmp_gt_u32 s53, 100000
s_cbranch_scc1 L_pdx_150
s_waitcnt vmcnt(0)
v_readfirstlane_b32 s48, v153
s_cmp_ge_u32 s48, 8
s_cbranch_scc1 L_pdx_150
s_sleep 16
s_branch L_pd_149
L_pdx_150:
s_waitcnt vmcnt(0)
s_barrier
s_and_b32 s49, s46, 1
s_lshl_b32 s49, s49, 7
s_lshr_b32 s48, s46, 1
s_lshl_b32 s48, s48, 2
s_add_u32 s48, s48, s49
v_mov_b32 v152, s48
global_load_dword v153, v152, s[40:41] sc1
s_waitcnt vmcnt(0)
v_readfirstlane_b32 s48, v153
s_cmp_ge_u32 s48, 32
s_cselect_b32 s87, 0, 0
L_t4_entry:
v_lshrrev_b32 v152, 4, v1
v_and_b32 v153, 15, v1
v_lshlrev_b32 v154, 9, v152
v_lshl_add_u32 v2, v153, 4, v154
v_lshlrev_b32 v3, 4, v1
v_bfe_u32 v154, v1, 2, 2
v_and_b32 v155, 1, v1
v_lshl_add_u32 v154, v154, 1, v155
v_lshlrev_b32 v155, 7, v152
v_lshl_add_u32 v4, v154, 4, v155
v_lshlrev_b32 v7, 3, v153
v_lshlrev_b32 v9, 2, v1
v_lshl_add_u32 v154, v152, 2, 0
v_cmp_gt_u32 s[66:67], v154, v153
v_lshl_add_u32 v154, v152, 2, 1
v_cmp_gt_u32 s[68:69], v154, v153
v_lshl_add_u32 v154, v152, 2, 2
v_cmp_gt_u32 s[70:71], v154, v153
v_lshl_add_u32 v154, v152, 2, 3
v_cmp_gt_u32 s[72:73], v154, v153
v_mov_b32 v8, 1879048192
v_cmp_ne_u32 vcc, 0, v1
s_nop 1
v_cndmask_b32 v8, 0, v8, vcc
v_mov_b32 v134, 0
v_mov_b32 v135, 0
v_mov_b32 v141, 0
v_mov_b32 v142, 0
v_mov_b32 v145, 0
v_mov_b32 v146, 0
s_mov_b32 s80, 1037384597
s_mov_b32 s81, s80
s_lshr_b32 s56, s54, 3
s_and_b32 s57, s54, 7
s_add_u32 s57, s57, s55
s_lshl_b32 s58, s56, 5
s_add_u32 s58, s58, s57
s_mul_i32 s58, s58, 12288
s_mul_i32 s48, s55, 384
s_add_u32 s48, s48, 0
v_min_u32 v5, 23, v1
v_lshl_add_u32 v5, v5, 7, s48
s_mov_b32 s64, 0
s_cmp_gt_u32 s64, s56
s_cbranch_scc1 L_t4px_152
s_mov_b32 s53, 0
L_t4p_151:
buffer_load_dword v152, v5, s[4:7], 0 offen sc1
s_add_u32 s53, s53, 1
s_cmp_gt_u32 s53, 100000
s_cbranch_scc1 L_t4px_152
s_waitcnt vmcnt(0)
v_min_u32_dpp v152, v152, v152 row_ror:8 row_mask:0xf bank_mask:0xf
s_nop 1
v_min_u32_dpp v152, v152, v152 row_ror:4 row_mask:0xf bank_mask:0xf
s_nop 1
v_min_u32_dpp v152, v152, v152 row_ror:2 row_mask:0xf bank_mask:0xf
s_nop 1
v_min_u32_dpp v152, v152, v152 row_ror:1 row_mask:0xf bank_mask:0xf
s_nop 0
v_readlane_b32 s64, v152, 0
v_readlane_b32 s48, v152, 16
s_min_u32 s64, s64, s48
s_cmp_gt_u32 s64, s56
s_cbranch_scc1 L_t4px_152
s_sleep 8
s_branch L_t4p_151
L_t4px_152:
s_add_u32 s74, s58, 16777216
s_add_u32 s75, s58, 16781312
s_add_u32 s76, s58, 16785408
buffer_load_dwordx4 a[48:51], v2, s[4:7], s74 offen offset:0 sc1
buffer_load_dwordx4 a[52:55], v2, s[4:7], s74 offen offset:2048 sc1
buffer_load_dwordx4 a[56:59], v2, s[4:7], s75 offen offset:0 sc1
buffer_load_dwordx4 a[60:63], v2, s[4:7], s75 offen offset:2048 sc1
buffer_load_dwordx4 a[64:67], v2, s[4:7], s76 offen offset:0 sc1
buffer_load_dwordx4 a[68:71], v2, s[4:7], s76 offen offset:2048 sc1
buffer_load_dwordx4 a[72:75], v2, s[4:7], s74 offen offset:256 sc1
buffer_load_dwordx4 a[76:79], v2, s[4:7], s74 offen offset:2304 sc1
buffer_load_dwordx4 a[80:83], v2, s[4:7], s75 offen offset:256 sc1
buffer_load_dwordx4 a[84:87], v2, s[4:7], s75 offen offset:2304 sc1
buffer_load_dwordx4 a[88:91], v2, s[4:7], s76 offen offset:256 sc1
buffer_load_dwordx4 a[92:95], v2, s[4:7], s76 offen offset:2304 sc1
s_add_u32 s74, s58, 83886080
s_add_u32 s75, s58, 83890176
s_add_u32 s76, s58, 83894272
buffer_load_dwordx4 a[0:3], v2, s[4:7], s74 offen offset:0 sc1
buffer_load_dwordx4 a[4:7], v2, s[4:7], s74 offen offset:2048 sc1
buffer_load_dwordx4 a[8:11], v2, s[4:7], s75 offen offset:0 sc1
buffer_load_dwordx4 a[12:15], v2, s[4:7], s75 offen offset:2048 sc1
buffer_load_dwordx4 a[16:19], v2, s[4:7], s76 offen offset:0 sc1
buffer_load_dwordx4 a[20:23], v2, s[4:7], s76 offen offset:2048 sc1
buffer_load_dwordx4 a[24:27], v2, s[4:7], s74 offen offset:256 sc1
buffer_load_dwordx4 a[28:31], v2, s[4:7], s74 offen offset:2304 sc1
buffer_load_dwordx4 a[32:35], v2, s[4:7], s75 offen offset:256 sc1
buffer_load_dwordx4 a[36:39], v2, s[4:7], s75 offen offset:2304 sc1
buffer_load_dwordx4 a[40:43], v2, s[4:7], s76 offen offset:256 sc1
buffer_load_dwordx4 a[44:47], v2, s[4:7], s76 offen offset:2304 sc1
s_add_u32 s74, s58, 50331648
s_add_u32 s75, s58, 50335744
s_add_u32 s76, s58, 50339840
buffer_load_dwordx4 a[96:99], v3, s[4:7], s74 offen offset:0 sc1
buffer_load_dwordx4 a[100:103], v3, s[4:7], s74 offen offset:1024 sc1
buffer_load_dwordx4 a[104:107], v3, s[4:7], s74 offen offset:2048 sc1
buffer_load_dwordx4 a[108:111], v3, s[4:7], s74 offen offset:3072 sc1
buffer_load_dwordx4 a[112:115], v3, s[4:7], s75 offen offset:0 sc1
buffer_load_dwordx4 a[116:119], v3, s[4:7], s75 offen offset:1024 sc1
buffer_load_dwordx4 a[120:123], v3, s[4:7], s75 offen offset:2048 sc1
buffer_load_dwordx4 a[124:127], v3, s[4:7], s75 offen offset:3072 sc1
buffer_load_dwordx4 a[128:131], v3, s[4:7], s76 offen offset:0 sc1
buffer_load_dwordx4 a[132:135], v3, s[4:7], s76 offen offset:1024 sc1
buffer_load_dwordx4 a[136:139], v3, s[4:7], s76 offen offset:2048 sc1
buffer_load_dwordx4 a[140:143], v3, s[4:7], s76 offen offset:3072 sc1
L_t4_153:
s_waitcnt vmcnt(12)
v_mfma_f32_16x16x32_bf16 v[112:115], a[48:51], a[0:3], 0
v_mfma_f32_16x16x32_bf16 v[116:119], a[48:51], a[24:27], 0
v_mfma_f32_16x16x32_bf16 v[120:123], a[72:75], a[24:27], 0
v_mfma_f32_16x16x32_bf16 v[112:115], a[52:55], a[4:7], v[112:115]
v_mfma_f32_16x16x32_bf16 v[116:119], a[52:55], a[28:31], v[116:119]
v_mfma_f32_16x16x32_bf16 v[120:123], a[76:79], a[28:31], v[120:123]
v_mfma_f32_16x16x32_bf16 v[112:115], a[56:59], a[8:11], v[112:115]
v_mfma_f32_16x16x32_bf16 v[116:119], a[56:59], a[32:35], v[116:119]
v_mfma_f32_16x16x32_bf16 v[120:123], a[80:83], a[32:35], v[120:123]
v_mfma_f32_16x16x32_bf16 v[112:115], a[60:63], a[12:15], v[112:115]
v_mfma_f32_16x16x32_bf16 v[116:119], a[60:63], a[36:39], v[116:119]
v_mfma_f32_16x16x32_bf16 v[120:123], a[84:87], a[36:39], v[120:123]
v_mfma_f32_16x16x32_bf16 v[112:115], a[64:67], a[16:19], v[112:115]
v_mfma_f32_16x16x32_bf16 v[116:119], a[64:67], a[40:43], v[116:119]
v_mfma_f32_16x16x32_bf16 v[120:123], a[88:91], a[40:43], v[120:123]
v_mfma_f32_16x16x32_bf16 v[112:115], a[68:71], a[20:23], v[112:115]
v_mfma_f32_16x16x32_bf16 v[116:119], a[68:71], a[44:47], v[116:119]
v_mfma_f32_16x16x32_bf16 v[120:123], a[92:95], a[44:47], v[120:123]
s_add_u32 s54, s54, s84
s_sub_u32 s48, s54, s85
s_sub_u32 s49, s86, s85
s_cmp_lt_u32 s48, s49
s_cselect_b32 s49, s49, 0
s_add_u32 s54, s54, s49
s_cmp_lt_u32 s54, s82
s_cselect_b32 s63, 1, 0
s_cbranch_scc0 L_t4n_155
s_lshr_b32 s60, s54, 3
s_and_b32 s61, s54, 7
s_add_u32 s61, s61, s55
s_lshl_b32 s62, s60, 5
s_add_u32 s62, s62, s61
s_mul_i32 s62, s62, 12288
s_cmp_gt_u32 s64, s60
s_cbranch_scc1 L_t4px_157
s_mov_b32 s53, 0
L_t4p_156:
buffer_load_dword v152, v5, s[4:7], 0 offen sc1
s_add_u32 s53, s53, 1
s_cmp_gt_u32 s53, 100000
s_cbranch_scc1 L_t4px_157
s_waitcnt vmcnt(0)
v_min_u32_dpp v152, v152, v152 row_ror:8 row_mask:0xf bank_mask:0xf
s_nop 1
v_min_u32_dpp v152, v152, v152 row_ror:4 row_mask:0xf bank_mask:0xf
s_nop 1
v_min_u32_dpp v152, v152, v152 row_ror:2 row_mask:0xf bank_mask:0xf
s_nop 1
v_min_u32_dpp v152, v152, v152 row_ror:1 row_mask:0xf bank_mask:0xf
s_nop 0
v_readlane_b32 s64, v152, 0
v_readlane_b32 s48, v152, 16
s_min_u32 s64, s64, s48
s_cmp_gt_u32 s64, s60
s_cbranch_scc1 L_t4px_157
s_sleep 8
s_branch L_t4p_156
L_t4px_157:
L_t4n_155:
s_mul_i32 s48, s57, 384
s_add_u32 s48, s48, 32768
v_min_u32 v6, 2, v1
v_lshl_add_u32 v6, v6, 7, s48
s_mov_b32 s65, 0
s_cmp_ge_u32 s56, 60
s_cselect_b32 s83, 1, 0
s_sub_u32 s83, s56, s83
s_lshl_b32 s59, s56, 8
s_add_u32 s59, s59, 184549376
buffer_load_dword v148, v7, s[4:7], s59 offen offset:0 sc1
buffer_load_dword v149, v7, s[4:7], s59 offen offset:128 sc1
v_mov_b32 v153, 0xff800000
v_cndmask_b32 v112, v112, v153, s[66:67]
v_cndmask_b32 v120, v120, v153, s[66:67]
v_cndmask_b32 v113, v113, v153, s[68:69]
v_cndmask_b32 v121, v121, v153, s[68:69]
v_cndmask_b32 v114, v114, v153, s[70:71]
v_cndmask_b32 v122, v122, v153, s[70:71]
v_cndmask_b32 v115, v115, v153, s[72:73]
v_cndmask_b32 v123, v123, v153, s[72:73]
s_cmp_gt_u32 s65, s83
s_cbranch_scc1 L_p3x_159
s_mov_b32 s53, 0
L_p3_158:
buffer_load_dword v152, v6, s[4:7], 0 offen sc1
s_add_u32 s53, s53, 1
s_cmp_gt_u32 s53, 100000
s_cbranch_scc1 L_p3x_159
s_waitcnt vmcnt(0)
v_readlane_b32 s65, v152, 0
v_readlane_b32 s48, v152, 1
s_min_u32 s65, s65, s48
v_readlane_b32 s48, v152, 2
s_min_u32 s65, s65, s48
s_cmp_gt_u32 s65, s83
s_cbranch_scc1 L_p3x_159
s_sleep 3
s_branch L_p3_158
L_p3x_159:
s_cmp_lt_u32 s56, 60
s_cbranch_scc1 L_t4ns_162
s_sleep 6
s_cmp_eq_u32 s56, 63
s_cbranch_scc1 L_t4ns_162
s_sleep 10
L_t4ns_162:
s_lshr_b32 s48, s58, 2
s_add_u32 s49, s48, 150994944
s_add_u32 s50, s48, 159383552
s_mov_b32 s53, 0
L_t4k_160:
buffer_load_dwordx4 v[192:195], v4, s[4:7], s49 offen offset:0 sc1
buffer_load_dwordx4 v[196:199], v4, s[4:7], s49 offen offset:512 sc1
buffer_load_dwordx4 v[200:203], v4, s[4:7], s49 offen offset:1024 sc1
buffer_load_dwordx4 v[204:207], v4, s[4:7], s49 offen offset:1536 sc1
buffer_load_dwordx4 v[208:211], v4, s[4:7], s49 offen offset:2048 sc1
buffer_load_dwordx4 v[212:215], v4, s[4:7], s49 offen offset:2560 sc1
buffer_load_dwordx4 v[216:219], v3, s[4:7], s50 offen offset:0 sc1
buffer_load_dwordx4 v[220:223], v3, s[4:7], s50 offen offset:1024 sc1
buffer_load_dwordx4 v[224:227], v3, s[4:7], s50 offen offset:2048 sc1
s_add_u32 s53, s53, 1
s_cmp_gt_u32 s53, 100000
s_cbranch_scc1 L_t4kx_161
s_waitcnt vmcnt(8)
v_mfma_f32_16x16x32_bf16 v[124:127], v[192:195], a[0:3], 0
v_mfma_f32_16x16x32_bf16 v[128:131], v[192:195], a[24:27], 0
v_max3_u32 v152, v192, v193, v194
v_max_u32 v152, v152, v195
s_waitcnt vmcnt(7)
v_mfma_f32_16x16x32_bf16 v[124:127], v[196:199], a[4:7], v[124:127]
v_mfma_f32_16x16x32_bf16 v[128:131], v[196:199], a[28:31], v[128:131]
v_max3_u32 v152, v152, v196, v197
v_max3_u32 v152, v152, v198, v199
s_waitcnt vmcnt(6)
v_mfma_f32_16x16x32_bf16 v[124:127], v[200:203], a[8:11], v[124:127]
v_mfma_f32_16x16x32_bf16 v[128:131], v[200:203], a[32:35], v[128:131]
v_max3_u32 v152, v152, v200, v201
v_max3_u32 v152, v152, v202, v203
s_waitcnt vmcnt(5)
v_mfma_f32_16x16x32_bf16 v[124:127], v[204:207], a[12:15], v[124:127]
v_mfma_f32_16x16x32_bf16 v[128:131], v[204:207], a[36:39], v[128:131]
v_max3_u32 v152, v152, v204, v205
v_max3_u32 v152, v152, v206, v207
s_waitcnt vmcnt(4)
v_mfma_f32_16x16x32_bf16 v[124:127], v[208:211], a[16:19], v[124:127]
v_mfma_f32_16x16x32_bf16 v[128:131], v[208:211], a[40:43], v[128:131]
v_max3_u32 v152, v152, v208, v209
v_max3_u32 v152, v152, v210, v211
s_waitcnt vmcnt(3)
v_mfma_f32_16x16x32_bf16 v[124:127], v[212:215], a[20:23], v[124:127]
v_mfma_f32_16x16x32_bf16 v[128:131], v[212:215], a[44:47], v[128:131]
v_max3_u32 v152, v152, v212, v213
v_max3_u32 v152, v152, v214, v215
s_waitcnt vmcnt(2)
v_max3_u32 v152, v152, v216, v217
v_max3_u32 v152, v152, v218, v219
s_waitcnt vmcnt(1)
v_max3_u32 v152, v152, v220, v221
v_max3_u32 v152, v152, v222, v223
s_waitcnt vmcnt(0)
v_max3_u32 v152, v152, v224, v225
v_max3_u32 v152, v152, v226, v227
v_cmp_eq_u32 vcc, -1, v152
s_cbranch_vccnz L_t4k_160
L_t4kx_161:
s_waitcnt vmcnt(0)
s_cmp_eq_u32 s63, 0
s_cbranch_scc1 L_t4q_163
s_add_u32 s74, s62, 16777216
s_add_u32 s75, s62, 16781312
s_add_u32 s76, s62, 16785408
buffer_load_dwordx4 a[48:51], v2, s[4:7], s74 offen offset:0 sc1
buffer_load_dwordx4 a[52:55], v2, s[4:7], s74 offen offset:2048 sc1
buffer_load_dwordx4 a[56:59], v2, s[4:7], s75 offen offset:0 sc1
buffer_load_dwordx4 a[60:63], v2, s[4:7], s75 offen offset:2048 sc1
buffer_load_dwordx4 a[64:67], v2, s[4:7], s76 offen offset:0 sc1
buffer_load_dwordx4 a[68:71], v2, s[4:7], s76 offen offset:2048 sc1
buffer_load_dwordx4 a[72:75], v2, s[4:7], s74 offen offset:256 sc1
buffer_load_dwordx4 a[76:79], v2, s[4:7], s74 offen offset:2304 sc1
buffer_load_dwordx4 a[80:83], v2, s[4:7], s75 offen offset:256 sc1
buffer_load_dwordx4 a[84:87], v2, s[4:7], s75 offen offset:2304 sc1
buffer_load_dwordx4 a[88:91], v2, s[4:7], s76 offen offset:256 sc1
buffer_load_dwordx4 a[92:95], v2, s[4:7], s76 offen offset:2304 sc1
s_add_u32 s74, s62, 83886080
s_add_u32 s75, s62, 83890176
s_add_u32 s76, s62, 83894272
buffer_load_dwordx4 a[0:3], v2, s[4:7], s74 offen offset:0 sc1
buffer_load_dwordx4 a[4:7], v2, s[4:7], s74 offen offset:2048 sc1
buffer_load_dwordx4 a[8:11], v2, s[4:7], s75 offen offset:0 sc1
buffer_load_dwordx4 a[12:15], v2, s[4:7], s75 offen offset:2048 sc1
buffer_load_dwordx4 a[16:19], v2, s[4:7], s76 offen offset:0 sc1
buffer_load_dwordx4 a[20:23], v2, s[4:7], s76 offen offset:2048 sc1
buffer_load_dwordx4 a[24:27], v2, s[4:7], s74 offen offset:256 sc1
buffer_load_dwordx4 a[28:31], v2, s[4:7], s74 offen offset:2304 sc1
buffer_load_dwordx4 a[32:35], v2, s[4:7], s75 offen offset:256 sc1
buffer_load_dwordx4 a[36:39], v2, s[4:7], s75 offen offset:2304 sc1
buffer_load_dwordx4 a[40:43], v2, s[4:7], s76 offen offset:256 sc1
buffer_load_dwordx4 a[44:47], v2, s[4:7], s76 offen offset:2304 sc1
L_t4q_163:
v_max3_f32 v152, v112, v113, v114
v_max3_f32 v152, v152, v115, v124
v_max_f32 v152, v152, v125
v_mov_b32 v156, v152
s_nop 0
s_nop 0
v_permlane32_swap_b32 v152, v156
v_max_f32 v152, v152, v156
v_mov_b32 v156, v152
s_nop 0
s_nop 0
v_permlane16_swap_b32 v152, v156
v_max_f32 v152, v152, v156
v_mul_f32 v152, s80, v152
v_pk_fma_f32 v[112:113], v[112:113], s[80:81], v[152:153] op_sel_hi:[1,1,0] neg_lo:[0,0,1] neg_hi:[0,0,1]
v_pk_fma_f32 v[114:115], v[114:115], s[80:81], v[152:153] op_sel_hi:[1,1,0] neg_lo:[0,0,1] neg_hi:[0,0,1]
v_pk_fma_f32 v[124:125], v[124:125], s[80:81], v[152:153] op_sel_hi:[1,1,0] neg_lo:[0,0,1] neg_hi:[0,0,1]
v_exp_f32 v112, v112
v_exp_f32 v113, v113
v_exp_f32 v114, v114
v_exp_f32 v115, v115
v_exp_f32 v124, v124
v_exp_f32 v125, v125
v_cvt_pk_bf16_f32 v132, v112, v113
v_cvt_pk_bf16_f32 v133, v114, v115
v_cvt_pk_bf16_f32 v140, v124, v125
v_cvt_pk_bf16_f32 v143, v124, v125
v_pk_add_f32 v[112:113], v[112:113], v[114:115]
v_pk_add_f32 v[112:113], v[112:113], v[124:125]
v_add_f32 v152, v112, v113
v_mov_b32 v156, v152
s_nop 0
s_nop 0
v_permlane32_swap_b32 v152, v156
v_add_f32 v152, v152, v156
v_mov_b32 v156, v152
s_nop 0
s_nop 0
v_permlane16_swap_b32 v152, v156
v_add_f32 v152, v152, v156
v_rcp_f32 v152, v152
s_nop 0
v_mul_f32 v152, v152, v148
v_max3_f32 v154, v116, v117, v118
v_max3_f32 v154, v154, v119, v120
v_max3_f32 v154, v154, v121, v122
v_max3_f32 v154, v154, v123, v128
v_max_f32 v154, v154, v129
v_mov_b32 v156, v154
s_nop 0
s_nop 0
v_permlane32_swap_b32 v154, v156
v_max_f32 v154, v154, v156
v_mov_b32 v156, v154
s_nop 0
s_nop 0
v_permlane16_swap_b32 v154, v156
v_max_f32 v154, v154, v156
v_mul_f32 v154, s80, v154
v_pk_fma_f32 v[116:117], v[116:117], s[80:81], v[154:155] op_sel_hi:[1,1,0] neg_lo:[0,0,1] neg_hi:[0,0,1]
v_pk_fma_f32 v[118:119], v[118:119], s[80:81], v[154:155] op_sel_hi:[1,1,0] neg_lo:[0,0,1] neg_hi:[0,0,1]
v_pk_fma_f32 v[120:121], v[120:121], s[80:81], v[154:155] op_sel_hi:[1,1,0] neg_lo:[0,0,1] neg_hi:[0,0,1]
v_pk_fma_f32 v[122:123], v[122:123], s[80:81], v[154:155] op_sel_hi:[1,1,0] neg_lo:[0,0,1] neg_hi:[0,0,1]
v_pk_fma_f32 v[128:129], v[128:129], s[80:81], v[154:155] op_sel_hi:[1,1,0] neg_lo:[0,0,1] neg_hi:[0,0,1]
v_exp_f32 v116, v116
v_exp_f32 v117, v117
v_exp_f32 v118, v118
v_exp_f32 v119, v119
v_exp_f32 v120, v120
v_exp_f32 v121, v121
v_exp_f32 v122, v122
v_exp_f32 v123, v123
v_exp_f32 v128, v128
v_exp_f32 v129, v129
v_cvt_pk_bf16_f32 v136, v116, v117
v_cvt_pk_bf16_f32 v137, v118, v119
v_cvt_pk_bf16_f32 v138, v120, v121
v_cvt_pk_bf16_f32 v139, v122, v123
v_cvt_pk_bf16_f32 v144, v128, v129
v_cvt_pk_bf16_f32 v147, v128, v129
v_pk_add_f32 v[116:117], v[116:117], v[118:119]
v_pk_add_f32 v[116:117], v[116:117], v[120:121]
v_pk_add_f32 v[116:117], v[116:117], v[122:123]
v_pk_add_f32 v[116:117], v[116:117], v[128:129]
v_add_f32 v154, v116, v117
v_mov_b32 v156, v154
s_nop 0
s_nop 0
v_permlane32_swap_b32 v154, v156
v_add_f32 v154, v154, v156
v_mov_b32 v156, v154
s_nop 0
s_nop 0
v_permlane16_swap_b32 v154, v156
v_add_f32 v154, v154, v156
v_rcp_f32 v154, v154
s_nop 0
v_mul_f32 v154, v154, v149
s_add_u32 s77, s58, 117440512
s_add_u32 s78, s58, 117444608
s_add_u32 s79, s58, 117448704
s_cmp_lg_u32 s87, 0
s_cbranch_scc1 L_t4l2_164
v_mfma_f32_16x16x32_bf16 v[16:19], a[96:99], v[132:135], 0
v_mfma_f32_16x16x32_bf16 v[20:23], a[96:99], v[136:139], 0
v_mfma_f32_16x16x32_bf16 v[24:27], a[100:103], v[132:135], 0
v_mfma_f32_16x16x32_bf16 v[28:31], a[100:103], v[136:139], 0
s_nop 2
v_mfma_f32_16x16x16_bf16 v[16:19], v[216:217], v[140:141], v[16:19]
v_mfma_f32_16x16x16_bf16 v[20:23], v[216:217], v[144:145], v[20:23]
v_mfma_f32_16x16x16_bf16 v[24:27], v[216:217], v[142:143], v[24:27]
v_mfma_f32_16x16x16_bf16 v[28:31], v[216:217], v[146:147], v[28:31]
v_mfma_f32_16x16x32_bf16 v[32:35], a[104:107], v[132:135], 0
v_mfma_f32_16x16x32_bf16 v[36:39], a[104:107], v[136:139], 0
s_nop 2
v_pk_mul_f32 v[16:17], v[16:17], v[152:153] op_sel_hi:[1,0]
v_pk_mul_f32 v[18:19], v[18:19], v[152:153] op_sel_hi:[1,0]
v_mfma_f32_16x16x32_bf16 v[40:43], a[108:111], v[132:135], 0
v_cvt_pk_bf16_f32 v160, v16, v17
v_cvt_pk_bf16_f32 v161, v18, v19
v_pk_mul_f32 v[24:25], v[24:25], v[152:153] op_sel_hi:[1,0]
v_mfma_f32_16x16x32_bf16 v[44:47], a[108:111], v[136:139], 0
v_pk_mul_f32 v[26:27], v[26:27], v[152:153] op_sel_hi:[1,0]
v_cvt_pk_bf16_f32 v162, v24, v25
v_mfma_f32_16x16x16_bf16 v[32:35], v[218:219], v[140:141], v[32:35]
v_cvt_pk_bf16_f32 v163, v26, v27
buffer_store_dwordx4 v[160:163], v2, s[4:7], s77 offen offset:0 sc1
v_pk_mul_f32 v[20:21], v[20:21], v[154:155] op_sel_hi:[1,0]
v_mfma_f32_16x16x16_bf16 v[36:39], v[218:219], v[144:145], v[36:39]
v_pk_mul_f32 v[22:23], v[22:23], v[154:155] op_sel_hi:[1,0]
v_cvt_pk_bf16_f32 v164, v20, v21
v_mfma_f32_16x16x16_bf16 v[40:43], v[218:219], v[142:143], v[40:43]
v_cvt_pk_bf16_f32 v165, v22, v23
v_pk_mul_f32 v[28:29], v[28:29], v[154:155] op_sel_hi:[1,0]
v_pk_mul_f32 v[30:31], v[30:31], v[154:155] op_sel_hi:[1,0]
v_mfma_f32_16x16x16_bf16 v[44:47], v[218:219], v[146:147], v[44:47]
v_cvt_pk_bf16_f32 v166, v28, v29
v_cvt_pk_bf16_f32 v167, v30, v31
buffer_store_dwordx4 v[164:167], v2, s[4:7], s77 offen offset:256 sc1
v_mfma_f32_16x16x32_bf16 v[48:51], a[112:115], v[132:135], 0
v_mfma_f32_16x16x32_bf16 v[52:55], a[112:115], v[136:139], 0
v_pk_mul_f32 v[32:33], v[32:33], v[152:153] op_sel_hi:[1,0]
v_pk_mul_f32 v[34:35], v[34:35], v[152:153] op_sel_hi:[1,0]
v_mfma_f32_16x16x32_bf16 v[56:59], a[116:119], v[132:135], 0
v_cvt_pk_bf16_f32 v168, v32, v33
v_cvt_pk_bf16_f32 v169, v34, v35
v_pk_mul_f32 v[40:41], v[40:41], v[152:153] op_sel_hi:[1,0]
v_mfma_f32_16x16x32_bf16 v[60:63], a[116:119], v[136:139], 0
v_pk_mul_f32 v[42:43], v[42:43], v[152:153] op_sel_hi:[1,0]
v_cvt_pk_bf16_f32 v170, v40, v41
v_mfma_f32_16x16x16_bf16 v[48:51], v[220:221], v[140:141], v[48:51]
v_cvt_pk_bf16_f32 v171, v42, v43
buffer_store_dwordx4 v[168:171], v2, s[4:7], s77 offen offset:2048 sc1
v_pk_mul_f32 v[36:37], v[36:37], v[154:155] op_sel_hi:[1,0]
v_mfma_f32_16x16x16_bf16 v[52:55], v[220:221], v[144:145], v[52:55]
v_pk_mul_f32 v[38:39], v[38:39], v[154:155] op_sel_hi:[1,0]
v_cvt_pk_bf16_f32 v172, v36, v37
v_mfma_f32_16x16x16_bf16 v[56:59], v[220:221], v[142:143], v[56:59]
v_cvt_pk_bf16_f32 v173, v38, v39
v_pk_mul_f32 v[44:45], v[44:45], v[154:155] op_sel_hi:[1,0]
v_pk_mul_f32 v[46:47], v[46:47], v[154:155] op_sel_hi:[1,0]
v_mfma_f32_16x16x16_bf16 v[60:63], v[220:221], v[146:147], v[60:63]
v_cvt_pk_bf16_f32 v174, v44, v45
v_cvt_pk_bf16_f32 v175, v46, v47
buffer_store_dwordx4 v[172:175], v2, s[4:7], s77 offen offset:2304 sc1
v_mfma_f32_16x16x32_bf16 v[64:67], a[120:123], v[132:135], 0
v_mfma_f32_16x16x32_bf16 v[68:71], a[120:123], v[136:139], 0
v_pk_mul_f32 v[48:49], v[48:49], v[152:153] op_sel_hi:[1,0]
v_pk_mul_f32 v[50:51], v[50:51], v[152:153] op_sel_hi:[1,0]
v_mfma_f32_16x16x32_bf16 v[72:75], a[124:127], v[132:135], 0
v_cvt_pk_bf16_f32 v160, v48, v49
v_cvt_pk_bf16_f32 v161, v50, v51
v_pk_mul_f32 v[56:57], v[56:57], v[152:153] op_sel_hi:[1,0]
v_mfma_f32_16x16x32_bf16 v[76:79], a[124:127], v[136:139], 0
v_pk_mul_f32 v[58:59], v[58:59], v[152:153] op_sel_hi:[1,0]
v_cvt_pk_bf16_f32 v162, v56, v57
v_mfma_f32_16x16x16_bf16 v[64:67], v[222:223], v[140:141], v[64:67]
v_cvt_pk_bf16_f32 v163, v58, v59
buffer_store_dwordx4 v[160:163], v2, s[4:7], s78 offen offset:0 sc1
v_pk_mul_f32 v[52:53], v[52:53], v[154:155] op_sel_hi:[1,0]
v_mfma_f32_16x16x16_bf16 v[68:71], v[222:223], v[144:145], v[68:71]
v_pk_mul_f32 v[54:55], v[54:55], v[154:155] op_sel_hi:[1,0]
v_cvt_pk_bf16_f32 v164, v52, v53
v_mfma_f32_16x16x16_bf16 v[72:75], v[222:223], v[142:143], v[72:75]
v_cvt_pk_bf16_f32 v165, v54, v55
v_pk_mul_f32 v[60:61], v[60:61], v[154:155] op_sel_hi:[1,0]
v_pk_mul_f32 v[62:63], v[62:63], v[154:155] op_sel_hi:[1,0]
v_mfma_f32_16x16x16_bf16 v[76:79], v[222:223], v[146:147], v[76:79]
v_cvt_pk_bf16_f32 v166, v60, v61
v_cvt_pk_bf16_f32 v167, v62, v63
buffer_store_dwordx4 v[164:167], v2, s[4:7], s78 offen offset:256 sc1
v_mfma_f32_16x16x32_bf16 v[80:83], a[128:131], v[132:135], 0
v_mfma_f32_16x16x32_bf16 v[84:87], a[128:131], v[136:139], 0
v_pk_mul_f32 v[64:65], v[64:65], v[152:153] op_sel_hi:[1,0]
v_pk_mul_f32 v[66:67], v[66:67], v[152:153] op_sel_hi:[1,0]
v_mfma_f32_16x16x32_bf16 v[88:91], a[132:135], v[132:135], 0
v_cvt_pk_bf16_f32 v168, v64, v65
v_cvt_pk_bf16_f32 v169, v66, v67
v_pk_mul_f32 v[72:73], v[72:73], v[152:153] op_sel_hi:[1,0]
v_mfma_f32_16x16x32_bf16 v[92:95], a[132:135], v[136:139], 0
v_pk_mul_f32 v[74:75], v[74:75], v[152:153] op_sel_hi:[1,0]
v_cvt_pk_bf16_f32 v170, v72, v73
v_mfma_f32_16x16x16_bf16 v[80:83], v[224:225], v[140:141], v[80:83]
v_cvt_pk_bf16_f32 v171, v74, v75
buffer_store_dwordx4 v[168:171], v2, s[4:7], s78 offen offset:2048 sc1
v_pk_mul_f32 v[68:69], v[68:69], v[154:155] op_sel_hi:[1,0]
v_mfma_f32_16x16x16_bf16 v[84:87], v[224:225], v[144:145], v[84:87]
v_pk_mul_f32 v[70:71], v[70:71], v[154:155] op_sel_hi:[1,0]
v_cvt_pk_bf16_f32 v172, v68, v69
v_mfma_f32_16x16x16_bf16 v[88:91], v[224:225], v[142:143], v[88:91]
v_cvt_pk_bf16_f32 v173, v70, v71
v_pk_mul_f32 v[76:77], v[76:77], v[154:155] op_sel_hi:[1,0]
v_pk_mul_f32 v[78:79], v[78:79], v[154:155] op_sel_hi:[1,0]
v_mfma_f32_16x16x16_bf16 v[92:95], v[224:225], v[146:147], v[92:95]
v_cvt_pk_bf16_f32 v174, v76, v77
v_cvt_pk_bf16_f32 v175, v78, v79
buffer_store_dwordx4 v[172:175], v2, s[4:7], s78 offen offset:2304 sc1
v_mfma_f32_16x16x32_bf16 v[96:99], a[136:139], v[132:135], 0
v_mfma_f32_16x16x32_bf16 v[100:103], a[136:139], v[136:139], 0
v_pk_mul_f32 v[80:81], v[80:81], v[152:153] op_sel_hi:[1,0]
v_pk_mul_f32 v[82:83], v[82:83], v[152:153] op_sel_hi:[1,0]
v_mfma_f32_16x16x32_bf16 v[104:107], a[140:143], v[132:135], 0
v_cvt_pk_bf16_f32 v160, v80, v81
v_cvt_pk_bf16_f32 v161, v82, v83
v_pk_mul_f32 v[88:89], v[88:89], v[152:153] op_sel_hi:[1,0]
v_mfma_f32_16x16x32_bf16 v[108:111], a[140:143], v[136:139], 0
v_pk_mul_f32 v[90:91], v[90:91], v[152:153] op_sel_hi:[1,0]
v_cvt_pk_bf16_f32 v162, v88, v89
v_mfma_f32_16x16x16_bf16 v[96:99], v[226:227], v[140:141], v[96:99]
v_cvt_pk_bf16_f32 v163, v90, v91
buffer_store_dwordx4 v[160:163], v2, s[4:7], s79 offen offset:0 sc1
v_pk_mul_f32 v[84:85], v[84:85], v[154:155] op_sel_hi:[1,0]
v_mfma_f32_16x16x16_bf16 v[100:103], v[226:227], v[144:145], v[100:103]
v_pk_mul_f32 v[86:87], v[86:87], v[154:155] op_sel_hi:[1,0]
v_cvt_pk_bf16_f32 v164, v84, v85
v_mfma_f32_16x16x16_bf16 v[104:107], v[226:227], v[142:143], v[104:107]
v_cvt_pk_bf16_f32 v165, v86, v87
v_pk_mul_f32 v[92:93], v[92:93], v[154:155] op_sel_hi:[1,0]
v_pk_mul_f32 v[94:95], v[94:95], v[154:155] op_sel_hi:[1,0]
v_mfma_f32_16x16x16_bf16 v[108:111], v[226:227], v[146:147], v[108:111]
v_cvt_pk_bf16_f32 v166, v92, v93
v_cvt_pk_bf16_f32 v167, v94, v95
buffer_store_dwordx4 v[164:167], v2, s[4:7], s79 offen offset:256 sc1
v_pk_mul_f32 v[96:97], v[96:97], v[152:153] op_sel_hi:[1,0]
v_pk_mul_f32 v[98:99], v[98:99], v[152:153] op_sel_hi:[1,0]
v_cvt_pk_bf16_f32 v168, v96, v97
v_cvt_pk_bf16_f32 v169, v98, v99
v_pk_mul_f32 v[104:105], v[104:105], v[152:153] op_sel_hi:[1,0]
v_pk_mul_f32 v[106:107], v[106:107], v[152:153] op_sel_hi:[1,0]
v_cvt_pk_bf16_f32 v170, v104, v105
v_cvt_pk_bf16_f32 v171, v106, v107
buffer_store_dwordx4 v[168:171], v2, s[4:7], s79 offen offset:2048 sc1
v_pk_mul_f32 v[100:101], v[100:101], v[154:155] op_sel_hi:[1,0]
v_pk_mul_f32 v[102:103], v[102:103], v[154:155] op_sel_hi:[1,0]
v_cvt_pk_bf16_f32 v172, v100, v101
v_cvt_pk_bf16_f32 v173, v102, v103
v_pk_mul_f32 v[108:109], v[108:109], v[154:155] op_sel_hi:[1,0]
v_pk_mul_f32 v[110:111], v[110:111], v[154:155] op_sel_hi:[1,0]
v_cvt_pk_bf16_f32 v174, v108, v109
v_cvt_pk_bf16_f32 v175, v110, v111
buffer_store_dwordx4 v[172:175], v2, s[4:7], s79 offen offset:2304 sc1
s_branch L_t4l2j_165
L_t4l2_164:
v_mfma_f32_16x16x32_bf16 v[16:19], a[96:99], v[132:135], 0
v_mfma_f32_16x16x32_bf16 v[20:23], a[96:99], v[136:139], 0
v_mfma_f32_16x16x32_bf16 v[24:27], a[100:103], v[132:135], 0
v_mfma_f32_16x16x32_bf16 v[28:31], a[100:103], v[136:139], 0
s_nop 2
v_mfma_f32_16x16x16_bf16 v[16:19], v[216:217], v[140:141], v[16:19]
v_mfma_f32_16x16x16_bf16 v[20:23], v[216:217], v[144:145], v[20:23]
v_mfma_f32_16x16x16_bf16 v[24:27], v[216:217], v[142:143], v[24:27]
v_mfma_f32_16x16x16_bf16 v[28:31], v[216:217], v[146:147], v[28:31]
v_mfma_f32_16x16x32_bf16 v[32:35], a[104:107], v[132:135], 0
v_mfma_f32_16x16x32_bf16 v[36:39], a[104:107], v[136:139], 0
s_nop 2
v_pk_mul_f32 v[16:17], v[16:17], v[152:153] op_sel_hi:[1,0]
v_pk_mul_f32 v[18:19], v[18:19], v[152:153] op_sel_hi:[1,0]
v_mfma_f32_16x16x32_bf16 v[40:43], a[108:111], v[132:135], 0
v_cvt_pk_bf16_f32 v160, v16, v17
v_cvt_pk_bf16_f32 v161, v18, v19
v_pk_mul_f32 v[24:25], v[24:25], v[152:153] op_sel_hi:[1,0]
v_mfma_f32_16x16x32_bf16 v[44:47], a[108:111], v[136:139], 0
v_pk_mul_f32 v[26:27], v[26:27], v[152:153] op_sel_hi:[1,0]
v_cvt_pk_bf16_f32 v162, v24, v25
v_mfma_f32_16x16x16_bf16 v[32:35], v[218:219], v[140:141], v[32:35]
v_cvt_pk_bf16_f32 v163, v26, v27
buffer_store_dwordx4 v[160:163], v2, s[4:7], s77 offen offset:0
v_pk_mul_f32 v[20:21], v[20:21], v[154:155] op_sel_hi:[1,0]
v_mfma_f32_16x16x16_bf16 v[36:39], v[218:219], v[144:145], v[36:39]
v_pk_mul_f32 v[22:23], v[22:23], v[154:155] op_sel_hi:[1,0]
v_cvt_pk_bf16_f32 v164, v20, v21
v_mfma_f32_16x16x16_bf16 v[40:43], v[218:219], v[142:143], v[40:43]
v_cvt_pk_bf16_f32 v165, v22, v23
v_pk_mul_f32 v[28:29], v[28:29], v[154:155] op_sel_hi:[1,0]
v_pk_mul_f32 v[30:31], v[30:31], v[154:155] op_sel_hi:[1,0]
v_mfma_f32_16x16x16_bf16 v[44:47], v[218:219], v[146:147], v[44:47]
v_cvt_pk_bf16_f32 v166, v28, v29
v_cvt_pk_bf16_f32 v167, v30, v31
buffer_store_dwordx4 v[164:167], v2, s[4:7], s77 offen offset:256
v_mfma_f32_16x16x32_bf16 v[48:51], a[112:115], v[132:135], 0
v_mfma_f32_16x16x32_bf16 v[52:55], a[112:115], v[136:139], 0
v_pk_mul_f32 v[32:33], v[32:33], v[152:153] op_sel_hi:[1,0]
v_pk_mul_f32 v[34:35], v[34:35], v[152:153] op_sel_hi:[1,0]
v_mfma_f32_16x16x32_bf16 v[56:59], a[116:119], v[132:135], 0
v_cvt_pk_bf16_f32 v168, v32, v33
v_cvt_pk_bf16_f32 v169, v34, v35
v_pk_mul_f32 v[40:41], v[40:41], v[152:153] op_sel_hi:[1,0]
v_mfma_f32_16x16x32_bf16 v[60:63], a[116:119], v[136:139], 0
v_pk_mul_f32 v[42:43], v[42:43], v[152:153] op_sel_hi:[1,0]
v_cvt_pk_bf16_f32 v170, v40, v41
v_mfma_f32_16x16x16_bf16 v[48:51], v[220:221], v[140:141], v[48:51]
v_cvt_pk_bf16_f32 v171, v42, v43
buffer_store_dwordx4 v[168:171], v2, s[4:7], s77 offen offset:2048
v_pk_mul_f32 v[36:37], v[36:37], v[154:155] op_sel_hi:[1,0]
v_mfma_f32_16x16x16_bf16 v[52:55], v[220:221], v[144:145], v[52:55]
v_pk_mul_f32 v[38:39], v[38:39], v[154:155] op_sel_hi:[1,0]
v_cvt_pk_bf16_f32 v172, v36, v37
v_mfma_f32_16x16x16_bf16 v[56:59], v[220:221], v[142:143], v[56:59]
v_cvt_pk_bf16_f32 v173, v38, v39
v_pk_mul_f32 v[44:45], v[44:45], v[154:155] op_sel_hi:[1,0]
v_pk_mul_f32 v[46:47], v[46:47], v[154:155] op_sel_hi:[1,0]
v_mfma_f32_16x16x16_bf16 v[60:63], v[220:221], v[146:147], v[60:63]
v_cvt_pk_bf16_f32 v174, v44, v45
v_cvt_pk_bf16_f32 v175, v46, v47
buffer_store_dwordx4 v[172:175], v2, s[4:7], s77 offen offset:2304
v_mfma_f32_16x16x32_bf16 v[64:67], a[120:123], v[132:135], 0
v_mfma_f32_16x16x32_bf16 v[68:71], a[120:123], v[136:139], 0
v_pk_mul_f32 v[48:49], v[48:49], v[152:153] op_sel_hi:[1,0]
v_pk_mul_f32 v[50:51], v[50:51], v[152:153] op_sel_hi:[1,0]
v_mfma_f32_16x16x32_bf16 v[72:75], a[124:127], v[132:135], 0
v_cvt_pk_bf16_f32 v160, v48, v49
v_cvt_pk_bf16_f32 v161, v50, v51
v_pk_mul_f32 v[56:57], v[56:57], v[152:153] op_sel_hi:[1,0]
v_mfma_f32_16x16x32_bf16 v[76:79], a[124:127], v[136:139], 0
v_pk_mul_f32 v[58:59], v[58:59], v[152:153] op_sel_hi:[1,0]
v_cvt_pk_bf16_f32 v162, v56, v57
v_mfma_f32_16x16x16_bf16 v[64:67], v[222:223], v[140:141], v[64:67]
v_cvt_pk_bf16_f32 v163, v58, v59
buffer_store_dwordx4 v[160:163], v2, s[4:7], s78 offen offset:0
v_pk_mul_f32 v[52:53], v[52:53], v[154:155] op_sel_hi:[1,0]
v_mfma_f32_16x16x16_bf16 v[68:71], v[222:223], v[144:145], v[68:71]
v_pk_mul_f32 v[54:55], v[54:55], v[154:155] op_sel_hi:[1,0]
v_cvt_pk_bf16_f32 v164, v52, v53
v_mfma_f32_16x16x16_bf16 v[72:75], v[222:223], v[142:143], v[72:75]
v_cvt_pk_bf16_f32 v165, v54, v55
v_pk_mul_f32 v[60:61], v[60:61], v[154:155] op_sel_hi:[1,0]
v_pk_mul_f32 v[62:63], v[62:63], v[154:155] op_sel_hi:[1,0]
v_mfma_f32_16x16x16_bf16 v[76:79], v[222:223], v[146:147], v[76:79]
v_cvt_pk_bf16_f32 v166, v60, v61
v_cvt_pk_bf16_f32 v167, v62, v63
buffer_store_dwordx4 v[164:167], v2, s[4:7], s78 offen offset:256
v_mfma_f32_16x16x32_bf16 v[80:83], a[128:131], v[132:135], 0
v_mfma_f32_16x16x32_bf16 v[84:87], a[128:131], v[136:139], 0
v_pk_mul_f32 v[64:65], v[64:65], v[152:153] op_sel_hi:[1,0]
v_pk_mul_f32 v[66:67], v[66:67], v[152:153] op_sel_hi:[1,0]
v_mfma_f32_16x16x32_bf16 v[88:91], a[132:135], v[132:135], 0
v_cvt_pk_bf16_f32 v168, v64, v65
v_cvt_pk_bf16_f32 v169, v66, v67
v_pk_mul_f32 v[72:73], v[72:73], v[152:153] op_sel_hi:[1,0]
v_mfma_f32_16x16x32_bf16 v[92:95], a[132:135], v[136:139], 0
v_pk_mul_f32 v[74:75], v[74:75], v[152:153] op_sel_hi:[1,0]
v_cvt_pk_bf16_f32 v170, v72, v73
v_mfma_f32_16x16x16_bf16 v[80:83], v[224:225], v[140:141], v[80:83]
v_cvt_pk_bf16_f32 v171, v74, v75
buffer_store_dwordx4 v[168:171], v2, s[4:7], s78 offen offset:2048
v_pk_mul_f32 v[68:69], v[68:69], v[154:155] op_sel_hi:[1,0]
v_mfma_f32_16x16x16_bf16 v[84:87], v[224:225], v[144:145], v[84:87]
v_pk_mul_f32 v[70:71], v[70:71], v[154:155] op_sel_hi:[1,0]
v_cvt_pk_bf16_f32 v172, v68, v69
v_mfma_f32_16x16x16_bf16 v[88:91], v[224:225], v[142:143], v[88:91]
v_cvt_pk_bf16_f32 v173, v70, v71
v_pk_mul_f32 v[76:77], v[76:77], v[154:155] op_sel_hi:[1,0]
v_pk_mul_f32 v[78:79], v[78:79], v[154:155] op_sel_hi:[1,0]
v_mfma_f32_16x16x16_bf16 v[92:95], v[224:225], v[146:147], v[92:95]
v_cvt_pk_bf16_f32 v174, v76, v77
v_cvt_pk_bf16_f32 v175, v78, v79
buffer_store_dwordx4 v[172:175], v2, s[4:7], s78 offen offset:2304
v_mfma_f32_16x16x32_bf16 v[96:99], a[136:139], v[132:135], 0
v_mfma_f32_16x16x32_bf16 v[100:103], a[136:139], v[136:139], 0
v_pk_mul_f32 v[80:81], v[80:81], v[152:153] op_sel_hi:[1,0]
v_pk_mul_f32 v[82:83], v[82:83], v[152:153] op_sel_hi:[1,0]
v_mfma_f32_16x16x32_bf16 v[104:107], a[140:143], v[132:135], 0
v_cvt_pk_bf16_f32 v160, v80, v81
v_cvt_pk_bf16_f32 v161, v82, v83
v_pk_mul_f32 v[88:89], v[88:89], v[152:153] op_sel_hi:[1,0]
v_mfma_f32_16x16x32_bf16 v[108:111], a[140:143], v[136:139], 0
v_pk_mul_f32 v[90:91], v[90:91], v[152:153] op_sel_hi:[1,0]
v_cvt_pk_bf16_f32 v162, v88, v89
v_mfma_f32_16x16x16_bf16 v[96:99], v[226:227], v[140:141], v[96:99]
v_cvt_pk_bf16_f32 v163, v90, v91
buffer_store_dwordx4 v[160:163], v2, s[4:7], s79 offen offset:0
v_pk_mul_f32 v[84:85], v[84:85], v[154:155] op_sel_hi:[1,0]
v_mfma_f32_16x16x16_bf16 v[100:103], v[226:227], v[144:145], v[100:103]
v_pk_mul_f32 v[86:87], v[86:87], v[154:155] op_sel_hi:[1,0]
v_cvt_pk_bf16_f32 v164, v84, v85
v_mfma_f32_16x16x16_bf16 v[104:107], v[226:227], v[142:143], v[104:107]
v_cvt_pk_bf16_f32 v165, v86, v87
v_pk_mul_f32 v[92:93], v[92:93], v[154:155] op_sel_hi:[1,0]
v_pk_mul_f32 v[94:95], v[94:95], v[154:155] op_sel_hi:[1,0]
v_mfma_f32_16x16x16_bf16 v[108:111], v[226:227], v[146:147], v[108:111]
v_cvt_pk_bf16_f32 v166, v92, v93
v_cvt_pk_bf16_f32 v167, v94, v95
buffer_store_dwordx4 v[164:167], v2, s[4:7], s79 offen offset:256
v_pk_mul_f32 v[96:97], v[96:97], v[152:153] op_sel_hi:[1,0]
v_pk_mul_f32 v[98:99], v[98:99], v[152:153] op_sel_hi:[1,0]
v_cvt_pk_bf16_f32 v168, v96, v97
v_cvt_pk_bf16_f32 v169, v98, v99
v_pk_mul_f32 v[104:105], v[104:105], v[152:153] op_sel_hi:[1,0]
v_pk_mul_f32 v[106:107], v[106:107], v[152:153] op_sel_hi:[1,0]
v_cvt_pk_bf16_f32 v170, v104, v105
v_cvt_pk_bf16_f32 v171, v106, v107
buffer_store_dwordx4 v[168:171], v2, s[4:7], s79 offen offset:2048
v_pk_mul_f32 v[100:101], v[100:101], v[154:155] op_sel_hi:[1,0]
v_pk_mul_f32 v[102:103], v[102:103], v[154:155] op_sel_hi:[1,0]
v_cvt_pk_bf16_f32 v172, v100, v101
v_cvt_pk_bf16_f32 v173, v102, v103
v_pk_mul_f32 v[108:109], v[108:109], v[154:155] op_sel_hi:[1,0]
v_pk_mul_f32 v[110:111], v[110:111], v[154:155] op_sel_hi:[1,0]
v_cvt_pk_bf16_f32 v174, v108, v109
v_cvt_pk_bf16_f32 v175, v110, v111
buffer_store_dwordx4 v[172:175], v2, s[4:7], s79 offen offset:2304
L_t4l2j_165:
s_cmp_eq_u32 s63, 0
s_cbranch_scc1 L_t4f_166
s_add_u32 s74, s62, 50331648
s_add_u32 s75, s62, 50335744
s_add_u32 s76, s62, 50339840
buffer_load_dwordx4 a[96:99], v3, s[4:7], s74 offen offset:0 sc1
buffer_load_dwordx4 a[100:103], v3, s[4:7], s74 offen offset:1024 sc1
buffer_load_dwordx4 a[104:107], v3, s[4:7], s74 offen offset:2048 sc1
buffer_load_dwordx4 a[108:111], v3, s[4:7], s74 offen offset:3072 sc1
buffer_load_dwordx4 a[112:115], v3, s[4:7], s75 offen offset:0 sc1
buffer_load_dwordx4 a[116:119], v3, s[4:7], s75 offen offset:1024 sc1
buffer_load_dwordx4 a[120:123], v3, s[4:7], s75 offen offset:2048 sc1
buffer_load_dwordx4 a[124:127], v3, s[4:7], s75 offen offset:3072 sc1
buffer_load_dwordx4 a[128:131], v3, s[4:7], s76 offen offset:0 sc1
buffer_load_dwordx4 a[132:135], v3, s[4:7], s76 offen offset:1024 sc1
buffer_load_dwordx4 a[136:139], v3, s[4:7], s76 offen offset:2048 sc1
buffer_load_dwordx4 a[140:143], v3, s[4:7], s76 offen offset:3072 sc1
s_waitcnt vmcnt(12)
s_branch L_t4f2_167
L_t4f_166:
s_waitcnt vmcnt(0)
L_t4f2_167:
s_lshl_b32 s48, s56, 3
s_lshr_b32 s49, s57, 2
s_add_u32 s48, s48, s49
s_lshl_b32 s48, s48, 5
s_and_b32 s49, s57, 3
s_add_u32 s48, s48, s49
s_lshl_b32 s48, s48, 2
s_add_u32 s48, s48, 65536
v_mov_b32 v156, 1
buffer_store_dword v156, v8, s[4:7], s48 offen sc1
s_cmp_eq_u32 s63, 0
s_cbranch_scc1 L_t4e_154
s_mov_b32 s56, s60
s_mov_b32 s57, s61
s_mov_b32 s58, s62
s_branch L_t4_153
L_t4e_154:
s_branch L_exit
L_chain:
s_mov_b32 s8, s20
s_mov_b32 s9, s21
s_mov_b32 s10, 7864320
s_mov_b32 s11, 0x20000
s_mov_b32 s12, s22
s_mov_b32 s13, s23
s_mov_b32 s14, 7864320
s_mov_b32 s15, 0x20000
s_mov_b32 s80, s24
s_mov_b32 s81, s25
s_mov_b32 s82, 7864320
s_mov_b32 s83, 0x20000
s_mov_b32 s84, s26
s_mov_b32 s85, s27
s_mov_b32 s86, 7864320
s_mov_b32 s87, 0x20000
s_mul_i32 s88, s45, 21846
s_lshr_b32 s88, s88, 16
s_mul_i32 s48, s88, 3
s_sub_u32 s89, s45, s48
v_lshrrev_b32 v122, 3, v1
v_mul_u32_u24 v122, 12288, v122
v_and_b32 v128, 7, v1
v_lshl_add_u32 v128, v128, 4, v122
v_lshrrev_b32 v122, 3, v1
v_mul_u32_u24 v122, 1280, v122
v_and_b32 v129, 7, v1
v_lshl_add_u32 v129, v129, 4, v122
s_mul_i32 s48, s44, 196608
s_lshl_b32 s91, s45, 7
s_add_u32 s91, s91, s48
s_lshl_b32 s48, s89, 2
s_add_u32 s48, s48, s44
s_lshl_b32 s49, s48, 7
s_mul_i32 s92, s88, 245760
s_add_u32 s92, s92, s49
s_cmp_lt_u32 s48, 10
s_cselect_b32 s92, s92, 1879048192
s_mul_i32 s93, s44, 24576
s_lshl_b32 s94, s44, 11
s_add_u32 s48, s89, 0
s_cmp_ge_u32 s48, 3
s_cselect_b32 s50, 3, 0
s_sub_u32 s48, s48, s50
s_mul_i32 s48, s48, 81920
s_add_u32 s95, s92, s48
s_add_u32 m0, s93, 0
s_add_u32 s49, s95, 0
buffer_load_dwordx4 v129, s[84:87], s49 offen nt lds
s_add_u32 m0, s93, 1024
s_add_u32 s49, s95, 10240
buffer_load_dwordx4 v129, s[84:87], s49 offen nt lds
s_add_u32 m0, s93, 2048
s_add_u32 s49, s95, 20480
buffer_load_dwordx4 v129, s[84:87], s49 offen nt lds
s_add_u32 m0, s93, 3072
s_add_u32 s49, s95, 30720
buffer_load_dwordx4 v129, s[84:87], s49 offen nt lds
s_add_u32 m0, s93, 4096
s_add_u32 s49, s95, 40960
buffer_load_dwordx4 v129, s[84:87], s49 offen nt lds
s_add_u32 m0, s93, 5120
s_add_u32 s49, s95, 51200
buffer_load_dwordx4 v129, s[84:87], s49 offen nt lds
s_add_u32 m0, s93, 6144
s_add_u32 s49, s95, 61440
buffer_load_dwordx4 v129, s[84:87], s49 offen nt lds
s_add_u32 m0, s93, 7168
s_add_u32 s49, s95, 71680
buffer_load_dwordx4 v129, s[84:87], s49 offen nt lds
s_add_u32 s48, s89, 1
s_cmp_ge_u32 s48, 3
s_cselect_b32 s50, 3, 0
s_sub_u32 s48, s48, s50
s_mul_i32 s48, s48, 81920
s_add_u32 s95, s92, s48
s_add_u32 m0, s93, 8192
s_add_u32 s49, s95, 0
buffer_load_dwordx4 v129, s[84:87], s49 offen nt lds
s_add_u32 m0, s93, 9216
s_add_u32 s49, s95, 10240
buffer_load_dwordx4 v129, s[84:87], s49 offen nt lds
s_add_u32 m0, s93, 10240
s_add_u32 s49, s95, 20480
buffer_load_dwordx4 v129, s[84:87], s49 offen nt lds
s_add_u32 m0, s93, 11264
s_add_u32 s49, s95, 30720
buffer_load_dwordx4 v129, s[84:87], s49 offen nt lds
s_add_u32 m0, s93, 12288
s_add_u32 s49, s95, 40960
buffer_load_dwordx4 v129, s[84:87], s49 offen nt lds
s_add_u32 m0, s93, 13312
s_add_u32 s49, s95, 51200
buffer_load_dwordx4 v129, s[84:87], s49 offen nt lds
s_add_u32 m0, s93, 14336
s_add_u32 s49, s95, 61440
buffer_load_dwordx4 v129, s[84:87], s49 offen nt lds
s_add_u32 m0, s93, 15360
s_add_u32 s49, s95, 71680
buffer_load_dwordx4 v129, s[84:87], s49 offen nt lds
s_add_u32 s48, s89, 2
s_cmp_ge_u32 s48, 3
s_cselect_b32 s50, 3, 0
s_sub_u32 s48, s48, s50
s_mul_i32 s48, s48, 81920
s_add_u32 s95, s92, s48
s_add_u32 m0, s93, 16384
s_add_u32 s49, s95, 0
buffer_load_dwordx4 v129, s[84:87], s49 offen nt lds
s_add_u32 m0, s93, 17408
s_add_u32 s49, s95, 10240
buffer_load_dwordx4 v129, s[84:87], s49 offen nt lds
s_add_u32 m0, s93, 18432
s_add_u32 s49, s95, 20480
buffer_load_dwordx4 v129, s[84:87], s49 offen nt lds
s_add_u32 m0, s93, 19456
s_add_u32 s49, s95, 30720
buffer_load_dwordx4 v129, s[84:87], s49 offen nt lds
s_add_u32 m0, s93, 20480
s_add_u32 s49, s95, 40960
buffer_load_dwordx4 v129, s[84:87], s49 offen nt lds
s_add_u32 m0, s93, 21504
s_add_u32 s49, s95, 51200
buffer_load_dwordx4 v129, s[84:87], s49 offen nt lds
s_add_u32 m0, s93, 22528
s_add_u32 s49, s95, 61440
buffer_load_dwordx4 v129, s[84:87], s49 offen nt lds
s_add_u32 m0, s93, 23552
s_add_u32 s49, s95, 71680
buffer_load_dwordx4 v129, s[84:87], s49 offen nt lds
s_add_u32 m0, s94, 98304
s_add_u32 s49, s91, 0
buffer_load_dwordx4 v128, s[8:11], s49 offen nt lds
s_add_u32 m0, s94, 99328
s_add_u32 s49, s91, 98304
buffer_load_dwordx4 v128, s[8:11], s49 offen nt lds
s_add_u32 m0, s94, 106496
s_add_u32 s49, s91, 0
buffer_load_dwordx4 v128, s[12:15], s49 offen nt lds
s_add_u32 m0, s94, 107520
s_add_u32 s49, s91, 98304
buffer_load_dwordx4 v128, s[12:15], s49 offen nt lds
s_add_u32 m0, s94, 114688
s_add_u32 s49, s91, 0
buffer_load_dwordx4 v128, s[80:83], s49 offen nt lds
s_add_u32 m0, s94, 115712
s_add_u32 s49, s91, 98304
buffer_load_dwordx4 v128, s[80:83], s49 offen nt lds
s_add_u32 m0, s94, 122880
s_add_u32 s49, s91, 786432
buffer_load_dwordx4 v128, s[8:11], s49 offen nt lds
s_add_u32 m0, s94, 123904
s_add_u32 s49, s91, 884736
buffer_load_dwordx4 v128, s[8:11], s49 offen nt lds
s_add_u32 m0, s94, 131072
s_add_u32 s49, s91, 786432
buffer_load_dwordx4 v128, s[12:15], s49 offen nt lds
s_add_u32 m0, s94, 132096
s_add_u32 s49, s91, 884736
buffer_load_dwordx4 v128, s[12:15], s49 offen nt lds
s_add_u32 m0, s94, 139264
s_add_u32 s49, s91, 786432
buffer_load_dwordx4 v128, s[80:83], s49 offen nt lds
s_add_u32 m0, s94, 140288
s_add_u32 s49, s91, 884736
buffer_load_dwordx4 v128, s[80:83], s49 offen nt lds
s_mov_b32 s64, 0xcccccccc
s_mov_b32 s65, 0xcccccccc
s_mov_b32 s66, 1037384597
s_mov_b32 s67, s66
v_lshlrev_b32 v2, 4, v1
v_mov_b32 v136, 0x4444
v_mov_b32 v137, 0xeeee
v_cndmask_b32 v165, v136, v137, s[64:65]
v_bfe_u32 v136, v1, 2, 2
v_and_b32 v137, 1, v1
v_lshl_add_u32 v136, v136, 1, v137
v_lshrrev_b32 v137, 4, v1
v_mov_b32 v142, 1879048192
v_lshlrev_b32 v138, 7, v137
v_lshl_add_u32 v4, v136, 4, v138
v_cndmask_b32 v0, v4, v142, s[64:65]
s_mul_i32 s51, s45, 4096
s_add_u32 s51, s51, 1048576
s_lshl_b32 s49, s44, 9
v_lshlrev_b32 v163, 2, v1
v_add_u32 v138, s51, v2
v_cndmask_b32 v139, v138, v142, s[64:65]
v_cndmask_b32 v140, v142, v138, s[64:65]
s_cmp_eq_u32 s44, 1
s_cselect_b64 vcc, -1, 0
v_cndmask_b32 v3, v142, v139, vcc
s_cmp_eq_u32 s44, 2
s_cselect_b64 vcc, -1, 0
v_cndmask_b32 v3, v3, v140, vcc
s_add_u32 s48, s51, 1024
s_cmp_eq_u32 s44, 0
s_cselect_b32 s48, s48, 1879048192
v_add_u32 v4, s48, v163
s_mul_i32 s68, s88, 12288
s_add_u32 s68, s68, 1048576
s_add_u32 s48, s89, 1
s_cmp_eq_u32 s48, 3
s_cselect_b32 s48, 0, s48
s_add_u32 s49, s48, 1
s_cmp_eq_u32 s49, 3
s_cselect_b32 s49, 0, s49
s_lshl_b32 s48, s48, 12
s_lshl_b32 s49, s49, 12
s_add_u32 s69, s68, s48
s_add_u32 s70, s68, s49
v_add_u32 v138, 20480, v2
v_add_u32 v139, 22528, v2
v_cndmask_b32 v140, v138, v139, s[64:65]
v_cndmask_b32 v141, v139, v138, s[64:65]
s_cmp_eq_u32 s44, 1
s_cselect_b64 vcc, -1, 0
v_cndmask_b32 v158, v139, v140, vcc
s_cmp_eq_u32 s44, 2
s_cselect_b64 vcc, -1, 0
v_cndmask_b32 v158, v158, v141, vcc
s_cmp_eq_u32 s44, 0
s_mov_b32 s50, 22528
s_cselect_b32 s50, 21504, s50
v_add_u32 v159, s50, v163
v_bfe_u32 v138, v1, 2, 2
v_lshlrev_b32 v138, 14, v138
v_lshl_add_u32 v138, v137, 6, v138
v_and_b32 v139, 3, v1
v_lshl_add_u32 v138, v139, 4, v138
s_lshl_b32 s48, s89, 2
s_add_u32 s48, s48, s44
s_lshl_b32 s49, s48, 16
s_lshl_b32 s50, s88, 8
s_add_u32 s49, s49, s50
s_cmp_lt_u32 s48, 10
s_cselect_b32 s49, s49, 1879048192
v_add_u32 v5, s49, v138
s_lshl_b32 s48, s45, 1
s_add_u32 s48, s48, s44
s_add_u32 s49, s45, 64
s_cmp_lt_u32 s45, 64
s_cselect_b32 s48, s48, s49
s_cselect_b32 s49, 2, 1
s_cmp_lt_u32 s44, s49
s_cselect_b32 s61, 1, 0
s_cselect_b32 s48, s48, 0
s_lshr_b32 s49, s48, 2
s_and_b32 s50, s48, 3
s_lshl_b32 s51, s49, 14
s_lshl_b32 s52, s50, 6
s_add_u32 s51, s51, s52
v_lshrrev_b32 v138, 2, v1
v_lshlrev_b32 v138, 8, v138
v_lshl_add_u32 v138, v139, 4, v138
v_add_u32 v6, s51, v138
s_lshr_b32 s74, s49, 2
s_and_b32 s49, s49, 3
s_lshl_b32 s49, s49, 8
s_add_u32 s49, s49, s52
s_and_b32 s51, s74, 7
s_lshl_b32 s51, s51, 10
s_add_u32 s49, s49, s51
v_and_b32 v138, 1, v137
v_lshlrev_b32 v138, 1, v138
v_lshrrev_b32 v139, 1, v137
v_add_u32 v138, v138, v139
v_lshlrev_b32 v138, 2, v138
v_lshl_add_u32 v138, v136, 4, v138
v_add_u32 v138, s49, v138
v_and_b32 v139, 10, v1
v_cmp_eq_u32 vcc, 0, v139
s_nop 1
v_cndmask_b32 v7, v142, v138, vcc
v_and_b32 v138, 15, v1
v_mov_b32 v76, 0
v_mov_b32 v139, 0x3f80
v_cmp_eq_u32 vcc, 0, v138
s_nop 1
v_cndmask_b32 v76, v76, v139, vcc
v_mov_b32 v139, 0x3f800000
v_cmp_eq_u32 vcc, 1, v138
s_nop 1
v_cndmask_b32 v76, v76, v139, vcc
v_mov_b32 v77, 0
v_mov_b32 v139, 0x3f80
v_cmp_eq_u32 vcc, 2, v138
s_nop 1
v_cndmask_b32 v77, v77, v139, vcc
v_mov_b32 v139, 0x3f800000
v_cmp_eq_u32 vcc, 3, v138
s_nop 1
v_cndmask_b32 v77, v77, v139, vcc
v_mov_b32 v78, 0
v_mov_b32 v139, 0x3f80
v_cmp_eq_u32 vcc, 4, v138
s_nop 1
v_cndmask_b32 v78, v78, v139, vcc
v_mov_b32 v139, 0x3f800000
v_cmp_eq_u32 vcc, 5, v138
s_nop 1
v_cndmask_b32 v78, v78, v139, vcc
v_mov_b32 v79, 0
v_mov_b32 v139, 0x3f80
v_cmp_eq_u32 vcc, 6, v138
s_nop 1
v_cndmask_b32 v79, v79, v139, vcc
v_mov_b32 v139, 0x3f800000
v_cmp_eq_u32 vcc, 7, v138
s_nop 1
v_cndmask_b32 v79, v79, v139, vcc
s_lshl_b32 s48, s44, 9
v_lshlrev_b32 v168, 5, v138
v_lshl_add_u32 v168, v137, 3, v168
v_add_u32 v168, s48, v168
v_lshlrev_b32 v139, 9, v137
v_lshl_add_u32 v166, v138, 4, v139
s_lshl_b32 s48, s44, 10
s_add_u32 s48, s48, 8192
v_add_u32 v170, s48, v2
v_lshrrev_b32 v139, 2, v138
v_lshlrev_b32 v139, 6, v139
v_and_b32 v140, 1, v138
v_lshl_add_u32 v139, v140, 5, v139
v_lshl_add_u32 v139, v137, 3, v139
v_bfe_u32 v140, v138, 1, 1
v_lshl_add_u32 v139, v140, 2, v139
s_lshl_b32 s48, s44, 8
s_add_u32 s48, s48, 4096
v_add_u32 v164, s48, v139
s_mov_b32 s48, 4096
v_lshrrev_b32 v122, 4, v1
v_lshlrev_b32 v122, 3, v122
v_bfe_u32 v123, v1, 2, 2
v_add_u32 v122, v122, v123
v_and_b32 v123, 3, v1
v_lshlrev_b32 v122, 5, v122
v_lshl_add_u32 v122, v123, 3, v122
v_add_u32 v169, s48, v122
v_lshrrev_b32 v139, 5, v1
v_lshlrev_b32 v139, 10, v139
v_and_b32 v140, 3, v1
v_lshl_add_u32 v139, v140, 8, v139
v_bfe_u32 v140, v1, 4, 1
v_lshl_add_u32 v139, v140, 7, v139
v_bfe_u32 v140, v1, 2, 2
v_lshl_add_u32 v139, v140, 4, v139
v_add_u32 v171, 36864, v139
s_mov_b32 s48, 0
v_lshrrev_b32 v122, 4, v1
v_lshlrev_b32 v122, 3, v122
v_bfe_u32 v123, v1, 2, 2
v_add_u32 v122, v122, v123
v_and_b32 v123, 3, v1
v_lshlrev_b32 v122, 5, v122
v_lshl_add_u32 v122, v123, 3, v122
v_add_u32 v160, s48, v122
s_lshl_b32 s48, s45, 7
s_add_u32 s76, s48, 0
s_add_u32 s48, s48, 32768
s_cmp_eq_u32 s44, 3
s_cselect_b32 s48, s48, 1879048192
v_mov_b32 v167, s48
v_cmp_eq_u32 vcc, 0, v1
s_nop 1
v_cndmask_b32 v167, v142, v167, vcc
s_lshl_b32 s72, s45, 12
s_mul_i32 s77, s88, 12288
s_lshl_b32 s73, s45, 10
s_mov_b32 s62, 0
s_mov_b32 s54, 0
s_mul_i32 s48, s88, 384
s_add_u32 s76, s48, 0
v_mov_b32 v87, 0
v_mov_b32 v48, 0
v_mov_b32 v49, 0
v_mov_b32 v50, 0
v_mov_b32 v51, 0
v_mov_b32 v52, 0
v_mov_b32 v53, 0
v_mov_b32 v54, 0
v_mov_b32 v55, 0
v_mov_b32 v56, 0
v_mov_b32 v57, 0
v_mov_b32 v58, 0
v_mov_b32 v59, 0
v_mov_b32 v60, 0
v_mov_b32 v61, 0
v_mov_b32 v62, 0
v_mov_b32 v63, 0
v_mov_b32 v64, 0
v_mov_b32 v65, 0
v_mov_b32 v66, 0
v_mov_b32 v67, 0
v_mov_b32 v68, 0
v_mov_b32 v69, 0
v_mov_b32 v70, 0
v_mov_b32 v71, 0
v_mov_b32 v72, 0
v_mov_b32 v73, 0
v_mov_b32 v74, 0
v_mov_b32 v75, 0
v_bfe_u32 v122, v1, 2, 2
v_lshlrev_b32 v122, 11, v122
v_lshrrev_b32 v123, 4, v1
v_lshl_add_u32 v122, v123, 8, v122
v_and_b32 v123, 3, v1
v_lshl_add_u32 v122, v123, 3, v122
s_lshl_b32 s48, s44, 5
v_add_u32 v130, s48, v122
v_add_u32 v131, 0x10000, v130
v_add_u32 v133, 0x20000, v130
v_lshrrev_b32 v122, 4, v1
v_lshlrev_b32 v122, 3, v122
v_bfe_u32 v123, v1, 2, 2
v_add_u32 v122, v122, v123
v_and_b32 v123, 3, v1
v_lshlrev_b32 v122, 7, v122
v_lshl_add_u32 v122, v123, 3, v122
v_add_u32 v132, s93, v122
s_waitcnt vmcnt(28)
ds_read_b64_tr_b16 a[240:241], v132 offset:0
ds_read_b64_tr_b16 a[242:243], v132 offset:512
ds_read_b64_tr_b16 a[244:245], v132 offset:4096
ds_read_b64_tr_b16 a[246:247], v132 offset:4608
ds_read_b64_tr_b16 a[248:249], v132 offset:32
ds_read_b64_tr_b16 a[250:251], v132 offset:544
ds_read_b64_tr_b16 a[252:253], v132 offset:4128
ds_read_b64_tr_b16 a[254:255], v132 offset:4640
s_waitcnt lgkmcnt(0)
ds_read_b64_tr_b16 v[176:177], v132 offset:64
ds_read_b64_tr_b16 v[178:179], v132 offset:576
ds_read_b64_tr_b16 v[180:181], v132 offset:4160
ds_read_b64_tr_b16 v[182:183], v132 offset:4672
ds_read_b64_tr_b16 v[184:185], v132 offset:96
ds_read_b64_tr_b16 v[186:187], v132 offset:608
ds_read_b64_tr_b16 v[188:189], v132 offset:4192
ds_read_b64_tr_b16 v[190:191], v132 offset:4704
s_waitcnt lgkmcnt(0)
s_waitcnt vmcnt(20)
ds_read_b64_tr_b16 v[192:193], v132 offset:8192
ds_read_b64_tr_b16 v[194:195], v132 offset:8704
ds_read_b64_tr_b16 v[196:197], v132 offset:12288
ds_read_b64_tr_b16 v[198:199], v132 offset:12800
ds_read_b64_tr_b16 v[200:201], v132 offset:8224
ds_read_b64_tr_b16 v[202:203], v132 offset:8736
ds_read_b64_tr_b16 v[204:205], v132 offset:12320
ds_read_b64_tr_b16 v[206:207], v132 offset:12832
s_waitcnt lgkmcnt(0)
ds_read_b64_tr_b16 v[208:209], v132 offset:8256
ds_read_b64_tr_b16 v[210:211], v132 offset:8768
ds_read_b64_tr_b16 v[212:213], v132 offset:12352
ds_read_b64_tr_b16 v[214:215], v132 offset:12864
ds_read_b64_tr_b16 v[216:217], v132 offset:8288
ds_read_b64_tr_b16 v[218:219], v132 offset:8800
ds_read_b64_tr_b16 v[220:221], v132 offset:12384
ds_read_b64_tr_b16 v[222:223], v132 offset:12896
s_waitcnt lgkmcnt(0)
s_waitcnt vmcnt(12)
ds_read_b64_tr_b16 v[224:225], v132 offset:16384
ds_read_b64_tr_b16 v[226:227], v132 offset:16896
ds_read_b64_tr_b16 v[228:229], v132 offset:20480
ds_read_b64_tr_b16 v[230:231], v132 offset:20992
ds_read_b64_tr_b16 v[232:233], v132 offset:16416
ds_read_b64_tr_b16 v[234:235], v132 offset:16928
ds_read_b64_tr_b16 v[236:237], v132 offset:20512
ds_read_b64_tr_b16 v[238:239], v132 offset:21024
s_waitcnt lgkmcnt(0)
ds_read_b64_tr_b16 v[240:241], v132 offset:16448
ds_read_b64_tr_b16 v[242:243], v132 offset:16960
ds_read_b64_tr_b16 v[244:245], v132 offset:20544
ds_read_b64_tr_b16 v[246:247], v132 offset:21056
ds_read_b64_tr_b16 v[248:249], v132 offset:16480
ds_read_b64_tr_b16 v[250:251], v132 offset:16992
ds_read_b64_tr_b16 v[252:253], v132 offset:20576
ds_read_b64_tr_b16 v[254:255], v132 offset:21088
s_waitcnt lgkmcnt(0)
s_barrier
s_add_u32 m0, s94, 0
s_add_u32 s49, s91, 1572864
buffer_load_dwordx4 v128, s[8:11], s49 offen nt lds
s_add_u32 m0, s94, 1024
s_add_u32 s49, s91, 1671168
buffer_load_dwordx4 v128, s[8:11], s49 offen nt lds
s_add_u32 m0, s94, 8192
s_add_u32 s49, s91, 1572864
buffer_load_dwordx4 v128, s[12:15], s49 offen nt lds
s_add_u32 m0, s94, 9216
s_add_u32 s49, s91, 1671168
buffer_load_dwordx4 v128, s[12:15], s49 offen nt lds
s_add_u32 m0, s94, 16384
s_add_u32 s49, s91, 1572864
buffer_load_dwordx4 v128, s[80:83], s49 offen nt lds
s_add_u32 m0, s94, 17408
s_add_u32 s49, s91, 1671168
buffer_load_dwordx4 v128, s[80:83], s49 offen nt lds
s_add_u32 m0, s94, 24576
s_add_u32 s49, s91, 2359296
buffer_load_dwordx4 v128, s[8:11], s49 offen nt lds
s_add_u32 m0, s94, 25600
s_add_u32 s49, s91, 2457600
buffer_load_dwordx4 v128, s[8:11], s49 offen nt lds
s_add_u32 m0, s94, 32768
s_add_u32 s49, s91, 2359296
buffer_load_dwordx4 v128, s[12:15], s49 offen nt lds
s_add_u32 m0, s94, 33792
s_add_u32 s49, s91, 2457600
buffer_load_dwordx4 v128, s[12:15], s49 offen nt lds
s_add_u32 m0, s94, 40960
s_add_u32 s49, s91, 2359296
buffer_load_dwordx4 v128, s[80:83], s49 offen nt lds
s_add_u32 m0, s94, 41984
s_add_u32 s49, s91, 2457600
buffer_load_dwordx4 v128, s[80:83], s49 offen nt lds
s_add_u32 m0, s94, 49152
s_add_u32 s49, s91, 3145728
buffer_load_dwordx4 v128, s[8:11], s49 offen nt lds
s_add_u32 m0, s94, 50176
s_add_u32 s49, s91, 3244032
buffer_load_dwordx4 v128, s[8:11], s49 offen nt lds
s_add_u32 m0, s94, 57344
s_add_u32 s49, s91, 3145728
buffer_load_dwordx4 v128, s[12:15], s49 offen nt lds
s_add_u32 m0, s94, 58368
s_add_u32 s49, s91, 3244032
buffer_load_dwordx4 v128, s[12:15], s49 offen nt lds
s_add_u32 m0, s94, 65536
s_add_u32 s49, s91, 3145728
buffer_load_dwordx4 v128, s[80:83], s49 offen nt lds
s_add_u32 m0, s94, 66560
s_add_u32 s49, s91, 3244032
buffer_load_dwordx4 v128, s[80:83], s49 offen nt lds
s_waitcnt vmcnt(24) lgkmcnt(0)
s_barrier
s_add_u32 m0, s94, 73728
s_add_u32 s49, s91, 3932160
buffer_load_dwordx4 v128, s[8:11], s49 offen nt lds
s_add_u32 m0, s94, 74752
s_add_u32 s49, s91, 4030464
buffer_load_dwordx4 v128, s[8:11], s49 offen nt lds
s_add_u32 m0, s94, 81920
s_add_u32 s49, s91, 3932160
buffer_load_dwordx4 v128, s[12:15], s49 offen nt lds
s_add_u32 m0, s94, 82944
s_add_u32 s49, s91, 4030464
buffer_load_dwordx4 v128, s[12:15], s49 offen nt lds
s_add_u32 m0, s94, 90112
s_add_u32 s49, s91, 3932160
buffer_load_dwordx4 v128, s[80:83], s49 offen nt lds
s_add_u32 m0, s94, 91136
s_add_u32 s49, s91, 4030464
buffer_load_dwordx4 v128, s[80:83], s49 offen nt lds
s_cmp_lg_u32 s44, 0
s_cbranch_scc1 L_wn_169
ds_read_b64_tr_b16 a[0:1], v131 offset:32768
ds_read_b64_tr_b16 a[2:3], v131 offset:32896
ds_read_b64_tr_b16 a[4:5], v131 offset:33792
ds_read_b64_tr_b16 a[6:7], v131 offset:33920
ds_read_b64_tr_b16 a[80:81], v131 offset:40960
ds_read_b64_tr_b16 a[82:83], v131 offset:41088
ds_read_b64_tr_b16 a[84:85], v131 offset:41984
ds_read_b64_tr_b16 a[86:87], v131 offset:42112
ds_read_b64_tr_b16 a[160:161], v131 offset:49152
ds_read_b64_tr_b16 a[162:163], v131 offset:49280
ds_read_b64_tr_b16 a[164:165], v131 offset:50176
ds_read_b64_tr_b16 a[166:167], v131 offset:50304
s_branch L_we_168
L_wn_169:
s_cmp_lg_u32 s44, 1
s_cbranch_scc1 L_wn_170
ds_read_b64_tr_b16 a[16:17], v131 offset:32768
ds_read_b64_tr_b16 a[18:19], v131 offset:32896
ds_read_b64_tr_b16 a[20:21], v131 offset:33792
ds_read_b64_tr_b16 a[22:23], v131 offset:33920
ds_read_b64_tr_b16 a[96:97], v131 offset:40960
ds_read_b64_tr_b16 a[98:99], v131 offset:41088
ds_read_b64_tr_b16 a[100:101], v131 offset:41984
ds_read_b64_tr_b16 a[102:103], v131 offset:42112
ds_read_b64_tr_b16 a[176:177], v131 offset:49152
ds_read_b64_tr_b16 a[178:179], v131 offset:49280
ds_read_b64_tr_b16 a[180:181], v131 offset:50176
ds_read_b64_tr_b16 a[182:183], v131 offset:50304
s_branch L_we_168
L_wn_170:
s_cmp_lg_u32 s44, 2
s_cbranch_scc1 L_wn_171
ds_read_b64_tr_b16 a[24:25], v131 offset:32768
ds_read_b64_tr_b16 a[26:27], v131 offset:32896
ds_read_b64_tr_b16 a[28:29], v131 offset:33792
ds_read_b64_tr_b16 a[30:31], v131 offset:33920
ds_read_b64_tr_b16 a[104:105], v131 offset:40960
ds_read_b64_tr_b16 a[106:107], v131 offset:41088
ds_read_b64_tr_b16 a[108:109], v131 offset:41984
ds_read_b64_tr_b16 a[110:111], v131 offset:42112
ds_read_b64_tr_b16 a[184:185], v131 offset:49152
ds_read_b64_tr_b16 a[186:187], v131 offset:49280
ds_read_b64_tr_b16 a[188:189], v131 offset:50176
ds_read_b64_tr_b16 a[190:191], v131 offset:50304
s_branch L_we_168
L_wn_171:
ds_read_b64_tr_b16 a[32:33], v131 offset:32768
ds_read_b64_tr_b16 a[34:35], v131 offset:32896
ds_read_b64_tr_b16 a[36:37], v131 offset:33792
ds_read_b64_tr_b16 a[38:39], v131 offset:33920
ds_read_b64_tr_b16 a[112:113], v131 offset:40960
ds_read_b64_tr_b16 a[114:115], v131 offset:41088
ds_read_b64_tr_b16 a[116:117], v131 offset:41984
ds_read_b64_tr_b16 a[118:119], v131 offset:42112
ds_read_b64_tr_b16 a[192:193], v131 offset:49152
ds_read_b64_tr_b16 a[194:195], v131 offset:49280
ds_read_b64_tr_b16 a[196:197], v131 offset:50176
ds_read_b64_tr_b16 a[198:199], v131 offset:50304
L_we_168:
s_waitcnt vmcnt(24) lgkmcnt(0)
s_barrier
s_add_u32 m0, s94, 98304
s_add_u32 s49, s91, 4718592
buffer_load_dwordx4 v128, s[8:11], s49 offen nt lds
s_add_u32 m0, s94, 99328
s_add_u32 s49, s91, 4816896
buffer_load_dwordx4 v128, s[8:11], s49 offen nt lds
s_add_u32 m0, s94, 106496
s_add_u32 s49, s91, 4718592
buffer_load_dwordx4 v128, s[12:15], s49 offen nt lds
s_add_u32 m0, s94, 107520
s_add_u32 s49, s91, 4816896
buffer_load_dwordx4 v128, s[12:15], s49 offen nt lds
s_add_u32 m0, s94, 114688
s_add_u32 s49, s91, 4718592
buffer_load_dwordx4 v128, s[80:83], s49 offen nt lds
s_add_u32 m0, s94, 115712
s_add_u32 s49, s91, 4816896
buffer_load_dwordx4 v128, s[80:83], s49 offen nt lds
s_cmp_lg_u32 s44, 0
s_cbranch_scc1 L_wn_174
ds_read_b64_tr_b16 a[16:17], v131 offset:57344
ds_read_b64_tr_b16 a[18:19], v131 offset:57472
ds_read_b64_tr_b16 a[20:21], v131 offset:58368
ds_read_b64_tr_b16 a[22:23], v131 offset:58496
ds_read_b64_tr_b16 a[96:97], v133 offset:0
ds_read_b64_tr_b16 a[98:99], v133 offset:128
ds_read_b64_tr_b16 a[100:101], v133 offset:1024
ds_read_b64_tr_b16 a[102:103], v133 offset:1152
ds_read_b64_tr_b16 a[176:177], v133 offset:8192
ds_read_b64_tr_b16 a[178:179], v133 offset:8320
ds_read_b64_tr_b16 a[180:181], v133 offset:9216
ds_read_b64_tr_b16 a[182:183], v133 offset:9344
s_branch L_we_173
L_wn_174:
s_cmp_lg_u32 s44, 1
s_cbranch_scc1 L_wn_175
ds_read_b64_tr_b16 a[0:1], v131 offset:57344
ds_read_b64_tr_b16 a[2:3], v131 offset:57472
ds_read_b64_tr_b16 a[4:5], v131 offset:58368
ds_read_b64_tr_b16 a[6:7], v131 offset:58496
ds_read_b64_tr_b16 a[80:81], v133 offset:0
ds_read_b64_tr_b16 a[82:83], v133 offset:128
ds_read_b64_tr_b16 a[84:85], v133 offset:1024
ds_read_b64_tr_b16 a[86:87], v133 offset:1152
ds_read_b64_tr_b16 a[160:161], v133 offset:8192
ds_read_b64_tr_b16 a[162:163], v133 offset:8320
ds_read_b64_tr_b16 a[164:165], v133 offset:9216
ds_read_b64_tr_b16 a[166:167], v133 offset:9344
s_branch L_we_173
L_wn_175:
s_cmp_lg_u32 s44, 2
s_cbranch_scc1 L_wn_176
ds_read_b64_tr_b16 a[32:33], v131 offset:57344
ds_read_b64_tr_b16 a[34:35], v131 offset:57472
ds_read_b64_tr_b16 a[36:37], v131 offset:58368
ds_read_b64_tr_b16 a[38:39], v131 offset:58496
ds_read_b64_tr_b16 a[112:113], v133 offset:0
ds_read_b64_tr_b16 a[114:115], v133 offset:128
ds_read_b64_tr_b16 a[116:117], v133 offset:1024
ds_read_b64_tr_b16 a[118:119], v133 offset:1152
ds_read_b64_tr_b16 a[192:193], v133 offset:8192
ds_read_b64_tr_b16 a[194:195], v133 offset:8320
ds_read_b64_tr_b16 a[196:197], v133 offset:9216
ds_read_b64_tr_b16 a[198:199], v133 offset:9344
s_branch L_we_173
L_wn_176:
ds_read_b64_tr_b16 a[24:25], v131 offset:57344
ds_read_b64_tr_b16 a[26:27], v131 offset:57472
ds_read_b64_tr_b16 a[28:29], v131 offset:58368
ds_read_b64_tr_b16 a[30:31], v131 offset:58496
ds_read_b64_tr_b16 a[104:105], v133 offset:0
ds_read_b64_tr_b16 a[106:107], v133 offset:128
ds_read_b64_tr_b16 a[108:109], v133 offset:1024
ds_read_b64_tr_b16 a[110:111], v133 offset:1152
ds_read_b64_tr_b16 a[184:185], v133 offset:8192
ds_read_b64_tr_b16 a[186:187], v133 offset:8320
ds_read_b64_tr_b16 a[188:189], v133 offset:9216
ds_read_b64_tr_b16 a[190:191], v133 offset:9344
L_we_173:
s_waitcnt vmcnt(24) lgkmcnt(0)
s_barrier
s_add_u32 m0, s94, 122880
s_add_u32 s49, s91, 5505024
buffer_load_dwordx4 v128, s[8:11], s49 offen nt lds
s_add_u32 m0, s94, 123904
s_add_u32 s49, s91, 5603328
buffer_load_dwordx4 v128, s[8:11], s49 offen nt lds
s_add_u32 m0, s94, 131072
s_add_u32 s49, s91, 5505024
buffer_load_dwordx4 v128, s[12:15], s49 offen nt lds
s_add_u32 m0, s94, 132096
s_add_u32 s49, s91, 5603328
buffer_load_dwordx4 v128, s[12:15], s49 offen nt lds
s_add_u32 m0, s94, 139264
s_add_u32 s49, s91, 5505024
buffer_load_dwordx4 v128, s[80:83], s49 offen nt lds
s_add_u32 m0, s94, 140288
s_add_u32 s49, s91, 5603328
buffer_load_dwordx4 v128, s[80:83], s49 offen nt lds
s_cmp_lg_u32 s44, 0
s_cbranch_scc1 L_wn_179
ds_read_b64_tr_b16 a[24:25], v130 offset:0
ds_read_b64_tr_b16 a[26:27], v130 offset:128
ds_read_b64_tr_b16 a[28:29], v130 offset:1024
ds_read_b64_tr_b16 a[30:31], v130 offset:1152
ds_read_b64_tr_b16 a[104:105], v130 offset:8192
ds_read_b64_tr_b16 a[106:107], v130 offset:8320
ds_read_b64_tr_b16 a[108:109], v130 offset:9216
ds_read_b64_tr_b16 a[110:111], v130 offset:9344
ds_read_b64_tr_b16 a[184:185], v130 offset:16384
ds_read_b64_tr_b16 a[186:187], v130 offset:16512
ds_read_b64_tr_b16 a[188:189], v130 offset:17408
ds_read_b64_tr_b16 a[190:191], v130 offset:17536
s_branch L_we_178
L_wn_179:
s_cmp_lg_u32 s44, 1
s_cbranch_scc1 L_wn_180
ds_read_b64_tr_b16 a[32:33], v130 offset:0
ds_read_b64_tr_b16 a[34:35], v130 offset:128
ds_read_b64_tr_b16 a[36:37], v130 offset:1024
ds_read_b64_tr_b16 a[38:39], v130 offset:1152
ds_read_b64_tr_b16 a[112:113], v130 offset:8192
ds_read_b64_tr_b16 a[114:115], v130 offset:8320
ds_read_b64_tr_b16 a[116:117], v130 offset:9216
ds_read_b64_tr_b16 a[118:119], v130 offset:9344
ds_read_b64_tr_b16 a[192:193], v130 offset:16384
ds_read_b64_tr_b16 a[194:195], v130 offset:16512
ds_read_b64_tr_b16 a[196:197], v130 offset:17408
ds_read_b64_tr_b16 a[198:199], v130 offset:17536
s_branch L_we_178
L_wn_180:
s_cmp_lg_u32 s44, 2
s_cbranch_scc1 L_wn_181
ds_read_b64_tr_b16 a[0:1], v130 offset:0
ds_read_b64_tr_b16 a[2:3], v130 offset:128
ds_read_b64_tr_b16 a[4:5], v130 offset:1024
ds_read_b64_tr_b16 a[6:7], v130 offset:1152
ds_read_b64_tr_b16 a[80:81], v130 offset:8192
ds_read_b64_tr_b16 a[82:83], v130 offset:8320
ds_read_b64_tr_b16 a[84:85], v130 offset:9216
ds_read_b64_tr_b16 a[86:87], v130 offset:9344
ds_read_b64_tr_b16 a[160:161], v130 offset:16384
ds_read_b64_tr_b16 a[162:163], v130 offset:16512
ds_read_b64_tr_b16 a[164:165], v130 offset:17408
ds_read_b64_tr_b16 a[166:167], v130 offset:17536
s_branch L_we_178
L_wn_181:
ds_read_b64_tr_b16 a[16:17], v130 offset:0
ds_read_b64_tr_b16 a[18:19], v130 offset:128
ds_read_b64_tr_b16 a[20:21], v130 offset:1024
ds_read_b64_tr_b16 a[22:23], v130 offset:1152
ds_read_b64_tr_b16 a[96:97], v130 offset:8192
ds_read_b64_tr_b16 a[98:99], v130 offset:8320
ds_read_b64_tr_b16 a[100:101], v130 offset:9216
ds_read_b64_tr_b16 a[102:103], v130 offset:9344
ds_read_b64_tr_b16 a[176:177], v130 offset:16384
ds_read_b64_tr_b16 a[178:179], v130 offset:16512
ds_read_b64_tr_b16 a[180:181], v130 offset:17408
ds_read_b64_tr_b16 a[182:183], v130 offset:17536
L_we_178:
s_waitcnt vmcnt(24) lgkmcnt(0)
s_barrier
s_add_u32 m0, s94, 0
s_add_u32 s49, s91, 6291456
buffer_load_dwordx4 v128, s[8:11], s49 offen nt lds
s_add_u32 m0, s94, 1024
s_add_u32 s49, s91, 6389760
buffer_load_dwordx4 v128, s[8:11], s49 offen nt lds
s_add_u32 m0, s94, 8192
s_add_u32 s49, s91, 6291456
buffer_load_dwordx4 v128, s[12:15], s49 offen nt lds
s_add_u32 m0, s94, 9216
s_add_u32 s49, s91, 6389760
buffer_load_dwordx4 v128, s[12:15], s49 offen nt lds
s_add_u32 m0, s94, 16384
s_add_u32 s49, s91, 6291456
buffer_load_dwordx4 v128, s[80:83], s49 offen nt lds
s_add_u32 m0, s94, 17408
s_add_u32 s49, s91, 6389760
buffer_load_dwordx4 v128, s[80:83], s49 offen nt lds
s_cmp_lg_u32 s44, 0
s_cbranch_scc1 L_wn_184
ds_read_b64_tr_b16 a[32:33], v130 offset:24576
ds_read_b64_tr_b16 a[34:35], v130 offset:24704
ds_read_b64_tr_b16 a[36:37], v130 offset:25600
ds_read_b64_tr_b16 a[38:39], v130 offset:25728
ds_read_b64_tr_b16 a[112:113], v130 offset:32768
ds_read_b64_tr_b16 a[114:115], v130 offset:32896
ds_read_b64_tr_b16 a[116:117], v130 offset:33792
ds_read_b64_tr_b16 a[118:119], v130 offset:33920
ds_read_b64_tr_b16 a[192:193], v130 offset:40960
ds_read_b64_tr_b16 a[194:195], v130 offset:41088
ds_read_b64_tr_b16 a[196:197], v130 offset:41984
ds_read_b64_tr_b16 a[198:199], v130 offset:42112
s_branch L_we_183
L_wn_184:
s_cmp_lg_u32 s44, 1
s_cbranch_scc1 L_wn_185
ds_read_b64_tr_b16 a[24:25], v130 offset:24576
ds_read_b64_tr_b16 a[26:27], v130 offset:24704
ds_read_b64_tr_b16 a[28:29], v130 offset:25600
ds_read_b64_tr_b16 a[30:31], v130 offset:25728
ds_read_b64_tr_b16 a[104:105], v130 offset:32768
ds_read_b64_tr_b16 a[106:107], v130 offset:32896
ds_read_b64_tr_b16 a[108:109], v130 offset:33792
ds_read_b64_tr_b16 a[110:111], v130 offset:33920
ds_read_b64_tr_b16 a[184:185], v130 offset:40960
ds_read_b64_tr_b16 a[186:187], v130 offset:41088
ds_read_b64_tr_b16 a[188:189], v130 offset:41984
ds_read_b64_tr_b16 a[190:191], v130 offset:42112
s_branch L_we_183
L_wn_185:
s_cmp_lg_u32 s44, 2
s_cbranch_scc1 L_wn_186
ds_read_b64_tr_b16 a[16:17], v130 offset:24576
ds_read_b64_tr_b16 a[18:19], v130 offset:24704
ds_read_b64_tr_b16 a[20:21], v130 offset:25600
ds_read_b64_tr_b16 a[22:23], v130 offset:25728
ds_read_b64_tr_b16 a[96:97], v130 offset:32768
ds_read_b64_tr_b16 a[98:99], v130 offset:32896
ds_read_b64_tr_b16 a[100:101], v130 offset:33792
ds_read_b64_tr_b16 a[102:103], v130 offset:33920
ds_read_b64_tr_b16 a[176:177], v130 offset:40960
ds_read_b64_tr_b16 a[178:179], v130 offset:41088
ds_read_b64_tr_b16 a[180:181], v130 offset:41984
ds_read_b64_tr_b16 a[182:183], v130 offset:42112
s_branch L_we_183
L_wn_186:
ds_read_b64_tr_b16 a[0:1], v130 offset:24576
ds_read_b64_tr_b16 a[2:3], v130 offset:24704
ds_read_b64_tr_b16 a[4:5], v130 offset:25600
ds_read_b64_tr_b16 a[6:7], v130 offset:25728
ds_read_b64_tr_b16 a[80:81], v130 offset:32768
ds_read_b64_tr_b16 a[82:83], v130 offset:32896
ds_read_b64_tr_b16 a[84:85], v130 offset:33792
ds_read_b64_tr_b16 a[86:87], v130 offset:33920
ds_read_b64_tr_b16 a[160:161], v130 offset:40960
ds_read_b64_tr_b16 a[162:163], v130 offset:41088
ds_read_b64_tr_b16 a[164:165], v130 offset:41984
ds_read_b64_tr_b16 a[166:167], v130 offset:42112
L_we_183:
s_waitcnt vmcnt(24) lgkmcnt(0)
s_barrier
s_add_u32 m0, s94, 24576
s_add_u32 s49, s91, 7077888
buffer_load_dwordx4 v128, s[8:11], s49 offen nt lds
s_add_u32 m0, s94, 25600
s_add_u32 s49, s91, 7176192
buffer_load_dwordx4 v128, s[8:11], s49 offen nt lds
s_add_u32 m0, s94, 32768
s_add_u32 s49, s91, 7077888
buffer_load_dwordx4 v128, s[12:15], s49 offen nt lds
s_add_u32 m0, s94, 33792
s_add_u32 s49, s91, 7176192
buffer_load_dwordx4 v128, s[12:15], s49 offen nt lds
s_add_u32 m0, s94, 40960
s_add_u32 s49, s91, 7077888
buffer_load_dwordx4 v128, s[80:83], s49 offen nt lds
s_add_u32 m0, s94, 41984
s_add_u32 s49, s91, 7176192
buffer_load_dwordx4 v128, s[80:83], s49 offen nt lds
s_cmp_lg_u32 s44, 0
s_cbranch_scc1 L_wn_189
ds_read_b64_tr_b16 a[8:9], v130 offset:49152
ds_read_b64_tr_b16 a[10:11], v130 offset:49280
ds_read_b64_tr_b16 a[12:13], v130 offset:50176
ds_read_b64_tr_b16 a[14:15], v130 offset:50304
ds_read_b64_tr_b16 a[88:89], v130 offset:57344
ds_read_b64_tr_b16 a[90:91], v130 offset:57472
ds_read_b64_tr_b16 a[92:93], v130 offset:58368
ds_read_b64_tr_b16 a[94:95], v130 offset:58496
ds_read_b64_tr_b16 a[168:169], v131 offset:0
ds_read_b64_tr_b16 a[170:171], v131 offset:128
ds_read_b64_tr_b16 a[172:173], v131 offset:1024
ds_read_b64_tr_b16 a[174:175], v131 offset:1152
s_branch L_we_188
L_wn_189:
s_cmp_lg_u32 s44, 1
s_cbranch_scc1 L_wn_190
ds_read_b64_tr_b16 a[40:41], v130 offset:49152
ds_read_b64_tr_b16 a[42:43], v130 offset:49280
ds_read_b64_tr_b16 a[44:45], v130 offset:50176
ds_read_b64_tr_b16 a[46:47], v130 offset:50304
ds_read_b64_tr_b16 a[120:121], v130 offset:57344
ds_read_b64_tr_b16 a[122:123], v130 offset:57472
ds_read_b64_tr_b16 a[124:125], v130 offset:58368
ds_read_b64_tr_b16 a[126:127], v130 offset:58496
ds_read_b64_tr_b16 a[200:201], v131 offset:0
ds_read_b64_tr_b16 a[202:203], v131 offset:128
ds_read_b64_tr_b16 a[204:205], v131 offset:1024
ds_read_b64_tr_b16 a[206:207], v131 offset:1152
s_branch L_we_188
L_wn_190:
s_cmp_lg_u32 s44, 2
s_cbranch_scc1 L_wn_191
ds_read_b64_tr_b16 a[48:49], v130 offset:49152
ds_read_b64_tr_b16 a[50:51], v130 offset:49280
ds_read_b64_tr_b16 a[52:53], v130 offset:50176
ds_read_b64_tr_b16 a[54:55], v130 offset:50304
ds_read_b64_tr_b16 a[128:129], v130 offset:57344
ds_read_b64_tr_b16 a[130:131], v130 offset:57472
ds_read_b64_tr_b16 a[132:133], v130 offset:58368
ds_read_b64_tr_b16 a[134:135], v130 offset:58496
ds_read_b64_tr_b16 a[208:209], v131 offset:0
ds_read_b64_tr_b16 a[210:211], v131 offset:128
ds_read_b64_tr_b16 a[212:213], v131 offset:1024
ds_read_b64_tr_b16 a[214:215], v131 offset:1152
s_branch L_we_188
L_wn_191:
ds_read_b64_tr_b16 a[56:57], v130 offset:49152
ds_read_b64_tr_b16 a[58:59], v130 offset:49280
ds_read_b64_tr_b16 a[60:61], v130 offset:50176
ds_read_b64_tr_b16 a[62:63], v130 offset:50304
ds_read_b64_tr_b16 a[136:137], v130 offset:57344
ds_read_b64_tr_b16 a[138:139], v130 offset:57472
ds_read_b64_tr_b16 a[140:141], v130 offset:58368
ds_read_b64_tr_b16 a[142:143], v130 offset:58496
ds_read_b64_tr_b16 a[216:217], v131 offset:0
ds_read_b64_tr_b16 a[218:219], v131 offset:128
ds_read_b64_tr_b16 a[220:221], v131 offset:1024
ds_read_b64_tr_b16 a[222:223], v131 offset:1152
L_we_188:
s_waitcnt vmcnt(24) lgkmcnt(0)
s_barrier
s_cmp_lg_u32 s44, 0
s_cbranch_scc1 L_wn_194
ds_read_b64_tr_b16 a[40:41], v131 offset:8192
ds_read_b64_tr_b16 a[42:43], v131 offset:8320
ds_read_b64_tr_b16 a[44:45], v131 offset:9216
ds_read_b64_tr_b16 a[46:47], v131 offset:9344
ds_read_b64_tr_b16 a[120:121], v131 offset:16384
ds_read_b64_tr_b16 a[122:123], v131 offset:16512
ds_read_b64_tr_b16 a[124:125], v131 offset:17408
ds_read_b64_tr_b16 a[126:127], v131 offset:17536
ds_read_b64_tr_b16 a[200:201], v131 offset:24576
ds_read_b64_tr_b16 a[202:203], v131 offset:24704
ds_read_b64_tr_b16 a[204:205], v131 offset:25600
ds_read_b64_tr_b16 a[206:207], v131 offset:25728
s_branch L_we_193
L_wn_194:
s_cmp_lg_u32 s44, 1
s_cbranch_scc1 L_wn_195
ds_read_b64_tr_b16 a[8:9], v131 offset:8192
ds_read_b64_tr_b16 a[10:11], v131 offset:8320
ds_read_b64_tr_b16 a[12:13], v131 offset:9216
ds_read_b64_tr_b16 a[14:15], v131 offset:9344
ds_read_b64_tr_b16 a[88:89], v131 offset:16384
ds_read_b64_tr_b16 a[90:91], v131 offset:16512
ds_read_b64_tr_b16 a[92:93], v131 offset:17408
ds_read_b64_tr_b16 a[94:95], v131 offset:17536
ds_read_b64_tr_b16 a[168:169], v131 offset:24576
ds_read_b64_tr_b16 a[170:171], v131 offset:24704
ds_read_b64_tr_b16 a[172:173], v131 offset:25600
ds_read_b64_tr_b16 a[174:175], v131 offset:25728
s_branch L_we_193
L_wn_195:
s_cmp_lg_u32 s44, 2
s_cbranch_scc1 L_wn_196
ds_read_b64_tr_b16 a[56:57], v131 offset:8192
ds_read_b64_tr_b16 a[58:59], v131 offset:8320
ds_read_b64_tr_b16 a[60:61], v131 offset:9216
ds_read_b64_tr_b16 a[62:63], v131 offset:9344
ds_read_b64_tr_b16 a[136:137], v131 offset:16384
ds_read_b64_tr_b16 a[138:139], v131 offset:16512
ds_read_b64_tr_b16 a[140:141], v131 offset:17408
ds_read_b64_tr_b16 a[142:143], v131 offset:17536
ds_read_b64_tr_b16 a[216:217], v131 offset:24576
ds_read_b64_tr_b16 a[218:219], v131 offset:24704
ds_read_b64_tr_b16 a[220:221], v131 offset:25600
ds_read_b64_tr_b16 a[222:223], v131 offset:25728
s_branch L_we_193
L_wn_196:
ds_read_b64_tr_b16 a[48:49], v131 offset:8192
ds_read_b64_tr_b16 a[50:51], v131 offset:8320
ds_read_b64_tr_b16 a[52:53], v131 offset:9216
ds_read_b64_tr_b16 a[54:55], v131 offset:9344
ds_read_b64_tr_b16 a[128:129], v131 offset:16384
ds_read_b64_tr_b16 a[130:131], v131 offset:16512
ds_read_b64_tr_b16 a[132:133], v131 offset:17408
ds_read_b64_tr_b16 a[134:135], v131 offset:17536
ds_read_b64_tr_b16 a[208:209], v131 offset:24576
ds_read_b64_tr_b16 a[210:211], v131 offset:24704
ds_read_b64_tr_b16 a[212:213], v131 offset:25600
ds_read_b64_tr_b16 a[214:215], v131 offset:25728
L_we_193:
s_waitcnt vmcnt(18) lgkmcnt(0)
s_barrier
s_cmp_lg_u32 s44, 0
s_cbranch_scc1 L_wn_199
ds_read_b64_tr_b16 a[48:49], v131 offset:32768
ds_read_b64_tr_b16 a[50:51], v131 offset:32896
ds_read_b64_tr_b16 a[52:53], v131 offset:33792
ds_read_b64_tr_b16 a[54:55], v131 offset:33920
ds_read_b64_tr_b16 a[128:129], v131 offset:40960
ds_read_b64_tr_b16 a[130:131], v131 offset:41088
ds_read_b64_tr_b16 a[132:133], v131 offset:41984
ds_read_b64_tr_b16 a[134:135], v131 offset:42112
ds_read_b64_tr_b16 a[208:209], v131 offset:49152
ds_read_b64_tr_b16 a[210:211], v131 offset:49280
ds_read_b64_tr_b16 a[212:213], v131 offset:50176
ds_read_b64_tr_b16 a[214:215], v131 offset:50304
s_branch L_we_198
L_wn_199:
s_cmp_lg_u32 s44, 1
s_cbranch_scc1 L_wn_200
ds_read_b64_tr_b16 a[56:57], v131 offset:32768
ds_read_b64_tr_b16 a[58:59], v131 offset:32896
ds_read_b64_tr_b16 a[60:61], v131 offset:33792
ds_read_b64_tr_b16 a[62:63], v131 offset:33920
ds_read_b64_tr_b16 a[136:137], v131 offset:40960
ds_read_b64_tr_b16 a[138:139], v131 offset:41088
ds_read_b64_tr_b16 a[140:141], v131 offset:41984
ds_read_b64_tr_b16 a[142:143], v131 offset:42112
ds_read_b64_tr_b16 a[216:217], v131 offset:49152
ds_read_b64_tr_b16 a[218:219], v131 offset:49280
ds_read_b64_tr_b16 a[220:221], v131 offset:50176
ds_read_b64_tr_b16 a[222:223], v131 offset:50304
s_branch L_we_198
L_wn_200:
s_cmp_lg_u32 s44, 2
s_cbranch_scc1 L_wn_201
ds_read_b64_tr_b16 a[8:9], v131 offset:32768
ds_read_b64_tr_b16 a[10:11], v131 offset:32896
ds_read_b64_tr_b16 a[12:13], v131 offset:33792
ds_read_b64_tr_b16 a[14:15], v131 offset:33920
ds_read_b64_tr_b16 a[88:89], v131 offset:40960
ds_read_b64_tr_b16 a[90:91], v131 offset:41088
ds_read_b64_tr_b16 a[92:93], v131 offset:41984
ds_read_b64_tr_b16 a[94:95], v131 offset:42112
ds_read_b64_tr_b16 a[168:169], v131 offset:49152
ds_read_b64_tr_b16 a[170:171], v131 offset:49280
ds_read_b64_tr_b16 a[172:173], v131 offset:50176
ds_read_b64_tr_b16 a[174:175], v131 offset:50304
s_branch L_we_198
L_wn_201:
ds_read_b64_tr_b16 a[40:41], v131 offset:32768
ds_read_b64_tr_b16 a[42:43], v131 offset:32896
ds_read_b64_tr_b16 a[44:45], v131 offset:33792
ds_read_b64_tr_b16 a[46:47], v131 offset:33920
ds_read_b64_tr_b16 a[120:121], v131 offset:40960
ds_read_b64_tr_b16 a[122:123], v131 offset:41088
ds_read_b64_tr_b16 a[124:125], v131 offset:41984
ds_read_b64_tr_b16 a[126:127], v131 offset:42112
ds_read_b64_tr_b16 a[200:201], v131 offset:49152
ds_read_b64_tr_b16 a[202:203], v131 offset:49280
ds_read_b64_tr_b16 a[204:205], v131 offset:50176
ds_read_b64_tr_b16 a[206:207], v131 offset:50304
L_we_198:
s_waitcnt vmcnt(12) lgkmcnt(0)
s_barrier
s_cmp_lg_u32 s44, 0
s_cbranch_scc1 L_wn_204
ds_read_b64_tr_b16 a[56:57], v131 offset:57344
ds_read_b64_tr_b16 a[58:59], v131 offset:57472
ds_read_b64_tr_b16 a[60:61], v131 offset:58368
ds_read_b64_tr_b16 a[62:63], v131 offset:58496
ds_read_b64_tr_b16 a[136:137], v133 offset:0
ds_read_b64_tr_b16 a[138:139], v133 offset:128
ds_read_b64_tr_b16 a[140:141], v133 offset:1024
ds_read_b64_tr_b16 a[142:143], v133 offset:1152
ds_read_b64_tr_b16 a[216:217], v133 offset:8192
ds_read_b64_tr_b16 a[218:219], v133 offset:8320
ds_read_b64_tr_b16 a[220:221], v133 offset:9216
ds_read_b64_tr_b16 a[222:223], v133 offset:9344
s_branch L_we_203
L_wn_204:
s_cmp_lg_u32 s44, 1
s_cbranch_scc1 L_wn_205
ds_read_b64_tr_b16 a[48:49], v131 offset:57344
ds_read_b64_tr_b16 a[50:51], v131 offset:57472
ds_read_b64_tr_b16 a[52:53], v131 offset:58368
ds_read_b64_tr_b16 a[54:55], v131 offset:58496
ds_read_b64_tr_b16 a[128:129], v133 offset:0
ds_read_b64_tr_b16 a[130:131], v133 offset:128
ds_read_b64_tr_b16 a[132:133], v133 offset:1024
ds_read_b64_tr_b16 a[134:135], v133 offset:1152
ds_read_b64_tr_b16 a[208:209], v133 offset:8192
ds_read_b64_tr_b16 a[210:211], v133 offset:8320
ds_read_b64_tr_b16 a[212:213], v133 offset:9216
ds_read_b64_tr_b16 a[214:215], v133 offset:9344
s_branch L_we_203
L_wn_205:
s_cmp_lg_u32 s44, 2
s_cbranch_scc1 L_wn_206
ds_read_b64_tr_b16 a[40:41], v131 offset:57344
ds_read_b64_tr_b16 a[42:43], v131 offset:57472
ds_read_b64_tr_b16 a[44:45], v131 offset:58368
ds_read_b64_tr_b16 a[46:47], v131 offset:58496
ds_read_b64_tr_b16 a[120:121], v133 offset:0
ds_read_b64_tr_b16 a[122:123], v133 offset:128
ds_read_b64_tr_b16 a[124:125], v133 offset:1024
ds_read_b64_tr_b16 a[126:127], v133 offset:1152
ds_read_b64_tr_b16 a[200:201], v133 offset:8192
ds_read_b64_tr_b16 a[202:203], v133 offset:8320
ds_read_b64_tr_b16 a[204:205], v133 offset:9216
ds_read_b64_tr_b16 a[206:207], v133 offset:9344
s_branch L_we_203
L_wn_206:
ds_read_b64_tr_b16 a[8:9], v131 offset:57344
ds_read_b64_tr_b16 a[10:11], v131 offset:57472
ds_read_b64_tr_b16 a[12:13], v131 offset:58368
ds_read_b64_tr_b16 a[14:15], v131 offset:58496
ds_read_b64_tr_b16 a[88:89], v133 offset:0
ds_read_b64_tr_b16 a[90:91], v133 offset:128
ds_read_b64_tr_b16 a[92:93], v133 offset:1024
ds_read_b64_tr_b16 a[94:95], v133 offset:1152
ds_read_b64_tr_b16 a[168:169], v133 offset:8192
ds_read_b64_tr_b16 a[170:171], v133 offset:8320
ds_read_b64_tr_b16 a[172:173], v133 offset:9216
ds_read_b64_tr_b16 a[174:175], v133 offset:9344
L_we_203:
s_waitcnt vmcnt(6) lgkmcnt(0)
s_barrier
s_mul_i32 s48, s45, 2731
s_lshr_b32 s48, s48, 16
s_and_b32 s49, s48, 1
s_lshl_b32 s49, s49, 7
s_lshr_b32 s48, s48, 1
s_lshl_b32 s48, s48, 2
s_add_u32 s48, s48, s49
v_mov_b32 v136, 32
v_writelane_b32 v136, 48, 1
v_writelane_b32 v136, 52, 2
v_writelane_b32 v136, s48, 3
s_add_u32 s48, s48, 16
v_writelane_b32 v136, s48, 4
global_load_dword v137, v136, s[40:41] sc1
ds_read_b64_tr_b16 a[64:65], v130 offset:0
ds_read_b64_tr_b16 a[66:67], v130 offset:128
ds_read_b64_tr_b16 a[68:69], v130 offset:1024
ds_read_b64_tr_b16 a[70:71], v130 offset:1152
ds_read_b64_tr_b16 a[144:145], v130 offset:8192
ds_read_b64_tr_b16 a[146:147], v130 offset:8320
ds_read_b64_tr_b16 a[148:149], v130 offset:9216
ds_read_b64_tr_b16 a[150:151], v130 offset:9344
ds_read_b64_tr_b16 a[224:225], v130 offset:16384
ds_read_b64_tr_b16 a[226:227], v130 offset:16512
ds_read_b64_tr_b16 a[228:229], v130 offset:17408
ds_read_b64_tr_b16 a[230:231], v130 offset:17536
s_waitcnt vmcnt(1) lgkmcnt(0)
s_barrier
ds_read_b64_tr_b16 a[72:73], v130 offset:24576
ds_read_b64_tr_b16 a[74:75], v130 offset:24704
ds_read_b64_tr_b16 a[76:77], v130 offset:25600
ds_read_b64_tr_b16 a[78:79], v130 offset:25728
ds_read_b64_tr_b16 a[152:153], v130 offset:32768
ds_read_b64_tr_b16 a[154:155], v130 offset:32896
ds_read_b64_tr_b16 a[156:157], v130 offset:33792
ds_read_b64_tr_b16 a[158:159], v130 offset:33920
ds_read_b64_tr_b16 a[232:233], v130 offset:40960
ds_read_b64_tr_b16 a[234:235], v130 offset:41088
ds_read_b64_tr_b16 a[236:237], v130 offset:41984
ds_read_b64_tr_b16 a[238:239], v130 offset:42112
s_waitcnt lgkmcnt(0)
s_barrier
s_mov_b32 s53, 0
L_cip_209:
s_waitcnt vmcnt(0)
v_readlane_b32 s48, v137, 0
v_readlane_b32 s63, v137, 1
v_readlane_b32 s58, v137, 2
s_lshr_b32 s48, s48, 6
s_min_u32 s48, s48, s63
s_min_u32 s48, s48, s58
s_cmp_lg_u32 s48, 0
s_cbranch_scc1 L_ci_208
s_add_u32 s53, s53, 1
s_cmp_gt_u32 s53, 100000
s_cbranch_scc1 L_ci_208
s_sleep 8
global_load_dword v137, v136, s[40:41] sc1
s_branch L_cip_209
L_ci_208:
s_mul_i32 s48, s45, 2731
s_lshr_b32 s48, s48, 16
s_mul_i32 s49, s48, 24
s_sub_u32 s49, s45, s49
s_sub_u32 s49, s49, s89
v_readlane_b32 s48, v137, 3
v_readlane_b32 s51, v137, 4
s_add_u32 s51, s49, 3
s_cmp_ge_u32 s48, s51
s_cselect_b32 s60, 1, 0
s_lshr_b32 s63, s63, 1
s_and_b32 s63, s63, 1
s_lshl_b32 s63, s63, 13
s_add_u32 s63, s63, 2097152
s_lshr_b32 s58, s58, 1
s_and_b32 s58, s58, 1
s_lshl_b32 s58, s58, 13
s_add_u32 s58, s58, 4194304
s_add_u32 s59, s58, 4096
s_lshl_b32 s56, s54, 14
s_add_u32 s56, s56, s63
s_add_u32 s75, s56, 4096
s_lshr_b32 s57, s54, 2
s_add_u32 s57, s57, 64
s_lshl_b32 s57, s57, 14
s_and_b32 s48, s54, 3
s_lshl_b32 s48, s48, 11
s_add_u32 s57, s57, s48
s_add_u32 s57, s57, s63
s_lshl_b32 s48, s44, 10
s_add_u32 s78, s56, s48
s_add_u32 s79, s75, s48
s_add_u32 s90, s57, s48
s_cmp_lt_u32 s44, 2
s_cselect_b32 s90, s90, 1879048192
s_lshl_b32 s48, s89, 12
s_add_u32 s51, s77, 50331648
s_add_u32 s49, s51, s69
s_sub_u32 s49, s49, s68
s_add_u32 s50, s51, s70
s_sub_u32 s50, s50, s68
s_add_u32 s51, s51, s48
s_add_u32 s77, s72, 16777216
s_cmp_eq_u32 s44, 1
s_cselect_b32 s77, s51, s77
s_cmp_eq_u32 s44, 2
s_cselect_b32 s77, s49, s77
s_cmp_eq_u32 s44, 3
s_cselect_b32 s77, s50, s77
s_lshl_b32 s71, s44, 12
s_add_u32 s71, s71, 32768
s_mov_b32 s95, s71
s_sub_u32 s48, s44, 1
s_and_b32 s48, s48, 1
s_lshl_b32 s48, s48, 8
v_add_u32 v166, s48, v166
v_mov_b32 v161, 0
s_lshl_b32 s48, s89, 2
s_add_u32 s48, s48, s44
s_cmp_ge_u32 s48, 10
s_cselect_b32 s86, 1, 0
s_mov_b32 s85, 0
s_mov_b32 s91, 1879048192
s_mov_b32 s80, 1
s_sub_u32 s48, s44, 1
s_cmp_lt_u32 s48, 2
s_cselect_b32 s81, 1, 0
s_cmp_eq_u32 s60, 0
s_cselect_b32 s81, 2, s81
s_mul_i32 s84, s45, 4096
s_add_u32 s84, s84, 1050624
v_min_u32 v162, 2, v1
v_lshl_add_u32 v162, v162, 7, s76
L_step_210:
v_xor_b32 v152, 1024, v170
v_xor_b32 v153, 2048, v170
v_xor_b32 v154, 3072, v170
s_mov_b32 m0, s95
s_mov_b32 s53, 0
s_cmp_eq_u32 s54, 0
s_cbranch_scc1 L_cp_213
s_cmp_gt_u32 s62, s80
s_cbranch_scc0 L_t1g_216
L_t1g2_217:
s_mov_b32 m0, s95
ds_read_b64_tr_b16 v[112:113], v171 offset:8
ds_read_b64_tr_b16 v[114:115], v171 offset:72
ds_read_b64_tr_b16 v[116:117], v171 offset:2056
ds_read_b64_tr_b16 v[118:119], v171 offset:2120
ds_read_b64_tr_b16 v[120:121], v171 offset:4104
ds_read_b64_tr_b16 v[122:123], v171 offset:4168
s_waitcnt lgkmcnt(4)
v_mfma_f32_16x16x32_bf16 v[24:27], v[112:115], a[240:243], 0
ds_read_b64_tr_b16 v[124:125], v171 offset:6152
ds_read_b64_tr_b16 v[126:127], v171 offset:6216
v_mfma_f32_16x16x32_bf16 v[28:31], v[112:115], a[248:251], 0
v_mfma_f32_16x16x32_bf16 v[32:35], v[112:115], v[176:179], 0
v_mfma_f32_16x16x32_bf16 v[36:39], v[112:115], v[184:187], 0
s_waitcnt lgkmcnt(4)
v_mfma_f32_16x16x32_bf16 v[24:27], v[116:119], a[244:247], v[24:27]
ds_read_b64_tr_b16 v[112:113], v171 offset:8200
ds_read_b64_tr_b16 v[114:115], v171 offset:8264
v_mfma_f32_16x16x32_bf16 v[28:31], v[116:119], a[252:255], v[28:31]
v_mfma_f32_16x16x32_bf16 v[32:35], v[116:119], v[180:183], v[32:35]
v_mfma_f32_16x16x32_bf16 v[36:39], v[116:119], v[188:191], v[36:39]
s_waitcnt lgkmcnt(4)
v_mfma_f32_16x16x32_bf16 v[24:27], v[120:123], v[192:195], v[24:27]
ds_read_b64_tr_b16 v[116:117], v171 offset:10248
ds_read_b64_tr_b16 v[118:119], v171 offset:10312
v_mfma_f32_16x16x32_bf16 v[28:31], v[120:123], v[200:203], v[28:31]
v_mfma_f32_16x16x32_bf16 v[32:35], v[120:123], v[208:211], v[32:35]
v_mfma_f32_16x16x32_bf16 v[36:39], v[120:123], v[216:219], v[36:39]
s_waitcnt lgkmcnt(4)
v_mfma_f32_16x16x32_bf16 v[24:27], v[124:127], v[196:199], v[24:27]
v_mfma_f32_16x16x32_bf16 v[28:31], v[124:127], v[204:207], v[28:31]
v_mfma_f32_16x16x32_bf16 v[32:35], v[124:127], v[212:215], v[32:35]
v_mfma_f32_16x16x32_bf16 v[36:39], v[124:127], v[220:223], v[36:39]
s_waitcnt lgkmcnt(2)
v_mfma_f32_16x16x32_bf16 v[24:27], v[112:115], v[224:227], v[24:27]
v_mfma_f32_16x16x32_bf16 v[28:31], v[112:115], v[232:235], v[28:31]
v_mfma_f32_16x16x32_bf16 v[32:35], v[112:115], v[240:243], v[32:35]
v_mfma_f32_16x16x32_bf16 v[36:39], v[112:115], v[248:251], v[36:39]
s_waitcnt lgkmcnt(0)
v_mfma_f32_16x16x32_bf16 v[24:27], v[116:119], v[228:231], v[24:27]
v_mfma_f32_16x16x32_bf16 v[28:31], v[116:119], v[236:239], v[28:31]
buffer_load_dwordx4 v[8:11], v2, s[4:7], s78 offen sc1
buffer_load_dwordx4 v[12:15], v2, s[4:7], s79 offen sc1
buffer_load_dwordx4 v[128:131], v2, s[4:7], s90 offen sc1
v_mfma_f32_16x16x32_bf16 v[32:35], v[116:119], v[244:247], v[32:35]
v_mfma_f32_16x16x32_bf16 v[36:39], v[116:119], v[252:255], v[36:39]
s_nop 1
v_cvt_pk_bf16_f32 v98, v24, v25
v_cvt_pk_bf16_f32 v99, v26, v27
v_cvt_pk_bf16_f32 v102, v28, v29
v_cvt_pk_bf16_f32 v103, v30, v31
s_nop 0
v_cvt_pk_bf16_f32 v106, v32, v33
v_cvt_pk_bf16_f32 v107, v34, v35
v_cvt_pk_bf16_f32 v110, v36, v37
v_cvt_pk_bf16_f32 v111, v38, v39
L_su2_221:
s_sleep 2
s_nop 7
buffer_load_dwordx4 v2, s[4:7], s91 offen offset:0 sc1 lds
buffer_load_dwordx4 v2, s[4:7], s91 offen offset:1024 sc1 lds
buffer_load_dwordx4 v2, s[4:7], s91 offen offset:2048 sc1 lds
buffer_load_dwordx4 v2, s[4:7], s91 offen offset:3072 sc1 lds
buffer_load_dword v161, v162, s[4:7], 0 offen sc1
s_cmp_lg_u32 s85, 0
s_cbranch_scc1 L_k3_218
s_waitcnt vmcnt(7)
ds_write_b128 v170, v[8:11] offset:0
v_max3_u32 v172, v8, v9, v10
v_max_u32 v172, v172, v11
s_waitcnt vmcnt(6)
ds_write_b128 v170, v[12:15] offset:4096
v_max3_u32 v172, v172, v12, v13
v_max3_u32 v172, v172, v14, v15
s_waitcnt vmcnt(5)
ds_write_b128 v170, v[128:131] offset:8192
v_max3_u32 v172, v172, v128, v129
v_max3_u32 v172, v172, v130, v131
v_cmp_eq_u32 vcc, -1, v172
s_cbranch_vccnz L_cp_213
L_cpk_215:
s_waitcnt lgkmcnt(0)
s_barrier
ds_read_b128 v[16:19], v152 offset:0
ds_read_b128 v[20:23], v153 offset:0
ds_read_b128 v[24:27], v154 offset:0
ds_read_b128 v[28:31], v152 offset:4096
ds_read_b128 v[32:35], v153 offset:4096
ds_read_b128 v[36:39], v154 offset:4096
ds_read_b128 v[40:43], v2 offset:16384
ds_read_b128 v[44:47], v2 offset:17408
v_smfmac_f32_16x16x64_bf16 v[48:51], v[8:11], a[0:7], v165
v_smfmac_f32_16x16x64_bf16 v[52:55], v[8:11], a[80:87], v165
v_smfmac_f32_16x16x64_bf16 v[48:51], v[12:15], a[8:15], v165
v_smfmac_f32_16x16x64_bf16 v[52:55], v[12:15], a[88:95], v165
s_waitcnt lgkmcnt(7)
v_smfmac_f32_16x16x64_bf16 v[48:51], v[16:19], a[16:23], v165
v_smfmac_f32_16x16x64_bf16 v[52:55], v[16:19], a[96:103], v165
s_waitcnt lgkmcnt(6)
v_smfmac_f32_16x16x64_bf16 v[48:51], v[20:23], a[24:31], v165
v_smfmac_f32_16x16x64_bf16 v[52:55], v[20:23], a[104:111], v165
s_waitcnt lgkmcnt(5)
v_smfmac_f32_16x16x64_bf16 v[48:51], v[24:27], a[32:39], v165
v_smfmac_f32_16x16x64_bf16 v[52:55], v[24:27], a[112:119], v165
s_waitcnt lgkmcnt(4)
v_smfmac_f32_16x16x64_bf16 v[48:51], v[28:31], a[40:47], v165
v_smfmac_f32_16x16x64_bf16 v[52:55], v[28:31], a[120:127], v165
s_waitcnt lgkmcnt(3)
v_smfmac_f32_16x16x64_bf16 v[48:51], v[32:35], a[48:55], v165
v_smfmac_f32_16x16x64_bf16 v[52:55], v[32:35], a[128:135], v165
s_waitcnt lgkmcnt(2)
v_smfmac_f32_16x16x64_bf16 v[48:51], v[36:39], a[56:63], v165
v_smfmac_f32_16x16x64_bf16 v[52:55], v[36:39], a[136:143], v165
s_waitcnt lgkmcnt(1)
v_smfmac_f32_16x16x64_bf16 v[48:51], v[40:43], a[64:71], v165
v_smfmac_f32_16x16x64_bf16 v[52:55], v[40:43], a[144:151], v165
s_waitcnt lgkmcnt(0)
v_smfmac_f32_16x16x64_bf16 v[48:51], v[44:47], a[72:79], v165
v_smfmac_f32_16x16x64_bf16 v[52:55], v[44:47], a[152:159], v165
v_smfmac_f32_16x16x64_bf16 v[56:59], v[8:11], a[160:167], v165
v_smfmac_f32_16x16x64_bf16 v[56:59], v[12:15], a[168:175], v165
s_and_b32 s55, s54, 1
s_lshl_b32 s55, 1, s55
s_nop 2
v_pk_add_f32 v[48:49], v[48:49], v[50:51]
v_pk_add_f32 v[52:53], v[52:53], v[54:55]
v_pk_mul_f32 v[48:49], v[48:49], s[66:67]
v_cvt_pk_bf16_f32 v130, v52, v53
v_cvt_pk_bf16_f32 v131, v52, v53
ds_write_b64 v168, v[130:131] offset:2048
v_cvt_pk_bf16_f32 v128, v48, v49
v_cvt_pk_bf16_f32 v129, v48, v49
ds_write_b64 v168, v[128:129] offset:0
v_smfmac_f32_16x16x64_bf16 v[56:59], v[16:19], a[176:183], v165
v_smfmac_f32_16x16x64_bf16 v[56:59], v[20:23], a[184:191], v165
v_smfmac_f32_16x16x64_bf16 v[56:59], v[24:27], a[192:199], v165
s_cmp_eq_u32 s54, 0
s_cbranch_scc1 L_first_222
L_first2_223:
s_cmp_lg_u32 s81, 0
s_waitcnt lgkmcnt(0)
s_barrier
ds_read_b64_tr_b16 v[112:113], v160 offset:0
ds_read_b64_tr_b16 v[114:115], v160 offset:128
ds_read_b64_tr_b16 v[116:117], v160 offset:1024
ds_read_b64_tr_b16 v[118:119], v160 offset:1152
s_cbranch_scc1 L_x12_226
ds_read_b64_tr_b16 v[88:89], v160 offset:2048
ds_read_b64_tr_b16 v[90:91], v160 offset:2176
ds_read_b64_tr_b16 v[92:93], v160 offset:3072
ds_read_b64_tr_b16 v[94:95], v160 offset:3200
v_smfmac_f32_16x16x64_bf16 v[56:59], v[28:31], a[200:207], v165
v_smfmac_f32_16x16x64_bf16 v[56:59], v[32:35], a[208:215], v165
v_smfmac_f32_16x16x64_bf16 v[56:59], v[36:39], a[216:223], v165
s_waitcnt lgkmcnt(0)
v_mfma_f32_16x16x32_bf16 v[120:123], v[88:91], v[112:115], 0
v_mfma_f32_16x16x32_bf16 v[120:123], v[92:95], v[116:119], v[120:123]
v_smfmac_f32_16x16x64_bf16 v[56:59], v[40:43], a[224:231], v165
v_smfmac_f32_16x16x64_bf16 v[56:59], v[44:47], a[232:239], v165
s_not_b32 s51, s54
v_mov_b32 v48, 0
v_mov_b32 v49, 0
v_mov_b32 v50, 0
v_mov_b32 v51, 0
v_mov_b32 v52, 0
v_cndmask_b32 v172, v120, v121, s[64:65]
v_bfi_b32 v172, 3, s55, v172
buffer_store_dword v172, v4, s[4:7], 0 offen
ds_write_b32 v159, v172
v_pk_add_f32 v[56:57], v[56:57], v[58:59]
v_cvt_pk_bf16_f32 v174, v56, v57
ds_write_b32 v164, v174
L_as2_225:
s_cmp_eq_u32 s54, 63
s_cbranch_scc1 L_final_211
s_waitcnt lgkmcnt(0)
s_barrier
ds_read_b64_tr_b16 v[144:145], v169 offset:0
ds_read_b64_tr_b16 v[146:147], v169 offset:128
ds_read_b128 v[136:139], v2 offset:20480
ds_read_b32 v142, v163 offset:21504
s_cmp_eq_u32 s44, 3
s_cbranch_scc1 L_w3_227
L_w3b_228:
v_mov_b32 v48, 0
v_mov_b32 v49, 0
v_mov_b32 v50, 0
v_mov_b32 v51, 0
v_mov_b32 v52, 0
v_mov_b32 v53, 0
v_mov_b32 v54, 0
v_mov_b32 v55, 0
v_mov_b32 v56, 0
v_mov_b32 v57, 0
v_mov_b32 v58, 0
v_mov_b32 v59, 0
s_sleep 1
s_mov_b32 s53, 0
buffer_load_dwordx4 v[128:131], v2, s[4:7], s69 offen sc1
buffer_load_dwordx4 v[132:135], v2, s[4:7], s70 offen sc1
buffer_load_dword v140, v163, s[4:7], s69 offen offset:1024 sc1
buffer_load_dword v141, v163, s[4:7], s70 offen offset:1024 sc1
s_waitcnt lgkmcnt(0)
v_smfmac_f32_16x16x64_bf16 v[60:63], v[144:147], a[240:247], v165
v_mov_b32 v112, 0x3f803f80
v_smfmac_f32_16x16x64_bf16 v[64:67], v[144:147], a[248:255], v165
v_mov_b32 v113, 0x3f803f80
v_smfmac_f32_16x16x64_bf16 v[68:71], v[144:147], v[176:183], v165
v_mov_b32 v114, 0x3f803f80
v_smfmac_f32_16x16x64_bf16 v[72:75], v[144:147], v[184:191], v165
v_mov_b32 v115, 0x3f803f80
s_sleep 2
s_nop 7
buffer_load_dwordx4 v[148:151], v2, s[4:7], s69 offen offset:2048 sc1
buffer_load_dwordx4 v[152:155], v2, s[4:7], s70 offen offset:2048 sc1
L_ap_229:
s_waitcnt vmcnt(5)
v_and_b32 v172, v128, v130
v_pk_add_f32 v[128:129], v[128:129], v[136:137]
v_pk_add_f32 v[130:131], v[130:131], v[138:139]
s_waitcnt vmcnt(4)
v_bitop3_b32 v172, v172, v132, v134 bitop3:0x80
v_pk_add_f32 v[128:129], v[128:129], v[132:133]
v_pk_add_f32 v[130:131], v[130:131], v[134:135]
v_max3_f32 v173, v128, v129, v130
s_waitcnt vmcnt(2)
v_bitop3_b32 v172, v172, v140, v141 bitop3:0x80
v_add_f32 v132, v140, v142
v_and_b32 v172, s55, v172
v_add_f32 v132, v132, v141
v_cmp_eq_u32 vcc, 0, v172
v_max3_f32 v173, v173, v131, v132
s_nop 1
v_max_f32_dpp v133, v173, v173 quad_perm:[2,3,0,1] row_mask:0xf bank_mask:0xf
v_max_f32_dpp v134, v173, v173 quad_perm:[2,3,0,1] row_mask:0xf bank_mask:0xf
s_cbranch_vccnz L_apr_233
L_apx_230:
s_nop 0
v_permlane32_swap_b32 v133, v134
v_max_f32 v173, v133, v134
v_max_f32 v172, v133, v134
s_nop 0
s_nop 0
v_permlane16_swap_b32 v172, v173
v_max_f32 v134, v172, v173
v_pk_add_f32 v[128:129], v[128:129], v[134:135] op_sel_hi:[1,0] neg_lo:[0,1] neg_hi:[0,1]
v_pk_add_f32 v[130:131], v[130:131], v[134:135] op_sel_hi:[1,0] neg_lo:[0,1] neg_hi:[0,1]
v_exp_f32 v128, v128
v_exp_f32 v129, v129
v_sub_f32 v132, v132, v134
v_exp_f32 v130, v130
v_exp_f32 v131, v131
v_exp_f32 v132, v132
v_cvt_pk_bf16_f32 v136, v128, v129
v_cvt_pk_bf16_f32 v137, v130, v131
v_mov_b32_dpp v138, v132 quad_perm:[0,1,0,1] row_mask:0xf bank_mask:0xf
v_mov_b32_dpp v80, v136 quad_perm:[0,1,0,1] row_mask:0xf bank_mask:0xf
v_mov_b32_dpp v82, v136 quad_perm:[2,3,2,3] row_mask:0xf bank_mask:0xf
v_mov_b32_dpp v81, v137 quad_perm:[0,1,0,1] row_mask:0xf bank_mask:0xf
v_mov_b32_dpp v83, v137 quad_perm:[2,3,2,3] row_mask:0xf bank_mask:0xf
v_mov_b32_dpp v139, v132 quad_perm:[2,3,2,3] row_mask:0xf bank_mask:0xf
v_cvt_pk_bf16_f32 v84, v138, v139
v_cvt_pk_bf16_f32 v85, v138, v139
v_mfma_f32_16x16x32_bf16 v[24:27], v[80:83], v[112:115], 0
v_mov_b32 v86, v84
v_mov_b32 v175, s54
v_mfma_f32_16x16x32_bf16 v[8:11], v[80:83], v[96:99], 0
v_mfma_f32_16x16x32_bf16 v[12:15], v[80:83], v[100:103], 0
s_waitcnt vmcnt(0)
v_bitop3_b32 v172, v148, v150, s54 bitop3:0x42
v_mfma_f32_16x16x32_bf16 v[16:19], v[80:83], v[104:107], 0
v_bitop3_b32 v173, v152, v154, s54 bitop3:0x42
v_bitop3_b32 v172, v172, v173, 1 bitop3:0x80
v_mfma_f32_16x16x32_bf16 v[20:23], v[80:83], v[108:111], 0
v_cmp_eq_u32 vcc, 0, v172
v_mfma_f32_16x16x16_bf16 v[24:27], v[86:87], v[112:113], v[24:27]
s_cbranch_vccnz L_vpr_231
L_vpx_232:
v_smfmac_f32_16x16x64_bf16 v[60:63], v[148:151], v[192:199], v165
v_smfmac_f32_16x16x64_bf16 v[60:63], v[152:155], v[224:231], v165
v_smfmac_f32_16x16x64_bf16 v[64:67], v[148:151], v[200:207], v165
buffer_store_dword v175, v167, s[4:7], 0 offen sc1
v_smfmac_f32_16x16x64_bf16 v[64:67], v[152:155], v[232:239], v165
s_nop 1
v_rcp_f32 v24, v24
v_smfmac_f32_16x16x64_bf16 v[68:71], v[148:151], v[208:215], v165
v_rcp_f32 v25, v25
v_smfmac_f32_16x16x64_bf16 v[68:71], v[152:155], v[240:247], v165
v_smfmac_f32_16x16x64_bf16 v[72:75], v[148:151], v[216:223], v165
v_cvt_pk_bf16_f32 v116, v60, v61
v_cvt_pk_bf16_f32 v117, v62, v63
v_smfmac_f32_16x16x64_bf16 v[72:75], v[152:155], v[248:255], v165
v_cvt_pk_bf16_f32 v118, v64, v65
v_cvt_pk_bf16_f32 v119, v66, v67
v_mfma_f32_16x16x16_bf16 v[8:11], v[84:85], v[116:117], v[8:11]
s_nop 0
v_cvt_pk_bf16_f32 v120, v68, v69
v_cvt_pk_bf16_f32 v121, v70, v71
v_mfma_f32_16x16x16_bf16 v[12:15], v[84:85], v[118:119], v[12:15]
s_nop 0
v_mfma_f32_16x16x16_bf16 v[16:19], v[84:85], v[120:121], v[16:19]
v_cvt_pk_bf16_f32 v122, v72, v73
v_cvt_pk_bf16_f32 v123, v74, v75
s_nop 0
s_nop 0
v_mfma_f32_16x16x16_bf16 v[20:23], v[84:85], v[122:123], v[20:23]
v_pk_mul_f32 v[8:9], v[8:9], v[24:25]
v_cvt_pk_bf16_f32 v140, v8, v9
v_bfi_b32 v140, 1, s54, v140
v_pk_mul_f32 v[12:13], v[12:13], v[24:25]
v_cvt_pk_bf16_f32 v141, v12, v13
v_pk_mul_f32 v[16:17], v[16:17], v[24:25]
v_cvt_pk_bf16_f32 v142, v16, v17
v_bfi_b32 v142, 1, s54, v142
v_pk_mul_f32 v[20:21], v[20:21], v[24:25]
v_cvt_pk_bf16_f32 v143, v20, v21
buffer_store_dwordx4 v[140:143], v5, s[4:7], s58 offen sc1
s_lshl_b32 s48, s44, 8
v_subrev_u32 v172, s48, v164
ds_read_b32 v148, v172 offset:0
ds_read_b32 v149, v172 offset:256
ds_read_b32 v150, v172 offset:512
ds_read_b32 v151, v172 offset:768
v_xor_b32 v171, 0x4000, v171
v_xor_b32 v166, 0x4000, v166
s_add_u32 s54, s54, 1
s_not_b32 s51, s54
s_cmp_eq_u32 s44, 3
s_cselect_b32 s85, 1, 0
s_lshl_b32 s56, s54, 14
s_add_u32 s56, s56, s63
s_add_u32 s75, s56, 4096
s_lshr_b32 s57, s54, 2
s_add_u32 s57, s57, 64
s_lshl_b32 s57, s57, 14
s_and_b32 s48, s54, 3
s_lshl_b32 s48, s48, 11
s_add_u32 s57, s57, s48
s_add_u32 s57, s57, s63
s_lshl_b32 s48, s44, 10
s_add_u32 s78, s56, s48
s_add_u32 s79, s75, s48
s_add_u32 s90, s57, s48
s_cmp_lt_u32 s44, 2
s_cselect_b32 s90, s90, 1879048192
s_cmp_lt_u32 s74, 8
s_cselect_b32 s52, s56, s57
s_mov_b32 s53, 0
s_cmp_eq_u32 s61, 0
s_cselect_b32 s82, 1879048192, s58
s_cselect_b32 s83, 1879048192, s59
s_cmp_gt_u32 s54, 56
s_cselect_b32 s48, s85, 0
s_cmp_lg_u32 s48, 0
s_cbranch_scc1 L_ke_235
L_ke2_236:
s_barrier
ds_read_b64_tr_b16 v[112:113], v171 offset:0
ds_read_b64_tr_b16 v[114:115], v171 offset:64
ds_read_b64_tr_b16 v[116:117], v171 offset:2048
ds_read_b64_tr_b16 v[118:119], v171 offset:2112
ds_read_b64_tr_b16 v[120:121], v171 offset:4096
ds_read_b64_tr_b16 v[122:123], v171 offset:4160
s_waitcnt lgkmcnt(4)
v_mfma_f32_16x16x32_bf16 v[24:27], v[112:115], a[240:243], 0
ds_read_b64_tr_b16 v[124:125], v171 offset:6144
ds_read_b64_tr_b16 v[126:127], v171 offset:6208
v_mov_b32 v60, 0
v_mfma_f32_16x16x32_bf16 v[28:31], v[112:115], a[248:251], 0
v_mov_b32 v61, 0
v_mfma_f32_16x16x32_bf16 v[32:35], v[112:115], v[176:179], 0
v_mov_b32 v62, 0
v_mfma_f32_16x16x32_bf16 v[36:39], v[112:115], v[184:187], 0
v_mov_b32 v63, 0
s_waitcnt lgkmcnt(4)
v_mfma_f32_16x16x32_bf16 v[24:27], v[116:119], a[244:247], v[24:27]
ds_read_b64_tr_b16 v[112:113], v171 offset:8192
ds_read_b64_tr_b16 v[114:115], v171 offset:8256
v_mov_b32 v64, 0
v_mfma_f32_16x16x32_bf16 v[28:31], v[116:119], a[252:255], v[28:31]
v_mov_b32 v65, 0
v_mfma_f32_16x16x32_bf16 v[32:35], v[116:119], v[180:183], v[32:35]
v_mov_b32 v66, 0
v_mfma_f32_16x16x32_bf16 v[36:39], v[116:119], v[188:191], v[36:39]
v_mov_b32 v67, 0
s_waitcnt lgkmcnt(4)
v_mfma_f32_16x16x32_bf16 v[24:27], v[120:123], v[192:195], v[24:27]
ds_read_b64_tr_b16 v[116:117], v171 offset:10240
ds_read_b64_tr_b16 v[118:119], v171 offset:10304
v_mov_b32 v68, 0
v_mfma_f32_16x16x32_bf16 v[28:31], v[120:123], v[200:203], v[28:31]
buffer_load_dwordx4 v[128:131], v6, s[4:7], s82 offen sc1
buffer_load_dwordx4 v[132:135], v6, s[4:7], s83 offen sc1
v_mfma_f32_16x16x32_bf16 v[32:35], v[120:123], v[208:211], v[32:35]
v_mov_b32 v69, 0
v_mfma_f32_16x16x32_bf16 v[36:39], v[120:123], v[216:219], v[36:39]
v_mov_b32 v70, 0
s_waitcnt lgkmcnt(4)
v_mfma_f32_16x16x32_bf16 v[24:27], v[124:127], v[196:199], v[24:27]
v_mov_b32 v71, 0
v_mfma_f32_16x16x32_bf16 v[28:31], v[124:127], v[204:207], v[28:31]
v_mov_b32 v72, 0
v_mfma_f32_16x16x32_bf16 v[32:35], v[124:127], v[212:215], v[32:35]
v_mov_b32 v73, 0
v_mfma_f32_16x16x32_bf16 v[36:39], v[124:127], v[220:223], v[36:39]
v_mov_b32 v74, 0
s_waitcnt lgkmcnt(2)
v_mfma_f32_16x16x32_bf16 v[24:27], v[112:115], v[224:227], v[24:27]
v_mov_b32 v75, 0
v_mfma_f32_16x16x32_bf16 v[28:31], v[112:115], v[232:235], v[28:31]
v_mfma_f32_16x16x32_bf16 v[32:35], v[112:115], v[240:243], v[32:35]
v_mfma_f32_16x16x32_bf16 v[36:39], v[112:115], v[248:251], v[36:39]
s_waitcnt lgkmcnt(0)
v_mfma_f32_16x16x32_bf16 v[24:27], v[116:119], v[228:231], v[24:27]
v_mfma_f32_16x16x32_bf16 v[28:31], v[116:119], v[236:239], v[28:31]
buffer_load_dwordx4 v[136:139], v6, s[4:7], s82 offen sc1
buffer_load_dwordx4 v[140:143], v6, s[4:7], s83 offen sc1
v_mfma_f32_16x16x32_bf16 v[32:35], v[116:119], v[244:247], v[32:35]
v_mfma_f32_16x16x32_bf16 v[36:39], v[116:119], v[252:255], v[36:39]
s_nop 2
v_cvt_pk_bf16_f32 v96, v24, v25
v_cvt_pk_bf16_f32 v97, v26, v27
v_cvt_pk_bf16_f32 v100, v28, v29
v_cvt_pk_bf16_f32 v101, v30, v31
v_cvt_pk_bf16_f32 v104, v32, v33
v_cvt_pk_bf16_f32 v105, v34, v35
v_cvt_pk_bf16_f32 v108, v36, v37
v_cvt_pk_bf16_f32 v109, v38, v39
s_cmp_eq_u32 s61, 0
s_cbranch_scc1 L_b3_234
L_bp_237:
s_waitcnt vmcnt(3)
v_mfma_f32_16x16x32_bf16 v[120:123], v[128:131], v[76:79], 0
v_bitop3_b32 v144, v128, v130, s51 bitop3:0x7e
s_waitcnt vmcnt(2)
v_mfma_f32_16x16x32_bf16 v[120:123], v[132:135], v[76:79], v[120:123]
v_bitop3_b32 v145, v132, v134, s51 bitop3:0x7e
v_bitop3_b32 v172, v144, v145, 1 bitop3:0xa8
v_cmp_eq_u32 vcc, 1, v172
s_cbranch_vccz L_bpx_238
buffer_load_dwordx4 v[128:131], v6, s[4:7], s82 offen sc1
buffer_load_dwordx4 v[132:135], v6, s[4:7], s83 offen sc1
s_waitcnt vmcnt(3)
s_nop 0
v_mfma_f32_16x16x32_bf16 v[120:123], v[136:139], v[76:79], 0
v_bitop3_b32 v144, v136, v138, s51 bitop3:0x7e
s_waitcnt vmcnt(2)
v_mfma_f32_16x16x32_bf16 v[120:123], v[140:143], v[76:79], v[120:123]
v_bitop3_b32 v145, v140, v142, s51 bitop3:0x7e
v_bitop3_b32 v172, v144, v145, 1 bitop3:0xa8
v_cmp_eq_u32 vcc, 1, v172
s_cbranch_vccz L_bpx_238
s_add_u32 s53, s53, 1
s_cmp_gt_u32 s53, 100000
s_cbranch_scc1 L_bpx_238
buffer_load_dwordx4 v[136:139], v6, s[4:7], s82 offen sc1
buffer_load_dwordx4 v[140:143], v6, s[4:7], s83 offen sc1
s_branch L_bp_237
L_bpx_238:
s_nop 0
s_nop 2
v_permlane32_swap_b32 v120, v121
v_permlane32_swap_b32 v122, v123
v_add_f32 v120, v120, v121
v_add_f32 v122, v122, v123
s_nop 0
s_nop 0
v_permlane16_swap_b32 v120, v122
v_add_f32 v120, v120, v122
s_nop 0
s_nop 0
v_mov_b32_dpp v121, v120 row_shl:2 row_mask:0xf bank_mask:0xf
v_cvt_pk_bf16_f32 v120, v120, v121
buffer_store_dword v120, v7, s[4:7], s52 offen sc1
s_waitcnt vmcnt(1)
L_b3_234:
s_waitcnt lgkmcnt(0)
s_barrier
s_sub_u32 s48, s44, 1
s_cmp_ge_u32 s48, 2
s_cbranch_scc1 L_rk_240
ds_read_b128 v[88:91], v166 offset:32768
ds_read_b128 v[92:95], v166 offset:34816
L_rk_240:
s_add_u32 s52, s54, 1
s_min_u32 s52, s52, 63
s_mov_b32 s80, s52
s_mul_i32 s48, s52, 393216
s_add_u32 s91, s48, s77
s_and_b32 s48, s52, 1
s_lshl_b32 s48, s48, 14
s_add_u32 s95, s48, s71
s_mul_i32 s48, s54, 98304
s_add_u32 s48, s48, s73
s_add_u32 s94, s48, 159285248
s_add_u32 s93, s48, 150896640
v_readlane_b32 s62, v161, 0
v_readlane_b32 s48, v161, 1
v_readlane_b32 s49, v161, 2
s_min_u32 s62, s62, s48
s_min_u32 s62, s62, s49
s_branch L_step_210
L_t1g_216:
s_mov_b32 s52, s80
s_cmp_gt_u32 s62, s52
s_cbranch_scc1 L_pf_241
s_mov_b32 s53, 0
v_min_u32 v172, 2, v1
v_lshl_add_u32 v172, v172, 7, s76
L_pfp_242:
buffer_load_dword v173, v172, s[4:7], 0 offen sc1
s_add_u32 s53, s53, 1
s_cmp_gt_u32 s53, 100000
s_cbranch_scc1 L_pf_241
s_waitcnt vmcnt(0)
v_readlane_b32 s62, v173, 0
v_readlane_b32 s48, v173, 1
v_readlane_b32 s49, v173, 2
s_min_u32 s62, s62, s48
s_min_u32 s62, s62, s49
s_cmp_gt_u32 s62, s52
s_cbranch_scc1 L_pf_241
s_sleep 2
s_branch L_pfp_242
L_pf_241:
s_waitcnt vmcnt(0)
s_branch L_t1g2_217
L_k3_218:
s_cmp_eq_u32 s85, 2
s_cbranch_scc1 L_k4_243
buffer_store_dwordx4 v[88:91], v0, s[4:7], s93 offen sc1
buffer_store_dwordx4 v[92:95], v0, s[4:7], s93 offen offset:512 sc1
buffer_store_dwordx4 v[148:151], v2, s[4:7], s94 offen sc1
s_waitcnt vmcnt(10)
ds_write_b128 v170, v[8:11] offset:0
v_max3_u32 v172, v8, v9, v10
v_max_u32 v172, v172, v11
s_waitcnt vmcnt(9)
ds_write_b128 v170, v[12:15] offset:4096
v_max3_u32 v172, v172, v12, v13
v_max3_u32 v172, v172, v14, v15
s_waitcnt vmcnt(8)
ds_write_b128 v170, v[128:131] offset:8192
v_max3_u32 v172, v172, v128, v129
v_max3_u32 v172, v172, v130, v131
v_cmp_eq_u32 vcc, -1, v172
s_cbranch_vccz L_cpk_215
s_branch L_cp_213
L_k4_243:
s_waitcnt vmcnt(7)
ds_write_b128 v170, v[8:11] offset:0
v_max3_u32 v172, v8, v9, v10
v_max_u32 v172, v172, v11
s_waitcnt vmcnt(6)
ds_write_b128 v170, v[12:15] offset:4096
v_max3_u32 v172, v172, v12, v13
v_max3_u32 v172, v172, v14, v15
s_waitcnt vmcnt(5)
ds_write_b128 v170, v[128:131] offset:8192
v_max3_u32 v172, v172, v128, v129
v_max3_u32 v172, v172, v130, v131
v_cmp_eq_u32 vcc, -1, v172
v_mov_b32 v175, s54
buffer_store_dword v175, v167, s[4:7], 0 offen sc1
s_cbranch_vccz L_cpk_215
s_branch L_cp_213
L_cp_213:
buffer_load_dwordx4 v[8:11], v2, s[4:7], s78 offen sc1
buffer_load_dwordx4 v[12:15], v2, s[4:7], s79 offen sc1
buffer_load_dwordx4 v[128:131], v2, s[4:7], s90 offen sc1
s_add_u32 s53, s53, 1
s_cmp_gt_u32 s53, 100000
s_cbranch_scc1 L_chdone_212
s_waitcnt vmcnt(2)
ds_write_b128 v170, v[8:11] offset:0
v_max3_u32 v172, v8, v9, v10
v_max_u32 v172, v172, v11
s_waitcnt vmcnt(1)
ds_write_b128 v170, v[12:15] offset:4096
v_max3_u32 v172, v172, v12, v13
v_max3_u32 v172, v172, v14, v15
s_waitcnt vmcnt(0)
ds_write_b128 v170, v[128:131] offset:8192
v_max3_u32 v172, v172, v128, v129
v_max3_u32 v172, v172, v130, v131
v_cmp_eq_u32 vcc, -1, v172
s_cbranch_vccnz L_cp_213
s_branch L_cpk_215
L_first_222:
s_mov_b32 s52, 1
s_cmp_gt_u32 s62, s52
s_cbranch_scc1 L_pf_244
s_mov_b32 s53, 0
v_min_u32 v172, 2, v1
v_lshl_add_u32 v172, v172, 7, s76
L_pfp_245:
buffer_load_dword v173, v172, s[4:7], 0 offen sc1
s_add_u32 s53, s53, 1
s_cmp_gt_u32 s53, 100000
s_cbranch_scc1 L_pf_244
s_waitcnt vmcnt(0)
v_readlane_b32 s62, v173, 0
v_readlane_b32 s48, v173, 1
v_readlane_b32 s49, v173, 2
s_min_u32 s62, s62, s48
s_min_u32 s62, s62, s49
s_cmp_gt_u32 s62, s52
s_cbranch_scc1 L_pf_244
s_sleep 2
s_branch L_pfp_245
L_pf_244:
s_mov_b32 s52, 0
s_mul_i32 s48, s52, 393216
s_add_u32 s91, s48, s77
s_and_b32 s48, s52, 1
s_lshl_b32 s48, s48, 14
s_add_u32 s95, s48, s71
s_mul_i32 s48, s54, 98304
s_add_u32 s48, s48, s73
s_add_u32 s94, s48, 159285248
s_add_u32 s93, s48, 150896640
s_mov_b32 m0, s95
s_nop 0
buffer_load_dwordx4 v2, s[4:7], s91 offen offset:0 sc1 lds
buffer_load_dwordx4 v2, s[4:7], s91 offen offset:1024 sc1 lds
buffer_load_dwordx4 v2, s[4:7], s91 offen offset:2048 sc1 lds
buffer_load_dwordx4 v2, s[4:7], s91 offen offset:3072 sc1 lds
s_mov_b32 s52, 1
s_mul_i32 s48, s52, 393216
s_add_u32 s91, s48, s77
s_and_b32 s48, s52, 1
s_lshl_b32 s48, s48, 14
s_add_u32 s95, s48, s71
s_mul_i32 s48, s54, 98304
s_add_u32 s48, s48, s73
s_add_u32 s94, s48, 159285248
s_add_u32 s93, s48, 150896640
s_mov_b32 m0, s95
s_nop 0
buffer_load_dwordx4 v2, s[4:7], s91 offen offset:0 sc1 lds
buffer_load_dwordx4 v2, s[4:7], s91 offen offset:1024 sc1 lds
buffer_load_dwordx4 v2, s[4:7], s91 offen offset:2048 sc1 lds
buffer_load_dwordx4 v2, s[4:7], s91 offen offset:3072 sc1 lds
s_waitcnt vmcnt(4) lgkmcnt(0)
s_barrier
s_sub_u32 s48, s44, 1
s_cmp_ge_u32 s48, 2
s_cbranch_scc1 L_rk_246
ds_read_b128 v[88:91], v166 offset:32768
ds_read_b128 v[92:95], v166 offset:34816
L_rk_246:
s_waitcnt lgkmcnt(0)
ds_read_b64_tr_b16 v[112:113], v171 offset:0
ds_read_b64_tr_b16 v[114:115], v171 offset:64
ds_read_b64_tr_b16 v[116:117], v171 offset:2048
ds_read_b64_tr_b16 v[118:119], v171 offset:2112
ds_read_b64_tr_b16 v[120:121], v171 offset:4096
ds_read_b64_tr_b16 v[122:123], v171 offset:4160
s_waitcnt lgkmcnt(4)
v_mfma_f32_16x16x32_bf16 v[60:63], v[112:115], a[240:243], 0
ds_read_b64_tr_b16 v[124:125], v171 offset:6144
ds_read_b64_tr_b16 v[126:127], v171 offset:6208
v_mfma_f32_16x16x32_bf16 v[64:67], v[112:115], a[248:251], 0
v_mfma_f32_16x16x32_bf16 v[68:71], v[112:115], v[176:179], 0
v_mfma_f32_16x16x32_bf16 v[72:75], v[112:115], v[184:187], 0
s_waitcnt lgkmcnt(4)
v_mfma_f32_16x16x32_bf16 v[60:63], v[116:119], a[244:247], v[60:63]
ds_read_b64_tr_b16 v[112:113], v171 offset:8192
ds_read_b64_tr_b16 v[114:115], v171 offset:8256
v_mfma_f32_16x16x32_bf16 v[64:67], v[116:119], a[252:255], v[64:67]
v_mfma_f32_16x16x32_bf16 v[68:71], v[116:119], v[180:183], v[68:71]
v_mfma_f32_16x16x32_bf16 v[72:75], v[116:119], v[188:191], v[72:75]
s_waitcnt lgkmcnt(4)
v_mfma_f32_16x16x32_bf16 v[60:63], v[120:123], v[192:195], v[60:63]
ds_read_b64_tr_b16 v[116:117], v171 offset:10240
ds_read_b64_tr_b16 v[118:119], v171 offset:10304
v_mfma_f32_16x16x32_bf16 v[64:67], v[120:123], v[200:203], v[64:67]
v_mfma_f32_16x16x32_bf16 v[68:71], v[120:123], v[208:211], v[68:71]
v_mfma_f32_16x16x32_bf16 v[72:75], v[120:123], v[216:219], v[72:75]
s_waitcnt lgkmcnt(4)
v_mfma_f32_16x16x32_bf16 v[60:63], v[124:127], v[196:199], v[60:63]
v_mfma_f32_16x16x32_bf16 v[64:67], v[124:127], v[204:207], v[64:67]
v_mfma_f32_16x16x32_bf16 v[68:71], v[124:127], v[212:215], v[68:71]
v_mfma_f32_16x16x32_bf16 v[72:75], v[124:127], v[220:223], v[72:75]
s_waitcnt lgkmcnt(2)
v_mfma_f32_16x16x32_bf16 v[60:63], v[112:115], v[224:227], v[60:63]
v_mfma_f32_16x16x32_bf16 v[64:67], v[112:115], v[232:235], v[64:67]
v_mfma_f32_16x16x32_bf16 v[68:71], v[112:115], v[240:243], v[68:71]
v_mfma_f32_16x16x32_bf16 v[72:75], v[112:115], v[248:251], v[72:75]
s_waitcnt lgkmcnt(0)
v_mfma_f32_16x16x32_bf16 v[60:63], v[116:119], v[228:231], v[60:63]
v_mfma_f32_16x16x32_bf16 v[64:67], v[116:119], v[236:239], v[64:67]
v_mfma_f32_16x16x32_bf16 v[68:71], v[116:119], v[244:247], v[68:71]
v_mfma_f32_16x16x32_bf16 v[72:75], v[116:119], v[252:255], v[72:75]
s_nop 4
v_cvt_pk_bf16_f32 v96, v60, v61
v_cvt_pk_bf16_f32 v97, v62, v63
v_cvt_pk_bf16_f32 v100, v64, v65
v_cvt_pk_bf16_f32 v101, v66, v67
v_cvt_pk_bf16_f32 v104, v68, v69
v_cvt_pk_bf16_f32 v105, v70, v71
v_cvt_pk_bf16_f32 v108, v72, v73
v_cvt_pk_bf16_f32 v109, v74, v75
ds_read_b64_tr_b16 v[112:113], v171 offset:8
ds_read_b64_tr_b16 v[114:115], v171 offset:72
ds_read_b64_tr_b16 v[116:117], v171 offset:2056
ds_read_b64_tr_b16 v[118:119], v171 offset:2120
ds_read_b64_tr_b16 v[120:121], v171 offset:4104
ds_read_b64_tr_b16 v[122:123], v171 offset:4168
s_waitcnt lgkmcnt(4)
v_mfma_f32_16x16x32_bf16 v[60:63], v[112:115], a[240:243], 0
ds_read_b64_tr_b16 v[124:125], v171 offset:6152
ds_read_b64_tr_b16 v[126:127], v171 offset:6216
v_mfma_f32_16x16x32_bf16 v[64:67], v[112:115], a[248:251], 0
v_mfma_f32_16x16x32_bf16 v[68:71], v[112:115], v[176:179], 0
v_mfma_f32_16x16x32_bf16 v[72:75], v[112:115], v[184:187], 0
s_waitcnt lgkmcnt(4)
v_mfma_f32_16x16x32_bf16 v[60:63], v[116:119], a[244:247], v[60:63]
ds_read_b64_tr_b16 v[112:113], v171 offset:8200
ds_read_b64_tr_b16 v[114:115], v171 offset:8264
v_mfma_f32_16x16x32_bf16 v[64:67], v[116:119], a[252:255], v[64:67]
v_mfma_f32_16x16x32_bf16 v[68:71], v[116:119], v[180:183], v[68:71]
v_mfma_f32_16x16x32_bf16 v[72:75], v[116:119], v[188:191], v[72:75]
s_waitcnt lgkmcnt(4)
v_mfma_f32_16x16x32_bf16 v[60:63], v[120:123], v[192:195], v[60:63]
ds_read_b64_tr_b16 v[116:117], v171 offset:10248
ds_read_b64_tr_b16 v[118:119], v171 offset:10312
v_mfma_f32_16x16x32_bf16 v[64:67], v[120:123], v[200:203], v[64:67]
v_mfma_f32_16x16x32_bf16 v[68:71], v[120:123], v[208:211], v[68:71]
v_mfma_f32_16x16x32_bf16 v[72:75], v[120:123], v[216:219], v[72:75]
s_waitcnt lgkmcnt(4)
v_mfma_f32_16x16x32_bf16 v[60:63], v[124:127], v[196:199], v[60:63]
v_mfma_f32_16x16x32_bf16 v[64:67], v[124:127], v[204:207], v[64:67]
v_mfma_f32_16x16x32_bf16 v[68:71], v[124:127], v[212:215], v[68:71]
v_mfma_f32_16x16x32_bf16 v[72:75], v[124:127], v[220:223], v[72:75]
s_waitcnt lgkmcnt(2)
v_mfma_f32_16x16x32_bf16 v[60:63], v[112:115], v[224:227], v[60:63]
v_mfma_f32_16x16x32_bf16 v[64:67], v[112:115], v[232:235], v[64:67]
v_mfma_f32_16x16x32_bf16 v[68:71], v[112:115], v[240:243], v[68:71]
v_mfma_f32_16x16x32_bf16 v[72:75], v[112:115], v[248:251], v[72:75]
s_waitcnt lgkmcnt(0)
v_mfma_f32_16x16x32_bf16 v[60:63], v[116:119], v[228:231], v[60:63]
v_mfma_f32_16x16x32_bf16 v[64:67], v[116:119], v[236:239], v[64:67]
v_mfma_f32_16x16x32_bf16 v[68:71], v[116:119], v[244:247], v[68:71]
v_mfma_f32_16x16x32_bf16 v[72:75], v[116:119], v[252:255], v[72:75]
s_nop 4
v_cvt_pk_bf16_f32 v98, v60, v61
v_cvt_pk_bf16_f32 v99, v62, v63
v_cvt_pk_bf16_f32 v102, v64, v65
v_cvt_pk_bf16_f32 v103, v66, v67
v_cvt_pk_bf16_f32 v106, v68, v69
v_cvt_pk_bf16_f32 v107, v70, v71
v_cvt_pk_bf16_f32 v110, v72, v73
v_cvt_pk_bf16_f32 v111, v74, v75
v_mov_b32 v60, 0
v_mov_b32 v61, 0
v_mov_b32 v62, 0
v_mov_b32 v63, 0
v_mov_b32 v64, 0
v_mov_b32 v65, 0
v_mov_b32 v66, 0
v_mov_b32 v67, 0
v_mov_b32 v68, 0
v_mov_b32 v69, 0
v_mov_b32 v70, 0
v_mov_b32 v71, 0
v_mov_b32 v72, 0
v_mov_b32 v73, 0
v_mov_b32 v74, 0
v_mov_b32 v75, 0
s_branch L_first2_223
L_x12_226:
s_cmp_eq_u32 s60, 0
s_cbranch_scc1 L_as_224
v_smfmac_f32_16x16x64_bf16 v[56:59], v[28:31], a[200:207], v165
v_smfmac_f32_16x16x64_bf16 v[56:59], v[32:35], a[208:215], v165
v_smfmac_f32_16x16x64_bf16 v[56:59], v[36:39], a[216:223], v165
s_waitcnt lgkmcnt(0)
v_mfma_f32_16x16x32_bf16 v[120:123], v[88:91], v[112:115], 0
v_mfma_f32_16x16x32_bf16 v[120:123], v[92:95], v[116:119], v[120:123]
v_smfmac_f32_16x16x64_bf16 v[56:59], v[40:43], a[224:231], v165
v_smfmac_f32_16x16x64_bf16 v[56:59], v[44:47], a[232:239], v165
s_not_b32 s51, s54
v_mov_b32 v48, 0
v_mov_b32 v49, 0
v_mov_b32 v50, 0
v_mov_b32 v51, 0
v_mov_b32 v52, 0
v_bfi_b32 v120, 3, s55, v120
v_bfi_b32 v122, 3, s55, v122
buffer_store_dwordx4 v[120:123], v3, s[4:7], 0 offen
ds_write_b128 v158, v[120:123]
v_pk_add_f32 v[56:57], v[56:57], v[58:59]
v_cvt_pk_bf16_f32 v174, v56, v57
ds_write_b32 v164, v174
s_branch L_as2_225
L_as_224:
s_sub_u32 s48, s44, 1
s_cmp_lt_u32 s48, 2
s_cbranch_scc1 L_ak_247
ds_read_b64_tr_b16 v[88:89], v160 offset:2048
ds_read_b64_tr_b16 v[90:91], v160 offset:2176
ds_read_b64_tr_b16 v[92:93], v160 offset:3072
ds_read_b64_tr_b16 v[94:95], v160 offset:3200
L_ak_247:
v_smfmac_f32_16x16x64_bf16 v[56:59], v[28:31], a[200:207], v165
v_smfmac_f32_16x16x64_bf16 v[56:59], v[32:35], a[208:215], v165
v_smfmac_f32_16x16x64_bf16 v[56:59], v[36:39], a[216:223], v165
s_waitcnt lgkmcnt(0)
v_mfma_f32_16x16x32_bf16 v[120:123], v[88:91], v[112:115], 0
v_mfma_f32_16x16x32_bf16 v[120:123], v[92:95], v[116:119], v[120:123]
v_smfmac_f32_16x16x64_bf16 v[56:59], v[40:43], a[224:231], v165
v_smfmac_f32_16x16x64_bf16 v[56:59], v[44:47], a[232:239], v165
s_not_b32 s51, s54
v_mov_b32 v48, 0
v_mov_b32 v49, 0
v_mov_b32 v50, 0
v_mov_b32 v51, 0
v_mov_b32 v52, 0
v_cndmask_b32 v172, v120, v121, s[64:65]
v_bfi_b32 v172, 3, s55, v172
buffer_store_dword v172, v4, s[4:7], 0 offen sc1
ds_write_b32 v159, v172
v_bfi_b32 v120, 3, s55, v120
v_bfi_b32 v122, 3, s55, v122
buffer_store_dwordx4 v[120:123], v3, s[4:7], 0 offen sc1
ds_write_b128 v158, v[120:123]
v_pk_add_f32 v[56:57], v[56:57], v[58:59]
v_cvt_pk_bf16_f32 v174, v56, v57
ds_write_b32 v164, v174
s_branch L_as2_225
L_w3_227:
s_waitcnt lgkmcnt(2)
v_bfi_b32 v120, 1, s51, v144
v_mov_b32 v121, v145
v_bfi_b32 v122, 1, s51, v146
v_mov_b32 v123, v147
s_cmp_eq_u32 s60, 0
s_cbranch_scc1 L_w3s_248
buffer_store_dwordx4 v[120:123], v2, s[4:7], s84 offen
s_branch L_w3b_228
L_w3s_248:
buffer_store_dwordx4 v[120:123], v2, s[4:7], s84 offen sc1
s_branch L_w3b_228
L_apr_233:
s_waitcnt vmcnt(0)
s_add_u32 s53, s53, 1
s_cmp_gt_u32 s53, 100000
s_cbranch_scc1 L_apx_230
buffer_load_dwordx4 v[128:131], v2, s[4:7], s69 offen sc1
buffer_load_dwordx4 v[132:135], v2, s[4:7], s70 offen sc1
buffer_load_dword v140, v163, s[4:7], s69 offen offset:1024 sc1
buffer_load_dword v141, v163, s[4:7], s70 offen offset:1024 sc1
buffer_load_dwordx4 v[148:151], v2, s[4:7], s69 offen offset:2048 sc1
buffer_load_dwordx4 v[152:155], v2, s[4:7], s70 offen offset:2048 sc1
s_branch L_ap_229
L_vpr_231:
buffer_load_dwordx4 v[148:151], v2, s[4:7], s69 offen offset:2048 sc1
buffer_load_dwordx4 v[152:155], v2, s[4:7], s70 offen offset:2048 sc1
s_waitcnt vmcnt(0)
v_bitop3_b32 v172, v148, v150, s54 bitop3:0x42
v_bitop3_b32 v173, v152, v154, s54 bitop3:0x42
v_bitop3_b32 v172, v172, v173, 1 bitop3:0x80
v_cmp_eq_u32 vcc, 0, v172
s_add_u32 s53, s53, 1
s_cmp_gt_u32 s53, 100000
s_cbranch_scc1 L_vpx_232
s_cbranch_vccnz L_vpr_231
s_branch L_vpx_232
L_ke_235:
s_mov_b32 s85, 2
s_mul_i32 s48, s54, 98304
s_add_u32 s48, s48, s73
s_add_u32 s94, s48, 159285248
s_add_u32 s93, s48, 150896640
s_waitcnt lgkmcnt(0)
buffer_store_dwordx4 v[88:91], v0, s[4:7], s93 offen sc1
buffer_store_dwordx4 v[92:95], v0, s[4:7], s93 offen offset:512 sc1
buffer_store_dwordx4 v[148:151], v2, s[4:7], s94 offen sc1
s_branch L_ke2_236
L_final_211:
s_waitcnt lgkmcnt(0)
s_barrier
s_cmp_lg_u32 s44, 3
s_cbranch_scc1 L_chdone_212
s_lshl_b32 s48, s44, 8
v_subrev_u32 v172, s48, v164
ds_read_b32 v148, v172 offset:0
ds_read_b32 v149, v172 offset:256
ds_read_b32 v150, v172 offset:512
ds_read_b32 v151, v172 offset:768
v_xor_b32 v171, 0x4000, v171
v_xor_b32 v166, 0x4000, v166
s_add_u32 s54, s54, 1
s_mul_i32 s48, s52, 393216
s_add_u32 s91, s48, s77
s_and_b32 s48, s52, 1
s_lshl_b32 s48, s48, 14
s_add_u32 s95, s48, s71
s_mul_i32 s48, s54, 98304
s_add_u32 s48, s48, s73
s_add_u32 s94, s48, 159285248
s_add_u32 s93, s48, 150896640
s_waitcnt lgkmcnt(0)
buffer_store_dwordx4 v[88:91], v0, s[4:7], s93 offen sc1
buffer_store_dwordx4 v[92:95], v0, s[4:7], s93 offen offset:512 sc1
buffer_store_dwordx4 v[148:151], v2, s[4:7], s94 offen sc1
s_waitcnt vmcnt(0)
v_mov_b32 v173, 64
buffer_store_dword v173, v167, s[4:7], 0 offen sc1
L_chdone_212:
L_exit:
s_endpgm
.section .rodata,"a"
.p2align 6
.amdhsa_kernel gated_mix__memory_aug_recurrent_mem_tr__mha_block__prompt_kernel
  .amdhsa_next_free_vgpr 512
  .amdhsa_next_free_sgpr 102
  .amdhsa_accum_offset 256
  .amdhsa_group_segment_fixed_size 0
  .amdhsa_kernarg_size 112
  .amdhsa_user_sgpr_count 2
  .amdhsa_user_sgpr_kernarg_segment_ptr 1
  .amdhsa_system_sgpr_workgroup_id_x 1
.end_amdhsa_kernel
```
